```python
import torch

def _softmax(x, axis=-1):
    return torch.softmax(x, dim=axis)

def _gelu(x):
    return torch.nn.functional.gelu(x, approximate='tanh')

def _silu(x):
    return torch.nn.functional.silu(x)

def _sigmoid(x):
    return torch.sigmoid(x)

def _layernorm(x, axis=-1, eps=1e-05):
    m = x.mean(dim=axis, keepdim=True)
    v = x.var(dim=axis, keepdim=True, unbiased=False)
    return (x - m) / torch.sqrt(v + eps)

def _scatter_add(tgt, idx, src, axis=0):
    return tgt.clone().index_add_(axis, idx, src)

def _segment_sum(src, seg, n):
    out = torch.zeros((n,) + src.shape[1:], dtype=src.dtype)
    return out.index_add_(0, seg, src)

def _pad(x, pw):
    flat = tuple((v for pair in reversed(pw) for v in pair))
    return torch.nn.functional.pad(x, flat)
kernel_name = 'adaLN_cond__ssm_conv_h3__glu_gated_bilinear__prompt'

def setup_inputs():

    _w = lambda a: (lambda t: t.to(torch.bfloat16) if t.is_floating_point() else t)(torch.as_tensor(a))

    def _A_setup():
        B, S, D = (1, 2048, 640)
        ks = 4
        return {'q': _w((lambda *s: torch.randn(*s, dtype=torch.bfloat16) * 0.05)(B, S, D)), 'k': _w((lambda *s: torch.randn(*s, dtype=torch.bfloat16) * 1.6)(B, S, D)), 'v': _w((lambda *s: torch.randn(*s, dtype=torch.bfloat16) * 1.6)(B, S, D)), 'shift_k': _w((lambda *s: torch.randn(*s, dtype=torch.bfloat16) * 1.6)(D, ks) * 0.5), 'ssm_k': _w((lambda *s: torch.randn(*s, dtype=torch.bfloat16) * 1.6)(D, S) * (1.0 / S ** 0.5)), 'ssm_D': _w((lambda *s: torch.randn(*s, dtype=torch.bfloat16) * 1.6)(D))}
    _A_in = _A_setup()

    def _B_setup():
        B, S, D, F = (1, 2048, 640, 1536)
        return {'x': _w((lambda *s: torch.randn(*s, dtype=torch.bfloat16) * 0.05)(B, S, D)), 'w_gate': _w((lambda *s: torch.randn(*s, dtype=torch.bfloat16) * 3.2)(D, F) * D ** (-0.5)), 'w_up': _w((lambda *s: torch.randn(*s, dtype=torch.bfloat16) * 3.2)(D, F) * D ** (-0.5)), 'w_down': _w((lambda *s: torch.randn(*s, dtype=torch.bfloat16) * 3.2)(F, D) * F ** (-0.5))}
    _B_in = _B_setup()
    return {'A_q': _A_in['q'], 'A_k': _A_in['k'], 'A_v': _A_in['v'], 'A_shift_k': _A_in['shift_k'], 'A_ssm_k': _A_in['ssm_k'], 'A_ssm_D': _A_in['ssm_D'], 'B_x': _B_in['x'], 'B_w_gate': _B_in['w_gate'], 'B_w_up': _B_in['w_up'], 'B_w_down': _B_in['w_down'], 'c': _w((lambda *s: torch.randn(*s, dtype=torch.bfloat16) * 0.2)(1, 640) * 8.0), 'w_mod': _w((lambda *s: torch.randn(*s, dtype=torch.bfloat16) * 0.2)(640, 6 * 640) * 640 ** (-0.5) * 8.0)}

def reference(A_q, A_k, A_v, A_shift_k, A_ssm_k, A_ssm_D, B_x, B_w_gate, B_w_up, B_w_down, c, w_mod):

    def _A_ref(q, k, v, shift_k, ssm_k, ssm_D):
        B, S, D = q.shape
        ks = shift_k.shape[-1]
        k_pad = _pad(k, ((0, 0), (ks - 1, 0), (0, 0)))
        k_shift = torch.zeros_like(k)
        for t in range(ks):
            k_shift = k_shift + k_pad[:, t:t + S, :] * shift_k[:, ks - 1 - t][None, None, :]
        kv = k_shift * v
        L = 2 * S
        kv_pad = _pad(kv, ((0, 0), (0, S), (0, 0)))
        kf_pad = _pad(ssm_k, ((0, 0), (0, S)))
        kv_f = (lambda x, axes=(-2, -1): torch.fft.rfft2(x.float(), dim=axes))(kv_pad[:, None, :, :], axes=(1, 2))
        kf_f = (lambda x, axes=(-2, -1): torch.fft.rfft2(x.float(), dim=axes))(kf_pad[:, None, :], axes=(1, 2))
        kf_f = (lambda x, *d: x.permute(*d))(kf_f, 1, 2, 0)
        y_f = kv_f * kf_f[None, :, :, :]
        y = (lambda x, s, axes=(-2, -1): torch.fft.irfft2(x, s=s, dim=axes).to(torch.bfloat16))(y_f, (1, L), axes=(1, 2))[:, 0, :S, :]
        y = y + kv * ssm_D[None, None, :]
        return q * y

    def _B_ref(x, w_gate, w_up, w_down):
        g = torch.einsum('bsd,df->bsf', x, w_gate)
        u = torch.einsum('bsd,df->bsf', x, w_up)
        h = g * u
        return torch.einsum('bsf,fd->bsd', h, w_down)
    x = A_q
    mod = (_silu(c) @ w_mod).reshape(c.shape[0], 6, 1, -1)
    sa, ca, ga, sb, cb, gb = (mod[:, 0].clone(), mod[:, 1].clone(), mod[:, 2].clone(), mod[:, 3].clone(), mod[:, 4].clone(), mod[:, 5].clone())
    h = _layernorm(x, axis=-1) * (1 + ca) + sa
    x = x + ga * _A_ref(h, A_k, A_v, A_shift_k, A_ssm_k, A_ssm_D)
    h = _layernorm(x, axis=-1) * (1 + cb) + sb
    x = x + gb * _B_ref(h, B_w_gate, B_w_up, B_w_down)
    return x
```

```asm
; @launch grid=(256,1,1) block=(256,1,1) lds=163840
.amdgcn_target "amdgcn-amd-amdhsa--gfx950"
.text
.globl adaLN_cond__ssm_conv_h3__glu_gated_bilinear__prompt_kernel
.p2align 8
.type adaLN_cond__ssm_conv_h3__glu_gated_bilinear__prompt_kernel,@function
adaLN_cond__ssm_conv_h3__glu_gated_bilinear__prompt_kernel:
    s_cmp_ge_u32 s2, 256
    s_cbranch_scc1 L_end
    s_load_dwordx16 s[4:19], s[0:1], 0
    s_load_dwordx8 s[20:27], s[0:1], 64
    s_load_dwordx4 s[28:31], s[0:1], 96
    s_load_dwordx2 s[32:33], s[0:1], 112
    v_lshrrev_b32 v1, 6, v0
    s_nop 0
    v_readfirstlane_b32 s3, v1
    v_and_b32 v1, 63, v0
    s_sub_u32 s50, s2, 224
    s_cbranch_scc1 L_nopf
    s_getpc_b64 s[36:37]
L_nopf_pc:
    s_sub_u32 s36, s36, L_nopf_pc-adaLN_cond__ssm_conv_h3__glu_gated_bilinear__prompt_kernel
    s_subb_u32 s37, s37, 0
    s_mov_b32 s38, L_code_end-adaLN_cond__ssm_conv_h3__glu_gated_bilinear__prompt_kernel
    s_mov_b32 s39, 0x20000
    v_lshlrev_b32 v2, 6, v0
    s_lshr_b32 s50, s50, 3
    s_lshl_b32 s50, s50, 14
    buffer_load_dword v243, v2, s[36:39], s50 offen
L_nopf:
    s_mov_b32 s49, 400000
    s_mov_b32 s57, 23461888
    s_and_b32 s50, s2, 7
    s_lshr_b32 s51, s2, 3
    s_lshr_b32 s52, s50, 2
    s_lshl_b32 s52, s52, 3
    s_lshr_b32 s53, s51, 2
    s_add_u32 s72, s52, s53
    s_and_b32 s52, s50, 3
    s_lshl_b32 s52, s52, 2
    s_and_b32 s53, s51, 3
    s_add_u32 s73, s52, s53
    s_and_b32 s75, s51, 7
    s_lshr_b32 s53, s51, 3
    s_lshl_b32 s52, s50, 2
    s_add_u32 s74, s52, s53
    s_lshl_b32 s52, s50, 5
    s_add_u32 s52, s52, s51
    s_lshl_b32 s53, s50, 4
    s_add_u32 s53, s53, s51
    s_add_u32 s53, s53, 32
    s_cmp_lt_u32 s50, 2
    s_cselect_b32 s70, s52, s53
    s_cselect_b32 s35, 0, s51
    s_lshr_b32 s53, s51, 2
    s_mul_i32 s54, s53, 5
    s_lshr_b32 s54, s54, 1
    s_mov_b32 s52, 0
    s_mul_i32 s55, s53, 1
    s_add_u32 s55, s55, 16
    s_cmp_lt_u32 s53, 4
    s_cselect_b32 s52, s55, s52
    s_cmp_lt_u32 s50, 2
    s_cselect_b32 s34, s54, s52
    s_mul_i32 s71, s51, 6
    s_add_u32 s71, s71, s50
    s_sub_u32 s71, s71, 98
    v_lshlrev_b32 v248, 4, v1
    s_lshr_b32 s50, s70, 4
    s_and_b32 s51, s70, 15
    s_mul_i32 s52, s51, 163840
    s_lshl_b32 s53, s50, 7
    s_add_u32 s52, s52, s53
    s_mul_i32 s53, s3, 40960
    s_add_u32 s53, s53, s52
    s_mul_i32 s54, s3, 4352
    s_mov_b32 s42, 2621440
    s_mov_b32 s43, 0x20000
    s_mov_b32 s46, 2621440
    s_mov_b32 s47, 0x20000
    v_lshrrev_b32 v2, 3, v1
    v_and_b32 v4, 3, v2
    v_xor_b32 v4, v4, v1
    v_and_b32 v4, 7, v4
    v_mul_u32_u24 v2, 1280, v2
    v_lshl_add_u32 v3, v4, 4, v2
    s_waitcnt lgkmcnt(0)
    s_load_dword s48, s[32:33], s57
    s_cmp_ge_u32 s35, 16
    s_cbranch_scc1 L_prep
    s_mov_b32 s40, s6
    s_mov_b32 s41, s7
    s_mov_b32 s44, s8
    s_mov_b32 s45, s9
    s_cmp_eq_u32 s3, 0
    s_cbranch_scc0 L_nohalo
    s_sub_u32 s55, s52, 10240
    v_add_u32 v5, s55, v3
    s_mov_b32 m0, 84992
    s_nop 0
    buffer_load_dwordx4 v5, s[40:43], 0 offen nt lds
L_nohalo:
    s_mov_b32 s55, s53
    s_add_u32 m0, s54, 86080
    s_nop 0
    buffer_load_dwordx4 v3, s[40:43], s55 offen nt lds
    s_add_u32 s55, s55, 10240
    s_add_u32 m0, s54, 87168
    s_nop 0
    buffer_load_dwordx4 v3, s[40:43], s55 offen nt lds
    s_add_u32 s55, s55, 10240
    s_add_u32 m0, s54, 88256
    s_nop 0
    buffer_load_dwordx4 v3, s[40:43], s55 offen nt lds
    s_add_u32 s55, s55, 10240
    s_add_u32 m0, s54, 89344
    s_nop 0
    buffer_load_dwordx4 v3, s[40:43], s55 offen nt lds
    s_mov_b32 s55, s53
    s_add_u32 m0, s54, 103488
    s_nop 0
    buffer_load_dwordx4 v3, s[44:47], s55 offen nt lds
    s_add_u32 s55, s55, 10240
    s_add_u32 m0, s54, 104576
    s_nop 0
    buffer_load_dwordx4 v3, s[44:47], s55 offen nt lds
    s_add_u32 s55, s55, 10240
    s_add_u32 m0, s54, 105664
    s_nop 0
    buffer_load_dwordx4 v3, s[44:47], s55 offen nt lds
    s_add_u32 s55, s55, 10240
    s_add_u32 m0, s54, 106752
    s_nop 0
    buffer_load_dwordx4 v3, s[44:47], s55 offen nt lds
    s_mov_b32 s36, s32
    s_mov_b32 s37, s33
    s_mov_b32 s38, 0x10000000
    s_mov_b32 s39, 0x20000
    s_lshr_b32 s50, s70, 4
    s_lshl_b32 s50, s50, 6
    s_lshl_b32 s55, s3, 4
    s_add_u32 s50, s50, s55
    v_and_b32 v4, 7, v1
    v_add_u32 v4, s50, v4
    v_lshlrev_b32 v5, 3, v4
    global_load_dwordx2 v[48:49], v5, s[10:11]
    global_load_dwordx2 v[50:51], v5, s[10:11] offset:64
    s_and_b32 s51, s70, 15
    s_lshl_b32 s51, s51, 8
    v_mul_u32_u24 v4, 4096, v4
    v_lshrrev_b32 v5, 3, v1
    v_lshl_add_u32 v5, v5, 4, s51
    v_add_u32 v245, v4, v5
    v_sub_u32 v5, 3952, v5
    v_add_u32 v247, v4, v5
    v_bfe_u32 v4, v1, 2, 2
    s_lshl_b32 s55, s3, 1
    v_xor_b32 v5, s55, v4
    v_lshlrev_b32 v4, 7, v4
    v_lshl_add_u32 v4, v5, 4, v4
    v_and_b32 v5, 1, v1
    v_lshl_add_u32 v4, v5, 3, v4
    v_lshrrev_b32 v5, 4, v1
    v_bfe_u32 v244, v1, 1, 1
    v_lshl_add_u32 v5, v5, 1, v244
    v_mul_u32_u24 v5, 1088, v5
    v_add_u32 v244, v4, v5
    v_add_u32 v244, 84992, v244
    v_xor_b32 v246, 16, v244
    s_mov_b32 s16, 32768
    s_lshl_b32 s58, s70, 2
    s_add_u32 s58, s58, s3
    s_lshl_b32 s59, s58, 1
    v_mov_b32 v250, 0
    v_mov_b32 v251, s59
    global_load_short_d16_hi v250, v251, s[14:15]
    s_waitcnt lgkmcnt(0)
    s_mul_i32 s48, s48, 0x9E3779B1
    s_add_u32 s48, s48, 0x7F4A7C15
    s_and_b32 s48, s48, -16
    s_getreg_b32 s30, hwreg(HW_REG_XCC_ID, 0, 4)
    s_or_b32 s30, s30, s48
    s_cmp_eq_u32 s3, 1
    s_cbranch_scc0 L_id1
    s_lshl_b32 s50, s2, 7
    s_add_u32 s50, s50, 23199744
    v_mov_b32 v254, 0
    v_mov_b32 v255, s30
    s_mov_b64 exec, 1
    buffer_store_dword v255, v254, s[36:39], s50 offen sc1
    s_mov_b64 exec, -1
L_id1:
    s_lshl_b32 s58, s70, 2
    s_add_u32 s58, s58, s3
    s_lshl_b32 s50, s58, 12
    s_mul_i32 s51, s3, 16640
    s_add_u32 m0, s51, 32
    s_mov_b32 s40, s12
    s_mov_b32 s41, s13
    s_mov_b32 s42, 0x280000
    s_mov_b32 s43, 0x20000
    buffer_load_dwordx4 v248, s[40:43], s50 offen offset:0 nt lds
    buffer_load_dwordx4 v248, s[40:43], s50 offen offset:1024 nt lds
    buffer_load_dwordx4 v248, s[40:43], s50 offen offset:2048 nt lds
    buffer_load_dwordx4 v248, s[40:43], s50 offen offset:3072 nt lds
    s_mov_b32 s44, s4
    s_mov_b32 s45, s5
    s_mov_b32 s46, 0x280000
    s_mov_b32 s47, 0x20000
    v_mov_b32 v241, v3
    s_mov_b32 s14, s53
    s_mov_b32 s15, s54
    s_mul_i32 s51, s3, 16640
    s_add_u32 s51, s51, 0
    v_add_u32 v230, s51, v248
    v_lshrrev_b32 v2, 1, v1
    v_mul_u32_u24 v2, 4160, v2
    v_and_b32 v4, 1, v1
    v_lshl_add_u32 v2, v4, 4, v2
    v_add_u32 v2, s51, v2
    v_mov_b32 v4, 0
    v_mov_b32 v5, 0
    v_mov_b32 v6, 0
    v_mov_b32 v7, 0
    s_mov_b64 exec, 0xff
    ds_write_b128 v2, v[4:7]
    s_mul_i32 s52, s3, 4608
    s_add_u32 s52, s52, 70656
    s_mov_b64 exec, 0x3fffffff
    v_add_u32 v2, s52, v248
    ds_write_b128 v2, v[4:7]
    s_mov_b64 exec, -1
    v_and_b32 v2, 15, v1
    v_lshrrev_b32 v3, 4, v1
    v_add_u32 v231, 1, v2
    v_and_b32 v232, 3, v231
    v_sub_u32 v231, v231, v232
    v_add_u32 v231, 24, v231
    v_lshlrev_b32 v231, 1, v231
    v_mul_u32_u24 v232, 4160, v232
    v_add_u32 v231, v231, v232
    v_lshlrev_b32 v232, 4, v3
    v_sub_u32 v231, v231, v232
    s_mul_i32 s51, s3, 16640
    s_add_u32 s51, s51, 0
    v_add_u32 v231, s51, v231
    v_lshlrev_b32 v2, 5, v2
    v_add_u32 v2, v2, v232
    s_mul_i32 s52, s3, 4608
    s_add_u32 s52, s52, 67088
    v_sub_u32 v232, s52, v2
    s_mov_b32 s17, 23199744
    v_and_b32 v6, 15, v1
    v_lshrrev_b32 v7, 4, v1
    v_lshlrev_b32 v6, 4, v6
    v_lshl_add_u32 v6, v7, 2, v6
    v_lshlrev_b32 v7, 2, v6
    v_add_u32 v7, 84992, v7
    v_lshlrev_b32 v6, 1, v6
    s_lshl_b32 s66, s3, 10
    s_add_u32 s67, s66, 23068672
    s_lshl_b32 s62, s3, 11
    s_add_u32 s50, s62, 93184
    v_add_u32 v249, s50, v6
    v_bfe_u32 v2, v1, 4, 1
    v_mul_u32_u24 v2, 504, v2
    v_add_u32 v6, v6, v2
    s_mul_i32 s68, s58, 4096
    s_add_u32 s65, s68, 2883584
    s_add_u32 s68, s68, 8650752
    v_and_b32 v238, 7, v1
    v_lshlrev_b32 v238, 7, v238
    s_lshr_b32 s52, s70, 4
    s_lshl_b32 s52, s52, 11
    s_add_u32 s51, s52, 53248
    s_add_u32 s50, s66, 94208
    v_mov_b32 v2, s51
    v_mov_b32 v3, s50
    v_cmp_lt_u32 vcc, 7, v1
    s_nop 1
    v_cndmask_b32 v2, v3, v2, vcc
    v_add_u32 v238, v238, v2
    v_min_u32 v233, 15, v1
    v_lshlrev_b32 v234, 10, v233
    s_and_b32 s51, s2, 135
    s_lshl_b32 s51, s51, 7
    v_add_u32 v234, s51, v234
    v_lshl_add_u32 v233, v233, 7, s52
    v_add_u32 v233, 32768, v233
    v_min_u32 v239, 3, v1
    v_lshlrev_b32 v2, 2, v239
    v_mov_b32 v239, 0x4201
    v_lshrrev_b32 v239, v2, v239
    v_and_b32 v239, 7, v239
    v_mul_u32_u24 v239, 5120, v239
    s_lshl_b32 s69, s58, 3
    s_add_u32 s69, s69, 23560192
    s_and_b32 s50, s3, 1
    s_mul_i32 s50, s50, 49152
    s_mul_i32 s64, s73, 192
    s_add_u32 s64, s64, s50
    s_mul_i32 s50, s34, 98304
    s_add_u32 s64, s64, s50
    s_cmp_ge_u32 s3, 2
    s_cselect_b32 s40, s20, s18
    s_cselect_b32 s41, s21, s19
    s_cselect_b32 s50, 1, 0
    s_mov_b32 s42, 1966080
    s_mov_b32 s43, 0x20000
    s_mul_i32 s61, s3, 3072
    v_add_u32 v2, 0, v1
    v_mul_u32_u24 v3, 171, v2
    v_lshrrev_b32 v3, 11, v3
    v_mul_u32_u24 v4, 12, v3
    v_sub_u32 v4, v2, v4
    v_bfe_u32 v2, v3, 2, 1
    v_lshl_add_u32 v2, v2, 1, s50
    v_xor_b32 v4, v4, v2
    v_mul_u32_u24 v3, 3072, v3
    v_lshl_add_u32 v224, v4, 4, v3
    v_add_u32 v2, 64, v1
    v_mul_u32_u24 v3, 171, v2
    v_lshrrev_b32 v3, 11, v3
    v_mul_u32_u24 v4, 12, v3
    v_sub_u32 v4, v2, v4
    v_bfe_u32 v2, v3, 2, 1
    v_lshl_add_u32 v2, v2, 1, s50
    v_xor_b32 v4, v4, v2
    v_mul_u32_u24 v3, 3072, v3
    v_lshl_add_u32 v225, v4, 4, v3
    v_subrev_u32 v225, 1024, v225
    v_add_u32 v2, 128, v1
    v_mul_u32_u24 v3, 171, v2
    v_lshrrev_b32 v3, 11, v3
    v_mul_u32_u24 v4, 12, v3
    v_sub_u32 v4, v2, v4
    v_bfe_u32 v2, v3, 2, 1
    v_lshl_add_u32 v2, v2, 1, s50
    v_xor_b32 v4, v4, v2
    v_mul_u32_u24 v3, 3072, v3
    v_lshl_add_u32 v226, v4, 4, v3
    v_subrev_u32 v226, 2048, v226
    v_lshrrev_b32 v2, 2, v1
    v_mul_u32_u24 v2, 192, v2
    v_and_b32 v3, 1, v1
    v_lshl_add_u32 v2, v3, 3, v2
    s_mul_i32 s50, s3, 3
    v_bfe_u32 v3, v1, 4, 1
    v_lshlrev_b32 v3, 1, v3
    v_bfe_u32 v4, v1, 1, 1
    v_add_u32 v227, s50, v4
    v_xor_b32 v227, v227, v3
    v_lshl_add_u32 v227, v227, 4, v2
    v_xor_b32 v228, 16, v227
    s_add_u32 s50, s50, 2
    v_xor_b32 v3, v3, v4
    v_xor_b32 v3, s50, v3
    v_lshl_add_u32 v3, v3, 4, v2
    v_mul_u32_u24 v4, 6144, v4
    v_add_u32 v229, v3, v4
    v_add_u32 v227, 102400, v227
    v_add_u32 v228, 102400, v228
    v_add_u32 v229, 102400, v229
    v_lshrrev_b32 v2, 3, v1
    v_bfe_u32 v3, v1, 4, 2
    v_lshlrev_b32 v3, 1, v3
    v_xor_b32 v3, v3, v1
    v_and_b32 v3, 7, v3
    v_mul_u32_u24 v2, 4096, v2
    v_lshl_add_u32 v172, v3, 4, v2
    v_add_u32 v172, 8650752, v172
    v_lshrrev_b32 v2, 2, v1
    v_lshlrev_b32 v2, 7, v2
    v_and_b32 v3, 3, v1
    v_lshl_add_u32 v2, v3, 3, v2
    v_bfe_u32 v3, v1, 3, 2
    v_xor_b32 v168, 0, v3
    v_lshl_add_u32 v168, v168, 5, v2
    v_xor_b32 v169, 1, v3
    v_lshl_add_u32 v169, v169, 5, v2
    v_xor_b32 v170, 2, v3
    v_lshl_add_u32 v170, v170, 5, v2
    v_xor_b32 v171, 3, v3
    v_lshl_add_u32 v171, v171, 5, v2
    v_and_b32 v175, 15, v1
    v_lshlrev_b32 v175, 4, v175
    v_bfe_u32 v2, v1, 4, 1
    v_lshrrev_b32 v3, 5, v1
    v_mul_u32_u24 v173, 49152, v2
    v_lshl_add_u32 v173, v3, 8, v173
    v_add_u32 v173, v173, v175
    v_lshl_add_u32 v2, v2, 1, v3
    v_mul_u32_u24 v174, 49152, v2
    v_add_u32 v174, v174, v175
    v_bfe_u32 v2, v0, 1, 2
    v_lshlrev_b32 v2, 1, v2
    s_lshr_b32 s50, s73, 1
    v_xor_b32 v2, s50, v2
    v_lshlrev_b32 v2, 4, v2
    v_lshl_add_u32 v216, v0, 7, v2
    s_and_b32 s50, s73, 1
    s_lshl_b32 s50, s50, 3
    v_add_u32 v216, s50, v216
    v_add_u32 v217, 0x8000, v216
    v_add_u32 v218, 0x10000, v216
    v_cmp_gt_u32 vcc, 128, v0
    s_nop 1
    v_cndmask_b32 v218, v217, v218, vcc
    v_lshrrev_b32 v2, 1, v1
    v_lshlrev_b32 v2, 9, v2
    v_and_b32 v3, 1, v1
    v_lshl_add_u32 v219, v3, 2, v2
    s_lshl_b32 s50, s3, 7
    s_add_u32 s50, s50, 112640
    v_add_u32 v219, s50, v219
    v_mov_b32 v2, s50
    v_cmp_lt_u32 vcc, 39, v1
    s_nop 1
    v_cndmask_b32 v219, v219, v2, vcc
    s_mov_b32 s17, 23199744
    s_lshl_b32 s77, s34, 7
    v_lshl_add_u32 v220, v0, 2, s77
    v_add_u32 v221, 1024, v220
    v_add_u32 v222, 2048, v220
    v_subrev_u32 v2, 2560, v220
    v_min_u32 v220, v220, v2
    v_subrev_u32 v2, 2560, v221
    v_min_u32 v221, v221, v2
    v_subrev_u32 v2, 2560, v222
    v_min_u32 v222, v222, v2
    v_mov_b32 v2, 0x80000000
    v_cmp_gt_u32 vcc, 128, v0
    s_nop 1
    v_cndmask_b32 v222, v2, v222, vcc
    s_mov_b32 s77, 23183360
    s_mul_i32 s50, s58, 4096
    v_lshlrev_b32 v2, 7, v1
    v_add_u32 v2, s50, v2
    s_lshr_b32 s50, s70, 4
    s_lshl_b32 s50, s50, 11
    s_add_u32 s50, s50, 23232512
    s_cmp_eq_u32 s3, 2
    s_cselect_b32 s50, s50, 268435456
    v_and_b32 v3, 15, v1
    v_lshl_add_u32 v3, v3, 7, s50
    v_cmp_lt_u32 vcc, 31, v1
    s_nop 1
    v_cndmask_b32 v2, v2, v3, vcc
    buffer_load_dword v235, v2, s[36:39], 0 offen sc1
    s_waitcnt vmcnt(8)
    s_barrier
    ds_read_b64_tr_b16 v[8:9], v244 offset:512
    ds_read_b64_tr_b16 v[10:11], v244 offset:1088
    ds_read_b64_tr_b16 v[12:13], v244 offset:1600
    ds_read_b64_tr_b16 v[14:15], v244 offset:18496
    ds_read_b64_tr_b16 v[16:17], v244 offset:19008
    ds_read_b64_tr_b16 v[18:19], v244 offset:9216
    ds_read_b64_tr_b16 v[20:21], v244 offset:9792
    ds_read_b64_tr_b16 v[22:23], v244 offset:10304
    ds_read_b64_tr_b16 v[24:25], v244 offset:27200
    ds_read_b64_tr_b16 v[26:27], v244 offset:27712
    ds_read_b64_tr_b16 v[28:29], v246 offset:512
    ds_read_b64_tr_b16 v[30:31], v246 offset:1088
    ds_read_b64_tr_b16 v[32:33], v246 offset:1600
    ds_read_b64_tr_b16 v[34:35], v246 offset:18496
    ds_read_b64_tr_b16 v[36:37], v246 offset:19008
    ds_read_b64_tr_b16 v[38:39], v246 offset:9216
    ds_read_b64_tr_b16 v[40:41], v246 offset:9792
    ds_read_b64_tr_b16 v[42:43], v246 offset:10304
    ds_read_b64_tr_b16 v[44:45], v246 offset:27200
    ds_read_b64_tr_b16 v[46:47], v246 offset:27712
    buffer_load_dword v242, v234, s[36:39], s17 offen sc1
    s_add_u32 m0, s15, 120896
    s_nop 0
    buffer_load_dwordx4 v241, s[44:47], s14 offen lds
    s_add_u32 s14, s14, 10240
    s_add_u32 m0, s15, 121984
    s_nop 0
    buffer_load_dwordx4 v241, s[44:47], s14 offen lds
    s_add_u32 s14, s14, 10240
    s_add_u32 m0, s15, 123072
    s_nop 0
    buffer_load_dwordx4 v241, s[44:47], s14 offen lds
    s_add_u32 s14, s14, 10240
    s_add_u32 m0, s15, 124160
    s_nop 0
    buffer_load_dwordx4 v241, s[44:47], s14 offen lds
    s_waitcnt vmcnt(12)
    v_alignbit_b32 v48, v48, v48, 16
    v_alignbit_b32 v49, v49, v49, 16
    s_waitcnt vmcnt(11)
    v_alignbit_b32 v50, v50, v50, 16
    v_alignbit_b32 v51, v51, v51, 16
    s_waitcnt lgkmcnt(14)
    v_alignbit_b32 v52, v9, v8, 16
    v_alignbit_b32 v53, v10, v9, 16
    v_alignbit_b32 v54, v11, v10, 16
    v_alignbit_b32 v55, v12, v11, 16
    v_alignbit_b32 v56, v13, v12, 16
    v_dot2_f32_bf16 v65, v9, v49, 0
    v_dot2_f32_bf16 v64, v52, v49, 0
    v_dot2_f32_bf16 v67, v10, v49, 0
    v_dot2_f32_bf16 v66, v53, v49, 0
    v_dot2_f32_bf16 v69, v11, v49, 0
    v_dot2_f32_bf16 v68, v54, v49, 0
    v_dot2_f32_bf16 v71, v12, v49, 0
    v_dot2_f32_bf16 v70, v55, v49, 0
    v_dot2_f32_bf16 v65, v10, v48, v65
    v_dot2_f32_bf16 v64, v53, v48, v64
    v_dot2_f32_bf16 v67, v11, v48, v67
    v_dot2_f32_bf16 v66, v54, v48, v66
    v_dot2_f32_bf16 v69, v12, v48, v69
    v_dot2_f32_bf16 v68, v55, v48, v68
    v_dot2_f32_bf16 v71, v13, v48, v71
    v_dot2_f32_bf16 v70, v56, v48, v70
    v_lshlrev_b32 v80, 16, v14
    v_and_b32 v81, 0xffff0000, v14
    v_lshlrev_b32 v82, 16, v15
    v_and_b32 v83, 0xffff0000, v15
    v_lshlrev_b32 v84, 16, v16
    v_and_b32 v85, 0xffff0000, v16
    v_lshlrev_b32 v86, 16, v17
    v_and_b32 v87, 0xffff0000, v17
    v_pk_mul_f32 v[64:65], v[64:65], v[80:81]
    v_pk_mul_f32 v[66:67], v[66:67], v[82:83]
    v_pk_mul_f32 v[68:69], v[68:69], v[84:85]
    v_pk_mul_f32 v[70:71], v[70:71], v[86:87]
    v_cvt_pk_bf16_f32 v96, v71, v70
    v_cvt_pk_bf16_f32 v97, v69, v68
    v_cvt_pk_bf16_f32 v98, v67, v66
    v_cvt_pk_bf16_f32 v99, v65, v64
    buffer_store_dwordx4 v[96:99], v247, s[36:39], 0 offen offset:128
    v_alignbit_b32 v58, v19, v18, 16
    s_waitcnt lgkmcnt(13)
    v_alignbit_b32 v59, v20, v19, 16
    v_alignbit_b32 v60, v21, v20, 16
    s_waitcnt lgkmcnt(12)
    v_alignbit_b32 v61, v22, v21, 16
    v_alignbit_b32 v62, v23, v22, 16
    v_dot2_f32_bf16 v73, v19, v49, 0
    v_dot2_f32_bf16 v72, v58, v49, 0
    v_dot2_f32_bf16 v75, v20, v49, 0
    v_dot2_f32_bf16 v74, v59, v49, 0
    v_dot2_f32_bf16 v77, v21, v49, 0
    v_dot2_f32_bf16 v76, v60, v49, 0
    v_dot2_f32_bf16 v79, v22, v49, 0
    v_dot2_f32_bf16 v78, v61, v49, 0
    v_dot2_f32_bf16 v73, v20, v48, v73
    v_dot2_f32_bf16 v72, v59, v48, v72
    v_dot2_f32_bf16 v75, v21, v48, v75
    v_dot2_f32_bf16 v74, v60, v48, v74
    v_dot2_f32_bf16 v77, v22, v48, v77
    v_dot2_f32_bf16 v76, v61, v48, v76
    v_dot2_f32_bf16 v79, v23, v48, v79
    v_dot2_f32_bf16 v78, v62, v48, v78
    s_waitcnt lgkmcnt(11)
    v_lshlrev_b32 v88, 16, v24
    v_and_b32 v89, 0xffff0000, v24
    v_lshlrev_b32 v90, 16, v25
    v_and_b32 v91, 0xffff0000, v25
    s_waitcnt lgkmcnt(10)
    v_lshlrev_b32 v92, 16, v26
    v_and_b32 v93, 0xffff0000, v26
    v_lshlrev_b32 v94, 16, v27
    v_and_b32 v95, 0xffff0000, v27
    v_pk_mul_f32 v[72:73], v[72:73], v[88:89]
    v_pk_mul_f32 v[74:75], v[74:75], v[90:91]
    v_pk_mul_f32 v[76:77], v[76:77], v[92:93]
    v_pk_mul_f32 v[78:79], v[78:79], v[94:95]
    v_cvt_pk_bf16_f32 v100, v79, v78
    v_cvt_pk_bf16_f32 v101, v77, v76
    v_cvt_pk_bf16_f32 v102, v75, v74
    v_cvt_pk_bf16_f32 v103, v73, v72
    buffer_store_dwordx4 v[100:103], v247, s[36:39], 0 offen offset:0
    s_waitcnt lgkmcnt(9)
    v_alignbit_b32 v52, v29, v28, 16
    s_waitcnt lgkmcnt(8)
    v_alignbit_b32 v53, v30, v29, 16
    v_alignbit_b32 v54, v31, v30, 16
    s_waitcnt lgkmcnt(7)
    v_alignbit_b32 v55, v32, v31, 16
    v_alignbit_b32 v56, v33, v32, 16
    v_dot2_f32_bf16 v65, v29, v51, 0
    v_dot2_f32_bf16 v64, v52, v51, 0
    v_dot2_f32_bf16 v67, v30, v51, 0
    v_dot2_f32_bf16 v66, v53, v51, 0
    v_dot2_f32_bf16 v69, v31, v51, 0
    v_dot2_f32_bf16 v68, v54, v51, 0
    v_dot2_f32_bf16 v71, v32, v51, 0
    v_dot2_f32_bf16 v70, v55, v51, 0
    v_dot2_f32_bf16 v65, v30, v50, v65
    v_dot2_f32_bf16 v64, v53, v50, v64
    v_dot2_f32_bf16 v67, v31, v50, v67
    v_dot2_f32_bf16 v66, v54, v50, v66
    v_dot2_f32_bf16 v69, v32, v50, v69
    v_dot2_f32_bf16 v68, v55, v50, v68
    v_dot2_f32_bf16 v71, v33, v50, v71
    v_dot2_f32_bf16 v70, v56, v50, v70
    s_waitcnt lgkmcnt(6)
    v_lshlrev_b32 v80, 16, v34
    v_and_b32 v81, 0xffff0000, v34
    v_lshlrev_b32 v82, 16, v35
    v_and_b32 v83, 0xffff0000, v35
    s_waitcnt lgkmcnt(5)
    v_lshlrev_b32 v84, 16, v36
    v_and_b32 v85, 0xffff0000, v36
    v_lshlrev_b32 v86, 16, v37
    v_and_b32 v87, 0xffff0000, v37
    v_pk_mul_f32 v[64:65], v[64:65], v[80:81]
    v_pk_mul_f32 v[66:67], v[66:67], v[82:83]
    v_pk_mul_f32 v[68:69], v[68:69], v[84:85]
    v_pk_mul_f32 v[70:71], v[70:71], v[86:87]
    v_cvt_pk_bf16_f32 v104, v71, v70
    v_cvt_pk_bf16_f32 v105, v69, v68
    v_cvt_pk_bf16_f32 v106, v67, v66
    v_cvt_pk_bf16_f32 v107, v65, v64
    buffer_store_dwordx4 v[104:107], v247, s[36:39], s16 offen offset:128
    s_waitcnt lgkmcnt(4)
    v_alignbit_b32 v58, v39, v38, 16
    s_waitcnt lgkmcnt(3)
    v_alignbit_b32 v59, v40, v39, 16
    v_alignbit_b32 v60, v41, v40, 16
    s_waitcnt lgkmcnt(2)
    v_alignbit_b32 v61, v42, v41, 16
    v_alignbit_b32 v62, v43, v42, 16
    v_dot2_f32_bf16 v73, v39, v51, 0
    v_dot2_f32_bf16 v72, v58, v51, 0
    v_dot2_f32_bf16 v75, v40, v51, 0
    v_dot2_f32_bf16 v74, v59, v51, 0
    v_dot2_f32_bf16 v77, v41, v51, 0
    v_dot2_f32_bf16 v76, v60, v51, 0
    v_dot2_f32_bf16 v79, v42, v51, 0
    v_dot2_f32_bf16 v78, v61, v51, 0
    v_dot2_f32_bf16 v73, v40, v50, v73
    v_dot2_f32_bf16 v72, v59, v50, v72
    v_dot2_f32_bf16 v75, v41, v50, v75
    v_dot2_f32_bf16 v74, v60, v50, v74
    v_dot2_f32_bf16 v77, v42, v50, v77
    v_dot2_f32_bf16 v76, v61, v50, v76
    v_dot2_f32_bf16 v79, v43, v50, v79
    v_dot2_f32_bf16 v78, v62, v50, v78
    s_waitcnt lgkmcnt(1)
    v_lshlrev_b32 v88, 16, v44
    v_and_b32 v89, 0xffff0000, v44
    v_lshlrev_b32 v90, 16, v45
    v_and_b32 v91, 0xffff0000, v45
    s_waitcnt lgkmcnt(0)
    v_lshlrev_b32 v92, 16, v46
    v_and_b32 v93, 0xffff0000, v46
    v_lshlrev_b32 v94, 16, v47
    v_and_b32 v95, 0xffff0000, v47
    v_pk_mul_f32 v[72:73], v[72:73], v[88:89]
    v_pk_mul_f32 v[74:75], v[74:75], v[90:91]
    v_pk_mul_f32 v[76:77], v[76:77], v[92:93]
    v_pk_mul_f32 v[78:79], v[78:79], v[94:95]
    v_cvt_pk_bf16_f32 v108, v79, v78
    v_cvt_pk_bf16_f32 v109, v77, v76
    v_cvt_pk_bf16_f32 v110, v75, v74
    v_cvt_pk_bf16_f32 v111, v73, v72
    buffer_store_dwordx4 v[108:111], v247, s[36:39], s16 offen offset:0
    s_waitcnt vmcnt(8)
    v_cmp_ne_u32 vcc, s30, v242
    s_cbranch_vccnz L_id_slow
    s_mov_b32 s30, 1
L_id_back:
    s_cmp_eq_u32 s30, 1
    s_cbranch_scc0 L_kv_far
L_kv_back:
    ds_read_b128 v[128:131], v230 offset:32
    ds_read_b64 v[132:133], v230 offset:48
    ds_read_b128 v[134:137], v230 offset:1056
    ds_read_b64 v[138:139], v230 offset:1072
    ds_read_b128 v[140:143], v230 offset:2080
    ds_read_b64 v[144:145], v230 offset:2096
    ds_read_b128 v[146:149], v230 offset:3104
    ds_read_b64 v[150:151], v230 offset:3120
    s_mov_b64 exec, 1
    s_waitcnt lgkmcnt(7)
    v_lshlrev_b32 v4, 16, v128
    v_alignbit_b32 v5, v129, v128, 16
    ds_write_b32 v230, v4 offset:4188
    ds_write_b32 v230, v128 offset:8348
    ds_write_b32 v230, v4 offset:12504
    ds_write_b32 v230, v5 offset:12508
    s_mov_b64 exec, -1
    v_alignbit_b32 v56, v129, v128, 16
    v_alignbit_b32 v57, v130, v129, 16
    v_alignbit_b32 v58, v131, v130, 16
    s_waitcnt lgkmcnt(10)
    v_alignbit_b32 v59, v132, v131, 16
    v_pk_mov_b32 v[60:61], v[128:129], v[130:131] op_sel:[1,0]
    v_pk_mov_b32 v[62:63], v[130:131], v[132:133] op_sel:[1,0]
    v_alignbit_b32 v64, v130, v129, 16
    v_alignbit_b32 v65, v131, v130, 16
    v_alignbit_b32 v66, v132, v131, 16
    v_alignbit_b32 v67, v133, v132, 16
    ds_write_b128 v230, v[56:59] offset:4192
    ds_write_b128 v230, v[60:63] offset:8352
    ds_write_b128 v230, v[64:67] offset:12512
    s_waitcnt lgkmcnt(12)
    v_alignbit_b32 v68, v135, v134, 16
    v_alignbit_b32 v69, v136, v135, 16
    v_alignbit_b32 v70, v137, v136, 16
    s_waitcnt lgkmcnt(11)
    v_alignbit_b32 v71, v138, v137, 16
    v_pk_mov_b32 v[72:73], v[134:135], v[136:137] op_sel:[1,0]
    v_pk_mov_b32 v[74:75], v[136:137], v[138:139] op_sel:[1,0]
    v_alignbit_b32 v76, v136, v135, 16
    v_alignbit_b32 v77, v137, v136, 16
    v_alignbit_b32 v78, v138, v137, 16
    v_alignbit_b32 v79, v139, v138, 16
    ds_write_b128 v230, v[68:71] offset:5216
    ds_write_b128 v230, v[72:75] offset:9376
    ds_write_b128 v230, v[76:79] offset:13536
    s_waitcnt lgkmcnt(13)
    v_alignbit_b32 v56, v141, v140, 16
    v_alignbit_b32 v57, v142, v141, 16
    v_alignbit_b32 v58, v143, v142, 16
    s_waitcnt lgkmcnt(12)
    v_alignbit_b32 v59, v144, v143, 16
    v_pk_mov_b32 v[60:61], v[140:141], v[142:143] op_sel:[1,0]
    v_pk_mov_b32 v[62:63], v[142:143], v[144:145] op_sel:[1,0]
    v_alignbit_b32 v64, v142, v141, 16
    v_alignbit_b32 v65, v143, v142, 16
    v_alignbit_b32 v66, v144, v143, 16
    v_alignbit_b32 v67, v145, v144, 16
    ds_write_b128 v230, v[56:59] offset:6240
    ds_write_b128 v230, v[60:63] offset:10400
    ds_write_b128 v230, v[64:67] offset:14560
    s_waitcnt lgkmcnt(14)
    v_alignbit_b32 v68, v147, v146, 16
    v_alignbit_b32 v69, v148, v147, 16
    v_alignbit_b32 v70, v149, v148, 16
    s_waitcnt lgkmcnt(13)
    v_alignbit_b32 v71, v150, v149, 16
    v_pk_mov_b32 v[72:73], v[146:147], v[148:149] op_sel:[1,0]
    v_pk_mov_b32 v[74:75], v[148:149], v[150:151] op_sel:[1,0]
    v_alignbit_b32 v76, v148, v147, 16
    v_alignbit_b32 v77, v149, v148, 16
    v_alignbit_b32 v78, v150, v149, 16
    v_alignbit_b32 v79, v151, v150, 16
    ds_write_b128 v230, v[68:71] offset:7264
    ds_write_b128 v230, v[72:75] offset:11424
    ds_write_b128 v230, v[76:79] offset:15584
    s_waitcnt vmcnt(0)
    s_barrier
    s_cmp_eq_u32 s3, 0
    s_cbranch_scc0 L_lf2
    s_cmp_eq_u32 s30, 1
    s_cbranch_scc0 L_lf2_far
    s_lshl_b32 s54, s70, 7
    s_add_u32 s54, s54, 23232512
    v_mov_b32 v254, 0
    v_mov_b32 v255, s48
    s_mov_b64 exec, 1
    buffer_store_dword v255, v254, s[36:39], s54 offen
    s_mov_b64 exec, -1
L_lf2:
    s_mov_b32 s55, 2883584
    s_mov_b32 s56, 2916352
    ds_read_b64_tr_b16 v[112:113], v244 offset:35904
    ds_read_b64_tr_b16 v[114:115], v244 offset:36416
    ds_read_b64_tr_b16 v[116:117], v244 offset:44608
    ds_read_b64_tr_b16 v[118:119], v244 offset:45120
    ds_read_b64_tr_b16 v[120:121], v246 offset:35904
    ds_read_b64_tr_b16 v[122:123], v246 offset:36416
    ds_read_b64_tr_b16 v[124:125], v246 offset:44608
    ds_read_b64_tr_b16 v[126:127], v246 offset:45120
    s_waitcnt lgkmcnt(6)
    buffer_store_dwordx4 v[112:115], v245, s[36:39], s55 offen offset:0
    s_waitcnt lgkmcnt(4)
    buffer_store_dwordx4 v[116:119], v245, s[36:39], s55 offen offset:128
    s_waitcnt lgkmcnt(2)
    buffer_store_dwordx4 v[120:123], v245, s[36:39], s56 offen offset:0
    s_waitcnt lgkmcnt(0)
    buffer_store_dwordx4 v[124:127], v245, s[36:39], s56 offen offset:128
    s_cmp_eq_u32 s30, 1
    s_cbranch_scc0 L_q_far
L_q_back:
    v_lshrrev_b32 v3, 4, v1
    v_lshlrev_b32 v2, 3, v3
    v_and_b32 v3, 15, v1
    v_sub_u32 v2, v2, v3
    v_subrev_u32 v2, 9, v2
    v_and_b32 v3, 1, v2
    v_cmp_eq_u32 vcc, 1, v3
    v_lshrrev_b32 v3, 16, v250
    s_nop 0
    v_cndmask_b32 v3, v3, v250, vcc
    v_lshrrev_b32 v2, 1, v2
    v_cmp_eq_u32 vcc, 0, v2
    s_nop 1
    v_cndmask_b32 v244, 0, v3, vcc
    v_cmp_eq_u32 vcc, 1, v2
    s_nop 1
    v_cndmask_b32 v245, 0, v3, vcc
    v_cmp_eq_u32 vcc, 2, v2
    s_nop 1
    v_cndmask_b32 v246, 0, v3, vcc
    v_cmp_eq_u32 vcc, 3, v2
    s_nop 1
    v_cndmask_b32 v247, 0, v3, vcc
    v_mov_b32 v230, v238
    v_mov_b32 v4, v231
    v_mov_b32 v5, v232
    ds_read_b64 a[128:129], v4 offset:0
    ds_read_b64 a[130:131], v4 offset:8
    ds_read_b64 a[132:133], v4 offset:512
    ds_read_b64 a[134:135], v4 offset:520
    ds_read_b64 a[136:137], v4 offset:1024
    ds_read_b64 a[138:139], v4 offset:1032
    ds_read_b64 a[140:141], v4 offset:1536
    ds_read_b64 a[142:143], v4 offset:1544
    ds_read_b64 a[144:145], v4 offset:64
    ds_read_b64 a[146:147], v4 offset:72
    ds_read_b64 a[148:149], v4 offset:576
    ds_read_b64 a[150:151], v4 offset:584
    ds_read_b64 a[152:153], v4 offset:1088
    ds_read_b64 a[154:155], v4 offset:1096
    ds_read_b64 a[156:157], v4 offset:1600
    ds_read_b64 a[158:159], v4 offset:1608
    ds_read_b64 a[160:161], v4 offset:128
    ds_read_b64 a[162:163], v4 offset:136
    ds_read_b64 a[164:165], v4 offset:640
    ds_read_b64 a[166:167], v4 offset:648
    ds_read_b64 a[168:169], v4 offset:1152
    ds_read_b64 a[170:171], v4 offset:1160
    ds_read_b64 a[172:173], v4 offset:1664
    ds_read_b64 a[174:175], v4 offset:1672
    ds_read_b64 a[176:177], v4 offset:192
    ds_read_b64 a[178:179], v4 offset:200
    ds_read_b64 a[180:181], v4 offset:704
    ds_read_b64 a[182:183], v4 offset:712
    ds_read_b64 a[184:185], v4 offset:1216
    ds_read_b64 a[186:187], v4 offset:1224
    ds_read_b64 a[188:189], v4 offset:1728
    ds_read_b64 a[190:191], v4 offset:1736
    ds_read_b64 a[192:193], v4 offset:256
    ds_read_b64 a[194:195], v4 offset:264
    ds_read_b64 a[196:197], v4 offset:768
    ds_read_b64 a[198:199], v4 offset:776
    ds_read_b64 a[200:201], v4 offset:1280
    ds_read_b64 a[202:203], v4 offset:1288
    ds_read_b64 a[204:205], v4 offset:1792
    ds_read_b64 a[206:207], v4 offset:1800
    ds_read_b64 a[208:209], v4 offset:320
    ds_read_b64 a[210:211], v4 offset:328
    ds_read_b64 a[212:213], v4 offset:832
    ds_read_b64 a[214:215], v4 offset:840
    ds_read_b64 a[216:217], v4 offset:1344
    ds_read_b64 a[218:219], v4 offset:1352
    ds_read_b64 a[220:221], v4 offset:1856
    ds_read_b64 a[222:223], v4 offset:1864
L_poll3:
    buffer_load_dword v234, v233, s[36:39], s17 offen sc1
    s_waitcnt vmcnt(0)
    v_cmp_ne_u32 vcc, s48, v234
    s_cbranch_vccz L_poll3_ok
    s_cmp_eq_u32 s49, 0
    s_cbranch_scc1 L_poll3_ok
    s_sub_u32 s49, s49, 1
    s_sleep 1
    s_branch L_poll3
L_poll3_ok:
    s_mul_i32 s50, s58, 4096
    s_mul_i32 s52, s3, 4608
    s_add_u32 m0, s52, 66560
    s_nop 0
    buffer_load_dwordx4 v248, s[36:39], s50 offen offset:3072 sc1 lds
    buffer_load_dwordx4 v248, s[36:39], s50 offen offset:2048 sc1 lds
    buffer_load_dwordx4 v248, s[36:39], s50 offen offset:1024 sc1 lds
    buffer_load_dwordx4 v248, s[36:39], s50 offen offset:0 sc1 lds
    s_waitcnt vmcnt(2)
    ds_read_b128 v[104:107], v5 offset:3584
    ds_read_b128 v[108:111], v5 offset:3072
    ds_read_b128 v[112:115], v5 offset:2560
    ds_read_b128 v[116:119], v5 offset:2048
    ds_read_b128 v[136:139], v5 offset:3648
    ds_read_b128 v[140:143], v5 offset:3136
    ds_read_b128 v[144:147], v5 offset:2624
    ds_read_b128 v[148:151], v5 offset:2112
    s_waitcnt lgkmcnt(7)
    v_mfma_f32_16x16x32_bf16 v[8:11], a[128:131], v[104:107], 0
    ds_read_b128 v[120:123], v5 offset:3712
    v_mfma_f32_16x16x32_bf16 v[8:11], v[244:247], v[104:107], v[8:11]
    s_barrier
    s_cmp_eq_u32 s3, 0
    s_cbranch_scc0 L_lf4
    s_cmp_eq_u32 s30, 1
    s_cbranch_scc0 L_lf4_far
    s_lshl_b32 s54, s70, 7
    s_add_u32 s54, s54, 23252992
    v_mov_b32 v254, 0
    v_mov_b32 v255, s48
    s_mov_b64 exec, 1
    buffer_store_dword v255, v254, s[36:39], s54 offen
    s_mov_b64 exec, -1
L_lf4:
    s_waitcnt lgkmcnt(7)
    v_mfma_f32_16x16x32_bf16 v[12:15], a[128:131], v[108:111], 0
    s_add_u32 m0, s61, 139264
    s_nop 0
    buffer_load_dwordx4 v224, s[40:43], s64 offen offset:0 lds
    v_mfma_f32_16x16x32_bf16 v[12:15], v[244:247], v[108:111], v[12:15]
    s_movk_i32 s4, 4096
    ds_read_b128 v[124:127], v5 offset:3200
    v_mfma_f32_16x16x32_bf16 v[12:15], a[132:135], v[104:107], v[12:15]
    s_movk_i32 s5, 8192
    v_mfma_f32_16x16x32_bf16 v[16:19], a[132:135], v[108:111], 0
    s_waitcnt lgkmcnt(7)
    s_add_u32 m0, s61, 139264
    v_mfma_f32_16x16x32_bf16 v[16:19], a[128:131], v[112:115], v[16:19]
    buffer_load_dwordx4 v225, s[40:43], s64 offen offset:1024 lds
    v_mfma_f32_16x16x32_bf16 v[16:19], v[244:247], v[112:115], v[16:19]
    s_lshl_b32 s6, s72, 10
    ds_read_b128 v[128:131], v5 offset:2688
    v_mfma_f32_16x16x32_bf16 v[16:19], a[136:139], v[104:107], v[16:19]
    s_add_u32 s6, s6, 23101440
    v_mfma_f32_16x16x32_bf16 v[20:23], a[132:135], v[112:115], 0
    s_lshl_b32 s7, s73, 6
    v_mfma_f32_16x16x32_bf16 v[20:23], a[136:139], v[108:111], v[20:23]
    s_waitcnt lgkmcnt(7)
    s_add_u32 m0, s61, 139264
    ds_read_b128 v[132:135], v5 offset:2176
    buffer_load_dwordx4 v226, s[40:43], s64 offen offset:2048 lds
    v_mfma_f32_16x16x32_bf16 v[20:23], a[128:131], v[116:119], v[20:23]
    s_add_u32 s64, s64, 98304
    v_mfma_f32_16x16x32_bf16 v[20:23], v[244:247], v[116:119], v[20:23]
    s_sub_u32 s35, s64, 1966080
    v_mfma_f32_16x16x32_bf16 v[20:23], a[140:143], v[104:107], v[20:23]
    s_waitcnt lgkmcnt(4)
    v_mfma_f32_16x16x32_bf16 v[8:11], a[144:147], v[136:139], v[8:11]
    s_min_u32 s64, s64, s35
    s_add_u32 m0, s61, 151552
    ds_read_b128 v[152:155], v5 offset:3776
    buffer_load_dwordx4 v224, s[40:43], s64 offen offset:0 lds
    v_mfma_f32_16x16x32_bf16 v[12:15], a[144:147], v[140:143], v[12:15]
    s_add_u32 s7, s7, s6
    v_mfma_f32_16x16x32_bf16 v[12:15], a[148:151], v[136:139], v[12:15]
    s_mul_i32 s8, s72, 768
    ds_read_b128 v[156:159], v5 offset:3264
    v_mfma_f32_16x16x32_bf16 v[16:19], a[148:151], v[140:143], v[16:19]
    s_add_u32 m0, s61, 151552
    v_mfma_f32_16x16x32_bf16 v[16:19], a[144:147], v[144:147], v[16:19]
    buffer_load_dwordx4 v225, s[40:43], s64 offen offset:1024 lds
    v_mfma_f32_16x16x32_bf16 v[16:19], a[152:155], v[136:139], v[16:19]
    s_mul_i32 s60, s73, 12
    ds_read_b128 v[160:163], v5 offset:2752
    v_mfma_f32_16x16x32_bf16 v[20:23], a[148:151], v[144:147], v[20:23]
    s_add_u32 s8, s8, s60
    v_mfma_f32_16x16x32_bf16 v[20:23], a[152:155], v[140:143], v[20:23]
    s_add_u32 m0, s61, 151552
    ds_read_b128 v[164:167], v5 offset:2240
    v_mfma_f32_16x16x32_bf16 v[20:23], a[144:147], v[148:151], v[20:23]
    buffer_load_dwordx4 v226, s[40:43], s64 offen offset:2048 lds
    v_mfma_f32_16x16x32_bf16 v[20:23], a[156:159], v[136:139], v[20:23]
    s_waitcnt lgkmcnt(4)
    v_mfma_f32_16x16x32_bf16 v[8:11], a[160:163], v[120:123], v[8:11]
    s_add_u32 s64, s64, 98304
    ds_read_b128 v[104:107], v5 offset:3840
    v_mfma_f32_16x16x32_bf16 v[12:15], a[160:163], v[124:127], v[12:15]
    s_sub_u32 s35, s64, 1966080
    v_mfma_f32_16x16x32_bf16 v[12:15], a[164:167], v[120:123], v[12:15]
    s_min_u32 s64, s64, s35
    s_add_u32 m0, s61, 102400
    ds_read_b128 v[108:111], v5 offset:3328
    buffer_load_dwordx4 v224, s[40:43], s64 offen offset:0 lds
    v_mfma_f32_16x16x32_bf16 v[16:19], a[164:167], v[124:127], v[16:19]
    s_mul_i32 s60, s3, 3
    v_mfma_f32_16x16x32_bf16 v[16:19], a[160:163], v[128:131], v[16:19]
    s_add_u32 s8, s8, s60
    v_mfma_f32_16x16x32_bf16 v[16:19], a[168:171], v[120:123], v[16:19]
    s_add_u32 m0, s61, 102400
    ds_read_b128 v[112:115], v5 offset:2816
    v_mfma_f32_16x16x32_bf16 v[20:23], a[164:167], v[128:131], v[20:23]
    buffer_load_dwordx4 v225, s[40:43], s64 offen offset:1024 lds
    v_mfma_f32_16x16x32_bf16 v[20:23], a[168:171], v[124:127], v[20:23]
    s_lshl_b32 s8, s8, 8
    ds_read_b128 v[116:119], v5 offset:2304
    v_mfma_f32_16x16x32_bf16 v[20:23], a[160:163], v[132:135], v[20:23]
    s_add_u32 s8, s8, 16777216
    v_mfma_f32_16x16x32_bf16 v[20:23], a[172:175], v[120:123], v[20:23]
    s_waitcnt lgkmcnt(4)
    v_mfma_f32_16x16x32_bf16 v[8:11], a[176:179], v[152:155], v[8:11]
    s_add_u32 m0, s61, 102400
    ds_read_b128 v[136:139], v5 offset:3904
    buffer_load_dwordx4 v226, s[40:43], s64 offen offset:2048 lds
    v_mfma_f32_16x16x32_bf16 v[12:15], a[176:179], v[156:159], v[12:15]
    s_add_u32 s64, s64, 98304
    v_mfma_f32_16x16x32_bf16 v[12:15], a[180:183], v[152:155], v[12:15]
    s_sub_u32 s35, s64, 1966080
    ds_read_b128 v[140:143], v5 offset:3392
    v_mfma_f32_16x16x32_bf16 v[16:19], a[180:183], v[156:159], v[16:19]
    s_min_u32 s64, s64, s35
    v_mfma_f32_16x16x32_bf16 v[16:19], a[176:179], v[160:163], v[16:19]
    s_add_u32 m0, s61, 114688
    s_nop 0
    buffer_load_dwordx4 v224, s[40:43], s64 offen offset:0 lds
    v_mfma_f32_16x16x32_bf16 v[16:19], a[184:187], v[152:155], v[16:19]
    s_lshl_b32 s9, s73, 2
    ds_read_b128 v[144:147], v5 offset:2880
    v_mfma_f32_16x16x32_bf16 v[20:23], a[180:183], v[160:163], v[20:23]
    s_add_u32 s9, s9, s3
    v_mfma_f32_16x16x32_bf16 v[20:23], a[184:187], v[156:159], v[20:23]
    s_mul_i32 s9, s9, 384
    ds_read_b128 v[148:151], v5 offset:2368
    v_mfma_f32_16x16x32_bf16 v[20:23], a[176:179], v[164:167], v[20:23]
    buffer_load_dword v240, v238, s[36:39], s17 offen sc1
    v_mfma_f32_16x16x32_bf16 v[20:23], a[188:191], v[152:155], v[20:23]
    s_waitcnt lgkmcnt(4)
    v_mfma_f32_16x16x32_bf16 v[8:11], a[192:195], v[104:107], v[8:11]
    s_add_u32 m0, s61, 114688
    ds_read_b128 v[120:123], v5 offset:3968
    ds_read_b64 a[224:225], v4 offset:384
    buffer_load_dwordx4 v225, s[40:43], s64 offen offset:1024 lds
    v_mfma_f32_16x16x32_bf16 v[12:15], a[192:195], v[108:111], v[12:15]
    s_add_u32 s9, s9, 23527424
    ds_read_b64 a[226:227], v4 offset:392
    ds_read_b128 v[124:127], v5 offset:3456
    v_mfma_f32_16x16x32_bf16 v[12:15], a[196:199], v[104:107], v[12:15]
    s_mul_i32 s31, s3, 32768
    ds_read_b64 a[228:229], v4 offset:896
    v_mfma_f32_16x16x32_bf16 v[16:19], a[196:199], v[108:111], v[16:19]
    s_lshl_b32 s60, s72, 7
    ds_read_b64 a[230:231], v4 offset:904
    v_mfma_f32_16x16x32_bf16 v[16:19], a[192:195], v[112:115], v[16:19]
    s_add_u32 m0, s61, 114688
    ds_read_b128 v[128:131], v5 offset:2944
    buffer_load_dwordx4 v226, s[40:43], s64 offen offset:2048 lds
    v_mfma_f32_16x16x32_bf16 v[16:19], a[200:203], v[104:107], v[16:19]
    s_add_u32 s64, s64, 98304
    ds_read_b64 a[232:233], v4 offset:1408
    v_mfma_f32_16x16x32_bf16 v[20:23], a[196:199], v[112:115], v[20:23]
    s_sub_u32 s35, s64, 1966080
    ds_read_b64 a[234:235], v4 offset:1416
    v_mfma_f32_16x16x32_bf16 v[20:23], a[200:203], v[108:111], v[20:23]
    s_min_u32 s64, s64, s35
    ds_read_b128 v[132:135], v5 offset:2432
    v_mfma_f32_16x16x32_bf16 v[20:23], a[192:195], v[116:119], v[20:23]
    s_add_u32 m0, s61, 126976
    ds_read_b64 a[236:237], v4 offset:1920
    buffer_load_dwordx4 v224, s[40:43], s64 offen offset:0 lds
    v_mfma_f32_16x16x32_bf16 v[20:23], a[204:207], v[104:107], v[20:23]
    s_waitcnt lgkmcnt(11)
    ds_read_b64 a[238:239], v4 offset:1928
    v_mfma_f32_16x16x32_bf16 v[8:11], a[208:211], v[136:139], v[8:11]
    s_add_u32 s31, s31, s60
    ds_read_b128 v[152:155], v5 offset:4032
    ds_read_b64 a[240:241], v4 offset:448
    v_mfma_f32_16x16x32_bf16 v[12:15], a[208:211], v[140:143], v[12:15]
    s_mul_i32 s60, s34, 131072
    ds_read_b64 a[242:243], v4 offset:456
    ds_read_b128 v[156:159], v5 offset:3520
    v_mfma_f32_16x16x32_bf16 v[12:15], a[212:215], v[136:139], v[12:15]
    s_add_u32 m0, s61, 126976
    ds_read_b64 a[244:245], v4 offset:960
    buffer_load_dwordx4 v225, s[40:43], s64 offen offset:1024 lds
    v_mfma_f32_16x16x32_bf16 v[16:19], a[212:215], v[140:143], v[16:19]
    s_add_u32 s10, s31, s60
    ds_read_b64 a[246:247], v4 offset:968
    v_mfma_f32_16x16x32_bf16 v[16:19], a[208:211], v[144:147], v[16:19]
    s_lshl_b32 s63, s3, 10
    ds_read_b128 v[160:163], v5 offset:3008
    v_mfma_f32_16x16x32_bf16 v[16:19], a[216:219], v[136:139], v[16:19]
    s_add_u32 s11, s10, 131072
    ds_read_b64 a[248:249], v4 offset:1472
    v_mfma_f32_16x16x32_bf16 v[20:23], a[212:215], v[144:147], v[20:23]
    s_add_u32 m0, s61, 126976
    ds_read_b64 a[250:251], v4 offset:1480
    buffer_load_dwordx4 v226, s[40:43], s64 offen offset:2048 lds
    v_mfma_f32_16x16x32_bf16 v[20:23], a[216:219], v[140:143], v[20:23]
    s_add_u32 s64, s64, 98304
    ds_read_b128 v[164:167], v5 offset:2496
    v_mfma_f32_16x16x32_bf16 v[20:23], a[208:211], v[148:151], v[20:23]
    s_sub_u32 s35, s64, 1966080
    ds_read_b64 a[252:253], v4 offset:1984
    v_mfma_f32_16x16x32_bf16 v[20:23], a[220:223], v[136:139], v[20:23]
    s_waitcnt lgkmcnt(11)
    ds_read_b64 a[254:255], v4 offset:1992
    v_mfma_f32_16x16x32_bf16 v[8:11], a[224:227], v[120:123], v[8:11]
    s_min_u32 s64, s64, s35
    ds_read_b128 v[112:115], v5 offset:2560
    v_mfma_f32_16x16x32_bf16 v[12:15], a[224:227], v[124:127], v[12:15]
    s_sub_u32 s31, s11, 2621440
    v_mfma_f32_16x16x32_bf16 v[12:15], a[228:231], v[120:123], v[12:15]
    s_min_u32 s11, s11, s31
    ds_read_b128 v[116:119], v5 offset:2048
    v_mfma_f32_16x16x32_bf16 v[16:19], a[228:231], v[124:127], v[16:19]
    s_add_u32 s12, s11, 131072
    v_mfma_f32_16x16x32_bf16 v[16:19], a[224:227], v[128:131], v[16:19]
    s_sub_u32 s31, s12, 2621440
    v_mfma_f32_16x16x32_bf16 v[16:19], a[232:235], v[120:123], v[16:19]
    s_min_u32 s12, s12, s31
    ds_read_b128 v[108:111], v5 offset:3072
    v_mfma_f32_16x16x32_bf16 v[20:23], a[228:231], v[128:131], v[20:23]
    s_add_u32 s13, s12, 131072
    s_waitcnt vmcnt(5)
    v_cmp_ne_u32 vcc, s48, v240
    s_cbranch_vccnz L_chk5_slow
L_chk5_back:
    v_mfma_f32_16x16x32_bf16 v[20:23], a[232:235], v[124:127], v[20:23]
    s_add_u32 m0, s66, 84992
    ds_read_b128 v[104:107], v5 offset:3584
    buffer_load_dwordx4 v248, s[36:39], s67 offen offset:0 sc1 lds
    v_mfma_f32_16x16x32_bf16 v[20:23], a[224:227], v[132:135], v[20:23]
    s_add_u32 s67, s67, 8192
    v_mfma_f32_16x16x32_bf16 v[20:23], a[236:239], v[120:123], v[20:23]
    s_waitcnt lgkmcnt(4)
    v_mfma_f32_16x16x32_bf16 v[8:11], a[240:243], v[152:155], v[8:11]
    s_sub_u32 s31, s13, 2621440
    ds_read_b128 v[120:123], v5 offset:1536
    ds_read_b64 v[56:57], v4 offset:2048
    v_mfma_f32_16x16x32_bf16 v[12:15], a[240:243], v[156:159], v[12:15]
    s_min_u32 s13, s13, s31
    ds_read_b64 v[58:59], v4 offset:2056
    ds_read_b128 v[124:127], v5 offset:1024
    v_mfma_f32_16x16x32_bf16 v[12:15], a[244:247], v[152:155], v[12:15]
    s_add_u32 m0, s66, 89088
    ds_read_b64 v[60:61], v4 offset:2560
    buffer_load_dwordx4 v248, s[36:39], s67 offen offset:0 sc1 lds
    v_mfma_f32_16x16x32_bf16 v[16:19], a[244:247], v[156:159], v[16:19]
    s_sub_u32 s67, s67, 4096
    ds_read_b64 v[62:63], v4 offset:2568
    v_mfma_f32_16x16x32_bf16 v[16:19], a[240:243], v[160:163], v[16:19]
    s_add_u32 s14, s13, 131072
    ds_read_b128 v[128:131], v5 offset:512
    v_mfma_f32_16x16x32_bf16 v[16:19], a[248:251], v[152:155], v[16:19]
    s_sub_u32 s31, s14, 2621440
    ds_read_b64 v[64:65], v4 offset:3072
    v_mfma_f32_16x16x32_bf16 v[20:23], a[244:247], v[160:163], v[20:23]
    s_add_u32 m0, s62, 93184
    ds_read_b64 v[66:67], v4 offset:3080
    buffer_load_dwordx4 v248, s[36:39], s65 offen offset:0 sc1 lds
    v_mfma_f32_16x16x32_bf16 v[20:23], a[248:251], v[156:159], v[20:23]
    s_min_u32 s14, s14, s31
    ds_read_b128 v[132:135], v5 offset:0
    v_mfma_f32_16x16x32_bf16 v[20:23], a[240:243], v[164:167], v[20:23]
    s_add_u32 s15, s14, 131072
    ds_read_b64 v[68:69], v4 offset:3584
    v_mfma_f32_16x16x32_bf16 v[20:23], a[252:255], v[152:155], v[20:23]
    s_waitcnt lgkmcnt(11)
    ds_read_b64 v[70:71], v4 offset:3592
    v_mfma_f32_16x16x32_bf16 v[24:27], a[136:139], v[112:115], 0
    s_add_u32 m0, s62, 93184
    ds_read_b128 v[144:147], v5 offset:2624
    buffer_load_dwordx4 v248, s[36:39], s65 offen offset:1024 sc1 lds
    v_mfma_f32_16x16x32_bf16 v[28:31], a[136:139], v[116:119], 0
    s_add_u32 s65, s65, 2048
    s_barrier
    ds_read_b128 v[148:151], v5 offset:2112
    v_mfma_f32_16x16x32_bf16 v[28:31], a[140:143], v[112:115], v[28:31]
    s_sub_u32 s31, s15, 2621440
    ds_read_b64_tr_b16 a[0:1], v227 offset:36864
    v_mfma_f32_16x16x32_bf16 v[32:35], a[140:143], v[116:119], 0
    s_min_u32 s15, s15, s31
    ds_read_b128 v[140:143], v5 offset:3136
    v_mfma_f32_16x16x32_bf16 v[24:27], a[132:135], v[116:119], v[24:27]
    s_add_u32 s18, s15, 131072
    ds_read_b64_tr_b16 a[2:3], v227 offset:39936
    v_mfma_f32_16x16x32_bf16 v[24:27], a[140:143], v[108:111], v[24:27]
    s_waitcnt lgkmcnt(5)
    ds_read_b128 v[152:155], v5 offset:1600
    v_mfma_f32_16x16x32_bf16 v[32:35], a[136:139], v[120:123], v[32:35]
    s_sub_u32 s31, s18, 2621440
    ds_read_b64_tr_b16 a[4:5], v228 offset:43008
    ds_read_b64_tr_b16 a[6:7], v228 offset:46080
    v_mfma_f32_16x16x32_bf16 v[32:35], v[56:59], v[112:115], v[32:35]
    s_min_u32 s18, s18, s31
    ds_read_b64 v[88:89], v4 offset:2112
    v_mfma_f32_16x16x32_bf16 v[36:39], a[140:143], v[120:123], 0
    s_add_u32 s19, s18, 131072
    ds_read_b64 v[90:91], v4 offset:2120
    v_mfma_f32_16x16x32_bf16 v[36:39], v[56:59], v[116:119], v[36:39]
    s_sub_u32 s31, s19, 2621440
    ds_read_b64_tr_b16 a[8:9], v229 offset:36864
    v_mfma_f32_16x16x32_bf16 v[28:31], a[132:135], v[120:123], v[28:31]
    s_min_u32 s19, s19, s31
    ds_read_b128 v[136:139], v5 offset:3648
    v_mfma_f32_16x16x32_bf16 v[28:31], v[56:59], v[108:111], v[28:31]
    s_add_u32 s20, s19, 131072
    ds_read_b64_tr_b16 a[10:11], v229 offset:39936
    v_mfma_f32_16x16x32_bf16 v[24:27], a[128:131], v[120:123], v[24:27]
    s_sub_u32 s31, s20, 2621440
    ds_read_b128 v[156:159], v5 offset:1088
    v_mfma_f32_16x16x32_bf16 v[24:27], v[244:247], v[120:123], v[24:27]
    s_min_u32 s20, s20, s31
    v_mfma_f32_16x16x32_bf16 v[24:27], v[56:59], v[104:107], v[24:27]
    s_add_u32 s21, s20, 131072
    ds_read_b64 v[92:93], v4 offset:2624
    v_mfma_f32_16x16x32_bf16 v[36:39], a[136:139], v[124:127], v[36:39]
    s_waitcnt lgkmcnt(2)
    s_barrier
    ds_read_b64 v[94:95], v4 offset:2632
    v_mfma_f32_16x16x32_bf16 v[36:39], v[60:63], v[112:115], v[36:39]
    s_add_u32 m0, s61, 139264
    ds_read_b64_tr_b16 a[12:13], v227 offset:49152
    buffer_load_dwordx4 v224, s[40:43], s64 offen offset:0 lds
    v_mfma_f32_16x16x32_bf16 v[32:35], a[132:135], v[124:127], v[32:35]
    s_sub_u32 s31, s21, 2621440
    ds_read_b128 v[160:163], v5 offset:576
    v_mfma_f32_16x16x32_bf16 v[32:35], v[60:63], v[108:111], v[32:35]
    s_min_u32 s21, s21, s31
    ds_read_b64_tr_b16 a[14:15], v227 offset:52224
    v_mfma_f32_16x16x32_bf16 v[28:31], a[128:131], v[124:127], v[28:31]
    s_add_u32 s22, s21, 131072
    ds_read_b64 v[96:97], v4 offset:3136
    v_mfma_f32_16x16x32_bf16 v[28:31], v[244:247], v[124:127], v[28:31]
    s_sub_u32 s31, s22, 2621440
    ds_read_b64_tr_b16 a[16:17], v228 offset:55296
    ds_read_b64_tr_b16 a[18:19], v228 offset:58368
    v_mfma_f32_16x16x32_bf16 v[28:31], v[60:63], v[104:107], v[28:31]
    s_add_u32 m0, s61, 139264
    ds_read_b64 v[98:99], v4 offset:3144
    buffer_load_dwordx4 v225, s[40:43], s64 offen offset:1024 lds
    v_mfma_f32_16x16x32_bf16 v[36:39], a[132:135], v[128:131], v[36:39]
    s_min_u32 s22, s22, s31
    ds_read_b128 v[164:167], v5 offset:64
    v_mfma_f32_16x16x32_bf16 v[36:39], v[64:67], v[108:111], v[36:39]
    s_add_u32 s23, s22, 131072
    ds_read_b64_tr_b16 a[20:21], v229 offset:49152
    v_mfma_f32_16x16x32_bf16 v[32:35], a[128:131], v[128:131], v[32:35]
    s_sub_u32 s31, s23, 2621440
    ds_read_b64 v[100:101], v4 offset:3648
    v_mfma_f32_16x16x32_bf16 v[32:35], v[244:247], v[128:131], v[32:35]
    s_add_u32 m0, s61, 139264
    ds_read_b64_tr_b16 a[22:23], v229 offset:52224
    buffer_load_dwordx4 v226, s[40:43], s64 offen offset:2048 lds
    v_mfma_f32_16x16x32_bf16 v[32:35], v[64:67], v[104:107], v[32:35]
    s_add_u32 s64, s64, 98304
    ds_read_b64 v[102:103], v4 offset:3656
    v_mfma_f32_16x16x32_bf16 v[36:39], a[128:131], v[132:135], v[36:39]
    s_sub_u32 s35, s64, 1966080
    v_mfma_f32_16x16x32_bf16 v[36:39], v[244:247], v[132:135], v[36:39]
    s_min_u32 s64, s64, s35
    v_mfma_f32_16x16x32_bf16 v[36:39], v[68:71], v[104:107], v[36:39]
    s_waitcnt lgkmcnt(1)
    s_barrier
    ds_read_b64_tr_b16 a[24:25], v227 offset:0
    ds_read_b64_tr_b16 a[26:27], v227 offset:3072
    v_mfma_f32_16x16x32_bf16 v[24:27], a[152:155], v[144:147], v[24:27]
    s_add_u32 m0, s61, 151552
    ds_read_b128 v[112:115], v5 offset:2688
    buffer_load_dwordx4 v224, s[40:43], s64 offen offset:0 lds
    v_mfma_f32_16x16x32_bf16 v[28:31], a[152:155], v[148:151], v[28:31]
    s_min_u32 s23, s23, s31
    ds_read_b128 v[116:119], v5 offset:2176
    v_mfma_f32_16x16x32_bf16 v[28:31], a[156:159], v[144:147], v[28:31]
    s_add_u32 s24, s23, 131072
    ds_read_b64_tr_b16 a[28:29], v228 offset:6144
    ds_read_b64_tr_b16 a[30:31], v228 offset:9216
    v_mfma_f32_16x16x32_bf16 v[32:35], a[156:159], v[148:151], v[32:35]
    s_sub_u32 s31, s24, 2621440
    ds_read_b128 v[108:111], v5 offset:3200
    v_mfma_f32_16x16x32_bf16 v[24:27], a[148:151], v[148:151], v[24:27]
    s_add_u32 m0, s61, 151552
    ds_read_b128 v[120:123], v5 offset:1664
    buffer_load_dwordx4 v225, s[40:43], s64 offen offset:1024 lds
    v_mfma_f32_16x16x32_bf16 v[24:27], a[156:159], v[140:143], v[24:27]
    s_min_u32 s24, s24, s31
    ds_read_b64_tr_b16 a[32:33], v229 offset:0
    ds_read_b64_tr_b16 a[34:35], v229 offset:3072
    v_mfma_f32_16x16x32_bf16 v[32:35], a[152:155], v[152:155], v[32:35]
    s_add_u32 s25, s24, 131072
    ds_read_b64 v[56:57], v4 offset:2176
    v_mfma_f32_16x16x32_bf16 v[32:35], v[88:91], v[144:147], v[32:35]
    s_sub_u32 s31, s25, 2621440
    ds_read_b64 v[58:59], v4 offset:2184
    v_mfma_f32_16x16x32_bf16 v[36:39], a[156:159], v[152:155], v[36:39]
    buffer_load_dwordx2 v[242:243], v239, s[36:39], s69 offen sc1
    v_mfma_f32_16x16x32_bf16 v[36:39], v[88:91], v[148:151], v[36:39]
    s_waitcnt lgkmcnt(2)
    s_waitcnt vmcnt(13)
    s_barrier
    ds_read_b128 v[104:107], v5 offset:3712
    v_mfma_f32_16x16x32_bf16 v[28:31], a[148:151], v[152:155], v[28:31]
    s_add_u32 m0, s61, 151552
    ds_read_b128 v[124:127], v5 offset:1152
    buffer_load_dwordx4 v226, s[40:43], s64 offen offset:2048 lds
    v_mfma_f32_16x16x32_bf16 v[28:31], v[88:91], v[140:143], v[28:31]
    ds_read_b64_tr_b16 a[36:37], v227 offset:12288
    ds_read_b64_tr_b16 a[38:39], v227 offset:15360
    v_mfma_f32_16x16x32_bf16 v[24:27], a[144:147], v[152:155], v[24:27]
    s_add_u32 s64, s64, 98304
    ds_read_b64 v[60:61], v4 offset:2688
    v_mfma_f32_16x16x32_bf16 v[24:27], v[88:91], v[136:139], v[24:27]
    s_sub_u32 s35, s64, 1966080
    ds_read_b64 v[62:63], v4 offset:2696
    v_mfma_f32_16x16x32_bf16 v[36:39], a[152:155], v[156:159], v[36:39]
    s_min_u32 s64, s64, s35
    s_add_u32 m0, s61, 102400
    ds_read_b64_tr_b16 a[40:41], v228 offset:18432
    ds_read_b64_tr_b16 a[42:43], v228 offset:21504
    buffer_load_dwordx4 v224, s[40:43], s64 offen offset:0 lds
    v_mfma_f32_16x16x32_bf16 v[36:39], v[92:95], v[144:147], v[36:39]
    s_min_u32 s25, s25, s31
    ds_read_b128 v[128:131], v5 offset:640
    ds_read_b64_tr_b16 a[44:45], v229 offset:12288
    v_mfma_f32_16x16x32_bf16 v[32:35], a[148:151], v[156:159], v[32:35]
    s_waitcnt vmcnt(8)
    s_barrier
    ds_read_b64 v[64:65], v4 offset:3200
    ds_read_b64_tr_b16 a[46:47], v229 offset:15360
    v_mfma_f32_16x16x32_bf16 v[32:35], v[92:95], v[140:143], v[32:35]
    s_add_u32 s26, s25, 131072
    ds_read_b128 v[184:187], v7 offset:0
    ds_read_b128 v[200:203], v7 offset:4096
    v_mfma_f32_16x16x32_bf16 v[28:31], a[144:147], v[156:159], v[28:31]
    s_add_u32 m0, s61, 102400
    ds_read_b64 v[66:67], v4 offset:3208
    buffer_load_dwordx4 v225, s[40:43], s64 offen offset:1024 lds
    v_mfma_f32_16x16x32_bf16 v[28:31], v[92:95], v[136:139], v[28:31]
    s_sub_u32 s31, s26, 2621440
    ds_read_b128 v[132:135], v5 offset:128
    v_mfma_f32_16x16x32_bf16 v[36:39], a[148:151], v[160:163], v[36:39]
    s_waitcnt lgkmcnt(4)
    s_barrier
    ds_read_b64 v[176:177], v249 offset:0
    ds_read_b128 v[188:191], v7 offset:1024
    v_mfma_f32_16x16x32_bf16 v[36:39], v[96:99], v[140:143], v[36:39]
    s_min_u32 s26, s26, s31
    ds_read_b64 v[68:69], v4 offset:3712
    ds_read_b64_tr_b16 a[48:49], v227 offset:24576
    v_mfma_f32_16x16x32_bf16 v[32:35], a[144:147], v[160:163], v[32:35]
    s_add_u32 m0, s61, 102400
    ds_read_b64 v[70:71], v4 offset:3720
    ds_read_b64_tr_b16 a[50:51], v227 offset:27648
    buffer_load_dwordx4 v226, s[40:43], s64 offen offset:2048 lds
    v_mfma_f32_16x16x32_bf16 v[32:35], v[96:99], v[136:139], v[32:35]
    s_add_u32 s64, s64, 98304
    ds_read_b128 v[204:207], v7 offset:5120
    ds_read_b64_tr_b16 a[52:53], v228 offset:30720
    v_mfma_f32_16x16x32_bf16 v[36:39], a[144:147], v[164:167], v[36:39]
    s_sub_u32 s35, s64, 1966080
    ds_read_b64 v[178:179], v249 offset:512
    ds_read_b64_tr_b16 a[54:55], v228 offset:33792
    v_mfma_f32_16x16x32_bf16 v[36:39], v[100:103], v[136:139], v[36:39]
    ds_read_b128 v[192:195], v7 offset:2048
    ds_read_b128 v[208:211], v7 offset:6144
    v_mfma_f32_16x16x32_bf16 v[24:27], a[168:171], v[112:115], v[24:27]
    s_min_u32 s64, s64, s35
    s_add_u32 m0, s61, 114688
    ds_read_b128 v[144:147], v5 offset:2752
    ds_read_b64_tr_b16 a[56:57], v229 offset:24576
    buffer_load_dwordx4 v224, s[40:43], s64 offen offset:0 lds
    v_mfma_f32_16x16x32_bf16 v[28:31], a[168:171], v[116:119], v[28:31]
    s_add_u32 s27, s26, 131072
    ds_read_b128 v[148:151], v5 offset:2240
    ds_read_b64_tr_b16 a[58:59], v229 offset:27648
    v_mfma_f32_16x16x32_bf16 v[28:31], a[172:175], v[112:115], v[28:31]
    s_sub_u32 s31, s27, 2621440
    ds_read_b64 v[180:181], v249 offset:1024
    ds_read_b128 v[196:199], v7 offset:3072
    v_mfma_f32_16x16x32_bf16 v[32:35], a[172:175], v[116:119], v[32:35]
    s_min_u32 s27, s27, s31
    ds_read_b128 v[140:143], v5 offset:3264
    v_mfma_f32_16x16x32_bf16 v[24:27], a[164:167], v[116:119], v[24:27]
    s_add_u32 m0, s61, 114688
    ds_read_b128 v[152:155], v5 offset:1728
    buffer_load_dwordx4 v225, s[40:43], s64 offen offset:1024 lds
    v_mfma_f32_16x16x32_bf16 v[24:27], a[172:175], v[108:111], v[24:27]
    s_waitcnt lgkmcnt(4)
    s_waitcnt vmcnt(9)
    s_barrier
    ds_read_b128 v[212:215], v7 offset:7168
    ds_read_b64 v[182:183], v249 offset:1536
    v_mfma_f32_16x16x32_bf16 v[32:35], a[168:171], v[120:123], v[32:35]
    s_add_u32 s44, s27, 131072
    ds_read_b64 v[88:89], v4 offset:2240
    v_mfma_f32_16x16x32_bf16 v[32:35], v[56:59], v[112:115], v[32:35]
    s_sub_u32 s31, s44, 2621440
    ds_read_b64 v[90:91], v4 offset:2248
    v_mfma_f32_16x16x32_bf16 v[36:39], a[172:175], v[120:123], v[36:39]
    s_add_u32 m0, s61, 114688
    ds_read_b64_tr_b16 a[60:61], v227 offset:36864
    ds_read_b64_tr_b16 a[62:63], v227 offset:39936
    buffer_load_dwordx4 v226, s[40:43], s64 offen offset:2048 lds
    v_mfma_f32_16x16x32_bf16 v[36:39], v[56:59], v[116:119], v[36:39]
    s_add_u32 s64, s64, 98304
    ds_read_b128 v[136:139], v5 offset:3776
    ds_read_b64_tr_b16 a[64:65], v228 offset:43008
    v_mfma_f32_16x16x32_bf16 v[28:31], a[164:167], v[120:123], v[28:31]
    s_sub_u32 s35, s64, 1966080
    ds_read_b128 v[156:159], v5 offset:1216
    s_waitcnt vmcnt(7)
    v_cmp_ne_u32 vcc, s48, v243
    s_cbranch_vccnz L_m_slow
L_m_back:
    v_readlane_b32 s50, v242, 2
    v_readlane_b32 s51, v242, 3
    v_readlane_b32 s52, v242, 0
    v_readlane_b32 s53, v242, 1
    v_mov_b32 v253, s51
    v_mul_f32 v252, s50, v253
    v_mul_f32 v251, s52, v252
    v_mul_f32 v252, s53, v252
    v_lshlrev_b32 v232, 16, v176
    v_and_b32 v233, 0xffff0000, v176
    v_lshlrev_b32 v234, 16, v177
    v_and_b32 v235, 0xffff0000, v177
    v_pk_fma_f32 v[184:185], v[232:233], v[184:185], v[200:201]
    v_pk_fma_f32 v[186:187], v[234:235], v[186:187], v[202:203]
    v_pk_mul_f32 v[232:233], v[232:233], v[252:253] op_sel:[0,1] op_sel_hi:[1,1]
    v_pk_mul_f32 v[234:235], v[234:235], v[252:253] op_sel:[0,1] op_sel_hi:[1,1]
    v_pk_fma_f32 v[184:185], v[184:185], v[250:251], v[252:253] op_sel:[0,1,0] op_sel_hi:[1,1,0]
    v_pk_fma_f32 v[186:187], v[186:187], v[250:251], v[252:253] op_sel:[0,1,0] op_sel_hi:[1,1,0]
    v_pk_fma_f32 v[184:185], v[8:9], v[184:185], v[232:233]
    v_pk_fma_f32 v[186:187], v[10:11], v[186:187], v[234:235]
    v_cvt_pk_bf16_f32 v200, v184, v185
    v_cvt_pk_bf16_f32 v201, v186, v187
    v_lshlrev_b32 v236, 16, v178
    v_and_b32 v237, 0xffff0000, v178
    v_lshlrev_b32 v238, 16, v179
    v_and_b32 v239, 0xffff0000, v179
    v_pk_fma_f32 v[188:189], v[236:237], v[188:189], v[204:205]
    v_pk_fma_f32 v[190:191], v[238:239], v[190:191], v[206:207]
    v_pk_mul_f32 v[236:237], v[236:237], v[252:253] op_sel:[0,1] op_sel_hi:[1,1]
    v_pk_mul_f32 v[238:239], v[238:239], v[252:253] op_sel:[0,1] op_sel_hi:[1,1]
    v_pk_fma_f32 v[188:189], v[188:189], v[250:251], v[252:253] op_sel:[0,1,0] op_sel_hi:[1,1,0]
    v_pk_fma_f32 v[190:191], v[190:191], v[250:251], v[252:253] op_sel:[0,1,0] op_sel_hi:[1,1,0]
    v_pk_fma_f32 v[188:189], v[12:13], v[188:189], v[236:237]
    v_pk_fma_f32 v[190:191], v[14:15], v[190:191], v[238:239]
    v_cvt_pk_bf16_f32 v202, v188, v189
    v_cvt_pk_bf16_f32 v203, v190, v191
    s_nop 0
    v_permlane16_swap_b32 v200, v202
    v_permlane16_swap_b32 v201, v203
    buffer_store_dwordx4 v[200:203], v6, s[36:39], s68 offen offset:0 sc1
    s_waitcnt lgkmcnt(12)
    v_lshlrev_b32 v232, 16, v180
    v_and_b32 v233, 0xffff0000, v180
    v_lshlrev_b32 v234, 16, v181
    v_and_b32 v235, 0xffff0000, v181
    v_pk_fma_f32 v[192:193], v[232:233], v[192:193], v[208:209]
    v_pk_fma_f32 v[194:195], v[234:235], v[194:195], v[210:211]
    v_pk_mul_f32 v[232:233], v[232:233], v[252:253] op_sel:[0,1] op_sel_hi:[1,1]
    v_pk_mul_f32 v[234:235], v[234:235], v[252:253] op_sel:[0,1] op_sel_hi:[1,1]
    v_pk_fma_f32 v[192:193], v[192:193], v[250:251], v[252:253] op_sel:[0,1,0] op_sel_hi:[1,1,0]
    v_pk_fma_f32 v[194:195], v[194:195], v[250:251], v[252:253] op_sel:[0,1,0] op_sel_hi:[1,1,0]
    v_pk_fma_f32 v[192:193], v[16:17], v[192:193], v[232:233]
    v_pk_fma_f32 v[194:195], v[18:19], v[194:195], v[234:235]
    v_cvt_pk_bf16_f32 v208, v192, v193
    v_cvt_pk_bf16_f32 v209, v194, v195
    s_waitcnt lgkmcnt(7)
    v_lshlrev_b32 v236, 16, v182
    v_and_b32 v237, 0xffff0000, v182
    v_lshlrev_b32 v238, 16, v183
    v_and_b32 v239, 0xffff0000, v183
    v_pk_fma_f32 v[196:197], v[236:237], v[196:197], v[212:213]
    v_pk_fma_f32 v[198:199], v[238:239], v[198:199], v[214:215]
    v_pk_mul_f32 v[236:237], v[236:237], v[252:253] op_sel:[0,1] op_sel_hi:[1,1]
    v_pk_mul_f32 v[238:239], v[238:239], v[252:253] op_sel:[0,1] op_sel_hi:[1,1]
    v_pk_fma_f32 v[196:197], v[196:197], v[250:251], v[252:253] op_sel:[0,1,0] op_sel_hi:[1,1,0]
    v_pk_fma_f32 v[198:199], v[198:199], v[250:251], v[252:253] op_sel:[0,1,0] op_sel_hi:[1,1,0]
    v_pk_fma_f32 v[196:197], v[20:21], v[196:197], v[236:237]
    v_pk_fma_f32 v[198:199], v[22:23], v[198:199], v[238:239]
    v_cvt_pk_bf16_f32 v210, v196, v197
    v_cvt_pk_bf16_f32 v211, v198, v199
    s_nop 0
    v_permlane16_swap_b32 v208, v210
    v_permlane16_swap_b32 v209, v211
    buffer_store_dwordx4 v[208:211], v6, s[36:39], s68 offen offset:1024 sc1
    v_mfma_f32_16x16x32_bf16 v[28:31], v[56:59], v[108:111], v[28:31]
    v_mov_b32 v239, 126976
    v_mov_b32 v237, 1024
    v_mfma_f32_16x16x32_bf16 v[24:27], a[160:163], v[120:123], v[24:27]
    s_min_u32 s64, s64, s35
    s_add_u32 m0, s61, 126976
    ds_read_b64 v[92:93], v4 offset:2752
    ds_read_b64_tr_b16 a[66:67], v228 offset:46080
    buffer_load_dwordx4 v224, s[40:43], s64 offen offset:0 lds
    v_mfma_f32_16x16x32_bf16 v[24:27], v[56:59], v[104:107], v[24:27]
    s_min_u32 s44, s44, s31
    ds_read_b64 v[94:95], v4 offset:2760
    ds_read_b64_tr_b16 a[68:69], v229 offset:36864
    v_mfma_f32_16x16x32_bf16 v[36:39], a[168:171], v[124:127], v[36:39]
    s_add_u32 s45, s44, 131072
    v_cmp_lt_u32 vcc, 7, v1
    s_nop 1
    v_cndmask_b32 v239, v239, v237, vcc
    v_mfma_f32_16x16x32_bf16 v[36:39], v[60:63], v[112:115], v[36:39]
    s_sub_u32 s31, s45, 2621440
    ds_read_b128 v[160:163], v5 offset:704
    v_add_u32 v230, v230, v239
    v_mfma_f32_16x16x32_bf16 v[32:35], a[164:167], v[124:127], v[32:35]
    s_add_u32 m0, s61, 126976
    ds_read_b64 v[96:97], v4 offset:3264
    v_min_u32 v239, 25, v1
    buffer_load_dwordx4 v225, s[40:43], s64 offen offset:1024 lds
    v_mfma_f32_16x16x32_bf16 v[32:35], v[60:63], v[108:111], v[32:35]
    s_min_u32 s45, s45, s31
    v_lshlrev_b32 v239, 7, v239
    v_add_u32 v239, 101376, v239
    v_mfma_f32_16x16x32_bf16 v[28:31], a[160:163], v[124:127], v[28:31]
    s_add_u32 s46, s45, 131072
    ds_read_b64 v[98:99], v4 offset:3272
    ds_read_b64_tr_b16 a[70:71], v229 offset:39936
    v_mfma_f32_16x16x32_bf16 v[28:31], v[60:63], v[104:107], v[28:31]
    s_sub_u32 s31, s46, 2621440
    ds_read_b128 v[164:167], v5 offset:192
    v_mfma_f32_16x16x32_bf16 v[36:39], a[164:167], v[128:131], v[36:39]
    s_min_u32 s46, s46, s31
    v_cmp_lt_u32 vcc, 15, v1
    s_nop 1
    v_cndmask_b32 v238, v230, v239, vcc
    v_mfma_f32_16x16x32_bf16 v[36:39], v[64:67], v[108:111], v[36:39]
    ds_read_b64 v[100:101], v4 offset:3776
    buffer_load_dword v240, v238, s[36:39], s17 offen sc1
    v_mfma_f32_16x16x32_bf16 v[32:35], a[160:163], v[128:131], v[32:35]
    s_waitcnt lgkmcnt(2)
    s_waitcnt vmcnt(11)
    s_barrier
    ds_read_b64 v[102:103], v4 offset:3784
    v_mfma_f32_16x16x32_bf16 v[32:35], v[64:67], v[104:107], v[32:35]
    s_add_u32 s47, s46, 131072
    ds_read_b64_tr_b16 a[72:73], v227 offset:49152
    v_mfma_f32_16x16x32_bf16 v[36:39], a[160:163], v[132:135], v[36:39]
    s_add_u32 m0, s61, 126976
    ds_read_b64_tr_b16 a[74:75], v227 offset:52224
    buffer_load_dwordx4 v226, s[40:43], s64 offen offset:2048 lds
    v_mfma_f32_16x16x32_bf16 v[36:39], v[68:71], v[104:107], v[36:39]
    ds_read_b64_tr_b16 a[76:77], v228 offset:55296
    ds_read_b64_tr_b16 a[78:79], v228 offset:58368
    v_mfma_f32_16x16x32_bf16 v[24:27], a[184:187], v[144:147], v[24:27]
    s_add_u32 s64, s64, 98304
    ds_read_b128 v[112:115], v5 offset:2816
    v_mfma_f32_16x16x32_bf16 v[28:31], a[184:187], v[148:151], v[28:31]
    s_sub_u32 s35, s64, 1966080
    ds_read_b128 v[116:119], v5 offset:2304
    v_mfma_f32_16x16x32_bf16 v[28:31], a[188:191], v[144:147], v[28:31]
    s_min_u32 s64, s64, s35
    ds_read_b64_tr_b16 a[80:81], v229 offset:49152
    ds_read_b64_tr_b16 a[82:83], v229 offset:52224
    v_mfma_f32_16x16x32_bf16 v[32:35], a[188:191], v[148:151], v[32:35]
    s_add_u32 m0, s61, 139264
    ds_read_b128 v[108:111], v5 offset:3328
    buffer_load_dwordx4 v224, s[40:43], s64 offen offset:0 lds
    v_mfma_f32_16x16x32_bf16 v[24:27], a[180:183], v[148:151], v[24:27]
    s_sub_u32 s31, s47, 2621440
    ds_read_b128 v[120:123], v5 offset:1792
    v_mfma_f32_16x16x32_bf16 v[24:27], a[188:191], v[140:143], v[24:27]
    s_min_u32 s47, s47, s31
    v_mfma_f32_16x16x32_bf16 v[32:35], a[184:187], v[152:155], v[32:35]
    s_waitcnt lgkmcnt(2)
    s_waitcnt vmcnt(10)
    s_barrier
    ds_read_b64 v[56:57], v4 offset:2304
    v_mfma_f32_16x16x32_bf16 v[32:35], v[88:91], v[144:147], v[32:35]
    s_add_u32 m0, s61, 139264
    ds_read_b64 v[58:59], v4 offset:2312
    buffer_load_dwordx4 v225, s[40:43], s64 offen offset:1024 lds
    v_mfma_f32_16x16x32_bf16 v[36:39], a[188:191], v[152:155], v[36:39]
    ds_read_b64_tr_b16 a[84:85], v227 offset:0
    ds_read_b64_tr_b16 a[86:87], v227 offset:3072
    v_mfma_f32_16x16x32_bf16 v[36:39], v[88:91], v[148:151], v[36:39]
    ds_read_b128 v[104:107], v5 offset:3840
    v_mfma_f32_16x16x32_bf16 v[28:31], a[180:183], v[152:155], v[28:31]
    ds_read_b128 v[124:127], v5 offset:1280
    v_mfma_f32_16x16x32_bf16 v[28:31], v[88:91], v[140:143], v[28:31]
    ds_read_b64_tr_b16 a[88:89], v228 offset:6144
    ds_read_b64_tr_b16 a[90:91], v228 offset:9216
    v_mfma_f32_16x16x32_bf16 v[24:27], a[176:179], v[152:155], v[24:27]
    s_add_u32 m0, s61, 139264
    ds_read_b64 v[60:61], v4 offset:2816
    buffer_load_dwordx4 v226, s[40:43], s64 offen offset:2048 lds
    v_mfma_f32_16x16x32_bf16 v[24:27], v[88:91], v[136:139], v[24:27]
    s_add_u32 s64, s64, 98304
    ds_read_b64 v[62:63], v4 offset:2824
    v_mfma_f32_16x16x32_bf16 v[36:39], a[184:187], v[156:159], v[36:39]
    s_waitcnt vmcnt(7)
    s_barrier
    s_cmp_eq_u32 s3, 0
    s_cbranch_scc0 L_wf6
    s_and_b32 s54, s70, 1
    s_mul_i32 s54, s54, -60
    v_mov_b32 v254, s54
    s_lshl_b32 s54, s70, 6
    v_add_u32 v254, s54, v254
    s_mov_b32 s54, 23312384
    v_mov_b32 v255, s48
    s_mov_b64 exec, 1
    buffer_store_dword v255, v254, s[36:39], s54 offen sc1
    s_mov_b64 exec, -1
L_wf6:
    ds_read_b64_tr_b16 a[92:93], v229 offset:0
    ds_read_b64_tr_b16 a[94:95], v229 offset:3072
    v_mfma_f32_16x16x32_bf16 v[36:39], v[92:95], v[144:147], v[36:39]
    s_sub_u32 s35, s64, 1966080
    ds_read_b128 v[128:131], v5 offset:768
    v_mfma_f32_16x16x32_bf16 v[32:35], a[180:183], v[156:159], v[32:35]
    s_min_u32 s64, s64, s35
    s_add_u32 m0, s61, 151552
    ds_read_b64 v[64:65], v4 offset:3328
    buffer_load_dwordx4 v224, s[40:43], s64 offen offset:0 lds
    v_mfma_f32_16x16x32_bf16 v[32:35], v[92:95], v[140:143], v[32:35]
    v_mfma_f32_16x16x32_bf16 v[28:31], a[176:179], v[156:159], v[28:31]
    s_waitcnt lgkmcnt(2)
    s_barrier
    ds_read_b64 v[66:67], v4 offset:3336
    v_mfma_f32_16x16x32_bf16 v[28:31], v[92:95], v[136:139], v[28:31]
    ds_read_b128 v[132:135], v5 offset:256
    v_mfma_f32_16x16x32_bf16 v[36:39], a[180:183], v[160:163], v[36:39]
    ds_read_b64_tr_b16 a[96:97], v227 offset:12288
    ds_read_b64_tr_b16 a[98:99], v227 offset:15360
    v_mfma_f32_16x16x32_bf16 v[36:39], v[96:99], v[140:143], v[36:39]
    s_add_u32 m0, s61, 151552
    ds_read_b64 v[68:69], v4 offset:3840
    buffer_load_dwordx4 v225, s[40:43], s64 offen offset:1024 lds
    v_mfma_f32_16x16x32_bf16 v[32:35], a[176:179], v[160:163], v[32:35]
    ds_read_b64 v[70:71], v4 offset:3848
    v_mfma_f32_16x16x32_bf16 v[32:35], v[96:99], v[136:139], v[32:35]
    ds_read_b64_tr_b16 a[100:101], v228 offset:18432
    v_mfma_f32_16x16x32_bf16 v[36:39], a[176:179], v[164:167], v[36:39]
    ds_read_b64_tr_b16 a[102:103], v228 offset:21504
    s_waitcnt vmcnt(6)
    v_cmp_ne_u32 vcc, s48, v240
    s_cbranch_vccnz L_chk7_slow
L_chk7_back:
    v_mfma_f32_16x16x32_bf16 v[36:39], v[100:103], v[136:139], v[36:39]
    ds_read_b64_tr_b16 a[104:105], v229 offset:12288
    ds_read_b64_tr_b16 a[106:107], v229 offset:15360
    v_mfma_f32_16x16x32_bf16 v[24:27], a[200:203], v[112:115], v[24:27]
    s_add_u32 m0, s66, 84992
    ds_read_b128 v[144:147], v5 offset:2880
    buffer_load_dwordx4 v248, s[36:39], s67 offen offset:0 sc1 lds
    v_mfma_f32_16x16x32_bf16 v[28:31], a[200:203], v[116:119], v[28:31]
    s_add_u32 s67, s67, 8192
    ds_read_b128 v[148:151], v5 offset:2368
    v_mfma_f32_16x16x32_bf16 v[28:31], a[204:207], v[112:115], v[28:31]
    v_mfma_f32_16x16x32_bf16 v[32:35], a[204:207], v[116:119], v[32:35]
    s_waitcnt lgkmcnt(2)
    s_waitcnt vmcnt(6)
    s_barrier
    ds_read_b128 v[140:143], v5 offset:3392
    v_mfma_f32_16x16x32_bf16 v[24:27], a[196:199], v[116:119], v[24:27]
    s_add_u32 m0, s66, 89088
    ds_read_b128 v[152:155], v5 offset:1856
    buffer_load_dwordx4 v248, s[36:39], s67 offen offset:0 sc1 lds
    v_mfma_f32_16x16x32_bf16 v[24:27], a[204:207], v[108:111], v[24:27]
    s_sub_u32 s67, s67, 4096
    ds_read_b64_tr_b16 a[108:109], v227 offset:24576
    ds_read_b64_tr_b16 a[110:111], v227 offset:27648
    v_mfma_f32_16x16x32_bf16 v[32:35], a[200:203], v[120:123], v[32:35]
    ds_read_b64 v[88:89], v4 offset:2368
    v_mfma_f32_16x16x32_bf16 v[32:35], v[56:59], v[112:115], v[32:35]
    ds_read_b64 v[90:91], v4 offset:2376
    v_mfma_f32_16x16x32_bf16 v[36:39], a[204:207], v[120:123], v[36:39]
    ds_read_b64_tr_b16 a[112:113], v228 offset:30720
    ds_read_b64_tr_b16 a[114:115], v228 offset:33792
    v_mfma_f32_16x16x32_bf16 v[36:39], v[56:59], v[116:119], v[36:39]
    s_add_u32 m0, s62, 93184
    ds_read_b128 v[136:139], v5 offset:3904
    buffer_load_dwordx4 v248, s[36:39], s65 offen offset:0 sc1 lds
    v_mfma_f32_16x16x32_bf16 v[28:31], a[196:199], v[120:123], v[28:31]
    ds_read_b128 v[156:159], v5 offset:1344
    v_mfma_f32_16x16x32_bf16 v[28:31], v[56:59], v[108:111], v[28:31]
    ds_read_b64_tr_b16 a[116:117], v229 offset:24576
    ds_read_b64_tr_b16 a[118:119], v229 offset:27648
    v_mfma_f32_16x16x32_bf16 v[24:27], a[192:195], v[120:123], v[24:27]
    ds_read_b64 v[92:93], v4 offset:2880
    v_mfma_f32_16x16x32_bf16 v[24:27], v[56:59], v[104:107], v[24:27]
    s_add_u32 m0, s62, 93184
    ds_read_b64 v[94:95], v4 offset:2888
    buffer_load_dwordx4 v248, s[36:39], s65 offen offset:1024 sc1 lds
    v_mfma_f32_16x16x32_bf16 v[36:39], a[200:203], v[124:127], v[36:39]
    v_mfma_f32_16x16x32_bf16 v[36:39], v[60:63], v[112:115], v[36:39]
    s_waitcnt lgkmcnt(2)
    s_waitcnt vmcnt(6)
    s_barrier
    ds_read_b128 v[160:163], v5 offset:832
    v_mfma_f32_16x16x32_bf16 v[32:35], a[196:199], v[124:127], v[32:35]
    s_lshl_b32 s65, s75, 2
    s_add_u32 s65, s65, s3
    ds_read_b64 v[96:97], v4 offset:3392
    v_mfma_f32_16x16x32_bf16 v[32:35], v[60:63], v[108:111], v[32:35]
    ds_read_b64_tr_b16 a[120:121], v227 offset:36864
    ds_read_b64_tr_b16 a[122:123], v227 offset:39936
    v_mfma_f32_16x16x32_bf16 v[28:31], a[192:195], v[124:127], v[28:31]
    ds_read_b64 v[98:99], v4 offset:3400
    buffer_load_dword v220, v220, s[36:39], s77 offen sc1
    v_mfma_f32_16x16x32_bf16 v[28:31], v[60:63], v[104:107], v[28:31]
    s_mul_i32 s65, s65, 61440
    s_add_u32 s65, s65, 14417920
    ds_read_b128 v[164:167], v5 offset:320
    v_mfma_f32_16x16x32_bf16 v[36:39], a[196:199], v[128:131], v[36:39]
    s_mov_b32 s16, 0
    ds_read_b64_tr_b16 a[124:125], v228 offset:43008
    ds_read_b64_tr_b16 a[126:127], v228 offset:46080
    v_mfma_f32_16x16x32_bf16 v[36:39], v[64:67], v[108:111], v[36:39]
    ds_read_b64 v[100:101], v4 offset:3904
    buffer_load_dword v221, v221, s[36:39], s77 offen sc1
    v_mfma_f32_16x16x32_bf16 v[32:35], a[192:195], v[128:131], v[32:35]
    s_and_b32 s16, s16, 3
    s_add_u32 s62, s16, 0
    ds_read_b64 v[102:103], v4 offset:3912
    v_mfma_f32_16x16x32_bf16 v[32:35], v[64:67], v[104:107], v[32:35]
    ds_read_b64_tr_b16 a[128:129], v229 offset:36864
    buffer_load_dword v222, v222, s[36:39], s77 offen sc1
    v_mfma_f32_16x16x32_bf16 v[36:39], a[192:195], v[132:135], v[36:39]
    s_add_u32 m0, s61, 151552
    s_and_b32 s62, s62, 3
    ds_read_b64_tr_b16 a[130:131], v229 offset:39936
    v_mfma_f32_16x16x32_bf16 v[36:39], v[68:71], v[104:107], v[36:39]
    buffer_load_dwordx4 v226, s[40:43], s64 offen offset:2048 lds
    v_mfma_f32_16x16x32_bf16 v[24:27], a[216:219], v[144:147], v[24:27]
    s_add_u32 s64, s64, 98304
    s_mul_i32 s62, s62, 15360
    ds_read_b128 v[112:115], v5 offset:2944
    v_mfma_f32_16x16x32_bf16 v[28:31], a[216:219], v[148:151], v[28:31]
    s_sub_u32 s35, s64, 1966080
    s_add_u32 s62, s62, s65
    ds_read_b128 v[116:119], v5 offset:2432
    v_mfma_f32_16x16x32_bf16 v[28:31], a[220:223], v[144:147], v[28:31]
    s_min_u32 s64, s64, s35
    v_mfma_f32_16x16x32_bf16 v[32:35], a[220:223], v[148:151], v[32:35]
    s_add_u32 m0, s61, 102400
    ds_read_b128 v[108:111], v5 offset:3456
    buffer_load_dwordx4 v224, s[40:43], s64 offen offset:0 lds
    v_mfma_f32_16x16x32_bf16 v[24:27], a[212:215], v[148:151], v[24:27]
    ds_read_b128 v[120:123], v5 offset:1920
    v_mfma_f32_16x16x32_bf16 v[24:27], a[220:223], v[140:143], v[24:27]
    v_mfma_f32_16x16x32_bf16 v[32:35], a[216:219], v[152:155], v[32:35]
    ds_read_b64 v[56:57], v4 offset:2432
    v_mfma_f32_16x16x32_bf16 v[32:35], v[88:91], v[144:147], v[32:35]
    s_add_u32 m0, s61, 102400
    ds_read_b64 v[58:59], v4 offset:2440
    buffer_load_dwordx4 v225, s[40:43], s64 offen offset:1024 lds
    v_mfma_f32_16x16x32_bf16 v[36:39], a[220:223], v[152:155], v[36:39]
    v_mfma_f32_16x16x32_bf16 v[36:39], v[88:91], v[148:151], v[36:39]
    ds_read_b128 v[104:107], v5 offset:3968
    v_mfma_f32_16x16x32_bf16 v[28:31], a[212:215], v[152:155], v[28:31]
    s_add_u32 m0, s61, 102400
    ds_read_b128 v[124:127], v5 offset:1408
    v_mfma_f32_16x16x32_bf16 v[28:31], v[88:91], v[140:143], v[28:31]
    s_waitcnt lgkmcnt(10)
    buffer_load_dwordx4 v226, s[40:43], s64 offen offset:2048 lds
    v_mfma_f32_16x16x32_bf16 v[24:27], a[208:211], v[152:155], v[24:27]
    s_add_u32 s64, s64, 98304
    ds_read_b64 v[60:61], v4 offset:2944
    v_mfma_f32_16x16x32_bf16 v[24:27], v[88:91], v[136:139], v[24:27]
    s_sub_u32 s35, s64, 1966080
    ds_read_b64 v[62:63], v4 offset:2952
    v_mfma_f32_16x16x32_bf16 v[36:39], a[216:219], v[156:159], v[36:39]
    s_min_u32 s64, s64, s35
    v_mfma_f32_16x16x32_bf16 v[36:39], v[92:95], v[144:147], v[36:39]
    s_add_u32 m0, s61, 114688
    ds_read_b128 v[128:131], v5 offset:896
    buffer_load_dwordx4 v224, s[40:43], s64 offen offset:0 lds
    v_mfma_f32_16x16x32_bf16 v[32:35], a[212:215], v[156:159], v[32:35]
    ds_read_b64 v[64:65], v4 offset:3456
    v_mfma_f32_16x16x32_bf16 v[32:35], v[92:95], v[140:143], v[32:35]
    v_mfma_f32_16x16x32_bf16 v[28:31], a[208:211], v[156:159], v[28:31]
    ds_read_b64 v[66:67], v4 offset:3464
    v_mfma_f32_16x16x32_bf16 v[28:31], v[92:95], v[136:139], v[28:31]
    s_add_u32 m0, s61, 114688
    ds_read_b128 v[132:135], v5 offset:384
    buffer_load_dwordx4 v225, s[40:43], s64 offen offset:1024 lds
    v_mfma_f32_16x16x32_bf16 v[36:39], a[212:215], v[160:163], v[36:39]
    v_mfma_f32_16x16x32_bf16 v[36:39], v[96:99], v[140:143], v[36:39]
    ds_read_b64 v[68:69], v4 offset:3968
    v_mfma_f32_16x16x32_bf16 v[32:35], a[208:211], v[160:163], v[32:35]
    ds_read_b64 v[70:71], v4 offset:3976
    v_mfma_f32_16x16x32_bf16 v[32:35], v[96:99], v[136:139], v[32:35]
    s_waitcnt lgkmcnt(14)
    s_waitcnt vmcnt(5)
    s_barrier
    ds_read_b64_tr_b16 a[132:133], v227 offset:49152
    v_mfma_f32_16x16x32_bf16 v[36:39], a[208:211], v[164:167], v[36:39]
    s_add_u32 m0, s61, 114688
    ds_read_b64_tr_b16 a[134:135], v227 offset:52224
    buffer_load_dwordx4 v226, s[40:43], s64 offen offset:2048 lds
    v_mfma_f32_16x16x32_bf16 v[36:39], v[100:103], v[136:139], v[36:39]
    s_waitcnt lgkmcnt(12)
    ds_read_b64_tr_b16 a[136:137], v228 offset:55296
    ds_read_b64_tr_b16 a[138:139], v228 offset:58368
    v_mfma_f32_16x16x32_bf16 v[24:27], a[232:235], v[112:115], v[24:27]
    s_add_u32 s64, s64, 98304
    ds_read_b128 v[144:147], v5 offset:3008
    v_mfma_f32_16x16x32_bf16 v[28:31], a[232:235], v[116:119], v[28:31]
    s_sub_u32 s35, s64, 1966080
    ds_read_b128 v[148:151], v5 offset:2496
    v_mfma_f32_16x16x32_bf16 v[28:31], a[236:239], v[112:115], v[28:31]
    s_min_u32 s64, s64, s35
    ds_read_b64_tr_b16 a[140:141], v229 offset:49152
    ds_read_b64_tr_b16 a[142:143], v229 offset:52224
    v_mfma_f32_16x16x32_bf16 v[32:35], a[236:239], v[116:119], v[32:35]
    s_add_u32 m0, s61, 126976
    ds_read_b128 v[140:143], v5 offset:3520
    buffer_load_dwordx4 v224, s[40:43], s64 offen offset:0 lds
    v_mfma_f32_16x16x32_bf16 v[24:27], a[228:231], v[116:119], v[24:27]
    ds_read_b128 v[152:155], v5 offset:1984
    v_mfma_f32_16x16x32_bf16 v[24:27], a[236:239], v[108:111], v[24:27]
    v_mfma_f32_16x16x32_bf16 v[32:35], a[232:235], v[120:123], v[32:35]
    ds_read_b64 v[88:89], v4 offset:2496
    v_mfma_f32_16x16x32_bf16 v[32:35], v[56:59], v[112:115], v[32:35]
    s_add_u32 m0, s61, 126976
    ds_read_b64 v[90:91], v4 offset:2504
    buffer_load_dwordx4 v225, s[40:43], s64 offen offset:1024 lds
    v_mfma_f32_16x16x32_bf16 v[36:39], a[236:239], v[120:123], v[36:39]
    v_mfma_f32_16x16x32_bf16 v[36:39], v[56:59], v[116:119], v[36:39]
    s_waitcnt lgkmcnt(4)
    s_waitcnt vmcnt(5)
    s_barrier
    ds_read_b128 v[136:139], v5 offset:4032
    v_mfma_f32_16x16x32_bf16 v[28:31], a[228:231], v[120:123], v[28:31]
    ds_read_b128 v[156:159], v5 offset:1472
    v_mfma_f32_16x16x32_bf16 v[28:31], v[56:59], v[108:111], v[28:31]
    ds_read_b64_tr_b16 a[144:145], v227 offset:0
    ds_read_b64_tr_b16 a[146:147], v227 offset:3072
    v_mfma_f32_16x16x32_bf16 v[24:27], a[224:227], v[120:123], v[24:27]
    s_add_u32 m0, s61, 126976
    ds_read_b64 v[92:93], v4 offset:3008
    buffer_load_dwordx4 v226, s[40:43], s64 offen offset:2048 lds
    v_mfma_f32_16x16x32_bf16 v[24:27], v[56:59], v[104:107], v[24:27]
    s_add_u32 s64, s64, 98304
    ds_read_b64 v[94:95], v4 offset:3016
    v_mfma_f32_16x16x32_bf16 v[36:39], a[232:235], v[124:127], v[36:39]
    s_sub_u32 s35, s64, 1966080
    ds_read_b64_tr_b16 a[148:149], v228 offset:6144
    ds_read_b64_tr_b16 a[150:151], v228 offset:9216
    v_mfma_f32_16x16x32_bf16 v[36:39], v[60:63], v[112:115], v[36:39]
    s_min_u32 s64, s64, s35
    ds_read_b128 v[160:163], v5 offset:960
    v_mfma_f32_16x16x32_bf16 v[32:35], a[228:231], v[124:127], v[32:35]
    s_add_u32 m0, s61, 139264
    ds_read_b64 v[96:97], v4 offset:3520
    buffer_load_dwordx4 v224, s[40:43], s64 offen offset:0 lds
    v_mfma_f32_16x16x32_bf16 v[32:35], v[60:63], v[108:111], v[32:35]
    ds_read_b64_tr_b16 a[152:153], v229 offset:0
    ds_read_b64_tr_b16 a[154:155], v229 offset:3072
    v_mfma_f32_16x16x32_bf16 v[28:31], a[224:227], v[124:127], v[28:31]
    ds_read_b64 v[98:99], v4 offset:3528
    v_mfma_f32_16x16x32_bf16 v[28:31], v[60:63], v[104:107], v[28:31]
    s_add_u32 m0, s61, 139264
    ds_read_b128 v[164:167], v5 offset:448
    v_mfma_f32_16x16x32_bf16 v[36:39], a[228:231], v[128:131], v[36:39]
    buffer_load_dwordx4 v225, s[40:43], s64 offen offset:1024 lds
    v_mfma_f32_16x16x32_bf16 v[36:39], v[64:67], v[108:111], v[36:39]
    ds_read_b64 v[100:101], v4 offset:4032
    v_mfma_f32_16x16x32_bf16 v[32:35], a[224:227], v[128:131], v[32:35]
    ds_read_b64 v[102:103], v4 offset:4040
    v_mfma_f32_16x16x32_bf16 v[32:35], v[64:67], v[104:107], v[32:35]
    s_add_u32 m0, s61, 139264
    v_mfma_f32_16x16x32_bf16 v[36:39], a[224:227], v[132:135], v[36:39]
    buffer_load_dwordx4 v226, s[40:43], s64 offen offset:2048 lds
    v_mfma_f32_16x16x32_bf16 v[36:39], v[68:71], v[104:107], v[36:39]
    s_waitcnt lgkmcnt(14)
    v_mfma_f32_16x16x32_bf16 v[24:27], a[248:251], v[144:147], v[24:27]
    s_waitcnt lgkmcnt(4)
    s_waitcnt vmcnt(6)
    s_barrier
    ds_read_b64_tr_b16 a[156:157], v227 offset:12288
    ds_read_b64_tr_b16 a[158:159], v227 offset:15360
    v_mfma_f32_16x16x32_bf16 v[28:31], a[248:251], v[148:151], v[28:31]
    s_add_u32 s64, s64, 98304
    ds_read_b128 v[184:187], v7 offset:0
    ds_read_b64_tr_b16 a[160:161], v228 offset:18432
    v_mfma_f32_16x16x32_bf16 v[28:31], a[252:255], v[144:147], v[28:31]
    s_sub_u32 s35, s64, 1966080
    ds_read_b128 v[200:203], v7 offset:4096
    ds_read_b64_tr_b16 a[162:163], v228 offset:21504
    v_mfma_f32_16x16x32_bf16 v[32:35], a[252:255], v[148:151], v[32:35]
    s_min_u32 s64, s64, s35
    s_add_u32 m0, s61, 151552
    ds_read_b64 v[176:177], v249 offset:0
    ds_read_b64_tr_b16 a[164:165], v229 offset:12288
    buffer_load_dwordx4 v224, s[40:43], s64 offen offset:0 lds
    v_mfma_f32_16x16x32_bf16 v[24:27], a[244:247], v[148:151], v[24:27]
    ds_read_b128 v[188:191], v7 offset:1024
    ds_read_b64_tr_b16 a[166:167], v229 offset:15360
    v_mfma_f32_16x16x32_bf16 v[24:27], a[252:255], v[140:143], v[24:27]
    ds_read_b128 v[204:207], v7 offset:5120
    v_mfma_f32_16x16x32_bf16 v[32:35], a[248:251], v[152:155], v[32:35]
    ds_read_b64 v[178:179], v249 offset:512
    v_mfma_f32_16x16x32_bf16 v[32:35], v[88:91], v[144:147], v[32:35]
    ds_read_b128 v[192:195], v7 offset:2048
    buffer_load_dword v223, v219, s[36:39], s17 offen sc1
    v_mfma_f32_16x16x32_bf16 v[36:39], a[252:255], v[152:155], v[36:39]
    ds_read_b128 v[208:211], v7 offset:6144
    v_mfma_f32_16x16x32_bf16 v[36:39], v[88:91], v[148:151], v[36:39]
    ds_read_b64 v[180:181], v249 offset:1024
    v_mfma_f32_16x16x32_bf16 v[28:31], a[244:247], v[152:155], v[28:31]
    s_waitcnt lgkmcnt(5)
    s_waitcnt vmcnt(5)
    s_barrier
    ds_read_b128 v[196:199], v7 offset:3072
    ds_read_b64_tr_b16 a[168:169], v227 offset:24576
    v_mfma_f32_16x16x32_bf16 v[28:31], v[88:91], v[140:143], v[28:31]
    s_add_u32 m0, s61, 151552
    ds_read_b128 v[212:215], v7 offset:7168
    buffer_load_dwordx4 v225, s[40:43], s64 offen offset:1024 lds
    v_mfma_f32_16x16x32_bf16 v[24:27], a[240:243], v[152:155], v[24:27]
    ds_read_b64 v[182:183], v249 offset:1536
    v_mfma_f32_16x16x32_bf16 v[24:27], v[88:91], v[136:139], v[24:27]
    ds_read_b64_tr_b16 a[170:171], v227 offset:27648
    v_mfma_f32_16x16x32_bf16 v[36:39], a[248:251], v[156:159], v[36:39]
    ds_read_b64_tr_b16 a[172:173], v228 offset:30720
    v_mfma_f32_16x16x32_bf16 v[36:39], v[92:95], v[144:147], v[36:39]
    s_add_u32 m0, s61, 151552
    ds_read_b64_tr_b16 a[174:175], v228 offset:33792
    buffer_load_dwordx4 v226, s[40:43], s64 offen offset:2048 lds
    v_mfma_f32_16x16x32_bf16 v[32:35], a[244:247], v[156:159], v[32:35]
    s_add_u32 s64, s64, 98304
    ds_read_b64_tr_b16 a[176:177], v229 offset:24576
    v_mfma_f32_16x16x32_bf16 v[32:35], v[92:95], v[140:143], v[32:35]
    s_sub_u32 s35, s64, 1966080
    ds_read_b64_tr_b16 a[178:179], v229 offset:27648
    v_mfma_f32_16x16x32_bf16 v[28:31], a[240:243], v[156:159], v[28:31]
    s_min_u32 s64, s64, s35
    v_mfma_f32_16x16x32_bf16 v[28:31], v[92:95], v[136:139], v[28:31]
    v_mfma_f32_16x16x32_bf16 v[36:39], a[244:247], v[160:163], v[36:39]
    v_mfma_f32_16x16x32_bf16 v[36:39], v[96:99], v[140:143], v[36:39]
    v_mfma_f32_16x16x32_bf16 v[32:35], a[240:243], v[160:163], v[32:35]
    v_mfma_f32_16x16x32_bf16 v[32:35], v[96:99], v[136:139], v[32:35]
    v_mfma_f32_16x16x32_bf16 v[36:39], a[240:243], v[164:167], v[36:39]
    s_waitcnt vmcnt(2)
    v_cmp_ne_u32 vcc, s48, v223
    s_cbranch_vccnz L_chk8_slow
L_chk8_back:
    v_mfma_f32_16x16x32_bf16 v[36:39], v[100:103], v[136:139], v[36:39]
L_convend:
    s_waitcnt lgkmcnt(0)
    s_barrier
    s_add_u32 m0, s63, 0
    s_nop 0
    buffer_load_dwordx4 v172, s[36:39], s10 offen sc1 lds
    s_add_u32 m0, s63, 4096
    s_nop 0
    buffer_load_dwordx4 v172, s[36:39], s11 offen sc1 lds
    s_add_u32 m0, s63, 8192
    s_nop 0
    buffer_load_dwordx4 v172, s[36:39], s12 offen sc1 lds
    s_add_u32 m0, s63, 12288
    s_nop 0
    buffer_load_dwordx4 v172, s[36:39], s13 offen sc1 lds
    v_lshlrev_b32 v40, 16, v176
    v_and_b32 v41, 0xffff0000, v176
    v_lshlrev_b32 v42, 16, v177
    v_and_b32 v43, 0xffff0000, v177
    s_add_u32 m0, s63, 16384
    s_nop 0
    buffer_load_dwordx4 v172, s[36:39], s14 offen sc1 lds
    v_pk_fma_f32 v[184:185], v[40:41], v[184:185], v[200:201]
    v_pk_fma_f32 v[186:187], v[42:43], v[186:187], v[202:203]
    v_pk_mul_f32 v[40:41], v[40:41], v[252:253] op_sel:[0,1] op_sel_hi:[1,1]
    v_pk_mul_f32 v[42:43], v[42:43], v[252:253] op_sel:[0,1] op_sel_hi:[1,1]
    s_add_u32 m0, s63, 20480
    s_nop 0
    buffer_load_dwordx4 v172, s[36:39], s15 offen sc1 lds
    v_pk_fma_f32 v[184:185], v[184:185], v[250:251], v[252:253] op_sel:[0,1,0] op_sel_hi:[1,1,0]
    v_pk_fma_f32 v[186:187], v[186:187], v[250:251], v[252:253] op_sel:[0,1,0] op_sel_hi:[1,1,0]
    v_pk_fma_f32 v[184:185], v[24:25], v[184:185], v[40:41]
    v_pk_fma_f32 v[186:187], v[26:27], v[186:187], v[42:43]
    s_add_u32 m0, s63, 24576
    s_nop 0
    buffer_load_dwordx4 v172, s[36:39], s18 offen sc1 lds
    v_cvt_pk_bf16_f32 v200, v184, v185
    v_cvt_pk_bf16_f32 v201, v186, v187
    v_lshlrev_b32 v44, 16, v178
    v_and_b32 v45, 0xffff0000, v178
    s_add_u32 m0, s63, 28672
    s_nop 0
    buffer_load_dwordx4 v172, s[36:39], s19 offen sc1 lds
    v_lshlrev_b32 v46, 16, v179
    v_and_b32 v47, 0xffff0000, v179
    v_pk_fma_f32 v[188:189], v[44:45], v[188:189], v[204:205]
    v_pk_fma_f32 v[190:191], v[46:47], v[190:191], v[206:207]
    v_pk_mul_f32 v[44:45], v[44:45], v[252:253] op_sel:[0,1] op_sel_hi:[1,1]
    v_pk_mul_f32 v[46:47], v[46:47], v[252:253] op_sel:[0,1] op_sel_hi:[1,1]
    v_pk_fma_f32 v[188:189], v[188:189], v[250:251], v[252:253] op_sel:[0,1,0] op_sel_hi:[1,1,0]
    v_pk_fma_f32 v[190:191], v[190:191], v[250:251], v[252:253] op_sel:[0,1,0] op_sel_hi:[1,1,0]
    v_pk_fma_f32 v[188:189], v[28:29], v[188:189], v[44:45]
    v_pk_fma_f32 v[190:191], v[30:31], v[190:191], v[46:47]
    v_cvt_pk_bf16_f32 v202, v188, v189
    v_cvt_pk_bf16_f32 v203, v190, v191
    s_nop 0
    v_permlane16_swap_b32 v200, v202
    v_permlane16_swap_b32 v201, v203
    buffer_store_dwordx4 v[200:203], v6, s[36:39], s68 offen offset:2048 sc1
    v_lshlrev_b32 v40, 16, v180
    v_and_b32 v41, 0xffff0000, v180
    v_lshlrev_b32 v42, 16, v181
    v_and_b32 v43, 0xffff0000, v181
    v_pk_fma_f32 v[192:193], v[40:41], v[192:193], v[208:209]
    v_pk_fma_f32 v[194:195], v[42:43], v[194:195], v[210:211]
    v_pk_mul_f32 v[40:41], v[40:41], v[252:253] op_sel:[0,1] op_sel_hi:[1,1]
    v_pk_mul_f32 v[42:43], v[42:43], v[252:253] op_sel:[0,1] op_sel_hi:[1,1]
    v_pk_fma_f32 v[192:193], v[192:193], v[250:251], v[252:253] op_sel:[0,1,0] op_sel_hi:[1,1,0]
    v_pk_fma_f32 v[194:195], v[194:195], v[250:251], v[252:253] op_sel:[0,1,0] op_sel_hi:[1,1,0]
    v_pk_fma_f32 v[192:193], v[32:33], v[192:193], v[40:41]
    v_pk_fma_f32 v[194:195], v[34:35], v[194:195], v[42:43]
    v_cvt_pk_bf16_f32 v208, v192, v193
    v_cvt_pk_bf16_f32 v209, v194, v195
    v_lshlrev_b32 v44, 16, v182
    v_and_b32 v45, 0xffff0000, v182
    v_lshlrev_b32 v46, 16, v183
    v_and_b32 v47, 0xffff0000, v183
    v_pk_fma_f32 v[196:197], v[44:45], v[196:197], v[212:213]
    v_pk_fma_f32 v[198:199], v[46:47], v[198:199], v[214:215]
    v_pk_mul_f32 v[44:45], v[44:45], v[252:253] op_sel:[0,1] op_sel_hi:[1,1]
    v_pk_mul_f32 v[46:47], v[46:47], v[252:253] op_sel:[0,1] op_sel_hi:[1,1]
    v_pk_fma_f32 v[196:197], v[196:197], v[250:251], v[252:253] op_sel:[0,1,0] op_sel_hi:[1,1,0]
    v_pk_fma_f32 v[198:199], v[198:199], v[250:251], v[252:253] op_sel:[0,1,0] op_sel_hi:[1,1,0]
    v_pk_fma_f32 v[196:197], v[36:37], v[196:197], v[44:45]
    v_pk_fma_f32 v[198:199], v[38:39], v[198:199], v[46:47]
    v_cvt_pk_bf16_f32 v210, v196, v197
    v_cvt_pk_bf16_f32 v211, v198, v199
    s_nop 0
    v_permlane16_swap_b32 v208, v210
    v_permlane16_swap_b32 v209, v211
    buffer_store_dwordx4 v[208:211], v6, s[36:39], s68 offen offset:3072 sc1
    s_waitcnt vmcnt(9)
    s_barrier
    ds_read_b64_tr_b16 v[104:105], v168 offset:0
    ds_read_b64_tr_b16 v[106:107], v168 offset:2048
    ds_read_b64_tr_b16 v[108:109], v169 offset:0
    ds_read_b64_tr_b16 v[110:111], v169 offset:2048
    ds_read_b64_tr_b16 v[112:113], v170 offset:0
    ds_read_b64_tr_b16 v[114:115], v170 offset:2048
    ds_read_b64_tr_b16 v[116:117], v171 offset:0
    ds_read_b64_tr_b16 v[118:119], v171 offset:2048
    s_waitcnt lgkmcnt(6)
    v_mfma_f32_16x16x32_bf16 v[8:11], a[0:3], v[104:107], 0
    s_waitcnt vmcnt(8)
    s_barrier
    ds_read_b64_tr_b16 v[120:121], v168 offset:4096
    v_mfma_f32_16x16x32_bf16 v[12:15], a[4:7], v[104:107], 0
    s_barrier
    ds_read_b64_tr_b16 v[122:123], v168 offset:6144
    v_min_u32 v243, 23, v1
    v_mfma_f32_16x16x32_bf16 v[16:19], a[8:11], v[104:107], 0
    s_waitcnt lgkmcnt(6)
    s_add_u32 m0, s63, 32768
    ds_read_b64_tr_b16 v[124:125], v169 offset:4096
    v_and_b32 v244, 1, v243
    v_mfma_f32_16x16x32_bf16 v[20:23], a[0:3], v[108:111], 0
    buffer_load_dwordx4 v172, s[36:39], s20 offen sc1 lds
    v_mfma_f32_16x16x32_bf16 v[24:27], a[4:7], v[108:111], 0
    ds_read_b64_tr_b16 v[126:127], v169 offset:6144
    v_lshrrev_b32 v243, 1, v243
    v_mfma_f32_16x16x32_bf16 v[28:31], a[8:11], v[108:111], 0
    s_waitcnt lgkmcnt(6)
    ds_read_b64_tr_b16 v[128:129], v170 offset:4096
    v_lshlrev_b32 v243, 7, v243
    v_mfma_f32_16x16x32_bf16 v[32:35], a[0:3], v[112:115], 0
    s_add_u32 m0, s63, 36864
    ds_read_b64_tr_b16 v[130:131], v170 offset:6144
    v_lshl_add_u32 v243, v244, 2, v243
    v_mfma_f32_16x16x32_bf16 v[36:39], a[4:7], v[112:115], 0
    buffer_load_dwordx4 v172, s[36:39], s21 offen sc1 lds
    v_mfma_f32_16x16x32_bf16 v[40:43], a[8:11], v[112:115], 0
    s_mul_i32 s58, s3, 1536
    s_add_u32 s58, s58, 23273472
    ds_read_b64_tr_b16 v[132:133], v171 offset:4096
    ds_read_b64_tr_b16 a[180:181], v227 offset:36864
    s_waitcnt lgkmcnt(8)
    v_mfma_f32_16x16x32_bf16 v[44:47], a[0:3], v[116:119], 0
    s_waitcnt lgkmcnt(3)
    ds_read_b64_tr_b16 v[134:135], v171 offset:6144
    ds_read_b64_tr_b16 a[182:183], v227 offset:39936
    v_mfma_f32_16x16x32_bf16 v[48:51], a[4:7], v[116:119], 0
    ds_read_b64_tr_b16 a[184:185], v228 offset:43008
    ds_read_b64_tr_b16 a[186:187], v228 offset:46080
    v_mfma_f32_16x16x32_bf16 v[52:55], a[8:11], v[116:119], 0
    buffer_load_dword v244, v243, s[36:39], s58 offen sc1
    v_mfma_f32_16x16x32_bf16 v[8:11], a[12:15], v[120:123], v[8:11]
    s_waitcnt vmcnt(9)
    s_barrier
    ds_read_b64_tr_b16 v[104:105], v168 offset:8192
    ds_read_b64_tr_b16 a[188:189], v229 offset:36864
    v_mfma_f32_16x16x32_bf16 v[12:15], a[16:19], v[120:123], v[12:15]
    ds_read_b64_tr_b16 v[106:107], v168 offset:10240
    ds_read_b64_tr_b16 a[190:191], v229 offset:39936
    v_mfma_f32_16x16x32_bf16 v[16:19], a[20:23], v[120:123], v[16:19]
    s_add_u32 m0, s63, 40960
    ds_read_b64_tr_b16 v[108:109], v169 offset:8192
    v_mfma_f32_16x16x32_bf16 v[20:23], a[12:15], v[124:127], v[20:23]
    buffer_load_dwordx4 v172, s[36:39], s22 offen sc1 lds
    v_mfma_f32_16x16x32_bf16 v[24:27], a[16:19], v[124:127], v[24:27]
    ds_read_b64_tr_b16 v[110:111], v169 offset:10240
    v_mfma_f32_16x16x32_bf16 v[28:31], a[20:23], v[124:127], v[28:31]
    s_waitcnt lgkmcnt(2)
    s_barrier
    ds_read_b64_tr_b16 v[112:113], v170 offset:8192
    ds_read_b64_tr_b16 a[192:193], v227 offset:49152
    v_mfma_f32_16x16x32_bf16 v[32:35], a[12:15], v[128:131], v[32:35]
    s_add_u32 m0, s63, 45056
    ds_read_b64_tr_b16 v[114:115], v170 offset:10240
    ds_read_b64_tr_b16 a[194:195], v227 offset:52224
    v_mfma_f32_16x16x32_bf16 v[36:39], a[16:19], v[128:131], v[36:39]
    buffer_load_dwordx4 v172, s[36:39], s23 offen sc1 lds
    v_mfma_f32_16x16x32_bf16 v[40:43], a[20:23], v[128:131], v[40:43]
    ds_read_b64_tr_b16 v[116:117], v171 offset:8192
    ds_read_b64_tr_b16 a[196:197], v228 offset:55296
    v_mfma_f32_16x16x32_bf16 v[44:47], a[12:15], v[132:135], v[44:47]
    s_waitcnt lgkmcnt(3)
    ds_read_b64_tr_b16 v[118:119], v171 offset:10240
    ds_read_b64_tr_b16 a[198:199], v228 offset:58368
    v_mfma_f32_16x16x32_bf16 v[48:51], a[16:19], v[132:135], v[48:51]
    s_add_u32 m0, s63, 49152
    ds_read_b64_tr_b16 a[200:201], v229 offset:49152
    ds_read_b64_tr_b16 a[202:203], v229 offset:52224
    v_mfma_f32_16x16x32_bf16 v[52:55], a[20:23], v[132:135], v[52:55]
    buffer_load_dwordx4 v172, s[36:39], s24 offen sc1 lds
    v_mfma_f32_16x16x32_bf16 v[8:11], a[24:27], v[104:107], v[8:11]
    ds_read_b64_tr_b16 v[120:121], v168 offset:12288
    v_lshrrev_b32 v210, 4, v1
    v_mfma_f32_16x16x32_bf16 v[12:15], a[28:31], v[104:107], v[12:15]
    ds_read_b64_tr_b16 v[122:123], v168 offset:14336
    v_lshlrev_b32 v210, 3, v210
    v_mfma_f32_16x16x32_bf16 v[16:19], a[32:35], v[104:107], v[16:19]
    s_add_u32 m0, s63, 53248
    ds_read_b64_tr_b16 v[124:125], v169 offset:12288
    v_mfma_f32_16x16x32_bf16 v[20:23], a[24:27], v[108:111], v[20:23]
    buffer_load_dwordx4 v172, s[36:39], s25 offen sc1 lds
    v_mfma_f32_16x16x32_bf16 v[24:27], a[28:31], v[108:111], v[24:27]
    s_lshl_b32 s57, s3, 5
    s_add_u32 s57, s57, 163712
    ds_read_b64_tr_b16 v[126:127], v169 offset:14336
    v_mfma_f32_16x16x32_bf16 v[28:31], a[32:35], v[108:111], v[28:31]
    ds_read_b64_tr_b16 v[128:129], v170 offset:12288
    v_add_u32 v210, s57, v210
    v_mfma_f32_16x16x32_bf16 v[32:35], a[24:27], v[112:115], v[32:35]
    s_add_u32 m0, s63, 57344
    ds_read_b64_tr_b16 v[130:131], v170 offset:14336
    v_lshlrev_b32 v211, 2, v1
    v_mfma_f32_16x16x32_bf16 v[36:39], a[28:31], v[112:115], v[36:39]
    buffer_load_dwordx4 v172, s[36:39], s26 offen sc1 lds
    v_mfma_f32_16x16x32_bf16 v[40:43], a[32:35], v[112:115], v[40:43]
    s_waitcnt lgkmcnt(9)
    ds_read_b64_tr_b16 v[132:133], v171 offset:12288
    v_and_b32 v211, 12, v211
    v_mfma_f32_16x16x32_bf16 v[44:47], a[24:27], v[116:119], v[44:47]
    s_waitcnt lgkmcnt(3)
    ds_read_b64_tr_b16 v[134:135], v171 offset:14336
    v_add_u32 v211, 163712, v211
    v_mfma_f32_16x16x32_bf16 v[48:51], a[28:31], v[116:119], v[48:51]
    s_add_u32 m0, s63, 61440
    v_mfma_f32_16x16x32_bf16 v[52:55], a[32:35], v[116:119], v[52:55]
    buffer_load_dwordx4 v172, s[36:39], s27 offen sc1 lds
    v_mfma_f32_16x16x32_bf16 v[8:11], a[36:39], v[120:123], v[8:11]
    s_waitcnt vmcnt(12)
    s_barrier
    ds_read_b64_tr_b16 v[104:105], v168 offset:16384
    v_mfma_f32_16x16x32_bf16 v[12:15], a[40:43], v[120:123], v[12:15]
    s_waitcnt vmcnt(9)
    s_barrier
    s_cmp_eq_u32 s3, 0
    s_cbranch_scc0 L_wf9
    s_and_b32 s54, s70, 1
    s_mul_i32 s54, s54, -60
    v_mov_b32 v254, s54
    s_lshl_b32 s54, s70, 6
    v_add_u32 v254, s54, v254
    s_mov_b32 s54, 23332864
    v_mov_b32 v255, s48
    s_mov_b64 exec, 1
    buffer_store_dword v255, v254, s[36:39], s54 offen sc1
    s_mov_b64 exec, -1
L_wf9:
    ds_read_b64_tr_b16 v[106:107], v168 offset:18432
    v_mfma_f32_16x16x32_bf16 v[16:19], a[44:47], v[120:123], v[16:19]
    s_add_u32 m0, s63, 65536
    ds_read_b64_tr_b16 v[108:109], v169 offset:16384
    v_mfma_f32_16x16x32_bf16 v[20:23], a[36:39], v[124:127], v[20:23]
    buffer_load_dwordx4 v172, s[36:39], s44 offen sc1 lds
    v_mfma_f32_16x16x32_bf16 v[24:27], a[40:43], v[124:127], v[24:27]
    ds_read_b64_tr_b16 v[110:111], v169 offset:18432
    v_mfma_f32_16x16x32_bf16 v[28:31], a[44:47], v[124:127], v[28:31]
    ds_read_b64_tr_b16 v[112:113], v170 offset:16384
    s_waitcnt vmcnt(7)
    v_cmp_ne_u32 vcc, s48, v244
    s_cbranch_vccnz L_chk10_slow
L_chk10_back:
    s_waitcnt lgkmcnt(7)
    v_mfma_f32_16x16x32_bf16 v[32:35], a[36:39], v[128:131], v[32:35]
    s_add_u32 m0, s63, 69632
    ds_read_b64_tr_b16 v[114:115], v170 offset:18432
    v_mfma_f32_16x16x32_bf16 v[36:39], a[40:43], v[128:131], v[36:39]
    buffer_load_dwordx4 v172, s[36:39], s45 offen sc1 lds
    v_mfma_f32_16x16x32_bf16 v[40:43], a[44:47], v[128:131], v[40:43]
    s_waitcnt lgkmcnt(6)
    ds_read_b64_tr_b16 v[116:117], v171 offset:16384
    v_mfma_f32_16x16x32_bf16 v[44:47], a[36:39], v[132:135], v[44:47]
    s_waitcnt lgkmcnt(3)
    ds_read_b64_tr_b16 v[118:119], v171 offset:18432
    v_mfma_f32_16x16x32_bf16 v[48:51], a[40:43], v[132:135], v[48:51]
    s_add_u32 m0, s63, 73728
    v_mfma_f32_16x16x32_bf16 v[52:55], a[44:47], v[132:135], v[52:55]
    buffer_load_dwordx4 v172, s[36:39], s46 offen sc1 lds
    v_mfma_f32_16x16x32_bf16 v[8:11], a[48:51], v[104:107], v[8:11]
    ds_read_b64_tr_b16 v[120:121], v168 offset:20480
    v_mfma_f32_16x16x32_bf16 v[12:15], a[52:55], v[104:107], v[12:15]
    ds_read_b64_tr_b16 v[122:123], v168 offset:22528
    v_mfma_f32_16x16x32_bf16 v[16:19], a[56:59], v[104:107], v[16:19]
    s_add_u32 m0, s63, 77824
    ds_read_b64_tr_b16 v[124:125], v169 offset:20480
    v_mfma_f32_16x16x32_bf16 v[20:23], a[48:51], v[108:111], v[20:23]
    buffer_load_dwordx4 v172, s[36:39], s47 offen sc1 lds
    v_mfma_f32_16x16x32_bf16 v[24:27], a[52:55], v[108:111], v[24:27]
    ds_read_b64_tr_b16 v[126:127], v169 offset:22528
    v_add_u32 v172, 2048, v172
    v_mfma_f32_16x16x32_bf16 v[28:31], a[56:59], v[108:111], v[28:31]
    s_waitcnt lgkmcnt(6)
    ds_read_b64_tr_b16 v[128:129], v170 offset:20480
    v_mfma_f32_16x16x32_bf16 v[32:35], a[48:51], v[112:115], v[32:35]
    s_add_u32 m0, s61, 102400
    ds_read_b64_tr_b16 v[130:131], v170 offset:22528
    v_mfma_f32_16x16x32_bf16 v[36:39], a[52:55], v[112:115], v[36:39]
    buffer_load_dwordx4 v224, s[40:43], s64 offen offset:0 lds
    v_mfma_f32_16x16x32_bf16 v[40:43], a[56:59], v[112:115], v[40:43]
    s_waitcnt lgkmcnt(6)
    ds_read_b64_tr_b16 v[132:133], v171 offset:20480
    v_mfma_f32_16x16x32_bf16 v[44:47], a[48:51], v[116:119], v[44:47]
    s_waitcnt lgkmcnt(3)
    ds_read_b64_tr_b16 v[134:135], v171 offset:22528
    v_mfma_f32_16x16x32_bf16 v[48:51], a[52:55], v[116:119], v[48:51]
    s_add_u32 m0, s61, 102400
    v_mfma_f32_16x16x32_bf16 v[52:55], a[56:59], v[116:119], v[52:55]
    buffer_load_dwordx4 v225, s[40:43], s64 offen offset:1024 lds
    v_mfma_f32_16x16x32_bf16 v[8:11], a[60:63], v[120:123], v[8:11]
    ds_read_b64_tr_b16 v[104:105], v168 offset:24576
    v_mfma_f32_16x16x32_bf16 v[12:15], a[64:67], v[120:123], v[12:15]
    ds_read_b64_tr_b16 v[106:107], v168 offset:26624
    v_mfma_f32_16x16x32_bf16 v[16:19], a[68:71], v[120:123], v[16:19]
    s_add_u32 m0, s61, 102400
    ds_read_b64_tr_b16 v[108:109], v169 offset:24576
    v_mfma_f32_16x16x32_bf16 v[20:23], a[60:63], v[124:127], v[20:23]
    buffer_load_dwordx4 v226, s[40:43], s64 offen offset:2048 lds
    v_mfma_f32_16x16x32_bf16 v[24:27], a[64:67], v[124:127], v[24:27]
    s_add_u32 s64, s64, 98304
    ds_read_b64_tr_b16 v[110:111], v169 offset:26624
    v_mfma_f32_16x16x32_bf16 v[28:31], a[68:71], v[124:127], v[28:31]
    s_waitcnt lgkmcnt(6)
    s_sub_u32 s35, s64, 1966080
    ds_read_b64_tr_b16 v[112:113], v170 offset:24576
    v_mfma_f32_16x16x32_bf16 v[32:35], a[60:63], v[128:131], v[32:35]
    s_min_u32 s64, s64, s35
    ds_read_b64_tr_b16 v[114:115], v170 offset:26624
    v_mfma_f32_16x16x32_bf16 v[36:39], a[64:67], v[128:131], v[36:39]
    v_mfma_f32_16x16x32_bf16 v[40:43], a[68:71], v[128:131], v[40:43]
    s_waitcnt lgkmcnt(6)
    ds_read_b64_tr_b16 v[116:117], v171 offset:24576
    v_mfma_f32_16x16x32_bf16 v[44:47], a[60:63], v[132:135], v[44:47]
    s_waitcnt lgkmcnt(3)
    ds_read_b64_tr_b16 v[118:119], v171 offset:26624
    v_mfma_f32_16x16x32_bf16 v[48:51], a[64:67], v[132:135], v[48:51]
    s_add_u32 m0, s61, 114688
    v_mfma_f32_16x16x32_bf16 v[52:55], a[68:71], v[132:135], v[52:55]
    buffer_load_dwordx4 v224, s[40:43], s64 offen offset:0 lds
    v_mfma_f32_16x16x32_bf16 v[8:11], a[72:75], v[104:107], v[8:11]
    s_barrier
    ds_read_b64_tr_b16 v[120:121], v168 offset:28672
    v_mfma_f32_16x16x32_bf16 v[12:15], a[76:79], v[104:107], v[12:15]
    ds_read_b64_tr_b16 v[122:123], v168 offset:30720
    v_mfma_f32_16x16x32_bf16 v[16:19], a[80:83], v[104:107], v[16:19]
    s_add_u32 m0, s61, 114688
    ds_read_b64_tr_b16 v[124:125], v169 offset:28672
    v_mfma_f32_16x16x32_bf16 v[20:23], a[72:75], v[108:111], v[20:23]
    buffer_load_dwordx4 v225, s[40:43], s64 offen offset:1024 lds
    v_mfma_f32_16x16x32_bf16 v[24:27], a[76:79], v[108:111], v[24:27]
    ds_read_b64_tr_b16 v[126:127], v169 offset:30720
    v_mfma_f32_16x16x32_bf16 v[28:31], a[80:83], v[108:111], v[28:31]
    s_waitcnt lgkmcnt(6)
    ds_read_b64_tr_b16 v[128:129], v170 offset:28672
    v_mfma_f32_16x16x32_bf16 v[32:35], a[72:75], v[112:115], v[32:35]
    s_add_u32 m0, s61, 114688
    ds_read_b64_tr_b16 v[130:131], v170 offset:30720
    v_mfma_f32_16x16x32_bf16 v[36:39], a[76:79], v[112:115], v[36:39]
    buffer_load_dwordx4 v226, s[40:43], s64 offen offset:2048 lds
    v_mfma_f32_16x16x32_bf16 v[40:43], a[80:83], v[112:115], v[40:43]
    s_waitcnt lgkmcnt(6)
    s_add_u32 s64, s64, 98304
    ds_read_b64_tr_b16 v[132:133], v171 offset:28672
    v_mfma_f32_16x16x32_bf16 v[44:47], a[72:75], v[116:119], v[44:47]
    s_waitcnt lgkmcnt(3)
    ds_read_b64_tr_b16 v[134:135], v171 offset:30720
    v_mfma_f32_16x16x32_bf16 v[48:51], a[76:79], v[116:119], v[48:51]
    s_sub_u32 s35, s64, 1966080
    v_mfma_f32_16x16x32_bf16 v[52:55], a[80:83], v[116:119], v[52:55]
    s_min_u32 s64, s64, s35
    v_mfma_f32_16x16x32_bf16 v[8:11], a[84:87], v[120:123], v[8:11]
    ds_read_b64_tr_b16 v[104:105], v168 offset:32768
    v_mfma_f32_16x16x32_bf16 v[12:15], a[88:91], v[120:123], v[12:15]
    ds_read_b64_tr_b16 v[106:107], v168 offset:34816
    v_mfma_f32_16x16x32_bf16 v[16:19], a[92:95], v[120:123], v[16:19]
    s_add_u32 m0, s61, 126976
    ds_read_b64_tr_b16 v[108:109], v169 offset:32768
    v_mfma_f32_16x16x32_bf16 v[20:23], a[84:87], v[124:127], v[20:23]
    buffer_load_dwordx4 v224, s[40:43], s64 offen offset:0 lds
    v_mfma_f32_16x16x32_bf16 v[24:27], a[88:91], v[124:127], v[24:27]
    ds_read_b64_tr_b16 v[110:111], v169 offset:34816
    v_mfma_f32_16x16x32_bf16 v[28:31], a[92:95], v[124:127], v[28:31]
    s_waitcnt lgkmcnt(6)
    ds_read_b64_tr_b16 v[112:113], v170 offset:32768
    v_mfma_f32_16x16x32_bf16 v[32:35], a[84:87], v[128:131], v[32:35]
    s_add_u32 m0, s61, 126976
    ds_read_b64_tr_b16 v[114:115], v170 offset:34816
    v_lshrrev_b32 v238, 1, v1
    v_mfma_f32_16x16x32_bf16 v[36:39], a[88:91], v[128:131], v[36:39]
    buffer_load_dwordx4 v225, s[40:43], s64 offen offset:1024 lds
    v_mfma_f32_16x16x32_bf16 v[40:43], a[92:95], v[128:131], v[40:43]
    s_waitcnt lgkmcnt(6)
    ds_read_b64_tr_b16 v[116:117], v171 offset:32768
    v_lshlrev_b32 v238, 9, v238
    v_mfma_f32_16x16x32_bf16 v[44:47], a[84:87], v[132:135], v[44:47]
    s_waitcnt lgkmcnt(3)
    ds_read_b64_tr_b16 v[118:119], v171 offset:34816
    v_and_b32 v239, 1, v1
    v_mfma_f32_16x16x32_bf16 v[48:51], a[88:91], v[132:135], v[48:51]
    s_add_u32 m0, s61, 126976
    v_lshl_add_u32 v219, v239, 2, v238
    v_mfma_f32_16x16x32_bf16 v[52:55], a[92:95], v[132:135], v[52:55]
    s_lshl_b32 s55, s3, 7
    s_add_u32 s55, s55, 133120
    buffer_load_dwordx4 v226, s[40:43], s64 offen offset:2048 lds
    v_mfma_f32_16x16x32_bf16 v[8:11], a[96:99], v[104:107], v[8:11]
    s_add_u32 s64, s64, 98304
    ds_read_b64_tr_b16 v[120:121], v168 offset:36864
    v_add_u32 v219, s55, v219
    v_mfma_f32_16x16x32_bf16 v[12:15], a[100:103], v[104:107], v[12:15]
    s_sub_u32 s35, s64, 1966080
    ds_read_b64_tr_b16 v[122:123], v168 offset:38912
    v_min_u32 v238, 49, v1
    v_mfma_f32_16x16x32_bf16 v[16:19], a[104:107], v[104:107], v[16:19]
    s_min_u32 s64, s64, s35
    ds_read_b64_tr_b16 v[124:125], v169 offset:36864
    v_lshlrev_b32 v238, 7, v238
    v_mfma_f32_16x16x32_bf16 v[20:23], a[96:99], v[108:111], v[20:23]
    s_waitcnt vmcnt(6)
    s_barrier
    ds_read_b64_tr_b16 a[204:205], v227 offset:0
    ds_read_b64_tr_b16 a[206:207], v227 offset:3072
    v_mfma_f32_16x16x32_bf16 v[24:27], a[100:103], v[108:111], v[24:27]
    ds_read_b64_tr_b16 v[126:127], v169 offset:38912
    v_add_u32 v238, 99584, v238
    v_mfma_f32_16x16x32_bf16 v[28:31], a[104:107], v[108:111], v[28:31]
    s_waitcnt lgkmcnt(8)
    ds_read_b64_tr_b16 v[128:129], v170 offset:36864
    ds_read_b64_tr_b16 a[208:209], v228 offset:6144
    v_mfma_f32_16x16x32_bf16 v[32:35], a[96:99], v[112:115], v[32:35]
    ds_read_b64_tr_b16 v[130:131], v170 offset:38912
    ds_read_b64_tr_b16 a[210:211], v228 offset:9216
    v_mfma_f32_16x16x32_bf16 v[36:39], a[100:103], v[112:115], v[36:39]
    buffer_load_dwordx4 a[240:243], v248, s[36:39], s62 offen offset:0 sc1
    v_mfma_f32_16x16x32_bf16 v[40:43], a[104:107], v[112:115], v[40:43]
    s_waitcnt lgkmcnt(10)
    ds_read_b64_tr_b16 v[132:133], v171 offset:36864
    ds_read_b64_tr_b16 a[212:213], v229 offset:0
    v_mfma_f32_16x16x32_bf16 v[44:47], a[96:99], v[116:119], v[44:47]
    s_waitcnt lgkmcnt(3)
    ds_read_b64_tr_b16 v[134:135], v171 offset:38912
    ds_read_b64_tr_b16 a[214:215], v229 offset:3072
    v_mfma_f32_16x16x32_bf16 v[48:51], a[100:103], v[116:119], v[48:51]
    v_cmp_lt_u32 vcc, 39, v1
    s_nop 1
    v_cndmask_b32 v219, v219, v238, vcc
    v_mfma_f32_16x16x32_bf16 v[52:55], a[104:107], v[116:119], v[52:55]
    s_mov_b32 s17, 23199744
    buffer_load_dwordx4 a[244:247], v248, s[36:39], s62 offen offset:1024 sc1
    v_mfma_f32_16x16x32_bf16 v[8:11], a[108:111], v[120:123], v[8:11]
    s_barrier
    ds_read_b64_tr_b16 v[104:105], v168 offset:40960
    v_mfma_f32_16x16x32_bf16 v[12:15], a[112:115], v[120:123], v[12:15]
    ds_read_b64_tr_b16 v[106:107], v168 offset:43008
    ds_read_b64 v[200:201], v216
    v_mfma_f32_16x16x32_bf16 v[16:19], a[116:119], v[120:123], v[16:19]
    ds_read_b64_tr_b16 v[108:109], v169 offset:40960
    ds_read_b64 v[202:203], v217
    v_mfma_f32_16x16x32_bf16 v[20:23], a[108:111], v[124:127], v[20:23]
    buffer_load_dwordx4 a[248:251], v248, s[36:39], s62 offen offset:2048 sc1
    v_mfma_f32_16x16x32_bf16 v[24:27], a[112:115], v[124:127], v[24:27]
    ds_read_b64_tr_b16 v[110:111], v169 offset:43008
    ds_read_b64 v[204:205], v218
    v_mfma_f32_16x16x32_bf16 v[28:31], a[116:119], v[124:127], v[28:31]
    ds_read_b64_tr_b16 v[112:113], v170 offset:40960
    v_mfma_f32_16x16x32_bf16 v[32:35], a[108:111], v[128:131], v[32:35]
    ds_read_b64_tr_b16 v[114:115], v170 offset:43008
    v_mfma_f32_16x16x32_bf16 v[36:39], a[112:115], v[128:131], v[36:39]
    buffer_load_dwordx4 a[252:255], v248, s[36:39], s62 offen offset:3072 sc1
    v_mfma_f32_16x16x32_bf16 v[40:43], a[116:119], v[128:131], v[40:43]
    s_waitcnt lgkmcnt(9)
    s_waitcnt vmcnt(7)
    s_barrier
    ds_read_b64_tr_b16 v[116:117], v171 offset:40960
    ds_read_b64_tr_b16 a[216:217], v227 offset:12288
    v_mfma_f32_16x16x32_bf16 v[44:47], a[108:111], v[132:135], v[44:47]
    s_waitcnt lgkmcnt(3)
    ds_read_b64_tr_b16 v[118:119], v171 offset:43008
    ds_read_b64_tr_b16 a[218:219], v227 offset:15360
    v_lshlrev_b32 v230, 16, v200
    v_mfma_f32_16x16x32_bf16 v[48:51], a[112:115], v[132:135], v[48:51]
    s_add_u32 s62, s62, 4096
    ds_read_b64_tr_b16 a[220:221], v228 offset:18432
    ds_read_b64_tr_b16 a[222:223], v228 offset:21504
    v_and_b32 v231, 0xffff0000, v200
    v_mfma_f32_16x16x32_bf16 v[52:55], a[116:119], v[132:135], v[52:55]
    buffer_load_dwordx4 v[136:139], v248, s[36:39], s62 offen offset:0 sc1
    v_mfma_f32_16x16x32_bf16 v[8:11], a[120:123], v[104:107], v[8:11]
    s_lshl_b32 s56, s73, 7
    s_add_u32 s56, s56, 23353344
    ds_read_b64_tr_b16 v[120:121], v168 offset:45056
    ds_read_b64_tr_b16 a[224:225], v229 offset:12288
    v_mfma_f32_16x16x32_bf16 v[12:15], a[124:127], v[104:107], v[12:15]
    ds_read_b64_tr_b16 v[122:123], v168 offset:47104
    v_mov_b32 v242, 0
    v_mul_f32 v230, v230, v220
    v_mfma_f32_16x16x32_bf16 v[16:19], a[128:131], v[104:107], v[16:19]
    ds_read_b64_tr_b16 v[124:125], v169 offset:45056
    ds_read_b64_tr_b16 a[226:227], v229 offset:15360
    v_mul_f32 v231, v231, v220
    v_mfma_f32_16x16x32_bf16 v[20:23], a[120:123], v[108:111], v[20:23]
    buffer_load_dwordx4 v[140:143], v248, s[36:39], s62 offen offset:1024 sc1
    v_mfma_f32_16x16x32_bf16 v[24:27], a[124:127], v[108:111], v[24:27]
    ds_read_b64_tr_b16 v[126:127], v169 offset:47104
    v_mul_f32 v234, v230, v230
    v_mul_f32 v235, v231, v231
    v_mfma_f32_16x16x32_bf16 v[28:31], a[128:131], v[108:111], v[28:31]
    s_waitcnt lgkmcnt(12)
    ds_read_b64_tr_b16 v[128:129], v170 offset:45056
    v_lshlrev_b32 v232, 16, v201
    v_and_b32 v233, 0xffff0000, v201
    v_mfma_f32_16x16x32_bf16 v[32:35], a[120:123], v[112:115], v[32:35]
    ds_read_b64_tr_b16 v[130:131], v170 offset:47104
    v_mul_f32 v232, v232, v220
    v_mul_f32 v233, v233, v220
    v_mfma_f32_16x16x32_bf16 v[36:39], a[124:127], v[112:115], v[36:39]
    buffer_load_dwordx4 v[144:147], v248, s[36:39], s62 offen offset:2048 sc1
    v_mfma_f32_16x16x32_bf16 v[40:43], a[128:131], v[112:115], v[40:43]
    s_waitcnt lgkmcnt(11)
    ds_read_b64_tr_b16 v[132:133], v171 offset:45056
    v_mul_f32 v236, v232, v232
    v_mul_f32 v237, v233, v233
    v_mfma_f32_16x16x32_bf16 v[44:47], a[120:123], v[116:119], v[44:47]
    s_waitcnt lgkmcnt(3)
    ds_read_b64_tr_b16 v[134:135], v171 offset:47104
    v_lshlrev_b32 v206, 16, v202
    v_and_b32 v207, 0xffff0000, v202
    v_mfma_f32_16x16x32_bf16 v[48:51], a[124:127], v[116:119], v[48:51]
    v_mul_f32 v206, v206, v221
    v_mul_f32 v207, v207, v221
    v_add_f32 v230, v230, v206
    v_mfma_f32_16x16x32_bf16 v[52:55], a[128:131], v[116:119], v[52:55]
    buffer_load_dword v240, v219, s[36:39], s17 offen sc1
    v_mfma_f32_16x16x32_bf16 v[8:11], a[132:135], v[120:123], v[8:11]
    s_waitcnt vmcnt(8)
    s_barrier
    ds_read_b64_tr_b16 v[104:105], v168 offset:49152
    ds_read_b64_tr_b16 a[228:229], v227 offset:24576
    v_mfma_f32_16x16x32_bf16 v[12:15], a[136:139], v[120:123], v[12:15]
    ds_read_b64_tr_b16 v[106:107], v168 offset:51200
    ds_read_b64_tr_b16 a[230:231], v227 offset:27648
    v_add_f32 v231, v231, v207
    v_mfma_f32_16x16x32_bf16 v[16:19], a[140:143], v[120:123], v[16:19]
    ds_read_b64_tr_b16 v[108:109], v169 offset:49152
    ds_read_b64_tr_b16 a[232:233], v228 offset:30720
    v_fmac_f32 v234, v206, v206
    v_mfma_f32_16x16x32_bf16 v[20:23], a[132:135], v[124:127], v[20:23]
    buffer_load_dwordx4 v[148:151], v248, s[36:39], s62 offen offset:3072 sc1
    v_mfma_f32_16x16x32_bf16 v[24:27], a[136:139], v[124:127], v[24:27]
    s_add_u32 s62, s62, 4096
    ds_read_b64_tr_b16 v[110:111], v169 offset:51200
    ds_read_b64_tr_b16 a[234:235], v228 offset:33792
    v_fmac_f32 v235, v207, v207
    v_mfma_f32_16x16x32_bf16 v[28:31], a[140:143], v[124:127], v[28:31]
    s_waitcnt lgkmcnt(10)
    ds_read_b64_tr_b16 v[112:113], v170 offset:49152
    ds_read_b64_tr_b16 a[236:237], v229 offset:24576
    v_lshlrev_b32 v208, 16, v203
    v_mfma_f32_16x16x32_bf16 v[32:35], a[132:135], v[128:131], v[32:35]
    ds_read_b64_tr_b16 v[114:115], v170 offset:51200
    ds_read_b64_tr_b16 a[238:239], v229 offset:27648
    v_and_b32 v209, 0xffff0000, v203
    v_mfma_f32_16x16x32_bf16 v[36:39], a[136:139], v[128:131], v[36:39]
    buffer_load_dwordx4 v[152:155], v248, s[36:39], s62 offen offset:0 sc1
    v_mfma_f32_16x16x32_bf16 v[40:43], a[140:143], v[128:131], v[40:43]
    s_waitcnt lgkmcnt(12)
    ds_read_b64_tr_b16 v[116:117], v171 offset:49152
    v_mul_f32 v208, v208, v221
    v_mul_f32 v209, v209, v221
    v_mfma_f32_16x16x32_bf16 v[44:47], a[132:135], v[132:135], v[44:47]
    s_waitcnt lgkmcnt(3)
    ds_read_b64_tr_b16 v[118:119], v171 offset:51200
    v_add_f32 v232, v232, v208
    v_add_f32 v233, v233, v209
    v_mfma_f32_16x16x32_bf16 v[48:51], a[136:139], v[132:135], v[48:51]
    s_waitcnt lgkmcnt(2)
    s_barrier
    v_fmac_f32 v236, v208, v208
    v_fmac_f32 v237, v209, v209
    v_mfma_f32_16x16x32_bf16 v[52:55], a[140:143], v[132:135], v[52:55]
    buffer_load_dwordx4 v[156:159], v248, s[36:39], s62 offen offset:1024 sc1
    v_mfma_f32_16x16x32_bf16 v[8:11], a[144:147], v[104:107], v[8:11]
    ds_read_b64_tr_b16 v[120:121], v168 offset:53248
    v_lshlrev_b32 v206, 16, v204
    v_and_b32 v207, 0xffff0000, v204
    v_mfma_f32_16x16x32_bf16 v[12:15], a[148:151], v[104:107], v[12:15]
    ds_read_b64_tr_b16 v[122:123], v168 offset:55296
    v_mul_f32 v206, v206, v222
    v_mul_f32 v207, v207, v222
    v_mfma_f32_16x16x32_bf16 v[16:19], a[152:155], v[104:107], v[16:19]
    ds_read_b64_tr_b16 v[124:125], v169 offset:53248
    v_add_f32 v230, v230, v206
    v_add_f32 v231, v231, v207
    v_mfma_f32_16x16x32_bf16 v[20:23], a[144:147], v[108:111], v[20:23]
    buffer_load_dwordx4 v[160:163], v248, s[36:39], s62 offen offset:2048 sc1
    v_mfma_f32_16x16x32_bf16 v[24:27], a[148:151], v[108:111], v[24:27]
    ds_read_b64_tr_b16 v[126:127], v169 offset:55296
    v_fmac_f32 v234, v206, v206
    v_fmac_f32 v235, v207, v207
    v_mfma_f32_16x16x32_bf16 v[28:31], a[152:155], v[108:111], v[28:31]
    ds_read_b64_tr_b16 v[128:129], v170 offset:53248
    v_lshlrev_b32 v208, 16, v205
    v_and_b32 v209, 0xffff0000, v205
    v_mfma_f32_16x16x32_bf16 v[32:35], a[144:147], v[112:115], v[32:35]
    ds_read_b64_tr_b16 v[130:131], v170 offset:55296
    v_mul_f32 v208, v208, v222
    v_mul_f32 v209, v209, v222
    v_mfma_f32_16x16x32_bf16 v[36:39], a[148:151], v[112:115], v[36:39]
    buffer_load_dwordx4 v[164:167], v248, s[36:39], s62 offen offset:3072 sc1
    v_mfma_f32_16x16x32_bf16 v[40:43], a[152:155], v[112:115], v[40:43]
    s_add_u32 s62, s62, 4096
    ds_read_b64_tr_b16 v[132:133], v171 offset:53248
    v_add_f32 v232, v232, v208
    v_add_f32 v233, v233, v209
    s_waitcnt lgkmcnt(7)
    v_mfma_f32_16x16x32_bf16 v[44:47], a[144:147], v[116:119], v[44:47]
    s_waitcnt lgkmcnt(3)
    ds_read_b64_tr_b16 v[134:135], v171 offset:55296
    v_fmac_f32 v236, v208, v208
    v_fmac_f32 v237, v209, v209
    v_mfma_f32_16x16x32_bf16 v[48:51], a[148:151], v[116:119], v[48:51]
    v_permlane32_swap_b32 v230, v234
    v_permlane32_swap_b32 v231, v235
    v_permlane32_swap_b32 v232, v236
    v_mfma_f32_16x16x32_bf16 v[52:55], a[152:155], v[116:119], v[52:55]
    v_permlane32_swap_b32 v233, v237
    v_add_f32 v230, v230, v234
    v_add_f32 v231, v231, v235
    v_mfma_f32_16x16x32_bf16 v[8:11], a[156:159], v[120:123], v[8:11]
    ds_read_b64_tr_b16 v[104:105], v168 offset:57344
    v_add_f32 v232, v232, v236
    v_add_f32 v233, v233, v237
    v_mfma_f32_16x16x32_bf16 v[12:15], a[160:163], v[120:123], v[12:15]
    ds_read_b64_tr_b16 v[106:107], v168 offset:59392
    v_permlane16_swap_b32 v230, v232
    v_permlane16_swap_b32 v231, v233
    v_mfma_f32_16x16x32_bf16 v[16:19], a[164:167], v[120:123], v[16:19]
    ds_read_b64_tr_b16 v[108:109], v169 offset:57344
    v_add_f32 v230, v230, v232
    v_add_f32 v231, v231, v233
    v_mfma_f32_16x16x32_bf16 v[20:23], a[156:159], v[124:127], v[20:23]
    v_add_f32_dpp v230, v230, v230 row_ror:8 row_mask:0xf bank_mask:0xf
    v_add_f32_dpp v231, v231, v231 row_ror:8 row_mask:0xf bank_mask:0xf
    s_nop 0
    v_add_f32_dpp v230, v230, v230 row_ror:4 row_mask:0xf bank_mask:0xf
    v_mfma_f32_16x16x32_bf16 v[24:27], a[160:163], v[124:127], v[24:27]
    ds_read_b64_tr_b16 v[110:111], v169 offset:59392
    s_waitcnt vmcnt(5)
    v_cmp_ne_u32 vcc, s48, v240
    s_cbranch_vccnz L_chk11_slow
L_chk11_back:
    v_add_f32_dpp v231, v231, v231 row_ror:4 row_mask:0xf bank_mask:0xf
    v_mfma_f32_16x16x32_bf16 v[28:31], a[164:167], v[124:127], v[28:31]
    s_waitcnt lgkmcnt(6)
    ds_read_b64_tr_b16 v[112:113], v170 offset:57344
    v_add_f32_dpp v230, v230, v230 row_ror:2 row_mask:0xf bank_mask:0xf
    v_add_f32_dpp v231, v231, v231 row_ror:2 row_mask:0xf bank_mask:0xf
    v_mfma_f32_16x16x32_bf16 v[32:35], a[156:159], v[128:131], v[32:35]
    ds_read_b64_tr_b16 v[114:115], v170 offset:59392
    v_add_f32_dpp v230, v230, v230 row_ror:1 row_mask:0xf bank_mask:0xf
    v_add_f32_dpp v231, v231, v231 row_ror:1 row_mask:0xf bank_mask:0xf
    v_mfma_f32_16x16x32_bf16 v[36:39], a[160:163], v[128:131], v[36:39]
    buffer_load_dword v241, v242, s[36:39], s56 offen sc1
    v_mfma_f32_16x16x32_bf16 v[40:43], a[164:167], v[128:131], v[40:43]
    ds_read_b64_tr_b16 v[116:117], v171 offset:57344
    s_mov_b32 exec_lo, 0x00010001
    s_mov_b32 exec_hi, 0x00010001
    ds_write_b64 v210, v[230:231]
    s_mov_b64 exec, -1
    s_waitcnt lgkmcnt(8)
    v_mfma_f32_16x16x32_bf16 v[44:47], a[156:159], v[132:135], v[44:47]
    s_waitcnt lgkmcnt(3)
    ds_read_b64_tr_b16 v[118:119], v171 offset:59392
    v_mov_b32 v213, s48
    v_mov_b32 v215, s48
    v_mfma_f32_16x16x32_bf16 v[48:51], a[160:163], v[132:135], v[48:51]
    s_add_u32 m0, s63, 81920
    v_mfma_f32_16x16x32_bf16 v[52:55], a[164:167], v[132:135], v[52:55]
    buffer_load_dwordx4 v172, s[36:39], s10 offen sc1 lds
    v_mfma_f32_16x16x32_bf16 v[8:11], a[168:171], v[104:107], v[8:11]
    ds_read_b64_tr_b16 v[120:121], v168 offset:61440
    v_mfma_f32_16x16x32_bf16 v[12:15], a[172:175], v[104:107], v[12:15]
    s_waitcnt lgkmcnt(2)
    s_barrier
    ds_read_b64_tr_b16 v[122:123], v168 offset:63488
    v_add_u32 v168, 65536, v168
    v_mfma_f32_16x16x32_bf16 v[16:19], a[176:179], v[104:107], v[16:19]
    s_add_u32 m0, s63, 86016
    ds_read_b64_tr_b16 v[124:125], v169 offset:61440
    ds_read2_b32 v[230:231], v211 offset0:0 offset1:4
    ds_read2_b32 v[232:233], v211 offset0:8 offset1:12
    v_mfma_f32_16x16x32_bf16 v[20:23], a[168:171], v[108:111], v[20:23]
    buffer_load_dwordx4 v172, s[36:39], s11 offen sc1 lds
    v_mfma_f32_16x16x32_bf16 v[24:27], a[172:175], v[108:111], v[24:27]
    ds_read_b64_tr_b16 v[126:127], v169 offset:63488
    v_add_u32 v169, 65536, v169
    ds_read2_b32 v[234:235], v211 offset0:16 offset1:20
    v_mfma_f32_16x16x32_bf16 v[28:31], a[176:179], v[108:111], v[28:31]
    ds_read_b64_tr_b16 v[128:129], v170 offset:61440
    ds_read2_b32 v[236:237], v211 offset0:24 offset1:28
    v_mfma_f32_16x16x32_bf16 v[32:35], a[168:171], v[112:115], v[32:35]
    s_add_u32 m0, s63, 90112
    ds_read_b64_tr_b16 v[130:131], v170 offset:63488
    v_add_u32 v170, 65536, v170
    v_mfma_f32_16x16x32_bf16 v[36:39], a[172:175], v[112:115], v[36:39]
    buffer_load_dwordx4 v172, s[36:39], s12 offen sc1 lds
    v_mfma_f32_16x16x32_bf16 v[40:43], a[176:179], v[112:115], v[40:43]
    s_waitcnt lgkmcnt(10)
    ds_read_b64_tr_b16 v[132:133], v171 offset:61440
    v_mfma_f32_16x16x32_bf16 v[44:47], a[168:171], v[116:119], v[44:47]
    s_waitcnt lgkmcnt(3)
    ds_read_b64_tr_b16 v[134:135], v171 offset:63488
    v_add_u32 v171, 65536, v171
    v_add_f32 v230, v230, v232
    v_mfma_f32_16x16x32_bf16 v[48:51], a[172:175], v[116:119], v[48:51]
    s_add_u32 m0, s63, 94208
    v_add_f32 v231, v231, v233
    s_waitcnt lgkmcnt(3)
    v_add_f32 v234, v234, v236
    v_add_f32 v235, v235, v237
    v_mfma_f32_16x16x32_bf16 v[52:55], a[176:179], v[116:119], v[52:55]
    buffer_load_dwordx4 v172, s[36:39], s13 offen sc1 lds
    v_mfma_f32_16x16x32_bf16 v[8:11], a[180:183], v[120:123], v[8:11]
    ds_read_b64_tr_b16 v[104:105], v168 offset:0
    v_add_f32 v230, v230, v234
    v_add_f32 v231, v231, v235
    v_mfma_f32_16x16x32_bf16 v[12:15], a[184:187], v[120:123], v[12:15]
    ds_read_b64_tr_b16 v[106:107], v168 offset:2048
    v_mul_f32 v230, 0x3acccccd, v230
    v_mul_f32 v234, v230, v230
    v_mfma_f32_16x16x32_bf16 v[16:19], a[188:191], v[120:123], v[16:19]
    s_add_u32 m0, s63, 98304
    ds_read_b64_tr_b16 v[108:109], v169 offset:0
    v_mov_b32 v212, 0x3acccccd
    v_fma_f32 v231, v231, v212, -v234
    v_mfma_f32_16x16x32_bf16 v[20:23], a[180:183], v[124:127], v[20:23]
    buffer_load_dwordx4 v172, s[36:39], s14 offen sc1 lds
    v_mfma_f32_16x16x32_bf16 v[24:27], a[184:187], v[124:127], v[24:27]
    ds_read_b64_tr_b16 v[110:111], v169 offset:2048
    v_max_f32 v231, 0, v231
    v_add_f32 v231, 0x3727c5ac, v231
    v_mfma_f32_16x16x32_bf16 v[28:31], a[188:191], v[124:127], v[28:31]
    ds_read_b64_tr_b16 v[112:113], v170 offset:0
    v_rsq_f32 v212, v231
    s_nop 0
    v_mul_f32_e64 v214, -v230, v212
    s_waitcnt lgkmcnt(7)
    v_mfma_f32_16x16x32_bf16 v[32:35], a[180:183], v[128:131], v[32:35]
    s_add_u32 m0, s63, 102400
    ds_read_b64_tr_b16 v[114:115], v170 offset:2048
    v_mfma_f32_16x16x32_bf16 v[36:39], a[184:187], v[128:131], v[36:39]
    buffer_load_dwordx4 v172, s[36:39], s15 offen sc1 lds
    v_mfma_f32_16x16x32_bf16 v[40:43], a[188:191], v[128:131], v[40:43]
    s_waitcnt lgkmcnt(6)
    ds_read_b64_tr_b16 v[116:117], v171 offset:0
    v_mfma_f32_16x16x32_bf16 v[44:47], a[180:183], v[132:135], v[44:47]
    s_waitcnt lgkmcnt(3)
    ds_read_b64_tr_b16 v[118:119], v171 offset:2048
    v_mfma_f32_16x16x32_bf16 v[48:51], a[184:187], v[132:135], v[48:51]
    s_add_u32 m0, s63, 106496
    s_mov_b64 exec, 0xf
    buffer_store_dwordx4 v[212:215], v248, s[36:39], s7 offen sc1
    s_mov_b64 exec, -1
    v_mfma_f32_16x16x32_bf16 v[52:55], a[188:191], v[132:135], v[52:55]
    buffer_load_dwordx4 v172, s[36:39], s18 offen sc1 lds
    v_mfma_f32_16x16x32_bf16 v[8:11], a[192:195], v[104:107], v[8:11]
    ds_read_b64_tr_b16 v[120:121], v168 offset:4096
    v_mfma_f32_16x16x32_bf16 v[12:15], a[196:199], v[104:107], v[12:15]
    ds_read_b64_tr_b16 v[122:123], v168 offset:6144
    v_mfma_f32_16x16x32_bf16 v[16:19], a[200:203], v[104:107], v[16:19]
    s_add_u32 m0, s63, 110592
    ds_read_b64_tr_b16 v[124:125], v169 offset:4096
    v_mfma_f32_16x16x32_bf16 v[20:23], a[192:195], v[108:111], v[20:23]
    buffer_load_dwordx4 v172, s[36:39], s19 offen sc1 lds
    v_mfma_f32_16x16x32_bf16 v[24:27], a[196:199], v[108:111], v[24:27]
    ds_read_b64_tr_b16 v[126:127], v169 offset:6144
    v_mfma_f32_16x16x32_bf16 v[28:31], a[200:203], v[108:111], v[28:31]
    s_waitcnt lgkmcnt(6)
    ds_read_b64_tr_b16 v[128:129], v170 offset:4096
    v_mfma_f32_16x16x32_bf16 v[32:35], a[192:195], v[112:115], v[32:35]
    s_add_u32 m0, s63, 114688
    ds_read_b64_tr_b16 v[130:131], v170 offset:6144
    v_mfma_f32_16x16x32_bf16 v[36:39], a[196:199], v[112:115], v[36:39]
    buffer_load_dwordx4 v172, s[36:39], s20 offen sc1 lds
    v_mfma_f32_16x16x32_bf16 v[40:43], a[200:203], v[112:115], v[40:43]
    ds_read_b64_tr_b16 v[132:133], v171 offset:4096
    s_waitcnt vmcnt(9)
    v_cmp_ne_u32 vcc, s48, v241
    s_cbranch_vccnz L_chk12_slow
L_chk12_back:
    s_waitcnt lgkmcnt(7)
    v_mfma_f32_16x16x32_bf16 v[44:47], a[192:195], v[116:119], v[44:47]
    s_waitcnt lgkmcnt(3)
    ds_read_b64_tr_b16 v[134:135], v171 offset:6144
    v_mfma_f32_16x16x32_bf16 v[48:51], a[196:199], v[116:119], v[48:51]
    s_add_u32 m0, s63, 118784
    v_mfma_f32_16x16x32_bf16 v[52:55], a[200:203], v[116:119], v[52:55]
    buffer_load_dwordx4 v172, s[36:39], s21 offen sc1 lds
    v_mfma_f32_16x16x32_bf16 v[8:11], a[204:207], v[120:123], v[8:11]
    ds_read_b64_tr_b16 v[104:105], v168 offset:8192
    v_mfma_f32_16x16x32_bf16 v[12:15], a[208:211], v[120:123], v[12:15]
    ds_read_b64_tr_b16 v[106:107], v168 offset:10240
    v_mfma_f32_16x16x32_bf16 v[16:19], a[212:215], v[120:123], v[16:19]
    s_add_u32 m0, s63, 122880
    ds_read_b64_tr_b16 v[108:109], v169 offset:8192
    v_mfma_f32_16x16x32_bf16 v[20:23], a[204:207], v[124:127], v[20:23]
    buffer_load_dwordx4 v172, s[36:39], s22 offen sc1 lds
    v_mfma_f32_16x16x32_bf16 v[24:27], a[208:211], v[124:127], v[24:27]
    ds_read_b64_tr_b16 v[110:111], v169 offset:10240
    v_mfma_f32_16x16x32_bf16 v[28:31], a[212:215], v[124:127], v[28:31]
    s_waitcnt lgkmcnt(6)
    ds_read_b64_tr_b16 v[112:113], v170 offset:8192
    v_mfma_f32_16x16x32_bf16 v[32:35], a[204:207], v[128:131], v[32:35]
    s_add_u32 m0, s63, 126976
    ds_read_b64_tr_b16 v[114:115], v170 offset:10240
    v_mfma_f32_16x16x32_bf16 v[36:39], a[208:211], v[128:131], v[36:39]
    buffer_load_dwordx4 v172, s[36:39], s23 offen sc1 lds
    v_mfma_f32_16x16x32_bf16 v[40:43], a[212:215], v[128:131], v[40:43]
    s_waitcnt lgkmcnt(6)
    ds_read_b64_tr_b16 v[116:117], v171 offset:8192
    v_mfma_f32_16x16x32_bf16 v[44:47], a[204:207], v[132:135], v[44:47]
    s_waitcnt lgkmcnt(3)
    ds_read_b64_tr_b16 v[118:119], v171 offset:10240
    v_mfma_f32_16x16x32_bf16 v[48:51], a[208:211], v[132:135], v[48:51]
    s_add_u32 m0, s63, 131072
    v_mfma_f32_16x16x32_bf16 v[52:55], a[212:215], v[132:135], v[52:55]
    buffer_load_dwordx4 v172, s[36:39], s24 offen sc1 lds
    v_mfma_f32_16x16x32_bf16 v[8:11], a[216:219], v[104:107], v[8:11]
    ds_read_b64_tr_b16 v[120:121], v168 offset:12288
    v_mfma_f32_16x16x32_bf16 v[12:15], a[220:223], v[104:107], v[12:15]
    ds_read_b64_tr_b16 v[122:123], v168 offset:14336
    v_add_u32 v168, 16384, v168
    v_mfma_f32_16x16x32_bf16 v[16:19], a[224:227], v[104:107], v[16:19]
    s_add_u32 m0, s63, 135168
    ds_read_b64_tr_b16 v[124:125], v169 offset:12288
    v_mfma_f32_16x16x32_bf16 v[20:23], a[216:219], v[108:111], v[20:23]
    buffer_load_dwordx4 v172, s[36:39], s25 offen sc1 lds
    v_mfma_f32_16x16x32_bf16 v[24:27], a[220:223], v[108:111], v[24:27]
    ds_read_b64_tr_b16 v[126:127], v169 offset:14336
    v_add_u32 v169, 16384, v169
    v_mfma_f32_16x16x32_bf16 v[28:31], a[224:227], v[108:111], v[28:31]
    s_waitcnt lgkmcnt(6)
    ds_read_b64_tr_b16 v[128:129], v170 offset:12288
    v_mfma_f32_16x16x32_bf16 v[32:35], a[216:219], v[112:115], v[32:35]
    s_add_u32 m0, s63, 139264
    ds_read_b64_tr_b16 v[130:131], v170 offset:14336
    v_add_u32 v170, 16384, v170
    v_mfma_f32_16x16x32_bf16 v[36:39], a[220:223], v[112:115], v[36:39]
    buffer_load_dwordx4 v172, s[36:39], s26 offen sc1 lds
    v_mfma_f32_16x16x32_bf16 v[40:43], a[224:227], v[112:115], v[40:43]
    s_waitcnt lgkmcnt(6)
    ds_read_b64_tr_b16 v[132:133], v171 offset:12288
    v_mfma_f32_16x16x32_bf16 v[44:47], a[216:219], v[116:119], v[44:47]
    s_waitcnt lgkmcnt(3)
    ds_read_b64_tr_b16 v[134:135], v171 offset:14336
    v_add_u32 v171, 16384, v171
    v_mfma_f32_16x16x32_bf16 v[48:51], a[220:223], v[116:119], v[48:51]
    s_add_u32 m0, s63, 143360
    v_mfma_f32_16x16x32_bf16 v[52:55], a[224:227], v[116:119], v[52:55]
    buffer_load_dwordx4 v172, s[36:39], s27 offen sc1 lds
    v_mfma_f32_16x16x32_bf16 v[8:11], a[228:231], v[120:123], v[8:11]
    s_waitcnt vmcnt(12)
    s_barrier
    ds_read_b64_tr_b16 v[104:105], v168 offset:0
    v_mfma_f32_16x16x32_bf16 v[12:15], a[232:235], v[120:123], v[12:15]
    ds_read_b64_tr_b16 v[106:107], v168 offset:2048
    v_mfma_f32_16x16x32_bf16 v[16:19], a[236:239], v[120:123], v[16:19]
    s_add_u32 m0, s63, 147456
    ds_read_b64_tr_b16 v[108:109], v169 offset:0
    v_mfma_f32_16x16x32_bf16 v[20:23], a[228:231], v[124:127], v[20:23]
    buffer_load_dwordx4 v172, s[36:39], s44 offen sc1 lds
    v_mfma_f32_16x16x32_bf16 v[24:27], a[232:235], v[124:127], v[24:27]
    ds_read_b64_tr_b16 v[110:111], v169 offset:2048
    v_mfma_f32_16x16x32_bf16 v[28:31], a[236:239], v[124:127], v[28:31]
    s_waitcnt lgkmcnt(6)
    ds_read_b64_tr_b16 v[112:113], v170 offset:0
    v_mfma_f32_16x16x32_bf16 v[32:35], a[228:231], v[128:131], v[32:35]
    s_add_u32 m0, s63, 151552
    ds_read_b64_tr_b16 v[114:115], v170 offset:2048
    v_mfma_f32_16x16x32_bf16 v[36:39], a[232:235], v[128:131], v[36:39]
    buffer_load_dwordx4 v172, s[36:39], s45 offen sc1 lds
    v_mfma_f32_16x16x32_bf16 v[40:43], a[236:239], v[128:131], v[40:43]
    s_waitcnt lgkmcnt(6)
    ds_read_b64_tr_b16 v[116:117], v171 offset:0
    v_mfma_f32_16x16x32_bf16 v[44:47], a[228:231], v[132:135], v[44:47]
    s_waitcnt lgkmcnt(3)
    ds_read_b64_tr_b16 v[118:119], v171 offset:2048
    v_mfma_f32_16x16x32_bf16 v[48:51], a[232:235], v[132:135], v[48:51]
    s_add_u32 m0, s63, 155648
    v_mfma_f32_16x16x32_bf16 v[52:55], a[236:239], v[132:135], v[52:55]
    buffer_load_dwordx4 v172, s[36:39], s46 offen sc1 lds
    s_branch L_passB
L_prep:
    s_mov_b32 s36, s32
    s_mov_b32 s37, s33
    s_mov_b32 s38, 0x10000000
    s_mov_b32 s39, 0x20000
    s_cmp_eq_u32 s3, 3
    s_cbranch_scc0 L_noft
    s_lshl_b32 s50, s71, 12
    s_add_u32 s51, s50, 23199744
    s_add_u32 s52, s50, 22806528
    s_cmp_lt_u32 s71, 64
    s_cselect_b32 s51, s51, s52
    s_add_u32 s52, s50, 23199744
    s_cmp_lt_u32 s71, 80
    s_cselect_b32 s51, s51, s52
    v_and_b32 v2, 31, v1
    v_lshlrev_b32 v2, 7, v2
    buffer_load_dword v205, v2, s[36:39], s51 offen
L_noft:
    s_cmp_lt_u32 s71, 32
    s_cbranch_scc1 L_p_q
    s_sub_u32 s76, s71, 32
    s_sub_u32 s50, s76, 30
    s_cmp_lt_u32 s50, 10
    s_cselect_b32 s51, 10, 0
    s_sub_u32 s50, s76, 40
    s_cmp_lt_u32 s50, 10
    s_cselect_b32 s51, -10, s51
    s_add_u32 s76, s76, s51
    v_min_u32 v2, 39, v1
    s_mul_i32 s50, s3, 320
    v_lshl_add_u32 v60, v2, 3, s50
    global_load_dwordx2 v[62:63], v60, s[24:25]
    s_and_b32 s50, s3, 1
    s_mul_i32 s50, s50, 49152
    s_mul_i32 s64, s73, 192
    s_add_u32 s64, s64, s50
    s_mul_i32 s50, s34, 98304
    s_add_u32 s64, s64, s50
    s_cmp_ge_u32 s3, 2
    s_cselect_b32 s40, s20, s18
    s_cselect_b32 s41, s21, s19
    s_cselect_b32 s50, 1, 0
    s_mov_b32 s42, 1966080
    s_mov_b32 s43, 0x20000
    s_mul_i32 s61, s3, 3072
    v_add_u32 v2, 0, v1
    v_mul_u32_u24 v3, 171, v2
    v_lshrrev_b32 v3, 11, v3
    v_mul_u32_u24 v4, 12, v3
    v_sub_u32 v4, v2, v4
    v_bfe_u32 v2, v3, 2, 1
    v_lshl_add_u32 v2, v2, 1, s50
    v_xor_b32 v4, v4, v2
    v_mul_u32_u24 v3, 3072, v3
    v_lshl_add_u32 v228, v4, 4, v3
    v_add_u32 v2, 64, v1
    v_mul_u32_u24 v3, 171, v2
    v_lshrrev_b32 v3, 11, v3
    v_mul_u32_u24 v4, 12, v3
    v_sub_u32 v4, v2, v4
    v_bfe_u32 v2, v3, 2, 1
    v_lshl_add_u32 v2, v2, 1, s50
    v_xor_b32 v4, v4, v2
    v_mul_u32_u24 v3, 3072, v3
    v_lshl_add_u32 v229, v4, 4, v3
    v_subrev_u32 v229, 1024, v229
    v_add_u32 v2, 128, v1
    v_mul_u32_u24 v3, 171, v2
    v_lshrrev_b32 v3, 11, v3
    v_mul_u32_u24 v4, 12, v3
    v_sub_u32 v4, v2, v4
    v_bfe_u32 v2, v3, 2, 1
    v_lshl_add_u32 v2, v2, 1, s50
    v_xor_b32 v4, v4, v2
    v_mul_u32_u24 v3, 3072, v3
    v_lshl_add_u32 v230, v4, 4, v3
    v_subrev_u32 v230, 2048, v230
    v_lshrrev_b32 v2, 2, v1
    v_mul_u32_u24 v2, 192, v2
    v_and_b32 v3, 1, v1
    v_lshl_add_u32 v2, v3, 3, v2
    s_mul_i32 s50, s3, 3
    v_bfe_u32 v3, v1, 4, 1
    v_lshlrev_b32 v3, 1, v3
    v_bfe_u32 v4, v1, 1, 1
    v_add_u32 v231, s50, v4
    v_xor_b32 v231, v231, v3
    v_lshl_add_u32 v231, v231, 4, v2
    v_xor_b32 v232, 16, v231
    s_add_u32 s50, s50, 2
    v_xor_b32 v3, v3, v4
    v_xor_b32 v3, s50, v3
    v_lshl_add_u32 v3, v3, 4, v2
    v_mul_u32_u24 v4, 6144, v4
    v_add_u32 v233, v3, v4
    v_bfe_u32 v2, v1, 4, 1
    v_bfe_u32 v3, v1, 2, 2
    v_lshl_add_u32 v3, v2, 3, v3
    v_mul_u32_u24 v3, 1280, v3
    v_and_b32 v28, 3, v1
    v_lshl_add_u32 v3, v28, 3, v3
    v_lshrrev_b32 v29, 5, v1
    v_mul_u32_u24 v28, 160, v29
    s_mul_i32 s50, s3, 320
    s_add_u32 s50, s50, 140288
    v_add3_u32 v28, v28, v3, s50
    v_mul_u32_u24 v29, 245760, v29
    v_and_b32 v2, 31, v1
    v_lshl_add_u32 v29, v2, 4, v29
    s_lshr_b32 s50, s71, 1
    s_mov_b32 s51, 0x15555556
    s_mul_hi_u32 s51, s50, s51
    s_mul_i32 s52, s51, 12
    s_sub_u32 s52, s50, s52
    s_lshl_b32 s50, s3, 3
    s_add_u32 s50, s50, s51
    s_mul_i32 s50, s50, 60
    s_mul_i32 s52, s52, 5
    s_add_u32 s50, s50, s52
    s_lshl_b32 s50, s50, 10
    s_and_b32 s51, s71, 1
    s_lshl_b32 s51, s51, 9
    s_add_u32 s50, s50, s51
    s_add_u32 s68, s50, 14417920
    s_add_u32 s69, s68, 4096
    s_waitcnt lgkmcnt(0)
    s_mul_i32 s48, s48, 0x9E3779B1
    s_add_u32 s48, s48, 0x7F4A7C15
    s_and_b32 s48, s48, -16
    s_getreg_b32 s30, hwreg(HW_REG_XCC_ID, 0, 4)
    s_or_b32 s30, s30, s48
    s_cmp_eq_u32 s3, 1
    s_cbranch_scc0 L_id13
    s_lshl_b32 s50, s2, 7
    s_add_u32 s50, s50, 23199744
    v_mov_b32 v254, 0
    v_mov_b32 v255, s30
    s_mov_b64 exec, 1
    buffer_store_dword v255, v254, s[36:39], s50 offen sc1
    s_mov_b64 exec, -1
L_id13:
    s_mul_i32 s60, s3, 21760
    s_add_u32 s60, s60, 0
    s_mov_b32 s50, 0xbfb8aa3b
    s_waitcnt vmcnt(0)
    v_lshlrev_b32 v64, 16, v62
    v_and_b32 v65, 0xffff0000, v62
    v_lshlrev_b32 v66, 16, v63
    v_and_b32 v67, 0xffff0000, v63
    v_mul_f32 v68, s50, v64
    v_mul_f32 v69, s50, v65
    v_mul_f32 v70, s50, v66
    v_mul_f32 v71, s50, v67
    v_exp_f32 v68, v68
    v_exp_f32 v69, v69
    v_exp_f32 v70, v70
    v_exp_f32 v71, v71
    v_add_f32 v68, 1.0, v68
    v_add_f32 v69, 1.0, v69
    v_add_f32 v70, 1.0, v70
    v_add_f32 v71, 1.0, v71
    v_rcp_f32 v68, v68
    v_rcp_f32 v69, v69
    v_rcp_f32 v70, v70
    v_rcp_f32 v71, v71
    v_mul_f32 v64, v64, v68
    v_mul_f32 v65, v65, v69
    v_mul_f32 v66, v66, v70
    v_mul_f32 v67, v67, v71
    v_cvt_pk_bf16_f32 v62, v64, v65
    v_cvt_pk_bf16_f32 v63, v66, v67
    v_add_u32 v60, 87040, v60
    ds_write_b64 v60, v[62:63]
    s_mov_b32 s50, 0
    v_bfe_u32 v2, v1, 2, 2
    v_bfe_u32 v4, v1, 1, 1
    v_lshl_add_u32 v4, s50, 1, v4
    v_and_b32 v64, 2, v2
    v_xor_b32 v4, v4, v64
    v_lshlrev_b32 v2, 7, v2
    v_lshl_add_u32 v2, v4, 4, v2
    v_and_b32 v4, 1, v1
    v_lshl_add_u32 v2, v4, 3, v2
    v_lshrrev_b32 v4, 4, v1
    v_mul_u32_u24 v4, 1088, v4
    v_add_u32 v64, v2, v4
    v_xor_b32 v65, 32, v64
    v_add_u32 v64, s60, v64
    v_add_u32 v65, s60, v65
    v_and_b32 v66, 48, v1
    s_mul_i32 s50, s3, 320
    s_add_u32 s50, s50, 87040
    v_add_u32 v66, s50, v66
    ds_read_b128 v[72:75], v66 offset:0
    ds_read_b128 v[76:79], v66 offset:64
    ds_read_b128 v[80:83], v66 offset:128
    ds_read_b128 v[84:87], v66 offset:192
    ds_read_b128 v[88:91], v66 offset:256
    s_mov_b32 s44, s26
    s_mov_b32 s45, s27
    s_mov_b32 s46, 0x4b0000
    s_mov_b32 s47, 0x20000
    v_lshrrev_b32 v2, 3, v1
    v_and_b32 v4, 2, v2
    v_xor_b32 v4, v4, v1
    v_and_b32 v4, 7, v4
    v_mul_u32_u24 v2, 7680, v2
    v_lshl_add_u32 v61, v4, 4, v2
    s_mul_i32 s59, s3, 1228800
    s_lshl_b32 s50, s76, 7
    s_add_u32 s59, s59, s50
    s_cmp_lt_u32 s76, 60
    s_cselect_b32 s59, s59, 4915200
    s_add_u32 m0, s60, 0
    s_nop 0
    buffer_load_dwordx4 v61, s[44:47], s59 offen nt lds
    s_add_u32 s59, s59, 61440
    s_add_u32 m0, s60, 1088
    s_nop 0
    buffer_load_dwordx4 v61, s[44:47], s59 offen nt lds
    s_add_u32 s59, s59, 61440
    s_add_u32 m0, s60, 2176
    s_nop 0
    buffer_load_dwordx4 v61, s[44:47], s59 offen nt lds
    s_add_u32 s59, s59, 61440
    s_add_u32 m0, s60, 3264
    s_nop 0
    buffer_load_dwordx4 v61, s[44:47], s59 offen nt lds
    s_add_u32 s59, s59, 61440
    s_add_u32 m0, s60, 4352
    s_nop 0
    buffer_load_dwordx4 v61, s[44:47], s59 offen nt lds
    s_add_u32 s59, s59, 61440
    s_add_u32 m0, s60, 5440
    s_nop 0
    buffer_load_dwordx4 v61, s[44:47], s59 offen nt lds
    s_add_u32 s59, s59, 61440
    s_add_u32 m0, s60, 6528
    s_nop 0
    buffer_load_dwordx4 v61, s[44:47], s59 offen nt lds
    s_add_u32 s59, s59, 61440
    s_add_u32 m0, s60, 7616
    s_nop 0
    buffer_load_dwordx4 v61, s[44:47], s59 offen nt lds
    s_add_u32 s59, s59, 61440
    s_add_u32 m0, s60, 8704
    s_nop 0
    buffer_load_dwordx4 v61, s[44:47], s59 offen nt lds
    s_add_u32 s59, s59, 61440
    s_add_u32 m0, s60, 9792
    s_nop 0
    buffer_load_dwordx4 v61, s[44:47], s59 offen nt lds
    s_add_u32 s59, s59, 61440
    s_mov_b32 s66, s22
    s_mov_b32 s67, s23
    v_lshrrev_b32 v2, 3, v1
    v_bfe_u32 v3, v1, 4, 2
    v_lshlrev_b32 v3, 1, v3
    v_xor_b32 v3, v3, v1
    v_and_b32 v3, 7, v3
    v_mul_u32_u24 v2, 4096, v2
    v_lshl_add_u32 v172, v3, 4, v2
    v_add_u32 v172, 8650752, v172
    v_lshrrev_b32 v2, 2, v1
    v_lshlrev_b32 v2, 7, v2
    v_and_b32 v3, 3, v1
    v_lshl_add_u32 v2, v3, 3, v2
    v_bfe_u32 v3, v1, 3, 2
    v_xor_b32 v168, 0, v3
    v_lshl_add_u32 v168, v168, 5, v2
    v_xor_b32 v169, 1, v3
    v_lshl_add_u32 v169, v169, 5, v2
    v_xor_b32 v170, 2, v3
    v_lshl_add_u32 v170, v170, 5, v2
    v_xor_b32 v171, 3, v3
    v_lshl_add_u32 v171, v171, 5, v2
    v_and_b32 v175, 15, v1
    v_lshlrev_b32 v175, 4, v175
    v_bfe_u32 v2, v1, 4, 1
    v_lshrrev_b32 v3, 5, v1
    v_mul_u32_u24 v173, 49152, v2
    v_lshl_add_u32 v173, v3, 8, v173
    v_add_u32 v173, v173, v175
    v_lshl_add_u32 v2, v2, 1, v3
    v_mul_u32_u24 v174, 49152, v2
    v_add_u32 v174, v174, v175
    v_bfe_u32 v2, v0, 1, 2
    v_lshlrev_b32 v2, 1, v2
    s_lshr_b32 s50, s73, 1
    v_xor_b32 v2, s50, v2
    v_lshlrev_b32 v2, 4, v2
    v_lshl_add_u32 v216, v0, 7, v2
    s_and_b32 s50, s73, 1
    s_lshl_b32 s50, s50, 3
    v_add_u32 v216, s50, v216
    v_add_u32 v217, 0x8000, v216
    v_add_u32 v218, 0x10000, v216
    v_cmp_gt_u32 vcc, 128, v0
    s_nop 1
    v_cndmask_b32 v218, v217, v218, vcc
    v_lshrrev_b32 v2, 1, v1
    v_lshlrev_b32 v2, 9, v2
    v_and_b32 v3, 1, v1
    v_lshl_add_u32 v219, v3, 2, v2
    s_lshl_b32 s50, s3, 7
    s_add_u32 s50, s50, 112640
    v_add_u32 v219, s50, v219
    v_min_u32 v2, 49, v1
    v_lshlrev_b32 v2, 7, v2
    v_add_u32 v2, 98304, v2
    v_cmp_lt_u32 vcc, 39, v1
    s_nop 1
    v_cndmask_b32 v219, v219, v2, vcc
    s_mov_b32 s17, 23199744
    s_lshl_b32 s77, s34, 7
    v_lshl_add_u32 v220, v0, 2, s77
    v_add_u32 v221, 1024, v220
    v_add_u32 v222, 2048, v220
    v_subrev_u32 v2, 2560, v220
    v_min_u32 v220, v220, v2
    v_subrev_u32 v2, 2560, v221
    v_min_u32 v221, v221, v2
    v_subrev_u32 v2, 2560, v222
    v_min_u32 v222, v222, v2
    v_mov_b32 v2, 0x80000000
    v_cmp_gt_u32 vcc, 128, v0
    s_nop 1
    v_cndmask_b32 v222, v2, v222, vcc
    s_mov_b32 s77, 23183360
    s_lshl_b32 s65, s75, 2
    s_add_u32 s65, s65, s3
    s_mul_i32 s65, s65, 61440
    s_add_u32 s65, s65, 14417920
    s_mov_b32 s16, 0
    s_and_b32 s16, s16, 3
    s_add_u32 s62, s16, 0
    s_and_b32 s62, s62, 3
    s_mul_i32 s62, s62, 15360
    s_add_u32 s62, s62, s65
    s_movk_i32 s4, 4096
    s_movk_i32 s5, 8192
    s_lshl_b32 s6, s72, 10
    s_add_u32 s6, s6, 23101440
    s_lshl_b32 s7, s73, 6
    s_add_u32 s7, s7, s6
    s_mul_i32 s8, s72, 768
    s_mul_i32 s50, s73, 12
    s_add_u32 s8, s8, s50
    s_mul_i32 s50, s3, 3
    s_add_u32 s8, s8, s50
    s_lshl_b32 s8, s8, 8
    s_add_u32 s8, s8, 16777216
    s_lshl_b32 s9, s73, 2
    s_add_u32 s9, s9, s3
    s_mul_i32 s9, s9, 384
    s_add_u32 s9, s9, 23527424
    s_mul_i32 s51, s3, 32768
    s_lshl_b32 s50, s72, 7
    s_add_u32 s51, s51, s50
    s_mul_i32 s50, s34, 131072
    s_add_u32 s10, s51, s50
    s_lshl_b32 s63, s3, 10
    s_add_u32 s11, s10, 131072
    s_sub_u32 s51, s11, 2621440
    s_min_u32 s11, s11, s51
    s_add_u32 s12, s11, 131072
    s_sub_u32 s51, s12, 2621440
    s_min_u32 s12, s12, s51
    s_add_u32 s13, s12, 131072
    s_sub_u32 s51, s13, 2621440
    s_min_u32 s13, s13, s51
    s_add_u32 s14, s13, 131072
    s_sub_u32 s51, s14, 2621440
    s_min_u32 s14, s14, s51
    s_add_u32 s15, s14, 131072
    s_sub_u32 s51, s15, 2621440
    s_min_u32 s15, s15, s51
    s_add_u32 s18, s15, 131072
    s_sub_u32 s51, s18, 2621440
    s_min_u32 s18, s18, s51
    s_add_u32 s19, s18, 131072
    s_sub_u32 s51, s19, 2621440
    s_min_u32 s19, s19, s51
    s_add_u32 s20, s19, 131072
    s_sub_u32 s51, s20, 2621440
    s_min_u32 s20, s20, s51
    s_add_u32 s21, s20, 131072
    s_sub_u32 s51, s21, 2621440
    s_min_u32 s21, s21, s51
    s_add_u32 s22, s21, 131072
    s_sub_u32 s51, s22, 2621440
    s_min_u32 s22, s22, s51
    s_add_u32 s23, s22, 131072
    s_sub_u32 s51, s23, 2621440
    s_min_u32 s23, s23, s51
    s_add_u32 s24, s23, 131072
    s_sub_u32 s51, s24, 2621440
    s_min_u32 s24, s24, s51
    s_add_u32 s25, s24, 131072
    s_sub_u32 s51, s25, 2621440
    s_min_u32 s25, s25, s51
    s_add_u32 s26, s25, 131072
    s_sub_u32 s51, s26, 2621440
    s_min_u32 s26, s26, s51
    s_add_u32 s27, s26, 131072
    s_sub_u32 s51, s27, 2621440
    s_min_u32 s27, s27, s51
    s_add_u32 m0, s60, 10880
    s_nop 0
    buffer_load_dwordx4 v61, s[44:47], s59 offen nt lds
    s_add_u32 s59, s59, 61440
    s_add_u32 m0, s60, 11968
    s_nop 0
    buffer_load_dwordx4 v61, s[44:47], s59 offen nt lds
    s_add_u32 s59, s59, 61440
    s_add_u32 m0, s60, 13056
    s_nop 0
    buffer_load_dwordx4 v61, s[44:47], s59 offen nt lds
    s_add_u32 s59, s59, 61440
    s_add_u32 m0, s60, 14144
    s_nop 0
    buffer_load_dwordx4 v61, s[44:47], s59 offen nt lds
    s_add_u32 s59, s59, 61440
    s_add_u32 m0, s60, 15232
    s_nop 0
    buffer_load_dwordx4 v61, s[44:47], s59 offen nt lds
    s_add_u32 s59, s59, 61440
    s_add_u32 m0, s60, 16320
    s_nop 0
    buffer_load_dwordx4 v61, s[44:47], s59 offen nt lds
    s_add_u32 s59, s59, 61440
    s_add_u32 m0, s60, 17408
    s_nop 0
    buffer_load_dwordx4 v61, s[44:47], s59 offen nt lds
    s_add_u32 s59, s59, 61440
    s_add_u32 m0, s60, 18496
    s_nop 0
    buffer_load_dwordx4 v61, s[44:47], s59 offen nt lds
    s_add_u32 s59, s59, 61440
    s_add_u32 m0, s60, 19584
    s_nop 0
    buffer_load_dwordx4 v61, s[44:47], s59 offen nt lds
    s_add_u32 s59, s59, 61440
    s_add_u32 m0, s60, 20672
    s_nop 0
    buffer_load_dwordx4 v61, s[44:47], s59 offen nt lds
    s_mov_b32 s44, s66
    s_mov_b32 s45, s67
    s_mov_b32 s46, 0x1e0000
    s_mov_b32 s47, 0x20000
    s_mul_i32 s52, s71, 20480
    s_mul_i32 s53, s3, 5120
    s_add_u32 s52, s52, s53
    s_add_u32 m0, s53, 140288
    s_nop 0
    buffer_load_dwordx4 v248, s[44:47], s52 offen offset:0 nt lds
    buffer_load_dwordx4 v248, s[44:47], s52 offen offset:1024 nt lds
    buffer_load_dwordx4 v248, s[44:47], s52 offen offset:2048 nt lds
    buffer_load_dwordx4 v248, s[44:47], s52 offen offset:3072 nt lds
    s_add_u32 m0, s53, 144384
    s_add_u32 s52, s52, 4096
    buffer_load_dwordx4 v248, s[44:47], s52 offen offset:0 nt lds
    s_add_u32 s44, s27, 131072
    s_sub_u32 s51, s44, 2621440
    s_min_u32 s44, s44, s51
    s_add_u32 s45, s44, 131072
    s_sub_u32 s51, s45, 2621440
    s_min_u32 s45, s45, s51
    s_add_u32 s46, s45, 131072
    s_sub_u32 s51, s46, 2621440
    s_min_u32 s46, s46, s51
    s_add_u32 s47, s46, 131072
    s_sub_u32 s51, s47, 2621440
    s_min_u32 s47, s47, s51
    s_lshr_b32 s50, s2, 3
    s_and_b32 s50, s50, 15
    s_lshl_b32 s50, s50, 1
    s_and_b32 s51, s3, 1
    s_add_u32 s50, s50, s51
    s_mul_i32 s50, s50, 49152
    s_lshr_b32 s51, s73, 2
    s_mul_i32 s51, s51, 768
    s_add_u32 s50, s50, s51
    s_add_u32 s50, s50, 0
    v_add_u32 v2, 0, v1
    v_min_u32 v2, 95, v2
    v_mul_u32_u24 v3, 10923, v2
    v_lshrrev_b32 v3, 16, v3
    v_mul_u32_u24 v4, 6, v3
    v_sub_u32 v4, v2, v4
    v_mul_u32_u24 v3, 3072, v3
    v_lshl_add_u32 v2, v4, 7, v3
    buffer_load_dword v200, v2, s[40:43], s50 offen
    v_add_u32 v2, 64, v1
    v_min_u32 v2, 95, v2
    v_mul_u32_u24 v3, 10923, v2
    v_lshrrev_b32 v3, 16, v3
    v_mul_u32_u24 v4, 6, v3
    v_sub_u32 v4, v2, v4
    v_mul_u32_u24 v3, 3072, v3
    v_lshl_add_u32 v2, v4, 7, v3
    buffer_load_dword v201, v2, s[40:43], s50 offen
    s_waitcnt vmcnt(23)
    ds_read_b64_tr_b16 v[112:113], v64 offset:0
    ds_read_b64_tr_b16 v[114:115], v64 offset:512
    ds_read_b64_tr_b16 v[116:117], v65 offset:0
    ds_read_b64_tr_b16 v[118:119], v65 offset:512
    ds_read_b64_tr_b16 v[120:121], v64 offset:64
    ds_read_b64_tr_b16 v[122:123], v64 offset:576
    ds_read_b64_tr_b16 v[124:125], v65 offset:64
    ds_read_b64_tr_b16 v[126:127], v65 offset:576
    s_waitcnt lgkmcnt(6)
    v_mfma_f32_16x16x32_bf16 v[96:99], v[112:115], v[72:75], 0
    s_waitcnt lgkmcnt(4)
    v_mfma_f32_16x16x32_bf16 v[100:103], v[116:119], v[72:75], 0
    s_waitcnt lgkmcnt(2)
    v_mfma_f32_16x16x32_bf16 v[104:107], v[120:123], v[72:75], 0
    s_waitcnt lgkmcnt(0)
    v_mfma_f32_16x16x32_bf16 v[108:111], v[124:127], v[72:75], 0
    s_waitcnt vmcnt(19)
    ds_read_b64_tr_b16 v[128:129], v64 offset:4352
    ds_read_b64_tr_b16 v[130:131], v64 offset:4864
    ds_read_b64_tr_b16 v[132:133], v65 offset:4352
    ds_read_b64_tr_b16 v[134:135], v65 offset:4864
    ds_read_b64_tr_b16 v[136:137], v64 offset:4416
    ds_read_b64_tr_b16 v[138:139], v64 offset:4928
    ds_read_b64_tr_b16 v[140:141], v65 offset:4416
    ds_read_b64_tr_b16 v[142:143], v65 offset:4928
    s_waitcnt lgkmcnt(6)
    v_mfma_f32_16x16x32_bf16 v[96:99], v[128:131], v[76:79], v[96:99]
    s_waitcnt lgkmcnt(4)
    v_mfma_f32_16x16x32_bf16 v[100:103], v[132:135], v[76:79], v[100:103]
    s_waitcnt lgkmcnt(2)
    v_mfma_f32_16x16x32_bf16 v[104:107], v[136:139], v[76:79], v[104:107]
    s_waitcnt lgkmcnt(0)
    v_mfma_f32_16x16x32_bf16 v[108:111], v[140:143], v[76:79], v[108:111]
    s_waitcnt vmcnt(15)
    ds_read_b64_tr_b16 v[112:113], v64 offset:8704
    ds_read_b64_tr_b16 v[114:115], v64 offset:9216
    ds_read_b64_tr_b16 v[116:117], v65 offset:8704
    ds_read_b64_tr_b16 v[118:119], v65 offset:9216
    ds_read_b64_tr_b16 v[120:121], v64 offset:8768
    ds_read_b64_tr_b16 v[122:123], v64 offset:9280
    ds_read_b64_tr_b16 v[124:125], v65 offset:8768
    ds_read_b64_tr_b16 v[126:127], v65 offset:9280
    s_waitcnt lgkmcnt(6)
    v_mfma_f32_16x16x32_bf16 v[96:99], v[112:115], v[80:83], v[96:99]
    s_waitcnt lgkmcnt(4)
    v_mfma_f32_16x16x32_bf16 v[100:103], v[116:119], v[80:83], v[100:103]
    s_waitcnt lgkmcnt(2)
    v_mfma_f32_16x16x32_bf16 v[104:107], v[120:123], v[80:83], v[104:107]
    s_waitcnt lgkmcnt(0)
    v_mfma_f32_16x16x32_bf16 v[108:111], v[124:127], v[80:83], v[108:111]
    s_waitcnt vmcnt(11)
    ds_read_b64_tr_b16 v[128:129], v64 offset:13056
    ds_read_b64_tr_b16 v[130:131], v64 offset:13568
    ds_read_b64_tr_b16 v[132:133], v65 offset:13056
    ds_read_b64_tr_b16 v[134:135], v65 offset:13568
    ds_read_b64_tr_b16 v[136:137], v64 offset:13120
    ds_read_b64_tr_b16 v[138:139], v64 offset:13632
    ds_read_b64_tr_b16 v[140:141], v65 offset:13120
    ds_read_b64_tr_b16 v[142:143], v65 offset:13632
    s_waitcnt lgkmcnt(6)
    v_mfma_f32_16x16x32_bf16 v[96:99], v[128:131], v[84:87], v[96:99]
    s_waitcnt lgkmcnt(4)
    v_mfma_f32_16x16x32_bf16 v[100:103], v[132:135], v[84:87], v[100:103]
    s_waitcnt lgkmcnt(2)
    v_mfma_f32_16x16x32_bf16 v[104:107], v[136:139], v[84:87], v[104:107]
    s_waitcnt lgkmcnt(0)
    v_mfma_f32_16x16x32_bf16 v[108:111], v[140:143], v[84:87], v[108:111]
    s_waitcnt vmcnt(7)
    ds_read_b64_tr_b16 v[112:113], v64 offset:17408
    ds_read_b64_tr_b16 v[114:115], v64 offset:17920
    ds_read_b64_tr_b16 v[116:117], v65 offset:17408
    ds_read_b64_tr_b16 v[118:119], v65 offset:17920
    ds_read_b64_tr_b16 v[120:121], v64 offset:17472
    ds_read_b64_tr_b16 v[122:123], v64 offset:17984
    ds_read_b64_tr_b16 v[124:125], v65 offset:17472
    ds_read_b64_tr_b16 v[126:127], v65 offset:17984
    s_waitcnt lgkmcnt(6)
    v_mfma_f32_16x16x32_bf16 v[96:99], v[112:115], v[88:91], v[96:99]
    s_waitcnt lgkmcnt(4)
    v_mfma_f32_16x16x32_bf16 v[100:103], v[116:119], v[88:91], v[100:103]
    s_waitcnt lgkmcnt(2)
    v_mfma_f32_16x16x32_bf16 v[104:107], v[120:123], v[88:91], v[104:107]
    s_waitcnt lgkmcnt(0)
    v_mfma_f32_16x16x32_bf16 v[108:111], v[124:127], v[88:91], v[108:111]
    v_and_b32 v2, 48, v1
    s_lshl_b32 s50, s3, 8
    s_add_u32 s50, s50, 88320
    v_add_u32 v2, s50, v2
    v_lshlrev_b32 v3, 2, v1
    v_add_u32 v3, 88320, v3
    s_mov_b32 exec_lo, 0x00010001
    s_mov_b32 exec_hi, 0x00010001
    ds_write_b128 v2, v[96:99] offset:0
    ds_write_b128 v2, v[100:103] offset:64
    ds_write_b128 v2, v[104:107] offset:128
    ds_write_b128 v2, v[108:111] offset:192
    s_mov_b64 exec, -1
    s_waitcnt lgkmcnt(0)
    s_barrier
    ds_read_b32 v80, v3 offset:0
    ds_read_b32 v81, v3 offset:256
    ds_read_b32 v82, v3 offset:512
    ds_read_b32 v83, v3 offset:768
    s_waitcnt lgkmcnt(2)
    v_add_f32 v80, v80, v81
    s_waitcnt lgkmcnt(0)
    v_add_f32 v82, v82, v83
    v_add_f32 v80, v80, v82
    s_cmp_eq_u32 s3, 0
    s_cbranch_scc0 L_mod_done
    s_cmp_lt_u32 s76, 60
    s_cbranch_scc0 L_mod_done
    v_lshlrev_b32 v2, 2, v1
    s_mov_b32 s50, 429496730
    s_mul_hi_u32 s51, s76, s50
    s_mul_i32 s52, s51, 10
    s_sub_u32 s52, s76, s52
    v_cvt_pk_bf16_f32 v3, v80, v80
    v_lshlrev_b32 v3, 16, v3
    v_add_f32 v4, 1.0, v3
    v_cvt_pk_bf16_f32 v4, v4, v4
    v_lshlrev_b32 v4, 16, v4
    s_cmp_eq_u32 s51, 1
    s_cselect_b64 vcc, -1, 0
    s_cmp_eq_u32 s51, 4
    s_cselect_b64 vcc, -1, vcc
    v_cndmask_b32 v4, v3, v4, vcc
    s_cselect_b64 s[54:55], -1, 0
    v_cmp_eq_f32 vcc, 0, v4
    s_and_b64 vcc, vcc, s[54:55]
    v_mov_b32 v3, 0x2b800000
    v_cndmask_b32 v4, v4, v3, vcc
    v_mov_b32 v5, s48
    v_lshlrev_b32 v6, 3, v1
    s_lshl_b32 s53, s76, 9
    s_add_u32 s53, s53, 23560192
    buffer_store_dwordx2 v[4:5], v6, s[36:39], s53 offen sc1
    s_cmp_eq_u32 s51, 4
    s_cbranch_scc0 L_mod_noicb
    v_rcp_f32 v3, v4
    s_lshl_b32 s53, s52, 8
    s_add_u32 s53, s53, 23183360
    v_fma_f32 v5, -v4, v3, 1.0
    v_fmac_f32 v3, v5, v3
    buffer_store_dword v3, v2, s[36:39], s53 offen sc1
L_mod_noicb:
    s_lshl_b32 s53, s76, 8
    s_add_u32 s53, s53, 23134208
    buffer_store_dword v4, v2, s[36:39], s53 offen sc1
    s_sub_u32 s53, s51, 3
    s_cmp_lt_u32 s53, 2
    s_cbranch_scc0 L_mod_done
    v_mov_b32_dpp v3, v4 quad_perm:[1,0,3,2] row_mask:0xf bank_mask:0xf
    v_lshrrev_b32 v5, 16, v4
    v_or_b32 v5, v5, v3
    v_lshrrev_b32 v6, 5, v1
    v_lshlrev_b32 v6, 7, v6
    v_bfe_u32 v7, v1, 2, 2
    v_lshl_add_u32 v6, v7, 4, v6
    v_bfe_u32 v7, v1, 4, 1
    v_lshl_add_u32 v6, v7, 3, v6
    v_and_b32 v7, 2, v1
    v_lshl_add_u32 v6, v7, 1, v6
    s_xor_b32 s53, s53, 1
    s_lshl_b32 s53, s53, 6
    s_lshl_b32 s52, s52, 8
    s_add_u32 s53, s53, s52
    s_add_u32 s53, s53, 23166976
    s_mov_b32 exec_lo, 0x55555555
    s_mov_b32 exec_hi, 0x55555555
    buffer_store_dword v5, v6, s[36:39], s53 offen sc1
    s_mov_b64 exec, -1
L_mod_done:
    s_waitcnt vmcnt(0)
    s_barrier
    s_cmp_lt_u32 s76, 60
    s_cbranch_scc0 L_nofp2
    s_cmp_eq_u32 s3, 0
    s_cbranch_scc0 L_wf14
    s_lshl_b32 s54, s76, 7
    s_add_u32 s54, s54, 23298048
    v_mov_b32 v254, 0
    v_mov_b32 v255, s48
    s_mov_b64 exec, 1
    buffer_store_dword v255, v254, s[36:39], s54 offen sc1
    s_mov_b64 exec, -1
L_wf14:
L_nofp2:
    ds_read_b64_tr_b16 v[32:33], v28 offset:0
    ds_read_b64_tr_b16 v[34:35], v28 offset:5120
    ds_read_b64_tr_b16 v[36:37], v28 offset:32
    ds_read_b64_tr_b16 v[38:39], v28 offset:5152
    ds_read_b64_tr_b16 v[40:41], v28 offset:64
    ds_read_b64_tr_b16 v[42:43], v28 offset:5184
    ds_read_b64_tr_b16 v[44:45], v28 offset:96
    ds_read_b64_tr_b16 v[46:47], v28 offset:5216
    ds_read_b64_tr_b16 v[48:49], v28 offset:128
    ds_read_b64_tr_b16 v[50:51], v28 offset:5248
    s_waitcnt lgkmcnt(8)
    buffer_store_dwordx4 v[32:35], v29, s[36:39], s68 offen offset:0 sc1
    s_waitcnt lgkmcnt(6)
    buffer_store_dwordx4 v[36:39], v29, s[36:39], s68 offen offset:1024 sc1
    s_waitcnt lgkmcnt(4)
    buffer_store_dwordx4 v[40:43], v29, s[36:39], s68 offen offset:2048 sc1
    s_waitcnt lgkmcnt(2)
    buffer_store_dwordx4 v[44:47], v29, s[36:39], s68 offen offset:3072 sc1
    s_waitcnt lgkmcnt(0)
    buffer_store_dwordx4 v[48:51], v29, s[36:39], s69 offen offset:0 sc1
    v_add_u32 v231, 8192, v231
    v_add_u32 v237, 49152, v231
    v_add_u32 v232, 8192, v232
    v_add_u32 v238, 49152, v232
    v_add_u32 v233, 8192, v233
    v_add_u32 v239, 49152, v233
    s_add_u32 m0, s61, 8192
    s_nop 0
    buffer_load_dwordx4 v228, s[40:43], s64 offen offset:0 lds
    buffer_load_dwordx4 v229, s[40:43], s64 offen offset:1024 lds
    buffer_load_dwordx4 v230, s[40:43], s64 offen offset:2048 lds
    s_add_u32 s64, s64, 98304
    s_sub_u32 s35, s64, 1966080
    s_min_u32 s64, s64, s35
    s_add_u32 m0, s61, 20480
    s_nop 0
    buffer_load_dwordx4 v228, s[40:43], s64 offen offset:0 lds
    buffer_load_dwordx4 v229, s[40:43], s64 offen offset:1024 lds
    buffer_load_dwordx4 v230, s[40:43], s64 offen offset:2048 lds
    s_add_u32 s64, s64, 98304
    s_sub_u32 s35, s64, 1966080
    s_min_u32 s64, s64, s35
    s_add_u32 m0, s61, 32768
    s_nop 0
    buffer_load_dwordx4 v228, s[40:43], s64 offen offset:0 lds
    buffer_load_dwordx4 v229, s[40:43], s64 offen offset:1024 lds
    buffer_load_dwordx4 v230, s[40:43], s64 offen offset:2048 lds
    s_add_u32 s64, s64, 98304
    s_sub_u32 s35, s64, 1966080
    s_min_u32 s64, s64, s35
    s_add_u32 m0, s61, 45056
    s_nop 0
    buffer_load_dwordx4 v228, s[40:43], s64 offen offset:0 lds
    buffer_load_dwordx4 v229, s[40:43], s64 offen offset:1024 lds
    buffer_load_dwordx4 v230, s[40:43], s64 offen offset:2048 lds
    s_add_u32 s64, s64, 98304
    s_sub_u32 s35, s64, 1966080
    s_min_u32 s64, s64, s35
    s_branch L_p_w
L_p_q:
    s_and_b32 s50, s3, 1
    s_mul_i32 s50, s50, 49152
    s_mul_i32 s64, s73, 192
    s_add_u32 s64, s64, s50
    s_mul_i32 s50, s34, 98304
    s_add_u32 s64, s64, s50
    s_cmp_ge_u32 s3, 2
    s_cselect_b32 s40, s20, s18
    s_cselect_b32 s41, s21, s19
    s_cselect_b32 s50, 1, 0
    s_mov_b32 s42, 1966080
    s_mov_b32 s43, 0x20000
    s_mul_i32 s61, s3, 3072
    v_add_u32 v2, 0, v1
    v_mul_u32_u24 v3, 171, v2
    v_lshrrev_b32 v3, 11, v3
    v_mul_u32_u24 v4, 12, v3
    v_sub_u32 v4, v2, v4
    v_bfe_u32 v2, v3, 2, 1
    v_lshl_add_u32 v2, v2, 1, s50
    v_xor_b32 v4, v4, v2
    v_mul_u32_u24 v3, 3072, v3
    v_lshl_add_u32 v228, v4, 4, v3
    v_add_u32 v2, 64, v1
    v_mul_u32_u24 v3, 171, v2
    v_lshrrev_b32 v3, 11, v3
    v_mul_u32_u24 v4, 12, v3
    v_sub_u32 v4, v2, v4
    v_bfe_u32 v2, v3, 2, 1
    v_lshl_add_u32 v2, v2, 1, s50
    v_xor_b32 v4, v4, v2
    v_mul_u32_u24 v3, 3072, v3
    v_lshl_add_u32 v229, v4, 4, v3
    v_subrev_u32 v229, 1024, v229
    v_add_u32 v2, 128, v1
    v_mul_u32_u24 v3, 171, v2
    v_lshrrev_b32 v3, 11, v3
    v_mul_u32_u24 v4, 12, v3
    v_sub_u32 v4, v2, v4
    v_bfe_u32 v2, v3, 2, 1
    v_lshl_add_u32 v2, v2, 1, s50
    v_xor_b32 v4, v4, v2
    v_mul_u32_u24 v3, 3072, v3
    v_lshl_add_u32 v230, v4, 4, v3
    v_subrev_u32 v230, 2048, v230
    v_lshrrev_b32 v2, 2, v1
    v_mul_u32_u24 v2, 192, v2
    v_and_b32 v3, 1, v1
    v_lshl_add_u32 v2, v3, 3, v2
    s_mul_i32 s50, s3, 3
    v_bfe_u32 v3, v1, 4, 1
    v_lshlrev_b32 v3, 1, v3
    v_bfe_u32 v4, v1, 1, 1
    v_add_u32 v231, s50, v4
    v_xor_b32 v231, v231, v3
    v_lshl_add_u32 v231, v231, 4, v2
    v_xor_b32 v232, 16, v231
    s_add_u32 s50, s50, 2
    v_xor_b32 v3, v3, v4
    v_xor_b32 v3, s50, v3
    v_lshl_add_u32 v3, v3, 4, v2
    v_mul_u32_u24 v4, 6144, v4
    v_add_u32 v233, v3, v4
    s_waitcnt lgkmcnt(0)
    s_mul_i32 s48, s48, 0x9E3779B1
    s_add_u32 s48, s48, 0x7F4A7C15
    s_and_b32 s48, s48, -16
    s_getreg_b32 s30, hwreg(HW_REG_XCC_ID, 0, 4)
    s_or_b32 s30, s30, s48
    s_cmp_eq_u32 s3, 1
    s_cbranch_scc0 L_id15
    s_lshl_b32 s50, s2, 7
    s_add_u32 s50, s50, 23199744
    v_mov_b32 v254, 0
    v_mov_b32 v255, s30
    s_mov_b64 exec, 1
    buffer_store_dword v255, v254, s[36:39], s50 offen sc1
    s_mov_b64 exec, -1
L_id15:
    s_mov_b32 s44, s4
    s_mov_b32 s45, s5
    s_mov_b32 s46, 0x280000
    s_mov_b32 s47, 0x20000
    s_lshl_b32 s50, s71, 2
    s_add_u32 s50, s50, s3
    s_mul_i32 s56, s50, 10240
    v_lshrrev_b32 v2, 4, v1
    v_mul_u32_u24 v2, 1280, v2
    v_and_b32 v3, 15, v1
    v_lshl_add_u32 v31, v3, 4, v2
    buffer_load_dwordx4 v[64:67], v31, s[44:47], s56 offen offset:0
    buffer_load_dwordx4 v[68:71], v31, s[44:47], s56 offen offset:256
    buffer_load_dwordx4 v[72:75], v31, s[44:47], s56 offen offset:512
    buffer_load_dwordx4 v[76:79], v31, s[44:47], s56 offen offset:768
    buffer_load_dwordx4 v[80:83], v31, s[44:47], s56 offen offset:1024
    s_add_u32 s56, s56, 5120
    buffer_load_dwordx4 v[84:87], v31, s[44:47], s56 offen offset:0
    buffer_load_dwordx4 v[88:91], v31, s[44:47], s56 offen offset:256
    buffer_load_dwordx4 v[92:95], v31, s[44:47], s56 offen offset:512
    buffer_load_dwordx4 v[96:99], v31, s[44:47], s56 offen offset:768
    buffer_load_dwordx4 v[100:103], v31, s[44:47], s56 offen offset:1024
    s_add_u32 s56, s56, 1305600
    s_lshr_b32 s50, s2, 3
    s_and_b32 s50, s50, 15
    s_lshl_b32 s50, s50, 1
    s_and_b32 s51, s3, 1
    s_add_u32 s50, s50, s51
    s_mul_i32 s50, s50, 49152
    s_lshr_b32 s51, s73, 2
    s_mul_i32 s51, s51, 768
    s_add_u32 s50, s50, s51
    s_add_u32 s50, s50, 0
    v_add_u32 v2, 0, v1
    v_min_u32 v2, 95, v2
    v_mul_u32_u24 v3, 10923, v2
    v_lshrrev_b32 v3, 16, v3
    v_mul_u32_u24 v4, 6, v3
    v_sub_u32 v4, v2, v4
    v_mul_u32_u24 v3, 3072, v3
    v_lshl_add_u32 v2, v4, 7, v3
    buffer_load_dword v200, v2, s[40:43], s50 offen
    v_add_u32 v2, 64, v1
    v_min_u32 v2, 95, v2
    v_mul_u32_u24 v3, 10923, v2
    v_lshrrev_b32 v3, 16, v3
    v_mul_u32_u24 v4, 6, v3
    v_sub_u32 v4, v2, v4
    v_mul_u32_u24 v3, 3072, v3
    v_lshl_add_u32 v2, v4, 7, v3
    buffer_load_dword v201, v2, s[40:43], s50 offen
    v_bfe_u32 v2, v1, 4, 1
    v_bfe_u32 v3, v1, 2, 2
    v_lshl_add_u32 v3, v2, 3, v3
    v_mul_u32_u24 v3, 1280, v3
    v_and_b32 v28, 3, v1
    v_lshl_add_u32 v3, v28, 3, v3
    v_lshrrev_b32 v29, 5, v1
    v_mul_u32_u24 v28, 160, v29
    s_mul_i32 s50, s3, 320
    s_add_u32 s50, s50, 140288
    v_add3_u32 v28, v28, v3, s50
    v_mul_u32_u24 v29, 245760, v29
    v_and_b32 v2, 31, v1
    v_lshl_add_u32 v29, v2, 4, v29
    s_lshr_b32 s50, s71, 1
    s_mov_b32 s51, 0x15555556
    s_mul_hi_u32 s51, s50, s51
    s_mul_i32 s52, s51, 12
    s_sub_u32 s52, s50, s52
    s_lshl_b32 s50, s3, 3
    s_add_u32 s50, s50, s51
    s_mul_i32 s50, s50, 60
    s_mul_i32 s52, s52, 5
    s_add_u32 s50, s50, s52
    s_lshl_b32 s50, s50, 10
    s_and_b32 s51, s71, 1
    s_lshl_b32 s51, s51, 9
    s_add_u32 s50, s50, s51
    s_add_u32 s68, s50, 14417920
    s_add_u32 s69, s68, 4096
    s_mov_b32 s66, s22
    s_mov_b32 s67, s23
    v_lshrrev_b32 v2, 3, v1
    v_bfe_u32 v3, v1, 4, 2
    v_lshlrev_b32 v3, 1, v3
    v_xor_b32 v3, v3, v1
    v_and_b32 v3, 7, v3
    v_mul_u32_u24 v2, 4096, v2
    v_lshl_add_u32 v172, v3, 4, v2
    v_add_u32 v172, 8650752, v172
    v_lshrrev_b32 v2, 2, v1
    v_lshlrev_b32 v2, 7, v2
    v_and_b32 v3, 3, v1
    v_lshl_add_u32 v2, v3, 3, v2
    v_bfe_u32 v3, v1, 3, 2
    v_xor_b32 v168, 0, v3
    v_lshl_add_u32 v168, v168, 5, v2
    v_xor_b32 v169, 1, v3
    v_lshl_add_u32 v169, v169, 5, v2
    v_xor_b32 v170, 2, v3
    v_lshl_add_u32 v170, v170, 5, v2
    v_xor_b32 v171, 3, v3
    v_lshl_add_u32 v171, v171, 5, v2
    v_and_b32 v175, 15, v1
    v_lshlrev_b32 v175, 4, v175
    v_bfe_u32 v2, v1, 4, 1
    v_lshrrev_b32 v3, 5, v1
    v_mul_u32_u24 v173, 49152, v2
    v_lshl_add_u32 v173, v3, 8, v173
    v_add_u32 v173, v173, v175
    v_lshl_add_u32 v2, v2, 1, v3
    v_mul_u32_u24 v174, 49152, v2
    v_add_u32 v174, v174, v175
    v_bfe_u32 v2, v0, 1, 2
    v_lshlrev_b32 v2, 1, v2
    s_lshr_b32 s50, s73, 1
    v_xor_b32 v2, s50, v2
    v_lshlrev_b32 v2, 4, v2
    v_lshl_add_u32 v216, v0, 7, v2
    s_and_b32 s50, s73, 1
    s_lshl_b32 s50, s50, 3
    v_add_u32 v216, s50, v216
    v_add_u32 v217, 0x8000, v216
    v_add_u32 v218, 0x10000, v216
    v_cmp_gt_u32 vcc, 128, v0
    s_nop 1
    v_cndmask_b32 v218, v217, v218, vcc
    v_lshrrev_b32 v2, 1, v1
    v_lshlrev_b32 v2, 9, v2
    v_and_b32 v3, 1, v1
    v_lshl_add_u32 v219, v3, 2, v2
    s_lshl_b32 s50, s3, 7
    s_add_u32 s50, s50, 112640
    v_add_u32 v219, s50, v219
    v_min_u32 v2, 49, v1
    v_lshlrev_b32 v2, 7, v2
    v_add_u32 v2, 98304, v2
    v_cmp_lt_u32 vcc, 39, v1
    s_nop 1
    v_cndmask_b32 v219, v219, v2, vcc
    s_mov_b32 s17, 23199744
    s_lshl_b32 s77, s34, 7
    v_lshl_add_u32 v220, v0, 2, s77
    v_add_u32 v221, 1024, v220
    v_add_u32 v222, 2048, v220
    v_subrev_u32 v2, 2560, v220
    v_min_u32 v220, v220, v2
    v_subrev_u32 v2, 2560, v221
    v_min_u32 v221, v221, v2
    v_subrev_u32 v2, 2560, v222
    v_min_u32 v222, v222, v2
    v_mov_b32 v2, 0x80000000
    v_cmp_gt_u32 vcc, 128, v0
    s_nop 1
    v_cndmask_b32 v222, v2, v222, vcc
    s_mov_b32 s77, 23183360
    s_lshl_b32 s65, s75, 2
    s_add_u32 s65, s65, s3
    s_mul_i32 s65, s65, 61440
    s_add_u32 s65, s65, 14417920
    s_mov_b32 s16, 0
    s_and_b32 s16, s16, 3
    s_add_u32 s62, s16, 0
    s_and_b32 s62, s62, 3
    s_mul_i32 s62, s62, 15360
    s_add_u32 s62, s62, s65
    s_movk_i32 s4, 4096
    s_movk_i32 s5, 8192
    s_lshl_b32 s6, s72, 10
    s_add_u32 s6, s6, 23101440
    s_lshl_b32 s7, s73, 6
    s_add_u32 s7, s7, s6
    s_mul_i32 s8, s72, 768
    s_mul_i32 s50, s73, 12
    s_add_u32 s8, s8, s50
    s_mul_i32 s50, s3, 3
    s_add_u32 s8, s8, s50
    s_lshl_b32 s8, s8, 8
    s_add_u32 s8, s8, 16777216
    s_lshl_b32 s9, s73, 2
    s_add_u32 s9, s9, s3
    s_mul_i32 s9, s9, 384
    s_add_u32 s9, s9, 23527424
    s_mul_i32 s51, s3, 32768
    s_lshl_b32 s50, s72, 7
    s_add_u32 s51, s51, s50
    s_mul_i32 s50, s34, 131072
    s_add_u32 s10, s51, s50
    s_lshl_b32 s63, s3, 10
    s_add_u32 s11, s10, 131072
    s_sub_u32 s51, s11, 2621440
    s_min_u32 s11, s11, s51
    s_add_u32 s12, s11, 131072
    s_sub_u32 s51, s12, 2621440
    s_min_u32 s12, s12, s51
    s_add_u32 s13, s12, 131072
    s_sub_u32 s51, s13, 2621440
    s_min_u32 s13, s13, s51
    s_add_u32 s14, s13, 131072
    s_sub_u32 s51, s14, 2621440
    s_min_u32 s14, s14, s51
    s_add_u32 s15, s14, 131072
    s_sub_u32 s51, s15, 2621440
    s_min_u32 s15, s15, s51
    s_add_u32 s18, s15, 131072
    s_sub_u32 s51, s18, 2621440
    s_min_u32 s18, s18, s51
    s_add_u32 s19, s18, 131072
    s_sub_u32 s51, s19, 2621440
    s_min_u32 s19, s19, s51
    s_add_u32 s20, s19, 131072
    s_sub_u32 s51, s20, 2621440
    s_min_u32 s20, s20, s51
    s_add_u32 s21, s20, 131072
    s_sub_u32 s51, s21, 2621440
    s_min_u32 s21, s21, s51
    s_add_u32 s22, s21, 131072
    s_sub_u32 s51, s22, 2621440
    s_min_u32 s22, s22, s51
    s_add_u32 s23, s22, 131072
    s_sub_u32 s51, s23, 2621440
    s_min_u32 s23, s23, s51
    s_add_u32 s24, s23, 131072
    s_sub_u32 s51, s24, 2621440
    s_min_u32 s24, s24, s51
    s_add_u32 s25, s24, 131072
    s_sub_u32 s51, s25, 2621440
    s_min_u32 s25, s25, s51
    s_add_u32 s26, s25, 131072
    s_sub_u32 s51, s26, 2621440
    s_min_u32 s26, s26, s51
    s_add_u32 s27, s26, 131072
    s_sub_u32 s51, s27, 2621440
    s_min_u32 s27, s27, s51
    v_lshrrev_b32 v2, 4, v1
    v_and_b32 v3, 15, v1
    v_lshl_add_u32 v2, v3, 2, v2
    v_lshlrev_b32 v30, 2, v2
    s_lshl_b32 s57, s71, 2
    s_add_u32 s57, s57, s3
    s_lshl_b32 s57, s57, 5
    s_add_u32 s57, s57, 23068672
    s_mov_b32 s55, 0x3f803f80
    v_mov_b32 v180, 0
    v_mov_b32 v181, 0
    v_mov_b32 v182, 0
    v_mov_b32 v183, 0
    s_waitcnt vmcnt(11)
    v_dot2_f32_bf16 v180, v64, s55, v180
    v_dot2_f32_bf16 v182, v64, v64, v182
    s_waitcnt vmcnt(6)
    v_dot2_f32_bf16 v181, v84, s55, v181
    v_dot2_f32_bf16 v183, v84, v84, v183
    v_dot2_f32_bf16 v180, v65, s55, v180
    v_dot2_f32_bf16 v182, v65, v65, v182
    v_dot2_f32_bf16 v181, v85, s55, v181
    v_dot2_f32_bf16 v183, v85, v85, v183
    v_dot2_f32_bf16 v180, v66, s55, v180
    v_dot2_f32_bf16 v182, v66, v66, v182
    v_dot2_f32_bf16 v181, v86, s55, v181
    v_dot2_f32_bf16 v183, v86, v86, v183
    v_dot2_f32_bf16 v180, v67, s55, v180
    v_dot2_f32_bf16 v182, v67, v67, v182
    v_dot2_f32_bf16 v181, v87, s55, v181
    v_dot2_f32_bf16 v183, v87, v87, v183
    v_dot2_f32_bf16 v180, v68, s55, v180
    v_dot2_f32_bf16 v182, v68, v68, v182
    s_waitcnt vmcnt(5)
    v_dot2_f32_bf16 v181, v88, s55, v181
    v_dot2_f32_bf16 v183, v88, v88, v183
    v_dot2_f32_bf16 v180, v69, s55, v180
    v_dot2_f32_bf16 v182, v69, v69, v182
    v_dot2_f32_bf16 v181, v89, s55, v181
    v_dot2_f32_bf16 v183, v89, v89, v183
    v_dot2_f32_bf16 v180, v70, s55, v180
    v_dot2_f32_bf16 v182, v70, v70, v182
    v_dot2_f32_bf16 v181, v90, s55, v181
    v_dot2_f32_bf16 v183, v90, v90, v183
    v_dot2_f32_bf16 v180, v71, s55, v180
    v_dot2_f32_bf16 v182, v71, v71, v182
    v_dot2_f32_bf16 v181, v91, s55, v181
    v_dot2_f32_bf16 v183, v91, v91, v183
    v_dot2_f32_bf16 v180, v72, s55, v180
    v_dot2_f32_bf16 v182, v72, v72, v182
    s_waitcnt vmcnt(4)
    v_dot2_f32_bf16 v181, v92, s55, v181
    v_dot2_f32_bf16 v183, v92, v92, v183
    v_dot2_f32_bf16 v180, v73, s55, v180
    v_dot2_f32_bf16 v182, v73, v73, v182
    v_dot2_f32_bf16 v181, v93, s55, v181
    v_dot2_f32_bf16 v183, v93, v93, v183
    v_dot2_f32_bf16 v180, v74, s55, v180
    v_dot2_f32_bf16 v182, v74, v74, v182
    v_dot2_f32_bf16 v181, v94, s55, v181
    v_dot2_f32_bf16 v183, v94, v94, v183
    v_dot2_f32_bf16 v180, v75, s55, v180
    v_dot2_f32_bf16 v182, v75, v75, v182
    v_dot2_f32_bf16 v181, v95, s55, v181
    v_dot2_f32_bf16 v183, v95, v95, v183
    v_dot2_f32_bf16 v180, v76, s55, v180
    v_dot2_f32_bf16 v182, v76, v76, v182
    s_waitcnt vmcnt(3)
    v_dot2_f32_bf16 v181, v96, s55, v181
    v_dot2_f32_bf16 v183, v96, v96, v183
    v_dot2_f32_bf16 v180, v77, s55, v180
    v_dot2_f32_bf16 v182, v77, v77, v182
    v_dot2_f32_bf16 v181, v97, s55, v181
    v_dot2_f32_bf16 v183, v97, v97, v183
    v_dot2_f32_bf16 v180, v78, s55, v180
    v_dot2_f32_bf16 v182, v78, v78, v182
    v_dot2_f32_bf16 v181, v98, s55, v181
    v_dot2_f32_bf16 v183, v98, v98, v183
    v_dot2_f32_bf16 v180, v79, s55, v180
    v_dot2_f32_bf16 v182, v79, v79, v182
    v_dot2_f32_bf16 v181, v99, s55, v181
    v_dot2_f32_bf16 v183, v99, v99, v183
    v_dot2_f32_bf16 v180, v80, s55, v180
    v_dot2_f32_bf16 v182, v80, v80, v182
    s_waitcnt vmcnt(2)
    v_dot2_f32_bf16 v181, v100, s55, v181
    v_dot2_f32_bf16 v183, v100, v100, v183
    v_dot2_f32_bf16 v180, v81, s55, v180
    v_dot2_f32_bf16 v182, v81, v81, v182
    v_dot2_f32_bf16 v181, v101, s55, v181
    v_dot2_f32_bf16 v183, v101, v101, v183
    v_dot2_f32_bf16 v180, v82, s55, v180
    v_dot2_f32_bf16 v182, v82, v82, v182
    v_dot2_f32_bf16 v181, v102, s55, v181
    v_dot2_f32_bf16 v183, v102, v102, v183
    v_dot2_f32_bf16 v180, v83, s55, v180
    v_dot2_f32_bf16 v182, v83, v83, v182
    v_dot2_f32_bf16 v181, v103, s55, v181
    v_dot2_f32_bf16 v183, v103, v103, v183
    v_add_f32_dpp v180, v180, v180 row_ror:8 row_mask:0xf bank_mask:0xf
    s_nop 0
    v_add_f32_dpp v181, v181, v181 row_ror:8 row_mask:0xf bank_mask:0xf
    v_add_f32_dpp v182, v182, v182 row_ror:8 row_mask:0xf bank_mask:0xf
    v_add_f32_dpp v183, v183, v183 row_ror:8 row_mask:0xf bank_mask:0xf
    v_add_f32_dpp v180, v180, v180 row_ror:4 row_mask:0xf bank_mask:0xf
    v_add_f32_dpp v181, v181, v181 row_ror:4 row_mask:0xf bank_mask:0xf
    v_add_f32_dpp v182, v182, v182 row_ror:4 row_mask:0xf bank_mask:0xf
    v_add_f32_dpp v183, v183, v183 row_ror:4 row_mask:0xf bank_mask:0xf
    v_add_f32_dpp v180, v180, v180 row_ror:2 row_mask:0xf bank_mask:0xf
    v_add_f32_dpp v181, v181, v181 row_ror:2 row_mask:0xf bank_mask:0xf
    v_add_f32_dpp v182, v182, v182 row_ror:2 row_mask:0xf bank_mask:0xf
    v_add_f32_dpp v183, v183, v183 row_ror:2 row_mask:0xf bank_mask:0xf
    v_add_f32_dpp v180, v180, v180 row_ror:1 row_mask:0xf bank_mask:0xf
    v_add_f32_dpp v181, v181, v181 row_ror:1 row_mask:0xf bank_mask:0xf
    v_add_f32_dpp v182, v182, v182 row_ror:1 row_mask:0xf bank_mask:0xf
    v_add_f32_dpp v183, v183, v183 row_ror:1 row_mask:0xf bank_mask:0xf
    v_and_b32 v3, 15, v1
    v_cmp_eq_u32 vcc, 1, v3
    s_nop 1
    v_cndmask_b32 v180, v180, v181, vcc
    v_cndmask_b32 v182, v182, v183, vcc
    v_mul_f32 v180, 0x3acccccd, v180
    v_mul_f32 v186, v180, v180
    v_mov_b32 v184, 0x3acccccd
    v_fma_f32 v182, v182, v184, -v186
    v_max_f32 v182, 0, v182
    v_add_f32 v182, 0x3727c5ac, v182
    v_rsq_f32 v184, v182
    s_nop 0
    v_mul_f32_e64 v185, -v180, v184
    s_add_u32 s51, s57, 8192
    s_mov_b32 exec_lo, 0x00030003
    s_mov_b32 exec_hi, 0x00030003
    buffer_store_dword v184, v30, s[36:39], s57 offen sc1
    buffer_store_dword v185, v30, s[36:39], s51 offen sc1
    s_mov_b64 exec, -1
    s_add_u32 s57, s57, 4096
    buffer_load_dwordx4 v[104:107], v31, s[44:47], s56 offen offset:0
    buffer_load_dwordx4 v[108:111], v31, s[44:47], s56 offen offset:256
    buffer_load_dwordx4 v[112:115], v31, s[44:47], s56 offen offset:512
    buffer_load_dwordx4 v[116:119], v31, s[44:47], s56 offen offset:768
    buffer_load_dwordx4 v[120:123], v31, s[44:47], s56 offen offset:1024
    s_add_u32 s56, s56, 5120
    buffer_load_dwordx4 v[124:127], v31, s[44:47], s56 offen offset:0
    buffer_load_dwordx4 v[128:131], v31, s[44:47], s56 offen offset:256
    buffer_load_dwordx4 v[132:135], v31, s[44:47], s56 offen offset:512
    buffer_load_dwordx4 v[136:139], v31, s[44:47], s56 offen offset:768
    buffer_load_dwordx4 v[140:143], v31, s[44:47], s56 offen offset:1024
    s_mov_b32 s44, s66
    s_mov_b32 s45, s67
    s_mov_b32 s46, 0x1e0000
    s_mov_b32 s47, 0x20000
    s_mul_i32 s52, s71, 20480
    s_mul_i32 s53, s3, 5120
    s_add_u32 s52, s52, s53
    s_add_u32 m0, s53, 140288
    s_nop 0
    buffer_load_dwordx4 v248, s[44:47], s52 offen offset:0 nt lds
    buffer_load_dwordx4 v248, s[44:47], s52 offen offset:1024 nt lds
    buffer_load_dwordx4 v248, s[44:47], s52 offen offset:2048 nt lds
    buffer_load_dwordx4 v248, s[44:47], s52 offen offset:3072 nt lds
    s_add_u32 m0, s53, 144384
    s_add_u32 s52, s52, 4096
    buffer_load_dwordx4 v248, s[44:47], s52 offen offset:0 nt lds
    s_add_u32 s44, s27, 131072
    s_sub_u32 s51, s44, 2621440
    s_min_u32 s44, s44, s51
    s_add_u32 s45, s44, 131072
    s_sub_u32 s51, s45, 2621440
    s_min_u32 s45, s45, s51
    s_add_u32 s46, s45, 131072
    s_sub_u32 s51, s46, 2621440
    s_min_u32 s46, s46, s51
    s_add_u32 s47, s46, 131072
    s_sub_u32 s51, s47, 2621440
    s_min_u32 s47, s47, s51
    s_waitcnt vmcnt(15)
    s_barrier
    s_cmp_eq_u32 s3, 0
    s_cbranch_scc0 L_wf16
    s_lshl_b32 s54, s71, 7
    s_add_u32 s54, s54, 23293952
    v_mov_b32 v254, 0
    v_mov_b32 v255, s48
    s_mov_b64 exec, 1
    buffer_store_dword v255, v254, s[36:39], s54 offen sc1
    s_mov_b64 exec, -1
L_wf16:
    v_mov_b32 v188, 0
    v_mov_b32 v189, 0
    v_mov_b32 v190, 0
    v_mov_b32 v191, 0
    s_waitcnt vmcnt(14)
    v_dot2_f32_bf16 v188, v104, s55, v188
    v_dot2_f32_bf16 v190, v104, v104, v190
    s_waitcnt vmcnt(9)
    v_dot2_f32_bf16 v189, v124, s55, v189
    v_dot2_f32_bf16 v191, v124, v124, v191
    v_dot2_f32_bf16 v188, v105, s55, v188
    v_dot2_f32_bf16 v190, v105, v105, v190
    v_dot2_f32_bf16 v189, v125, s55, v189
    v_dot2_f32_bf16 v191, v125, v125, v191
    v_dot2_f32_bf16 v188, v106, s55, v188
    v_dot2_f32_bf16 v190, v106, v106, v190
    v_dot2_f32_bf16 v189, v126, s55, v189
    v_dot2_f32_bf16 v191, v126, v126, v191
    v_dot2_f32_bf16 v188, v107, s55, v188
    v_dot2_f32_bf16 v190, v107, v107, v190
    v_dot2_f32_bf16 v189, v127, s55, v189
    v_dot2_f32_bf16 v191, v127, v127, v191
    v_dot2_f32_bf16 v188, v108, s55, v188
    v_dot2_f32_bf16 v190, v108, v108, v190
    s_waitcnt vmcnt(8)
    v_dot2_f32_bf16 v189, v128, s55, v189
    v_dot2_f32_bf16 v191, v128, v128, v191
    v_dot2_f32_bf16 v188, v109, s55, v188
    v_dot2_f32_bf16 v190, v109, v109, v190
    v_dot2_f32_bf16 v189, v129, s55, v189
    v_dot2_f32_bf16 v191, v129, v129, v191
    v_dot2_f32_bf16 v188, v110, s55, v188
    v_dot2_f32_bf16 v190, v110, v110, v190
    v_dot2_f32_bf16 v189, v130, s55, v189
    v_dot2_f32_bf16 v191, v130, v130, v191
    v_dot2_f32_bf16 v188, v111, s55, v188
    v_dot2_f32_bf16 v190, v111, v111, v190
    v_dot2_f32_bf16 v189, v131, s55, v189
    v_dot2_f32_bf16 v191, v131, v131, v191
    v_dot2_f32_bf16 v188, v112, s55, v188
    v_dot2_f32_bf16 v190, v112, v112, v190
    s_waitcnt vmcnt(7)
    v_dot2_f32_bf16 v189, v132, s55, v189
    v_dot2_f32_bf16 v191, v132, v132, v191
    v_dot2_f32_bf16 v188, v113, s55, v188
    v_dot2_f32_bf16 v190, v113, v113, v190
    v_dot2_f32_bf16 v189, v133, s55, v189
    v_dot2_f32_bf16 v191, v133, v133, v191
    v_dot2_f32_bf16 v188, v114, s55, v188
    v_dot2_f32_bf16 v190, v114, v114, v190
    v_dot2_f32_bf16 v189, v134, s55, v189
    v_dot2_f32_bf16 v191, v134, v134, v191
    v_dot2_f32_bf16 v188, v115, s55, v188
    v_dot2_f32_bf16 v190, v115, v115, v190
    v_dot2_f32_bf16 v189, v135, s55, v189
    v_dot2_f32_bf16 v191, v135, v135, v191
    v_dot2_f32_bf16 v188, v116, s55, v188
    v_dot2_f32_bf16 v190, v116, v116, v190
    s_waitcnt vmcnt(6)
    v_dot2_f32_bf16 v189, v136, s55, v189
    v_dot2_f32_bf16 v191, v136, v136, v191
    v_dot2_f32_bf16 v188, v117, s55, v188
    v_dot2_f32_bf16 v190, v117, v117, v190
    v_dot2_f32_bf16 v189, v137, s55, v189
    v_dot2_f32_bf16 v191, v137, v137, v191
    v_dot2_f32_bf16 v188, v118, s55, v188
    v_dot2_f32_bf16 v190, v118, v118, v190
    v_dot2_f32_bf16 v189, v138, s55, v189
    v_dot2_f32_bf16 v191, v138, v138, v191
    v_dot2_f32_bf16 v188, v119, s55, v188
    v_dot2_f32_bf16 v190, v119, v119, v190
    v_dot2_f32_bf16 v189, v139, s55, v189
    v_dot2_f32_bf16 v191, v139, v139, v191
    v_dot2_f32_bf16 v188, v120, s55, v188
    v_dot2_f32_bf16 v190, v120, v120, v190
    s_waitcnt vmcnt(5)
    v_dot2_f32_bf16 v189, v140, s55, v189
    v_dot2_f32_bf16 v191, v140, v140, v191
    v_dot2_f32_bf16 v188, v121, s55, v188
    v_dot2_f32_bf16 v190, v121, v121, v190
    v_dot2_f32_bf16 v189, v141, s55, v189
    v_dot2_f32_bf16 v191, v141, v141, v191
    v_dot2_f32_bf16 v188, v122, s55, v188
    v_dot2_f32_bf16 v190, v122, v122, v190
    v_dot2_f32_bf16 v189, v142, s55, v189
    v_dot2_f32_bf16 v191, v142, v142, v191
    v_dot2_f32_bf16 v188, v123, s55, v188
    v_dot2_f32_bf16 v190, v123, v123, v190
    v_dot2_f32_bf16 v189, v143, s55, v189
    v_dot2_f32_bf16 v191, v143, v143, v191
    v_add_f32_dpp v188, v188, v188 row_ror:8 row_mask:0xf bank_mask:0xf
    s_nop 0
    v_add_f32_dpp v189, v189, v189 row_ror:8 row_mask:0xf bank_mask:0xf
    v_add_f32_dpp v190, v190, v190 row_ror:8 row_mask:0xf bank_mask:0xf
    v_add_f32_dpp v191, v191, v191 row_ror:8 row_mask:0xf bank_mask:0xf
    v_add_f32_dpp v188, v188, v188 row_ror:4 row_mask:0xf bank_mask:0xf
    v_add_f32_dpp v189, v189, v189 row_ror:4 row_mask:0xf bank_mask:0xf
    v_add_f32_dpp v190, v190, v190 row_ror:4 row_mask:0xf bank_mask:0xf
    v_add_f32_dpp v191, v191, v191 row_ror:4 row_mask:0xf bank_mask:0xf
    v_add_f32_dpp v188, v188, v188 row_ror:2 row_mask:0xf bank_mask:0xf
    v_add_f32_dpp v189, v189, v189 row_ror:2 row_mask:0xf bank_mask:0xf
    v_add_f32_dpp v190, v190, v190 row_ror:2 row_mask:0xf bank_mask:0xf
    v_add_f32_dpp v191, v191, v191 row_ror:2 row_mask:0xf bank_mask:0xf
    v_add_f32_dpp v188, v188, v188 row_ror:1 row_mask:0xf bank_mask:0xf
    v_add_f32_dpp v189, v189, v189 row_ror:1 row_mask:0xf bank_mask:0xf
    v_add_f32_dpp v190, v190, v190 row_ror:1 row_mask:0xf bank_mask:0xf
    v_add_f32_dpp v191, v191, v191 row_ror:1 row_mask:0xf bank_mask:0xf
    v_and_b32 v3, 15, v1
    v_cmp_eq_u32 vcc, 1, v3
    s_nop 1
    v_cndmask_b32 v188, v188, v189, vcc
    v_cndmask_b32 v190, v190, v191, vcc
    v_mul_f32 v188, 0x3acccccd, v188
    v_mul_f32 v194, v188, v188
    v_mov_b32 v192, 0x3acccccd
    v_fma_f32 v190, v190, v192, -v194
    v_max_f32 v190, 0, v190
    v_add_f32 v190, 0x3727c5ac, v190
    v_rsq_f32 v192, v190
    s_nop 0
    v_mul_f32_e64 v193, -v188, v192
    s_add_u32 s51, s57, 8192
    s_mov_b32 exec_lo, 0x00030003
    s_mov_b32 exec_hi, 0x00030003
    buffer_store_dword v192, v30, s[36:39], s57 offen sc1
    buffer_store_dword v193, v30, s[36:39], s51 offen sc1
    s_mov_b64 exec, -1
    s_add_u32 s57, s57, 4096
    s_waitcnt vmcnt(2)
    s_barrier
    ds_read_b64_tr_b16 v[32:33], v28 offset:0
    ds_read_b64_tr_b16 v[34:35], v28 offset:5120
    ds_read_b64_tr_b16 v[36:37], v28 offset:32
    ds_read_b64_tr_b16 v[38:39], v28 offset:5152
    ds_read_b64_tr_b16 v[40:41], v28 offset:64
    ds_read_b64_tr_b16 v[42:43], v28 offset:5184
    ds_read_b64_tr_b16 v[44:45], v28 offset:96
    ds_read_b64_tr_b16 v[46:47], v28 offset:5216
    ds_read_b64_tr_b16 v[48:49], v28 offset:128
    ds_read_b64_tr_b16 v[50:51], v28 offset:5248
    s_waitcnt lgkmcnt(8)
    buffer_store_dwordx4 v[32:35], v29, s[36:39], s68 offen offset:0 sc1
    s_waitcnt lgkmcnt(6)
    buffer_store_dwordx4 v[36:39], v29, s[36:39], s68 offen offset:1024 sc1
    s_waitcnt lgkmcnt(4)
    buffer_store_dwordx4 v[40:43], v29, s[36:39], s68 offen offset:2048 sc1
    s_waitcnt lgkmcnt(2)
    buffer_store_dwordx4 v[44:47], v29, s[36:39], s68 offen offset:3072 sc1
    s_waitcnt lgkmcnt(0)
    buffer_store_dwordx4 v[48:51], v29, s[36:39], s69 offen offset:0 sc1
    v_add_u32 v231, 8192, v231
    v_add_u32 v237, 49152, v231
    v_add_u32 v232, 8192, v232
    v_add_u32 v238, 49152, v232
    v_add_u32 v233, 8192, v233
    v_add_u32 v239, 49152, v233
    s_add_u32 m0, s61, 8192
    s_nop 0
    buffer_load_dwordx4 v228, s[40:43], s64 offen offset:0 lds
    buffer_load_dwordx4 v229, s[40:43], s64 offen offset:1024 lds
    buffer_load_dwordx4 v230, s[40:43], s64 offen offset:2048 lds
    s_add_u32 s64, s64, 98304
    s_sub_u32 s35, s64, 1966080
    s_min_u32 s64, s64, s35
    s_add_u32 m0, s61, 20480
    s_nop 0
    buffer_load_dwordx4 v228, s[40:43], s64 offen offset:0 lds
    buffer_load_dwordx4 v229, s[40:43], s64 offen offset:1024 lds
    buffer_load_dwordx4 v230, s[40:43], s64 offen offset:2048 lds
    s_add_u32 s64, s64, 98304
    s_sub_u32 s35, s64, 1966080
    s_min_u32 s64, s64, s35
    s_add_u32 m0, s61, 32768
    s_nop 0
    buffer_load_dwordx4 v228, s[40:43], s64 offen offset:0 lds
    buffer_load_dwordx4 v229, s[40:43], s64 offen offset:1024 lds
    buffer_load_dwordx4 v230, s[40:43], s64 offen offset:2048 lds
    s_add_u32 s64, s64, 98304
    s_sub_u32 s35, s64, 1966080
    s_min_u32 s64, s64, s35
    s_add_u32 m0, s61, 45056
    s_nop 0
    buffer_load_dwordx4 v228, s[40:43], s64 offen offset:0 lds
    buffer_load_dwordx4 v229, s[40:43], s64 offen offset:1024 lds
    buffer_load_dwordx4 v230, s[40:43], s64 offen offset:2048 lds
    s_add_u32 s64, s64, 98304
    s_sub_u32 s35, s64, 1966080
    s_min_u32 s64, s64, s35
    s_waitcnt vmcnt(17)
    s_barrier
    s_cmp_eq_u32 s3, 0
    s_cbranch_scc0 L_wf17
    s_lshl_b32 s54, s71, 7
    s_add_u32 s54, s54, 23420928
    v_mov_b32 v254, 0
    v_mov_b32 v255, s48
    s_mov_b64 exec, 1
    buffer_store_dword v255, v254, s[36:39], s54 offen sc1
    s_mov_b64 exec, -1
L_wf17:
L_p_w:
    s_waitcnt vmcnt(6)
    s_barrier
    ds_read_b64_tr_b16 a[0:1], v231 offset:0
    ds_read_b64_tr_b16 a[2:3], v231 offset:3072
    ds_read_b64_tr_b16 a[4:5], v232 offset:6144
    ds_read_b64_tr_b16 a[6:7], v232 offset:9216
    ds_read_b64_tr_b16 a[8:9], v233 offset:0
    ds_read_b64_tr_b16 a[10:11], v233 offset:3072
    ds_read_b64_tr_b16 a[12:13], v231 offset:12288
    ds_read_b64_tr_b16 a[14:15], v231 offset:15360
    ds_read_b64_tr_b16 a[16:17], v232 offset:18432
    ds_read_b64_tr_b16 a[18:19], v232 offset:21504
    ds_read_b64_tr_b16 a[20:21], v233 offset:12288
    ds_read_b64_tr_b16 a[22:23], v233 offset:15360
    s_add_u32 m0, s61, 57344
    s_nop 0
    buffer_load_dwordx4 v228, s[40:43], s64 offen offset:0 lds
    buffer_load_dwordx4 v229, s[40:43], s64 offen offset:1024 lds
    buffer_load_dwordx4 v230, s[40:43], s64 offen offset:2048 lds
    s_add_u32 s64, s64, 98304
    s_sub_u32 s35, s64, 1966080
    s_min_u32 s64, s64, s35
    s_add_u32 m0, s61, 69632
    s_nop 0
    buffer_load_dwordx4 v228, s[40:43], s64 offen offset:0 lds
    buffer_load_dwordx4 v229, s[40:43], s64 offen offset:1024 lds
    buffer_load_dwordx4 v230, s[40:43], s64 offen offset:2048 lds
    s_add_u32 s64, s64, 98304
    s_sub_u32 s35, s64, 1966080
    s_min_u32 s64, s64, s35
    s_cmp_eq_u32 s3, 0
    s_cbranch_scc0 L_wf18
    s_and_b32 s54, s71, 1
    s_mul_i32 s54, s54, -60
    v_mov_b32 v254, s54
    s_lshl_b32 s54, s71, 6
    v_add_u32 v254, s54, v254
    s_mov_b32 s54, 23273472
    v_mov_b32 v255, s48
    s_mov_b64 exec, 1
    buffer_store_dword v255, v254, s[36:39], s54 offen sc1
    s_mov_b64 exec, -1
L_wf18:
    s_waitcnt vmcnt(6)
    s_waitcnt lgkmcnt(0)
    s_barrier
    ds_read_b64_tr_b16 a[24:25], v231 offset:24576
    ds_read_b64_tr_b16 a[26:27], v231 offset:27648
    ds_read_b64_tr_b16 a[28:29], v232 offset:30720
    ds_read_b64_tr_b16 a[30:31], v232 offset:33792
    ds_read_b64_tr_b16 a[32:33], v233 offset:24576
    ds_read_b64_tr_b16 a[34:35], v233 offset:27648
    ds_read_b64_tr_b16 a[36:37], v231 offset:36864
    ds_read_b64_tr_b16 a[38:39], v231 offset:39936
    ds_read_b64_tr_b16 a[40:41], v232 offset:43008
    ds_read_b64_tr_b16 a[42:43], v232 offset:46080
    ds_read_b64_tr_b16 a[44:45], v233 offset:36864
    ds_read_b64_tr_b16 a[46:47], v233 offset:39936
    s_add_u32 m0, s61, 81920
    s_nop 0
    buffer_load_dwordx4 v228, s[40:43], s64 offen offset:0 lds
    buffer_load_dwordx4 v229, s[40:43], s64 offen offset:1024 lds
    buffer_load_dwordx4 v230, s[40:43], s64 offen offset:2048 lds
    s_add_u32 s64, s64, 98304
    s_sub_u32 s35, s64, 1966080
    s_min_u32 s64, s64, s35
    s_add_u32 m0, s61, 94208
    s_nop 0
    buffer_load_dwordx4 v228, s[40:43], s64 offen offset:0 lds
    buffer_load_dwordx4 v229, s[40:43], s64 offen offset:1024 lds
    buffer_load_dwordx4 v230, s[40:43], s64 offen offset:2048 lds
    s_add_u32 s64, s64, 98304
    s_sub_u32 s35, s64, 1966080
    s_min_u32 s64, s64, s35
    s_waitcnt vmcnt(6)
    s_waitcnt lgkmcnt(0)
    s_barrier
    ds_read_b64_tr_b16 a[48:49], v237 offset:0
    ds_read_b64_tr_b16 a[50:51], v237 offset:3072
    ds_read_b64_tr_b16 a[52:53], v238 offset:6144
    ds_read_b64_tr_b16 a[54:55], v238 offset:9216
    ds_read_b64_tr_b16 a[56:57], v239 offset:0
    ds_read_b64_tr_b16 a[58:59], v239 offset:3072
    ds_read_b64_tr_b16 a[60:61], v237 offset:12288
    ds_read_b64_tr_b16 a[62:63], v237 offset:15360
    ds_read_b64_tr_b16 a[64:65], v238 offset:18432
    ds_read_b64_tr_b16 a[66:67], v238 offset:21504
    ds_read_b64_tr_b16 a[68:69], v239 offset:12288
    ds_read_b64_tr_b16 a[70:71], v239 offset:15360
    s_add_u32 m0, s61, 8192
    s_nop 0
    buffer_load_dwordx4 v228, s[40:43], s64 offen offset:0 lds
    buffer_load_dwordx4 v229, s[40:43], s64 offen offset:1024 lds
    buffer_load_dwordx4 v230, s[40:43], s64 offen offset:2048 lds
    s_add_u32 s64, s64, 98304
    s_sub_u32 s35, s64, 1966080
    s_min_u32 s64, s64, s35
    s_add_u32 m0, s61, 20480
    s_nop 0
    buffer_load_dwordx4 v228, s[40:43], s64 offen offset:0 lds
    buffer_load_dwordx4 v229, s[40:43], s64 offen offset:1024 lds
    buffer_load_dwordx4 v230, s[40:43], s64 offen offset:2048 lds
    s_add_u32 s64, s64, 98304
    s_sub_u32 s35, s64, 1966080
    s_min_u32 s64, s64, s35
    s_waitcnt vmcnt(6)
    s_waitcnt lgkmcnt(0)
    s_barrier
    ds_read_b64_tr_b16 a[72:73], v237 offset:24576
    ds_read_b64_tr_b16 a[74:75], v237 offset:27648
    ds_read_b64_tr_b16 a[76:77], v238 offset:30720
    ds_read_b64_tr_b16 a[78:79], v238 offset:33792
    ds_read_b64_tr_b16 a[80:81], v239 offset:24576
    ds_read_b64_tr_b16 a[82:83], v239 offset:27648
    ds_read_b64_tr_b16 a[84:85], v237 offset:36864
    ds_read_b64_tr_b16 a[86:87], v237 offset:39936
    ds_read_b64_tr_b16 a[88:89], v238 offset:43008
    ds_read_b64_tr_b16 a[90:91], v238 offset:46080
    ds_read_b64_tr_b16 a[92:93], v239 offset:36864
    ds_read_b64_tr_b16 a[94:95], v239 offset:39936
    s_add_u32 m0, s61, 32768
    s_nop 0
    buffer_load_dwordx4 v228, s[40:43], s64 offen offset:0 lds
    buffer_load_dwordx4 v229, s[40:43], s64 offen offset:1024 lds
    buffer_load_dwordx4 v230, s[40:43], s64 offen offset:2048 lds
    s_add_u32 s64, s64, 98304
    s_sub_u32 s35, s64, 1966080
    s_min_u32 s64, s64, s35
    s_add_u32 m0, s61, 45056
    s_nop 0
    buffer_load_dwordx4 v228, s[40:43], s64 offen offset:0 lds
    buffer_load_dwordx4 v229, s[40:43], s64 offen offset:1024 lds
    buffer_load_dwordx4 v230, s[40:43], s64 offen offset:2048 lds
    s_add_u32 s64, s64, 98304
    s_sub_u32 s35, s64, 1966080
    s_min_u32 s64, s64, s35
    s_cmp_eq_u32 s72, 12
    s_cbranch_scc1 L_bias
    s_waitcnt vmcnt(6)
    s_waitcnt lgkmcnt(0)
    s_barrier
    ds_read_b64_tr_b16 a[96:97], v231 offset:0
    ds_read_b64_tr_b16 a[98:99], v231 offset:3072
    ds_read_b64_tr_b16 a[100:101], v232 offset:6144
    ds_read_b64_tr_b16 a[102:103], v232 offset:9216
    ds_read_b64_tr_b16 a[104:105], v233 offset:0
    ds_read_b64_tr_b16 a[106:107], v233 offset:3072
    ds_read_b64_tr_b16 a[108:109], v231 offset:12288
    ds_read_b64_tr_b16 a[110:111], v231 offset:15360
    ds_read_b64_tr_b16 a[112:113], v232 offset:18432
    ds_read_b64_tr_b16 a[114:115], v232 offset:21504
    ds_read_b64_tr_b16 a[116:117], v233 offset:12288
    ds_read_b64_tr_b16 a[118:119], v233 offset:15360
    s_add_u32 m0, s61, 57344
    s_nop 0
    buffer_load_dwordx4 v228, s[40:43], s64 offen offset:0 lds
    buffer_load_dwordx4 v229, s[40:43], s64 offen offset:1024 lds
    buffer_load_dwordx4 v230, s[40:43], s64 offen offset:2048 lds
    s_add_u32 s64, s64, 98304
    s_sub_u32 s35, s64, 1966080
    s_min_u32 s64, s64, s35
    s_add_u32 m0, s61, 69632
    s_nop 0
    buffer_load_dwordx4 v228, s[40:43], s64 offen offset:0 lds
    buffer_load_dwordx4 v229, s[40:43], s64 offen offset:1024 lds
    buffer_load_dwordx4 v230, s[40:43], s64 offen offset:2048 lds
    s_add_u32 s64, s64, 98304
    s_sub_u32 s35, s64, 1966080
    s_min_u32 s64, s64, s35
    s_waitcnt vmcnt(6)
    s_waitcnt lgkmcnt(0)
    s_barrier
    ds_read_b64_tr_b16 a[120:121], v231 offset:24576
    ds_read_b64_tr_b16 a[122:123], v231 offset:27648
    ds_read_b64_tr_b16 a[124:125], v232 offset:30720
    ds_read_b64_tr_b16 a[126:127], v232 offset:33792
    ds_read_b64_tr_b16 a[128:129], v233 offset:24576
    ds_read_b64_tr_b16 a[130:131], v233 offset:27648
    ds_read_b64_tr_b16 a[132:133], v231 offset:36864
    ds_read_b64_tr_b16 a[134:135], v231 offset:39936
    ds_read_b64_tr_b16 a[136:137], v232 offset:43008
    ds_read_b64_tr_b16 a[138:139], v232 offset:46080
    ds_read_b64_tr_b16 a[140:141], v233 offset:36864
    ds_read_b64_tr_b16 a[142:143], v233 offset:39936
    s_add_u32 m0, s61, 81920
    s_nop 0
    buffer_load_dwordx4 v228, s[40:43], s64 offen offset:0 lds
    buffer_load_dwordx4 v229, s[40:43], s64 offen offset:1024 lds
    buffer_load_dwordx4 v230, s[40:43], s64 offen offset:2048 lds
    s_add_u32 s64, s64, 98304
    s_sub_u32 s35, s64, 1966080
    s_min_u32 s64, s64, s35
    s_add_u32 m0, s61, 94208
    s_nop 0
    buffer_load_dwordx4 v228, s[40:43], s64 offen offset:0 lds
    buffer_load_dwordx4 v229, s[40:43], s64 offen offset:1024 lds
    buffer_load_dwordx4 v230, s[40:43], s64 offen offset:2048 lds
    s_add_u32 s64, s64, 98304
    s_sub_u32 s35, s64, 1966080
    s_min_u32 s64, s64, s35
    s_waitcnt vmcnt(6)
    s_waitcnt lgkmcnt(0)
    s_barrier
    ds_read_b64_tr_b16 a[144:145], v237 offset:0
    ds_read_b64_tr_b16 a[146:147], v237 offset:3072
    ds_read_b64_tr_b16 a[148:149], v238 offset:6144
    ds_read_b64_tr_b16 a[150:151], v238 offset:9216
    ds_read_b64_tr_b16 a[152:153], v239 offset:0
    ds_read_b64_tr_b16 a[154:155], v239 offset:3072
    ds_read_b64_tr_b16 a[156:157], v237 offset:12288
    ds_read_b64_tr_b16 a[158:159], v237 offset:15360
    ds_read_b64_tr_b16 a[160:161], v238 offset:18432
    ds_read_b64_tr_b16 a[162:163], v238 offset:21504
    ds_read_b64_tr_b16 a[164:165], v239 offset:12288
    ds_read_b64_tr_b16 a[166:167], v239 offset:15360
    s_add_u32 m0, s61, 8192
    s_nop 0
    buffer_load_dwordx4 v228, s[40:43], s64 offen offset:0 lds
    buffer_load_dwordx4 v229, s[40:43], s64 offen offset:1024 lds
    buffer_load_dwordx4 v230, s[40:43], s64 offen offset:2048 lds
    s_add_u32 s64, s64, 98304
    s_sub_u32 s35, s64, 1966080
    s_min_u32 s64, s64, s35
    s_add_u32 m0, s61, 20480
    s_nop 0
    buffer_load_dwordx4 v228, s[40:43], s64 offen offset:0 lds
    buffer_load_dwordx4 v229, s[40:43], s64 offen offset:1024 lds
    buffer_load_dwordx4 v230, s[40:43], s64 offen offset:2048 lds
    s_add_u32 s64, s64, 98304
    s_sub_u32 s35, s64, 1966080
    s_min_u32 s64, s64, s35
    s_waitcnt vmcnt(6)
    s_waitcnt lgkmcnt(0)
    s_barrier
    ds_read_b64_tr_b16 a[168:169], v237 offset:24576
    ds_read_b64_tr_b16 a[170:171], v237 offset:27648
    ds_read_b64_tr_b16 a[172:173], v238 offset:30720
    ds_read_b64_tr_b16 a[174:175], v238 offset:33792
    ds_read_b64_tr_b16 a[176:177], v239 offset:24576
    ds_read_b64_tr_b16 a[178:179], v239 offset:27648
    ds_read_b64_tr_b16 a[180:181], v237 offset:36864
    ds_read_b64_tr_b16 a[182:183], v237 offset:39936
    ds_read_b64_tr_b16 a[184:185], v238 offset:43008
    ds_read_b64_tr_b16 a[186:187], v238 offset:46080
    ds_read_b64_tr_b16 a[188:189], v239 offset:36864
    ds_read_b64_tr_b16 a[190:191], v239 offset:39936
    s_add_u32 m0, s61, 32768
    s_nop 0
    buffer_load_dwordx4 v228, s[40:43], s64 offen offset:0 lds
    buffer_load_dwordx4 v229, s[40:43], s64 offen offset:1024 lds
    buffer_load_dwordx4 v230, s[40:43], s64 offen offset:2048 lds
    s_add_u32 s64, s64, 98304
    s_sub_u32 s35, s64, 1966080
    s_min_u32 s64, s64, s35
    s_add_u32 m0, s61, 45056
    s_nop 0
    buffer_load_dwordx4 v228, s[40:43], s64 offen offset:0 lds
    buffer_load_dwordx4 v229, s[40:43], s64 offen offset:1024 lds
    buffer_load_dwordx4 v230, s[40:43], s64 offen offset:2048 lds
    s_add_u32 s64, s64, 98304
    s_sub_u32 s35, s64, 1966080
    s_min_u32 s64, s64, s35
    s_waitcnt vmcnt(6)
    s_waitcnt lgkmcnt(0)
    s_barrier
    ds_read_b64_tr_b16 a[192:193], v231 offset:0
    ds_read_b64_tr_b16 a[194:195], v231 offset:3072
    ds_read_b64_tr_b16 a[196:197], v232 offset:6144
    ds_read_b64_tr_b16 a[198:199], v232 offset:9216
    ds_read_b64_tr_b16 a[200:201], v233 offset:0
    ds_read_b64_tr_b16 a[202:203], v233 offset:3072
    ds_read_b64_tr_b16 a[204:205], v231 offset:12288
    ds_read_b64_tr_b16 a[206:207], v231 offset:15360
    ds_read_b64_tr_b16 a[208:209], v232 offset:18432
    ds_read_b64_tr_b16 a[210:211], v232 offset:21504
    ds_read_b64_tr_b16 a[212:213], v233 offset:12288
    ds_read_b64_tr_b16 a[214:215], v233 offset:15360
    s_waitcnt vmcnt(0)
    s_waitcnt lgkmcnt(0)
    s_barrier
    ds_read_b64_tr_b16 a[216:217], v231 offset:24576
    ds_read_b64_tr_b16 a[218:219], v231 offset:27648
    ds_read_b64_tr_b16 a[220:221], v232 offset:30720
    ds_read_b64_tr_b16 a[222:223], v232 offset:33792
    ds_read_b64_tr_b16 a[224:225], v233 offset:24576
    ds_read_b64_tr_b16 a[226:227], v233 offset:27648
    ds_read_b64_tr_b16 a[228:229], v231 offset:36864
    ds_read_b64_tr_b16 a[230:231], v231 offset:39936
    ds_read_b64_tr_b16 a[232:233], v232 offset:43008
    ds_read_b64_tr_b16 a[234:235], v232 offset:46080
    ds_read_b64_tr_b16 a[236:237], v233 offset:36864
    ds_read_b64_tr_b16 a[238:239], v233 offset:39936
    s_waitcnt lgkmcnt(0)
    s_barrier
    s_cmp_eq_u32 s2, 255
    s_cbranch_scc0 L_biasdone
    v_lshlrev_b32 v5, 7, v0
L_ep:
    buffer_load_dword v2, v5, s[36:39], s17 offen sc1
    s_waitcnt vmcnt(0)
    v_and_b32 v2, -16, v2
    v_cmp_ne_u32 vcc, s48, v2
    s_cbranch_vccz L_ep_ok
    s_cmp_eq_u32 s49, 0
    s_cbranch_scc1 L_ep_ok
    s_sub_u32 s49, s49, 1
    s_branch L_ep
L_ep_ok:
    s_barrier
    s_cmp_eq_u32 s3, 0
    s_cbranch_scc0 L_biasdone
    s_mov_b32 s50, 23461888
    v_mov_b32 v2, 0
    v_mov_b32 v3, s48
    s_mov_b64 exec, 1
    buffer_store_dword v3, v2, s[36:39], s50 offen sc1
    s_mov_b64 exec, -1
L_biasdone:
L_prepA:
L_poll19:
    buffer_load_dword v223, v219, s[36:39], s17 offen sc1
    s_waitcnt vmcnt(0)
    v_cmp_ne_u32 vcc, s48, v223
    s_cbranch_vccz L_poll19_ok
    s_cmp_eq_u32 s49, 0
    s_cbranch_scc1 L_poll19_ok
    s_sub_u32 s49, s49, 1
    s_sleep 1
    s_branch L_poll19
L_poll19_ok:
L_prepE:
    s_add_u32 m0, s63, 0
    s_nop 0
    buffer_load_dwordx4 v172, s[36:39], s10 offen sc1 lds
    s_add_u32 m0, s63, 4096
    s_nop 0
    buffer_load_dwordx4 v172, s[36:39], s11 offen sc1 lds
    s_add_u32 m0, s63, 8192
    s_nop 0
    buffer_load_dwordx4 v172, s[36:39], s12 offen sc1 lds
    s_add_u32 m0, s63, 12288
    s_nop 0
    buffer_load_dwordx4 v172, s[36:39], s13 offen sc1 lds
    s_add_u32 m0, s63, 16384
    s_nop 0
    buffer_load_dwordx4 v172, s[36:39], s14 offen sc1 lds
    s_add_u32 m0, s63, 20480
    s_nop 0
    buffer_load_dwordx4 v172, s[36:39], s15 offen sc1 lds
    s_add_u32 m0, s63, 24576
    s_nop 0
    buffer_load_dwordx4 v172, s[36:39], s18 offen sc1 lds
    s_add_u32 m0, s63, 28672
    s_nop 0
    buffer_load_dwordx4 v172, s[36:39], s19 offen sc1 lds
    buffer_load_dword v220, v220, s[36:39], s77 offen sc1
    buffer_load_dword v221, v221, s[36:39], s77 offen sc1
    buffer_load_dword v222, v222, s[36:39], s77 offen sc1
    s_waitcnt vmcnt(10)
    s_barrier
    ds_read_b64_tr_b16 v[104:105], v168 offset:0
    ds_read_b64_tr_b16 v[106:107], v168 offset:2048
    ds_read_b64_tr_b16 v[108:109], v169 offset:0
    ds_read_b64_tr_b16 v[110:111], v169 offset:2048
    ds_read_b64_tr_b16 v[112:113], v170 offset:0
    ds_read_b64_tr_b16 v[114:115], v170 offset:2048
    ds_read_b64_tr_b16 v[116:117], v171 offset:0
    ds_read_b64_tr_b16 v[118:119], v171 offset:2048
    s_waitcnt lgkmcnt(6)
    v_mfma_f32_16x16x32_bf16 v[8:11], a[0:3], v[104:107], 0
    s_waitcnt vmcnt(9)
    s_barrier
    ds_read_b64_tr_b16 v[120:121], v168 offset:4096
    v_mfma_f32_16x16x32_bf16 v[12:15], a[4:7], v[104:107], 0
    ds_read_b64_tr_b16 v[122:123], v168 offset:6144
    v_min_u32 v243, 23, v1
    v_mfma_f32_16x16x32_bf16 v[16:19], a[8:11], v[104:107], 0
    s_waitcnt lgkmcnt(6)
    s_add_u32 m0, s63, 32768
    ds_read_b64_tr_b16 v[124:125], v169 offset:4096
    v_and_b32 v244, 1, v243
    v_mfma_f32_16x16x32_bf16 v[20:23], a[0:3], v[108:111], 0
    buffer_load_dwordx4 v172, s[36:39], s20 offen sc1 lds
    v_mfma_f32_16x16x32_bf16 v[24:27], a[4:7], v[108:111], 0
    ds_read_b64_tr_b16 v[126:127], v169 offset:6144
    v_lshrrev_b32 v243, 1, v243
    v_mfma_f32_16x16x32_bf16 v[28:31], a[8:11], v[108:111], 0
    s_waitcnt lgkmcnt(6)
    ds_read_b64_tr_b16 v[128:129], v170 offset:4096
    v_lshlrev_b32 v243, 7, v243
    v_mfma_f32_16x16x32_bf16 v[32:35], a[0:3], v[112:115], 0
    s_add_u32 m0, s63, 36864
    ds_read_b64_tr_b16 v[130:131], v170 offset:6144
    v_lshl_add_u32 v243, v244, 2, v243
    v_mfma_f32_16x16x32_bf16 v[36:39], a[4:7], v[112:115], 0
    buffer_load_dwordx4 v172, s[36:39], s21 offen sc1 lds
    v_mfma_f32_16x16x32_bf16 v[40:43], a[8:11], v[112:115], 0
    s_waitcnt lgkmcnt(6)
    s_mul_i32 s58, s3, 1536
    s_add_u32 s58, s58, 23273472
    ds_read_b64_tr_b16 v[132:133], v171 offset:4096
    v_mfma_f32_16x16x32_bf16 v[44:47], a[0:3], v[116:119], 0
    s_waitcnt lgkmcnt(3)
    ds_read_b64_tr_b16 v[134:135], v171 offset:6144
    v_mfma_f32_16x16x32_bf16 v[48:51], a[4:7], v[116:119], 0
    v_mfma_f32_16x16x32_bf16 v[52:55], a[8:11], v[116:119], 0
    buffer_load_dword v244, v243, s[36:39], s58 offen sc1
    v_mfma_f32_16x16x32_bf16 v[8:11], a[12:15], v[120:123], v[8:11]
    s_waitcnt vmcnt(10)
    s_barrier
    ds_read_b64_tr_b16 v[104:105], v168 offset:8192
    v_mfma_f32_16x16x32_bf16 v[12:15], a[16:19], v[120:123], v[12:15]
    ds_read_b64_tr_b16 v[106:107], v168 offset:10240
    v_mfma_f32_16x16x32_bf16 v[16:19], a[20:23], v[120:123], v[16:19]
    s_add_u32 m0, s63, 40960
    ds_read_b64_tr_b16 v[108:109], v169 offset:8192
    v_mfma_f32_16x16x32_bf16 v[20:23], a[12:15], v[124:127], v[20:23]
    buffer_load_dwordx4 v172, s[36:39], s22 offen sc1 lds
    v_mfma_f32_16x16x32_bf16 v[24:27], a[16:19], v[124:127], v[24:27]
    ds_read_b64_tr_b16 v[110:111], v169 offset:10240
    v_mfma_f32_16x16x32_bf16 v[28:31], a[20:23], v[124:127], v[28:31]
    s_waitcnt lgkmcnt(6)
    ds_read_b64_tr_b16 v[112:113], v170 offset:8192
    v_mfma_f32_16x16x32_bf16 v[32:35], a[12:15], v[128:131], v[32:35]
    s_add_u32 m0, s63, 45056
    ds_read_b64_tr_b16 v[114:115], v170 offset:10240
    v_mfma_f32_16x16x32_bf16 v[36:39], a[16:19], v[128:131], v[36:39]
    buffer_load_dwordx4 v172, s[36:39], s23 offen sc1 lds
    v_mfma_f32_16x16x32_bf16 v[40:43], a[20:23], v[128:131], v[40:43]
    s_waitcnt lgkmcnt(6)
    ds_read_b64_tr_b16 v[116:117], v171 offset:8192
    v_lshrrev_b32 v210, 4, v1
    v_mfma_f32_16x16x32_bf16 v[44:47], a[12:15], v[132:135], v[44:47]
    s_waitcnt lgkmcnt(3)
    ds_read_b64_tr_b16 v[118:119], v171 offset:10240
    v_lshlrev_b32 v210, 3, v210
    v_mfma_f32_16x16x32_bf16 v[48:51], a[16:19], v[132:135], v[48:51]
    s_add_u32 m0, s63, 49152
    s_lshl_b32 s57, s3, 5
    s_add_u32 s57, s57, 163712
    v_mfma_f32_16x16x32_bf16 v[52:55], a[20:23], v[132:135], v[52:55]
    buffer_load_dwordx4 v172, s[36:39], s24 offen sc1 lds
    v_mfma_f32_16x16x32_bf16 v[8:11], a[24:27], v[104:107], v[8:11]
    ds_read_b64_tr_b16 v[120:121], v168 offset:12288
    v_add_u32 v210, s57, v210
    v_mfma_f32_16x16x32_bf16 v[12:15], a[28:31], v[104:107], v[12:15]
    ds_read_b64_tr_b16 v[122:123], v168 offset:14336
    v_lshlrev_b32 v211, 2, v1
    v_mfma_f32_16x16x32_bf16 v[16:19], a[32:35], v[104:107], v[16:19]
    s_add_u32 m0, s63, 53248
    ds_read_b64_tr_b16 v[124:125], v169 offset:12288
    v_and_b32 v211, 12, v211
    v_mfma_f32_16x16x32_bf16 v[20:23], a[24:27], v[108:111], v[20:23]
    buffer_load_dwordx4 v172, s[36:39], s25 offen sc1 lds
    v_mfma_f32_16x16x32_bf16 v[24:27], a[28:31], v[108:111], v[24:27]
    ds_read_b64_tr_b16 v[126:127], v169 offset:14336
    v_add_u32 v211, 163712, v211
    v_mfma_f32_16x16x32_bf16 v[28:31], a[32:35], v[108:111], v[28:31]
    s_waitcnt lgkmcnt(6)
    ds_read_b64_tr_b16 v[128:129], v170 offset:12288
    v_mfma_f32_16x16x32_bf16 v[32:35], a[24:27], v[112:115], v[32:35]
    s_add_u32 m0, s63, 57344
    ds_read_b64_tr_b16 v[130:131], v170 offset:14336
    v_mfma_f32_16x16x32_bf16 v[36:39], a[28:31], v[112:115], v[36:39]
    buffer_load_dwordx4 v172, s[36:39], s26 offen sc1 lds
    v_mfma_f32_16x16x32_bf16 v[40:43], a[32:35], v[112:115], v[40:43]
    s_waitcnt lgkmcnt(6)
    ds_read_b64_tr_b16 v[132:133], v171 offset:12288
    v_mfma_f32_16x16x32_bf16 v[44:47], a[24:27], v[116:119], v[44:47]
    s_waitcnt lgkmcnt(3)
    ds_read_b64_tr_b16 v[134:135], v171 offset:14336
    v_mfma_f32_16x16x32_bf16 v[48:51], a[28:31], v[116:119], v[48:51]
    s_add_u32 m0, s63, 61440
    v_mfma_f32_16x16x32_bf16 v[52:55], a[32:35], v[116:119], v[52:55]
    buffer_load_dwordx4 v172, s[36:39], s27 offen sc1 lds
    v_mfma_f32_16x16x32_bf16 v[8:11], a[36:39], v[120:123], v[8:11]
    s_waitcnt vmcnt(13)
    s_barrier
    ds_read_b64_tr_b16 v[104:105], v168 offset:16384
    v_mfma_f32_16x16x32_bf16 v[12:15], a[40:43], v[120:123], v[12:15]
    ds_read_b64_tr_b16 v[106:107], v168 offset:18432
    v_mfma_f32_16x16x32_bf16 v[16:19], a[44:47], v[120:123], v[16:19]
    s_add_u32 m0, s63, 65536
    ds_read_b64_tr_b16 v[108:109], v169 offset:16384
    v_mfma_f32_16x16x32_bf16 v[20:23], a[36:39], v[124:127], v[20:23]
    buffer_load_dwordx4 v172, s[36:39], s44 offen sc1 lds
    v_mfma_f32_16x16x32_bf16 v[24:27], a[40:43], v[124:127], v[24:27]
    ds_read_b64_tr_b16 v[110:111], v169 offset:18432
    v_mfma_f32_16x16x32_bf16 v[28:31], a[44:47], v[124:127], v[28:31]
    ds_read_b64_tr_b16 v[112:113], v170 offset:16384
    s_waitcnt vmcnt(7)
    v_cmp_ne_u32 vcc, s48, v244
    s_cbranch_vccnz L_chk20_slow
L_chk20_back:
    s_waitcnt lgkmcnt(7)
    v_mfma_f32_16x16x32_bf16 v[32:35], a[36:39], v[128:131], v[32:35]
    s_add_u32 m0, s63, 69632
    ds_read_b64_tr_b16 v[114:115], v170 offset:18432
    v_mfma_f32_16x16x32_bf16 v[36:39], a[40:43], v[128:131], v[36:39]
    buffer_load_dwordx4 v172, s[36:39], s45 offen sc1 lds
    v_mfma_f32_16x16x32_bf16 v[40:43], a[44:47], v[128:131], v[40:43]
    s_waitcnt lgkmcnt(6)
    ds_read_b64_tr_b16 v[116:117], v171 offset:16384
    v_mfma_f32_16x16x32_bf16 v[44:47], a[36:39], v[132:135], v[44:47]
    s_waitcnt lgkmcnt(3)
    ds_read_b64_tr_b16 v[118:119], v171 offset:18432
    v_mfma_f32_16x16x32_bf16 v[48:51], a[40:43], v[132:135], v[48:51]
    s_add_u32 m0, s63, 73728
    v_mfma_f32_16x16x32_bf16 v[52:55], a[44:47], v[132:135], v[52:55]
    buffer_load_dwordx4 v172, s[36:39], s46 offen sc1 lds
    v_mfma_f32_16x16x32_bf16 v[8:11], a[48:51], v[104:107], v[8:11]
    ds_read_b64_tr_b16 v[120:121], v168 offset:20480
    v_mfma_f32_16x16x32_bf16 v[12:15], a[52:55], v[104:107], v[12:15]
    ds_read_b64_tr_b16 v[122:123], v168 offset:22528
    v_mfma_f32_16x16x32_bf16 v[16:19], a[56:59], v[104:107], v[16:19]
    s_add_u32 m0, s63, 77824
    ds_read_b64_tr_b16 v[124:125], v169 offset:20480
    v_mfma_f32_16x16x32_bf16 v[20:23], a[48:51], v[108:111], v[20:23]
    buffer_load_dwordx4 v172, s[36:39], s47 offen sc1 lds
    v_mfma_f32_16x16x32_bf16 v[24:27], a[52:55], v[108:111], v[24:27]
    ds_read_b64_tr_b16 v[126:127], v169 offset:22528
    v_add_u32 v172, 2048, v172
    v_mfma_f32_16x16x32_bf16 v[28:31], a[56:59], v[108:111], v[28:31]
    s_waitcnt lgkmcnt(6)
    ds_read_b64_tr_b16 v[128:129], v170 offset:20480
    v_mfma_f32_16x16x32_bf16 v[32:35], a[48:51], v[112:115], v[32:35]
    ds_read_b64_tr_b16 v[130:131], v170 offset:22528
    v_mfma_f32_16x16x32_bf16 v[36:39], a[52:55], v[112:115], v[36:39]
    buffer_load_dwordx4 a[240:243], v248, s[36:39], s62 offen offset:0 sc1
    v_mfma_f32_16x16x32_bf16 v[40:43], a[56:59], v[112:115], v[40:43]
    s_waitcnt lgkmcnt(6)
    ds_read_b64_tr_b16 v[132:133], v171 offset:20480
    v_mfma_f32_16x16x32_bf16 v[44:47], a[48:51], v[116:119], v[44:47]
    s_waitcnt lgkmcnt(3)
    ds_read_b64_tr_b16 v[134:135], v171 offset:22528
    v_mfma_f32_16x16x32_bf16 v[48:51], a[52:55], v[116:119], v[48:51]
    v_mfma_f32_16x16x32_bf16 v[52:55], a[56:59], v[116:119], v[52:55]
    buffer_load_dwordx4 a[244:247], v248, s[36:39], s62 offen offset:1024 sc1
    v_mfma_f32_16x16x32_bf16 v[8:11], a[60:63], v[120:123], v[8:11]
    ds_read_b64_tr_b16 v[104:105], v168 offset:24576
    v_mfma_f32_16x16x32_bf16 v[12:15], a[64:67], v[120:123], v[12:15]
    ds_read_b64_tr_b16 v[106:107], v168 offset:26624
    v_mfma_f32_16x16x32_bf16 v[16:19], a[68:71], v[120:123], v[16:19]
    ds_read_b64_tr_b16 v[108:109], v169 offset:24576
    v_mfma_f32_16x16x32_bf16 v[20:23], a[60:63], v[124:127], v[20:23]
    buffer_load_dwordx4 a[248:251], v248, s[36:39], s62 offen offset:2048 sc1
    v_mfma_f32_16x16x32_bf16 v[24:27], a[64:67], v[124:127], v[24:27]
    ds_read_b64_tr_b16 v[110:111], v169 offset:26624
    v_mfma_f32_16x16x32_bf16 v[28:31], a[68:71], v[124:127], v[28:31]
    s_waitcnt lgkmcnt(6)
    ds_read_b64_tr_b16 v[112:113], v170 offset:24576
    v_mfma_f32_16x16x32_bf16 v[32:35], a[60:63], v[128:131], v[32:35]
    ds_read_b64_tr_b16 v[114:115], v170 offset:26624
    v_mfma_f32_16x16x32_bf16 v[36:39], a[64:67], v[128:131], v[36:39]
    buffer_load_dwordx4 a[252:255], v248, s[36:39], s62 offen offset:3072 sc1
    v_mfma_f32_16x16x32_bf16 v[40:43], a[68:71], v[128:131], v[40:43]
    s_waitcnt lgkmcnt(6)
    s_add_u32 s62, s62, 4096
    ds_read_b64_tr_b16 v[116:117], v171 offset:24576
    v_mfma_f32_16x16x32_bf16 v[44:47], a[60:63], v[132:135], v[44:47]
    s_waitcnt lgkmcnt(3)
    ds_read_b64_tr_b16 v[118:119], v171 offset:26624
    v_mfma_f32_16x16x32_bf16 v[48:51], a[64:67], v[132:135], v[48:51]
    v_mfma_f32_16x16x32_bf16 v[52:55], a[68:71], v[132:135], v[52:55]
    buffer_load_dwordx4 v[136:139], v248, s[36:39], s62 offen offset:0 sc1
    v_mfma_f32_16x16x32_bf16 v[8:11], a[72:75], v[104:107], v[8:11]
    s_barrier
    ds_read_b64_tr_b16 v[120:121], v168 offset:28672
    v_mfma_f32_16x16x32_bf16 v[12:15], a[76:79], v[104:107], v[12:15]
    ds_read_b64_tr_b16 v[122:123], v168 offset:30720
    v_mfma_f32_16x16x32_bf16 v[16:19], a[80:83], v[104:107], v[16:19]
    ds_read_b64_tr_b16 v[124:125], v169 offset:28672
    v_mfma_f32_16x16x32_bf16 v[20:23], a[72:75], v[108:111], v[20:23]
    buffer_load_dwordx4 v[140:143], v248, s[36:39], s62 offen offset:1024 sc1
    v_mfma_f32_16x16x32_bf16 v[24:27], a[76:79], v[108:111], v[24:27]
    ds_read_b64_tr_b16 v[126:127], v169 offset:30720
    v_mfma_f32_16x16x32_bf16 v[28:31], a[80:83], v[108:111], v[28:31]
    s_waitcnt lgkmcnt(6)
    ds_read_b64_tr_b16 v[128:129], v170 offset:28672
    v_mfma_f32_16x16x32_bf16 v[32:35], a[72:75], v[112:115], v[32:35]
    ds_read_b64_tr_b16 v[130:131], v170 offset:30720
    v_mfma_f32_16x16x32_bf16 v[36:39], a[76:79], v[112:115], v[36:39]
    buffer_load_dwordx4 v[144:147], v248, s[36:39], s62 offen offset:2048 sc1
    v_mfma_f32_16x16x32_bf16 v[40:43], a[80:83], v[112:115], v[40:43]
    s_waitcnt lgkmcnt(6)
    ds_read_b64_tr_b16 v[132:133], v171 offset:28672
    v_mfma_f32_16x16x32_bf16 v[44:47], a[72:75], v[116:119], v[44:47]
    s_waitcnt lgkmcnt(3)
    ds_read_b64_tr_b16 v[134:135], v171 offset:30720
    v_mfma_f32_16x16x32_bf16 v[48:51], a[76:79], v[116:119], v[48:51]
    v_mfma_f32_16x16x32_bf16 v[52:55], a[80:83], v[116:119], v[52:55]
    buffer_load_dwordx4 v[148:151], v248, s[36:39], s62 offen offset:3072 sc1
    v_mfma_f32_16x16x32_bf16 v[8:11], a[84:87], v[120:123], v[8:11]
    s_add_u32 s62, s62, 4096
    ds_read_b64_tr_b16 v[104:105], v168 offset:32768
    v_mfma_f32_16x16x32_bf16 v[12:15], a[88:91], v[120:123], v[12:15]
    ds_read_b64_tr_b16 v[106:107], v168 offset:34816
    v_mfma_f32_16x16x32_bf16 v[16:19], a[92:95], v[120:123], v[16:19]
    ds_read_b64_tr_b16 v[108:109], v169 offset:32768
    v_mfma_f32_16x16x32_bf16 v[20:23], a[84:87], v[124:127], v[20:23]
    buffer_load_dwordx4 v[152:155], v248, s[36:39], s62 offen offset:0 sc1
    v_mfma_f32_16x16x32_bf16 v[24:27], a[88:91], v[124:127], v[24:27]
    ds_read_b64_tr_b16 v[110:111], v169 offset:34816
    v_mfma_f32_16x16x32_bf16 v[28:31], a[92:95], v[124:127], v[28:31]
    s_waitcnt lgkmcnt(6)
    ds_read_b64_tr_b16 v[112:113], v170 offset:32768
    v_mfma_f32_16x16x32_bf16 v[32:35], a[84:87], v[128:131], v[32:35]
    ds_read_b64_tr_b16 v[114:115], v170 offset:34816
    v_lshrrev_b32 v238, 1, v1
    v_mfma_f32_16x16x32_bf16 v[36:39], a[88:91], v[128:131], v[36:39]
    buffer_load_dwordx4 v[156:159], v248, s[36:39], s62 offen offset:1024 sc1
    v_mfma_f32_16x16x32_bf16 v[40:43], a[92:95], v[128:131], v[40:43]
    s_waitcnt lgkmcnt(6)
    ds_read_b64_tr_b16 v[116:117], v171 offset:32768
    v_lshlrev_b32 v238, 9, v238
    v_mfma_f32_16x16x32_bf16 v[44:47], a[84:87], v[132:135], v[44:47]
    s_waitcnt lgkmcnt(3)
    ds_read_b64_tr_b16 v[118:119], v171 offset:34816
    v_and_b32 v239, 1, v1
    v_mfma_f32_16x16x32_bf16 v[48:51], a[88:91], v[132:135], v[48:51]
    v_lshl_add_u32 v219, v239, 2, v238
    v_mfma_f32_16x16x32_bf16 v[52:55], a[92:95], v[132:135], v[52:55]
    s_lshl_b32 s55, s3, 7
    s_add_u32 s55, s55, 133120
    buffer_load_dwordx4 v[160:163], v248, s[36:39], s62 offen offset:2048 sc1
    v_mfma_f32_16x16x32_bf16 v[8:11], a[96:99], v[104:107], v[8:11]
    ds_read_b64_tr_b16 v[120:121], v168 offset:36864
    v_add_u32 v219, s55, v219
    v_mfma_f32_16x16x32_bf16 v[12:15], a[100:103], v[104:107], v[12:15]
    ds_read_b64_tr_b16 v[122:123], v168 offset:38912
    v_min_u32 v238, 49, v1
    v_mfma_f32_16x16x32_bf16 v[16:19], a[104:107], v[104:107], v[16:19]
    ds_read_b64_tr_b16 v[124:125], v169 offset:36864
    v_lshlrev_b32 v238, 7, v238
    v_mfma_f32_16x16x32_bf16 v[20:23], a[96:99], v[108:111], v[20:23]
    buffer_load_dwordx4 v[164:167], v248, s[36:39], s62 offen offset:3072 sc1
    v_mfma_f32_16x16x32_bf16 v[24:27], a[100:103], v[108:111], v[24:27]
    s_add_u32 s62, s62, 4096
    ds_read_b64_tr_b16 v[126:127], v169 offset:38912
    v_add_u32 v238, 99584, v238
    v_mfma_f32_16x16x32_bf16 v[28:31], a[104:107], v[108:111], v[28:31]
    s_waitcnt lgkmcnt(6)
    ds_read_b64_tr_b16 v[128:129], v170 offset:36864
    v_mfma_f32_16x16x32_bf16 v[32:35], a[96:99], v[112:115], v[32:35]
    ds_read_b64_tr_b16 v[130:131], v170 offset:38912
    v_mfma_f32_16x16x32_bf16 v[36:39], a[100:103], v[112:115], v[36:39]
    v_mfma_f32_16x16x32_bf16 v[40:43], a[104:107], v[112:115], v[40:43]
    s_waitcnt lgkmcnt(6)
    ds_read_b64_tr_b16 v[132:133], v171 offset:36864
    v_mfma_f32_16x16x32_bf16 v[44:47], a[96:99], v[116:119], v[44:47]
    s_waitcnt lgkmcnt(3)
    ds_read_b64_tr_b16 v[134:135], v171 offset:38912
    v_mfma_f32_16x16x32_bf16 v[48:51], a[100:103], v[116:119], v[48:51]
    v_cmp_lt_u32 vcc, 39, v1
    s_nop 1
    v_cndmask_b32 v219, v219, v238, vcc
    v_mfma_f32_16x16x32_bf16 v[52:55], a[104:107], v[116:119], v[52:55]
    s_mov_b32 s17, 23199744
    v_mfma_f32_16x16x32_bf16 v[8:11], a[108:111], v[120:123], v[8:11]
    s_waitcnt vmcnt(12)
    s_barrier
    ds_read_b64_tr_b16 v[104:105], v168 offset:40960
    v_mfma_f32_16x16x32_bf16 v[12:15], a[112:115], v[120:123], v[12:15]
    ds_read_b64_tr_b16 v[106:107], v168 offset:43008
    ds_read_b64 v[200:201], v216
    v_mfma_f32_16x16x32_bf16 v[16:19], a[116:119], v[120:123], v[16:19]
    ds_read_b64_tr_b16 v[108:109], v169 offset:40960
    ds_read_b64 v[202:203], v217
    v_mfma_f32_16x16x32_bf16 v[20:23], a[108:111], v[124:127], v[20:23]
    v_mfma_f32_16x16x32_bf16 v[24:27], a[112:115], v[124:127], v[24:27]
    ds_read_b64_tr_b16 v[110:111], v169 offset:43008
    ds_read_b64 v[204:205], v218
    v_mfma_f32_16x16x32_bf16 v[28:31], a[116:119], v[124:127], v[28:31]
    s_waitcnt lgkmcnt(9)
    ds_read_b64_tr_b16 v[112:113], v170 offset:40960
    v_mfma_f32_16x16x32_bf16 v[32:35], a[108:111], v[128:131], v[32:35]
    ds_read_b64_tr_b16 v[114:115], v170 offset:43008
    v_mfma_f32_16x16x32_bf16 v[36:39], a[112:115], v[128:131], v[36:39]
    v_mfma_f32_16x16x32_bf16 v[40:43], a[116:119], v[128:131], v[40:43]
    s_waitcnt lgkmcnt(9)
    ds_read_b64_tr_b16 v[116:117], v171 offset:40960
    v_mfma_f32_16x16x32_bf16 v[44:47], a[108:111], v[132:135], v[44:47]
    s_waitcnt lgkmcnt(3)
    ds_read_b64_tr_b16 v[118:119], v171 offset:43008
    v_lshlrev_b32 v230, 16, v200
    v_and_b32 v231, 0xffff0000, v200
    v_mfma_f32_16x16x32_bf16 v[48:51], a[112:115], v[132:135], v[48:51]
    v_mul_f32 v230, v230, v220
    v_mul_f32 v231, v231, v220
    v_mul_f32 v234, v230, v230
    v_mfma_f32_16x16x32_bf16 v[52:55], a[116:119], v[132:135], v[52:55]
    v_mul_f32 v235, v231, v231
    v_lshlrev_b32 v232, 16, v201
    v_and_b32 v233, 0xffff0000, v201
    v_mfma_f32_16x16x32_bf16 v[8:11], a[120:123], v[104:107], v[8:11]
    s_lshl_b32 s56, s73, 7
    s_add_u32 s56, s56, 23353344
    ds_read_b64_tr_b16 v[120:121], v168 offset:45056
    v_mul_f32 v232, v232, v220
    v_mfma_f32_16x16x32_bf16 v[12:15], a[124:127], v[104:107], v[12:15]
    ds_read_b64_tr_b16 v[122:123], v168 offset:47104
    v_mov_b32 v242, 0
    v_mul_f32 v233, v233, v220
    v_mfma_f32_16x16x32_bf16 v[16:19], a[128:131], v[104:107], v[16:19]
    ds_read_b64_tr_b16 v[124:125], v169 offset:45056
    v_mul_f32 v236, v232, v232
    v_mul_f32 v237, v233, v233
    v_mfma_f32_16x16x32_bf16 v[20:23], a[120:123], v[108:111], v[20:23]
    v_lshlrev_b32 v206, 16, v202
    v_and_b32 v207, 0xffff0000, v202
    v_mul_f32 v206, v206, v221
    v_mfma_f32_16x16x32_bf16 v[24:27], a[124:127], v[108:111], v[24:27]
    ds_read_b64_tr_b16 v[126:127], v169 offset:47104
    v_mul_f32 v207, v207, v221
    v_add_f32 v230, v230, v206
    v_mfma_f32_16x16x32_bf16 v[28:31], a[128:131], v[108:111], v[28:31]
    s_waitcnt lgkmcnt(6)
    ds_read_b64_tr_b16 v[128:129], v170 offset:45056
    v_add_f32 v231, v231, v207
    v_fmac_f32 v234, v206, v206
    v_mfma_f32_16x16x32_bf16 v[32:35], a[120:123], v[112:115], v[32:35]
    ds_read_b64_tr_b16 v[130:131], v170 offset:47104
    v_fmac_f32 v235, v207, v207
    v_lshlrev_b32 v208, 16, v203
    v_mfma_f32_16x16x32_bf16 v[36:39], a[124:127], v[112:115], v[36:39]
    v_and_b32 v209, 0xffff0000, v203
    v_mul_f32 v208, v208, v221
    v_mul_f32 v209, v209, v221
    v_mfma_f32_16x16x32_bf16 v[40:43], a[128:131], v[112:115], v[40:43]
    s_waitcnt lgkmcnt(6)
    ds_read_b64_tr_b16 v[132:133], v171 offset:45056
    v_add_f32 v232, v232, v208
    v_add_f32 v233, v233, v209
    v_mfma_f32_16x16x32_bf16 v[44:47], a[120:123], v[116:119], v[44:47]
    s_waitcnt lgkmcnt(3)
    ds_read_b64_tr_b16 v[134:135], v171 offset:47104
    v_fmac_f32 v236, v208, v208
    v_fmac_f32 v237, v209, v209
    v_mfma_f32_16x16x32_bf16 v[48:51], a[124:127], v[116:119], v[48:51]
    v_lshlrev_b32 v206, 16, v204
    v_and_b32 v207, 0xffff0000, v204
    v_mul_f32 v206, v206, v222
    v_mfma_f32_16x16x32_bf16 v[52:55], a[128:131], v[116:119], v[52:55]
    buffer_load_dword v240, v219, s[36:39], s17 offen sc1
    v_mfma_f32_16x16x32_bf16 v[8:11], a[132:135], v[120:123], v[8:11]
    ds_read_b64_tr_b16 v[104:105], v168 offset:49152
    v_mul_f32 v207, v207, v222
    v_add_f32 v230, v230, v206
    v_mfma_f32_16x16x32_bf16 v[12:15], a[136:139], v[120:123], v[12:15]
    ds_read_b64_tr_b16 v[106:107], v168 offset:51200
    v_add_f32 v231, v231, v207
    v_fmac_f32 v234, v206, v206
    v_mfma_f32_16x16x32_bf16 v[16:19], a[140:143], v[120:123], v[16:19]
    ds_read_b64_tr_b16 v[108:109], v169 offset:49152
    v_fmac_f32 v235, v207, v207
    v_lshlrev_b32 v208, 16, v205
    v_mfma_f32_16x16x32_bf16 v[20:23], a[132:135], v[124:127], v[20:23]
    v_and_b32 v209, 0xffff0000, v205
    v_mul_f32 v208, v208, v222
    v_mul_f32 v209, v209, v222
    v_mfma_f32_16x16x32_bf16 v[24:27], a[136:139], v[124:127], v[24:27]
    ds_read_b64_tr_b16 v[110:111], v169 offset:51200
    v_add_f32 v232, v232, v208
    v_add_f32 v233, v233, v209
    v_mfma_f32_16x16x32_bf16 v[28:31], a[140:143], v[124:127], v[28:31]
    s_waitcnt lgkmcnt(6)
    ds_read_b64_tr_b16 v[112:113], v170 offset:49152
    v_fmac_f32 v236, v208, v208
    v_fmac_f32 v237, v209, v209
    v_mfma_f32_16x16x32_bf16 v[32:35], a[132:135], v[128:131], v[32:35]
    ds_read_b64_tr_b16 v[114:115], v170 offset:51200
    v_permlane32_swap_b32 v230, v234
    v_permlane32_swap_b32 v231, v235
    v_mfma_f32_16x16x32_bf16 v[36:39], a[136:139], v[128:131], v[36:39]
    v_permlane32_swap_b32 v232, v236
    v_permlane32_swap_b32 v233, v237
    v_add_f32 v230, v230, v234
    v_mfma_f32_16x16x32_bf16 v[40:43], a[140:143], v[128:131], v[40:43]
    s_waitcnt lgkmcnt(6)
    ds_read_b64_tr_b16 v[116:117], v171 offset:49152
    v_add_f32 v231, v231, v235
    v_add_f32 v232, v232, v236
    v_mfma_f32_16x16x32_bf16 v[44:47], a[132:135], v[132:135], v[44:47]
    s_waitcnt lgkmcnt(3)
    ds_read_b64_tr_b16 v[118:119], v171 offset:51200
    v_add_f32 v233, v233, v237
    v_permlane16_swap_b32 v230, v232
    v_mfma_f32_16x16x32_bf16 v[48:51], a[136:139], v[132:135], v[48:51]
    v_permlane16_swap_b32 v231, v233
    v_add_f32 v230, v230, v232
    v_add_f32 v231, v231, v233
    v_mfma_f32_16x16x32_bf16 v[52:55], a[140:143], v[132:135], v[52:55]
    v_add_f32_dpp v230, v230, v230 row_ror:8 row_mask:0xf bank_mask:0xf
    v_add_f32_dpp v231, v231, v231 row_ror:8 row_mask:0xf bank_mask:0xf
    s_nop 0
    v_add_f32_dpp v230, v230, v230 row_ror:4 row_mask:0xf bank_mask:0xf
    v_mfma_f32_16x16x32_bf16 v[8:11], a[144:147], v[104:107], v[8:11]
    ds_read_b64_tr_b16 v[120:121], v168 offset:53248
    v_add_f32_dpp v231, v231, v231 row_ror:4 row_mask:0xf bank_mask:0xf
    v_add_f32_dpp v230, v230, v230 row_ror:2 row_mask:0xf bank_mask:0xf
    v_mfma_f32_16x16x32_bf16 v[12:15], a[148:151], v[104:107], v[12:15]
    ds_read_b64_tr_b16 v[122:123], v168 offset:55296
    v_add_f32_dpp v231, v231, v231 row_ror:2 row_mask:0xf bank_mask:0xf
    v_add_f32_dpp v230, v230, v230 row_ror:1 row_mask:0xf bank_mask:0xf
    v_mfma_f32_16x16x32_bf16 v[16:19], a[152:155], v[104:107], v[16:19]
    ds_read_b64_tr_b16 v[124:125], v169 offset:53248
    v_add_f32_dpp v231, v231, v231 row_ror:1 row_mask:0xf bank_mask:0xf
    v_mfma_f32_16x16x32_bf16 v[20:23], a[144:147], v[108:111], v[20:23]
    s_mov_b32 exec_lo, 0x00010001
    s_mov_b32 exec_hi, 0x00010001
    ds_write_b64 v210, v[230:231]
    s_mov_b64 exec, -1
    v_mov_b32 v213, s48
    v_mfma_f32_16x16x32_bf16 v[24:27], a[148:151], v[108:111], v[24:27]
    ds_read_b64_tr_b16 v[126:127], v169 offset:55296
    v_mov_b32 v215, s48
    v_mfma_f32_16x16x32_bf16 v[28:31], a[152:155], v[108:111], v[28:31]
    s_waitcnt lgkmcnt(7)
    ds_read_b64_tr_b16 v[128:129], v170 offset:53248
    v_mfma_f32_16x16x32_bf16 v[32:35], a[144:147], v[112:115], v[32:35]
    ds_read_b64_tr_b16 v[130:131], v170 offset:55296
    v_mfma_f32_16x16x32_bf16 v[36:39], a[148:151], v[112:115], v[36:39]
    v_mfma_f32_16x16x32_bf16 v[40:43], a[152:155], v[112:115], v[40:43]
    s_waitcnt lgkmcnt(3)
    s_barrier
    ds_read_b64_tr_b16 v[132:133], v171 offset:53248
    ds_read2_b32 v[230:231], v211 offset0:0 offset1:4
    v_mfma_f32_16x16x32_bf16 v[44:47], a[144:147], v[116:119], v[44:47]
    s_waitcnt lgkmcnt(3)
    ds_read_b64_tr_b16 v[134:135], v171 offset:55296
    ds_read2_b32 v[232:233], v211 offset0:8 offset1:12
    ds_read2_b32 v[234:235], v211 offset0:16 offset1:20
    v_mfma_f32_16x16x32_bf16 v[48:51], a[148:151], v[116:119], v[48:51]
    ds_read2_b32 v[236:237], v211 offset0:24 offset1:28
    v_mfma_f32_16x16x32_bf16 v[52:55], a[152:155], v[116:119], v[52:55]
    v_mfma_f32_16x16x32_bf16 v[8:11], a[156:159], v[120:123], v[8:11]
    ds_read_b64_tr_b16 v[104:105], v168 offset:57344
    v_mfma_f32_16x16x32_bf16 v[12:15], a[160:163], v[120:123], v[12:15]
    ds_read_b64_tr_b16 v[106:107], v168 offset:59392
    v_mfma_f32_16x16x32_bf16 v[16:19], a[164:167], v[120:123], v[16:19]
    ds_read_b64_tr_b16 v[108:109], v169 offset:57344
    s_waitcnt lgkmcnt(5)
    v_add_f32 v230, v230, v232
    v_add_f32 v231, v231, v233
    v_mfma_f32_16x16x32_bf16 v[20:23], a[156:159], v[124:127], v[20:23]
    s_waitcnt lgkmcnt(3)
    v_add_f32 v234, v234, v236
    v_add_f32 v235, v235, v237
    v_add_f32 v230, v230, v234
    v_mfma_f32_16x16x32_bf16 v[24:27], a[160:163], v[124:127], v[24:27]
    ds_read_b64_tr_b16 v[110:111], v169 offset:59392
    s_waitcnt vmcnt(0)
    v_cmp_ne_u32 vcc, s48, v240
    s_cbranch_vccnz L_chk21_slow
L_chk21_back:
    v_add_f32 v231, v231, v235
    v_mfma_f32_16x16x32_bf16 v[28:31], a[164:167], v[124:127], v[28:31]
    ds_read_b64_tr_b16 v[112:113], v170 offset:57344
    v_mul_f32 v230, 0x3acccccd, v230
    v_mul_f32 v234, v230, v230
    v_mfma_f32_16x16x32_bf16 v[32:35], a[156:159], v[128:131], v[32:35]
    ds_read_b64_tr_b16 v[114:115], v170 offset:59392
    v_mov_b32 v212, 0x3acccccd
    v_fma_f32 v231, v231, v212, -v234
    v_mfma_f32_16x16x32_bf16 v[36:39], a[160:163], v[128:131], v[36:39]
    buffer_load_dword v241, v242, s[36:39], s56 offen sc1
    v_mfma_f32_16x16x32_bf16 v[40:43], a[164:167], v[128:131], v[40:43]
    ds_read_b64_tr_b16 v[116:117], v171 offset:57344
    v_max_f32 v231, 0, v231
    v_add_f32 v231, 0x3727c5ac, v231
    v_mfma_f32_16x16x32_bf16 v[44:47], a[156:159], v[132:135], v[44:47]
    s_waitcnt lgkmcnt(3)
    ds_read_b64_tr_b16 v[118:119], v171 offset:59392
    v_rsq_f32 v212, v231
    s_nop 0
    v_mul_f32_e64 v214, -v230, v212
    v_mfma_f32_16x16x32_bf16 v[48:51], a[160:163], v[132:135], v[48:51]
    s_add_u32 m0, s63, 81920
    s_mov_b64 exec, 0xf
    buffer_store_dwordx4 v[212:215], v248, s[36:39], s7 offen sc1
    s_mov_b64 exec, -1
    v_mfma_f32_16x16x32_bf16 v[52:55], a[164:167], v[132:135], v[52:55]
    buffer_load_dwordx4 v172, s[36:39], s10 offen sc1 lds
    v_mfma_f32_16x16x32_bf16 v[8:11], a[168:171], v[104:107], v[8:11]
    ds_read_b64_tr_b16 v[120:121], v168 offset:61440
    v_mfma_f32_16x16x32_bf16 v[12:15], a[172:175], v[104:107], v[12:15]
    ds_read_b64_tr_b16 v[122:123], v168 offset:63488
    v_add_u32 v168, 65536, v168
    v_mfma_f32_16x16x32_bf16 v[16:19], a[176:179], v[104:107], v[16:19]
    s_add_u32 m0, s63, 86016
    ds_read_b64_tr_b16 v[124:125], v169 offset:61440
    v_mfma_f32_16x16x32_bf16 v[20:23], a[168:171], v[108:111], v[20:23]
    buffer_load_dwordx4 v172, s[36:39], s11 offen sc1 lds
    v_mfma_f32_16x16x32_bf16 v[24:27], a[172:175], v[108:111], v[24:27]
    ds_read_b64_tr_b16 v[126:127], v169 offset:63488
    v_add_u32 v169, 65536, v169
    v_mfma_f32_16x16x32_bf16 v[28:31], a[176:179], v[108:111], v[28:31]
    s_waitcnt lgkmcnt(6)
    ds_read_b64_tr_b16 v[128:129], v170 offset:61440
    v_mfma_f32_16x16x32_bf16 v[32:35], a[168:171], v[112:115], v[32:35]
    s_add_u32 m0, s63, 90112
    ds_read_b64_tr_b16 v[130:131], v170 offset:63488
    v_add_u32 v170, 65536, v170
    v_mfma_f32_16x16x32_bf16 v[36:39], a[172:175], v[112:115], v[36:39]
    buffer_load_dwordx4 v172, s[36:39], s12 offen sc1 lds
    v_mfma_f32_16x16x32_bf16 v[40:43], a[176:179], v[112:115], v[40:43]
    s_waitcnt lgkmcnt(6)
    ds_read_b64_tr_b16 v[132:133], v171 offset:61440
    v_mfma_f32_16x16x32_bf16 v[44:47], a[168:171], v[116:119], v[44:47]
    s_waitcnt lgkmcnt(3)
    ds_read_b64_tr_b16 v[134:135], v171 offset:63488
    v_add_u32 v171, 65536, v171
    v_mfma_f32_16x16x32_bf16 v[48:51], a[172:175], v[116:119], v[48:51]
    s_add_u32 m0, s63, 94208
    v_mfma_f32_16x16x32_bf16 v[52:55], a[176:179], v[116:119], v[52:55]
    buffer_load_dwordx4 v172, s[36:39], s13 offen sc1 lds
    v_mfma_f32_16x16x32_bf16 v[8:11], a[180:183], v[120:123], v[8:11]
    ds_read_b64_tr_b16 v[104:105], v168 offset:0
    v_mfma_f32_16x16x32_bf16 v[12:15], a[184:187], v[120:123], v[12:15]
    ds_read_b64_tr_b16 v[106:107], v168 offset:2048
    v_mfma_f32_16x16x32_bf16 v[16:19], a[188:191], v[120:123], v[16:19]
    s_add_u32 m0, s63, 98304
    ds_read_b64_tr_b16 v[108:109], v169 offset:0
    v_mfma_f32_16x16x32_bf16 v[20:23], a[180:183], v[124:127], v[20:23]
    buffer_load_dwordx4 v172, s[36:39], s14 offen sc1 lds
    v_mfma_f32_16x16x32_bf16 v[24:27], a[184:187], v[124:127], v[24:27]
    ds_read_b64_tr_b16 v[110:111], v169 offset:2048
    v_mfma_f32_16x16x32_bf16 v[28:31], a[188:191], v[124:127], v[28:31]
    s_waitcnt lgkmcnt(6)
    ds_read_b64_tr_b16 v[112:113], v170 offset:0
    v_mfma_f32_16x16x32_bf16 v[32:35], a[180:183], v[128:131], v[32:35]
    s_add_u32 m0, s63, 102400
    ds_read_b64_tr_b16 v[114:115], v170 offset:2048
    v_mfma_f32_16x16x32_bf16 v[36:39], a[184:187], v[128:131], v[36:39]
    buffer_load_dwordx4 v172, s[36:39], s15 offen sc1 lds
    v_mfma_f32_16x16x32_bf16 v[40:43], a[188:191], v[128:131], v[40:43]
    s_waitcnt lgkmcnt(6)
    ds_read_b64_tr_b16 v[116:117], v171 offset:0
    v_mfma_f32_16x16x32_bf16 v[44:47], a[180:183], v[132:135], v[44:47]
    s_waitcnt lgkmcnt(3)
    ds_read_b64_tr_b16 v[118:119], v171 offset:2048
    v_mfma_f32_16x16x32_bf16 v[48:51], a[184:187], v[132:135], v[48:51]
    s_add_u32 m0, s63, 106496
    v_mfma_f32_16x16x32_bf16 v[52:55], a[188:191], v[132:135], v[52:55]
    buffer_load_dwordx4 v172, s[36:39], s18 offen sc1 lds
    v_mfma_f32_16x16x32_bf16 v[8:11], a[192:195], v[104:107], v[8:11]
    ds_read_b64_tr_b16 v[120:121], v168 offset:4096
    v_mfma_f32_16x16x32_bf16 v[12:15], a[196:199], v[104:107], v[12:15]
    ds_read_b64_tr_b16 v[122:123], v168 offset:6144
    v_mfma_f32_16x16x32_bf16 v[16:19], a[200:203], v[104:107], v[16:19]
    s_add_u32 m0, s63, 110592
    ds_read_b64_tr_b16 v[124:125], v169 offset:4096
    v_mfma_f32_16x16x32_bf16 v[20:23], a[192:195], v[108:111], v[20:23]
    buffer_load_dwordx4 v172, s[36:39], s19 offen sc1 lds
    v_mfma_f32_16x16x32_bf16 v[24:27], a[196:199], v[108:111], v[24:27]
    ds_read_b64_tr_b16 v[126:127], v169 offset:6144
    v_mfma_f32_16x16x32_bf16 v[28:31], a[200:203], v[108:111], v[28:31]
    s_waitcnt lgkmcnt(6)
    ds_read_b64_tr_b16 v[128:129], v170 offset:4096
    v_mfma_f32_16x16x32_bf16 v[32:35], a[192:195], v[112:115], v[32:35]
    s_add_u32 m0, s63, 114688
    ds_read_b64_tr_b16 v[130:131], v170 offset:6144
    v_mfma_f32_16x16x32_bf16 v[36:39], a[196:199], v[112:115], v[36:39]
    buffer_load_dwordx4 v172, s[36:39], s20 offen sc1 lds
    v_mfma_f32_16x16x32_bf16 v[40:43], a[200:203], v[112:115], v[40:43]
    ds_read_b64_tr_b16 v[132:133], v171 offset:4096
    s_waitcnt vmcnt(9)
    v_cmp_ne_u32 vcc, s48, v241
    s_cbranch_vccnz L_chk22_slow
L_chk22_back:
    s_waitcnt lgkmcnt(7)
    v_mfma_f32_16x16x32_bf16 v[44:47], a[192:195], v[116:119], v[44:47]
    s_waitcnt lgkmcnt(3)
    ds_read_b64_tr_b16 v[134:135], v171 offset:6144
    v_mfma_f32_16x16x32_bf16 v[48:51], a[196:199], v[116:119], v[48:51]
    s_add_u32 m0, s63, 118784
    v_mfma_f32_16x16x32_bf16 v[52:55], a[200:203], v[116:119], v[52:55]
    buffer_load_dwordx4 v172, s[36:39], s21 offen sc1 lds
    v_mfma_f32_16x16x32_bf16 v[8:11], a[204:207], v[120:123], v[8:11]
    ds_read_b64_tr_b16 v[104:105], v168 offset:8192
    v_mfma_f32_16x16x32_bf16 v[12:15], a[208:211], v[120:123], v[12:15]
    ds_read_b64_tr_b16 v[106:107], v168 offset:10240
    v_mfma_f32_16x16x32_bf16 v[16:19], a[212:215], v[120:123], v[16:19]
    s_add_u32 m0, s63, 122880
    ds_read_b64_tr_b16 v[108:109], v169 offset:8192
    v_mfma_f32_16x16x32_bf16 v[20:23], a[204:207], v[124:127], v[20:23]
    buffer_load_dwordx4 v172, s[36:39], s22 offen sc1 lds
    v_mfma_f32_16x16x32_bf16 v[24:27], a[208:211], v[124:127], v[24:27]
    ds_read_b64_tr_b16 v[110:111], v169 offset:10240
    v_mfma_f32_16x16x32_bf16 v[28:31], a[212:215], v[124:127], v[28:31]
    s_waitcnt lgkmcnt(6)
    ds_read_b64_tr_b16 v[112:113], v170 offset:8192
    v_mfma_f32_16x16x32_bf16 v[32:35], a[204:207], v[128:131], v[32:35]
    s_add_u32 m0, s63, 126976
    ds_read_b64_tr_b16 v[114:115], v170 offset:10240
    v_mfma_f32_16x16x32_bf16 v[36:39], a[208:211], v[128:131], v[36:39]
    buffer_load_dwordx4 v172, s[36:39], s23 offen sc1 lds
    v_mfma_f32_16x16x32_bf16 v[40:43], a[212:215], v[128:131], v[40:43]
    s_waitcnt lgkmcnt(6)
    ds_read_b64_tr_b16 v[116:117], v171 offset:8192
    v_mfma_f32_16x16x32_bf16 v[44:47], a[204:207], v[132:135], v[44:47]
    s_waitcnt lgkmcnt(3)
    ds_read_b64_tr_b16 v[118:119], v171 offset:10240
    v_mfma_f32_16x16x32_bf16 v[48:51], a[208:211], v[132:135], v[48:51]
    s_add_u32 m0, s63, 131072
    v_mfma_f32_16x16x32_bf16 v[52:55], a[212:215], v[132:135], v[52:55]
    buffer_load_dwordx4 v172, s[36:39], s24 offen sc1 lds
    v_mfma_f32_16x16x32_bf16 v[8:11], a[216:219], v[104:107], v[8:11]
    ds_read_b64_tr_b16 v[120:121], v168 offset:12288
    v_mfma_f32_16x16x32_bf16 v[12:15], a[220:223], v[104:107], v[12:15]
    ds_read_b64_tr_b16 v[122:123], v168 offset:14336
    v_add_u32 v168, 16384, v168
    v_mfma_f32_16x16x32_bf16 v[16:19], a[224:227], v[104:107], v[16:19]
    s_add_u32 m0, s63, 135168
    ds_read_b64_tr_b16 v[124:125], v169 offset:12288
    v_mfma_f32_16x16x32_bf16 v[20:23], a[216:219], v[108:111], v[20:23]
    buffer_load_dwordx4 v172, s[36:39], s25 offen sc1 lds
    v_mfma_f32_16x16x32_bf16 v[24:27], a[220:223], v[108:111], v[24:27]
    ds_read_b64_tr_b16 v[126:127], v169 offset:14336
    v_add_u32 v169, 16384, v169
    v_mfma_f32_16x16x32_bf16 v[28:31], a[224:227], v[108:111], v[28:31]
    s_waitcnt lgkmcnt(6)
    ds_read_b64_tr_b16 v[128:129], v170 offset:12288
    v_mfma_f32_16x16x32_bf16 v[32:35], a[216:219], v[112:115], v[32:35]
    s_add_u32 m0, s63, 139264
    ds_read_b64_tr_b16 v[130:131], v170 offset:14336
    v_add_u32 v170, 16384, v170
    v_mfma_f32_16x16x32_bf16 v[36:39], a[220:223], v[112:115], v[36:39]
    buffer_load_dwordx4 v172, s[36:39], s26 offen sc1 lds
    v_mfma_f32_16x16x32_bf16 v[40:43], a[224:227], v[112:115], v[40:43]
    s_waitcnt lgkmcnt(6)
    ds_read_b64_tr_b16 v[132:133], v171 offset:12288
    v_mfma_f32_16x16x32_bf16 v[44:47], a[216:219], v[116:119], v[44:47]
    s_waitcnt lgkmcnt(3)
    ds_read_b64_tr_b16 v[134:135], v171 offset:14336
    v_add_u32 v171, 16384, v171
    v_mfma_f32_16x16x32_bf16 v[48:51], a[220:223], v[116:119], v[48:51]
    s_add_u32 m0, s63, 143360
    v_mfma_f32_16x16x32_bf16 v[52:55], a[224:227], v[116:119], v[52:55]
    buffer_load_dwordx4 v172, s[36:39], s27 offen sc1 lds
    v_mfma_f32_16x16x32_bf16 v[8:11], a[228:231], v[120:123], v[8:11]
    s_waitcnt vmcnt(12)
    s_barrier
    ds_read_b64_tr_b16 v[104:105], v168 offset:0
    v_mfma_f32_16x16x32_bf16 v[12:15], a[232:235], v[120:123], v[12:15]
    ds_read_b64_tr_b16 v[106:107], v168 offset:2048
    v_mfma_f32_16x16x32_bf16 v[16:19], a[236:239], v[120:123], v[16:19]
    s_add_u32 m0, s63, 147456
    ds_read_b64_tr_b16 v[108:109], v169 offset:0
    v_mfma_f32_16x16x32_bf16 v[20:23], a[228:231], v[124:127], v[20:23]
    buffer_load_dwordx4 v172, s[36:39], s44 offen sc1 lds
    v_mfma_f32_16x16x32_bf16 v[24:27], a[232:235], v[124:127], v[24:27]
    ds_read_b64_tr_b16 v[110:111], v169 offset:2048
    v_mfma_f32_16x16x32_bf16 v[28:31], a[236:239], v[124:127], v[28:31]
    s_waitcnt lgkmcnt(6)
    ds_read_b64_tr_b16 v[112:113], v170 offset:0
    v_mfma_f32_16x16x32_bf16 v[32:35], a[228:231], v[128:131], v[32:35]
    s_add_u32 m0, s63, 151552
    ds_read_b64_tr_b16 v[114:115], v170 offset:2048
    v_mfma_f32_16x16x32_bf16 v[36:39], a[232:235], v[128:131], v[36:39]
    buffer_load_dwordx4 v172, s[36:39], s45 offen sc1 lds
    v_mfma_f32_16x16x32_bf16 v[40:43], a[236:239], v[128:131], v[40:43]
    s_waitcnt lgkmcnt(6)
    ds_read_b64_tr_b16 v[116:117], v171 offset:0
    v_mfma_f32_16x16x32_bf16 v[44:47], a[228:231], v[132:135], v[44:47]
    s_waitcnt lgkmcnt(3)
    ds_read_b64_tr_b16 v[118:119], v171 offset:2048
    v_mfma_f32_16x16x32_bf16 v[48:51], a[232:235], v[132:135], v[48:51]
    s_add_u32 m0, s63, 155648
    v_mfma_f32_16x16x32_bf16 v[52:55], a[236:239], v[132:135], v[52:55]
    buffer_load_dwordx4 v172, s[36:39], s46 offen sc1 lds
L_passB:
    v_mfma_f32_16x16x32_bf16 v[56:59], a[0:3], v[104:107], 0
    s_add_u32 s59, s63, 73728
    ds_read_b64_tr_b16 v[120:121], v168 offset:4096
    v_add_u32 v223, s59, v175
    v_mfma_f32_16x16x32_bf16 v[60:63], a[4:7], v[104:107], 0
    ds_read_b64_tr_b16 v[122:123], v168 offset:6144
    v_and_b32 v247, 48, v1
    v_mfma_f32_16x16x32_bf16 v[64:67], a[8:11], v[104:107], 0
    s_add_u32 m0, s63, 159744
    s_add_u32 s59, s63, 77824
    ds_read_b64_tr_b16 v[124:125], v169 offset:4096
    v_mfma_f32_16x16x32_bf16 v[68:71], a[0:3], v[108:111], 0
    buffer_load_dwordx4 v172, s[36:39], s47 offen sc1 lds
    v_mfma_f32_16x16x32_bf16 v[72:75], a[4:7], v[108:111], 0
    ds_read_b64_tr_b16 v[126:127], v169 offset:6144
    v_add_u32 v247, s59, v247
    v_mfma_f32_16x16x32_bf16 v[76:79], a[8:11], v[108:111], 0
    s_waitcnt lgkmcnt(6)
    ds_read_b64_tr_b16 v[128:129], v170 offset:4096
    v_add_u32 v216, 81920, v216
    v_mfma_f32_16x16x32_bf16 v[80:83], a[0:3], v[112:115], 0
    s_add_u32 m0, s63, 77824
    ds_read_b64_tr_b16 v[130:131], v170 offset:6144
    v_add_u32 v217, 81920, v217
    v_mfma_f32_16x16x32_bf16 v[84:87], a[4:7], v[112:115], 0
    buffer_load_dwordx4 v248, s[36:39], s9 offen sc1 lds
    v_mfma_f32_16x16x32_bf16 v[88:91], a[8:11], v[112:115], 0
    s_waitcnt lgkmcnt(6)
    ds_read_b64_tr_b16 v[132:133], v171 offset:4096
    v_add_u32 v218, 81920, v218
    v_mfma_f32_16x16x32_bf16 v[92:95], a[0:3], v[116:119], 0
    s_waitcnt lgkmcnt(3)
    ds_read_b64_tr_b16 v[134:135], v171 offset:6144
    v_lshrrev_b32 v253, 4, v1
    v_mfma_f32_16x16x32_bf16 v[96:99], a[4:7], v[116:119], 0
    v_lshlrev_b32 v253, 3, v253
    v_mfma_f32_16x16x32_bf16 v[100:103], a[8:11], v[116:119], 0
    s_lshl_b32 s57, s3, 5
    s_add_u32 s57, s57, 0
    v_mfma_f32_16x16x32_bf16 v[56:59], a[12:15], v[120:123], v[56:59]
    ds_read_b64_tr_b16 v[104:105], v168 offset:8192
    v_add_u32 v253, s57, v253
    v_mfma_f32_16x16x32_bf16 v[60:63], a[16:19], v[120:123], v[60:63]
    ds_read_b64_tr_b16 v[106:107], v168 offset:10240
    v_lshlrev_b32 v2, 2, v1
    v_mfma_f32_16x16x32_bf16 v[64:67], a[20:23], v[120:123], v[64:67]
    ds_read_b64_tr_b16 v[108:109], v169 offset:8192
    v_and_b32 v2, 12, v2
    v_mfma_f32_16x16x32_bf16 v[68:71], a[12:15], v[124:127], v[68:71]
    buffer_load_dwordx4 a[0:3], v248, s[36:39], s62 offen offset:0 sc1
    v_mfma_f32_16x16x32_bf16 v[72:75], a[16:19], v[124:127], v[72:75]
    ds_read_b64_tr_b16 v[110:111], v169 offset:10240
    v_add_u32 v2, 0, v2
    v_mfma_f32_16x16x32_bf16 v[76:79], a[20:23], v[124:127], v[76:79]
    s_waitcnt lgkmcnt(6)
    ds_read_b64_tr_b16 v[112:113], v170 offset:8192
    v_mfma_f32_16x16x32_bf16 v[80:83], a[12:15], v[128:131], v[80:83]
    ds_read_b64_tr_b16 v[114:115], v170 offset:10240
    v_mfma_f32_16x16x32_bf16 v[84:87], a[16:19], v[128:131], v[84:87]
    buffer_load_dwordx4 a[4:7], v248, s[36:39], s62 offen offset:1024 sc1
    v_mfma_f32_16x16x32_bf16 v[88:91], a[20:23], v[128:131], v[88:91]
    s_waitcnt lgkmcnt(6)
    ds_read_b64_tr_b16 v[116:117], v171 offset:8192
    v_mfma_f32_16x16x32_bf16 v[92:95], a[12:15], v[132:135], v[92:95]
    s_waitcnt lgkmcnt(3)
    ds_read_b64_tr_b16 v[118:119], v171 offset:10240
    v_mfma_f32_16x16x32_bf16 v[96:99], a[16:19], v[132:135], v[96:99]
    s_add_u32 m0, s63, 73728
    v_mfma_f32_16x16x32_bf16 v[100:103], a[20:23], v[132:135], v[100:103]
    buffer_load_dwordx4 v248, s[36:39], s6 offen sc1 lds
    v_mfma_f32_16x16x32_bf16 v[56:59], a[24:27], v[104:107], v[56:59]
    ds_read_b64_tr_b16 v[120:121], v168 offset:12288
    v_mfma_f32_16x16x32_bf16 v[60:63], a[28:31], v[104:107], v[60:63]
    ds_read_b64_tr_b16 v[122:123], v168 offset:14336
    v_mfma_f32_16x16x32_bf16 v[64:67], a[32:35], v[104:107], v[64:67]
    ds_read_b64_tr_b16 v[124:125], v169 offset:12288
    v_mfma_f32_16x16x32_bf16 v[68:71], a[24:27], v[108:111], v[68:71]
    buffer_load_dwordx4 a[8:11], v248, s[36:39], s62 offen offset:2048 sc1
    v_mfma_f32_16x16x32_bf16 v[72:75], a[28:31], v[108:111], v[72:75]
    s_add_u32 s62, s16, 1
    s_and_b32 s62, s62, 3
    ds_read_b64_tr_b16 v[126:127], v169 offset:14336
    v_mfma_f32_16x16x32_bf16 v[76:79], a[32:35], v[108:111], v[76:79]
    s_waitcnt lgkmcnt(6)
    s_mul_i32 s62, s62, 15360
    ds_read_b64_tr_b16 v[128:129], v170 offset:12288
    v_mfma_f32_16x16x32_bf16 v[80:83], a[24:27], v[112:115], v[80:83]
    s_add_u32 s62, s62, s65
    ds_read_b64_tr_b16 v[130:131], v170 offset:14336
    v_mfma_f32_16x16x32_bf16 v[84:87], a[28:31], v[112:115], v[84:87]
    buffer_load_dwordx4 a[12:15], v248, s[36:39], s62 offen offset:0 sc1
    v_mfma_f32_16x16x32_bf16 v[88:91], a[32:35], v[112:115], v[88:91]
    s_waitcnt vmcnt(5)
    ds_read_b64_tr_b16 v[132:133], v171 offset:12288
    ds_read_b128 v[176:179], v247 offset:0
    s_waitcnt lgkmcnt(8)
    v_mfma_f32_16x16x32_bf16 v[92:95], a[24:27], v[116:119], v[92:95]
    s_waitcnt lgkmcnt(3)
    ds_read_b64_tr_b16 v[134:135], v171 offset:14336
    ds_read_b128 v[180:183], v247 offset:64
    v_mfma_f32_16x16x32_bf16 v[96:99], a[28:31], v[116:119], v[96:99]
    ds_read_b128 v[184:187], v247 offset:128
    ds_read_b128 v[188:191], v247 offset:192
    v_mfma_f32_16x16x32_bf16 v[100:103], a[32:35], v[116:119], v[100:103]
    buffer_load_dwordx4 a[16:19], v248, s[36:39], s62 offen offset:1024 sc1
    v_mfma_f32_16x16x32_bf16 v[56:59], a[36:39], v[120:123], v[56:59]
    s_barrier
    ds_read_b64_tr_b16 v[104:105], v168 offset:16384
    ds_read_b128 v[192:195], v247 offset:256
    v_mfma_f32_16x16x32_bf16 v[60:63], a[40:43], v[120:123], v[60:63]
    ds_read_b64_tr_b16 v[106:107], v168 offset:18432
    ds_read_b128 v[196:199], v247 offset:320
    v_mfma_f32_16x16x32_bf16 v[64:67], a[44:47], v[120:123], v[64:67]
    ds_read_b64_tr_b16 v[108:109], v169 offset:16384
    ds_read_b64 v[224:225], v216
    v_mfma_f32_16x16x32_bf16 v[68:71], a[36:39], v[124:127], v[68:71]
    buffer_load_dwordx4 a[20:23], v248, s[36:39], s62 offen offset:2048 sc1
    v_mfma_f32_16x16x32_bf16 v[72:75], a[40:43], v[124:127], v[72:75]
    s_waitcnt vmcnt(4)
    ds_read_b64_tr_b16 v[110:111], v169 offset:18432
    ds_read_b128 v[200:203], v223 offset:0
    v_mfma_f32_16x16x32_bf16 v[76:79], a[44:47], v[124:127], v[76:79]
    s_waitcnt lgkmcnt(12)
    ds_read_b64_tr_b16 v[112:113], v170 offset:16384
    ds_read_b128 v[204:207], v223 offset:256
    v_mfma_f32_16x16x32_bf16 v[80:83], a[36:39], v[128:131], v[80:83]
    ds_read_b64_tr_b16 v[114:115], v170 offset:18432
    ds_read_b128 v[208:211], v223 offset:512
    v_mfma_f32_16x16x32_bf16 v[84:87], a[40:43], v[128:131], v[84:87]
    buffer_load_dwordx4 a[24:27], v248, s[36:39], s62 offen offset:3072 sc1
    v_mfma_f32_16x16x32_bf16 v[88:91], a[44:47], v[128:131], v[88:91]
    s_waitcnt lgkmcnt(12)
    s_add_u32 s62, s62, 4096
    ds_read_b64_tr_b16 v[116:117], v171 offset:16384
    ds_read_b128 v[212:215], v223 offset:768
    v_mfma_f32_16x16x32_bf16 v[92:95], a[36:39], v[132:135], v[92:95]
    s_waitcnt lgkmcnt(3)
    ds_read_b64_tr_b16 v[118:119], v171 offset:18432
    ds_read_b64 v[226:227], v217
    v_mfma_f32_16x16x32_bf16 v[96:99], a[40:43], v[132:135], v[96:99]
    ds_read_b64 v[228:229], v218
    v_mfma_f32_16x16x32_bf16 v[100:103], a[44:47], v[132:135], v[100:103]
    buffer_load_dwordx4 a[28:31], v248, s[36:39], s62 offen offset:0 sc1
    v_mfma_f32_16x16x32_bf16 v[56:59], a[48:51], v[104:107], v[56:59]
    ds_read_b64_tr_b16 v[120:121], v168 offset:20480
    v_xor_b32 v3, s48, v201
    v_mfma_f32_16x16x32_bf16 v[60:63], a[52:55], v[104:107], v[60:63]
    ds_read_b64_tr_b16 v[122:123], v168 offset:22528
    v_bitop3_b32 v3, v203, s48, v3 bitop3:0xbe
    v_mfma_f32_16x16x32_bf16 v[64:67], a[56:59], v[104:107], v[64:67]
    ds_read_b64_tr_b16 v[124:125], v169 offset:20480
    v_bitop3_b32 v3, v205, s48, v3 bitop3:0xbe
    v_mfma_f32_16x16x32_bf16 v[68:71], a[48:51], v[108:111], v[68:71]
    buffer_load_dwordx4 a[32:35], v248, s[36:39], s62 offen offset:1024 sc1
    v_mfma_f32_16x16x32_bf16 v[72:75], a[52:55], v[108:111], v[72:75]
    ds_read_b64_tr_b16 v[126:127], v169 offset:22528
    v_bitop3_b32 v3, v207, s48, v3 bitop3:0xbe
    v_lshlrev_b32 v230, 16, v224
    v_mfma_f32_16x16x32_bf16 v[76:79], a[56:59], v[108:111], v[76:79]
    ds_read_b64_tr_b16 v[128:129], v170 offset:20480
    s_waitcnt lgkmcnt(10)
    v_bitop3_b32 v3, v209, s48, v3 bitop3:0xbe
    v_and_b32 v231, 0xffff0000, v224
    v_mfma_f32_16x16x32_bf16 v[80:83], a[48:51], v[112:115], v[80:83]
    ds_read_b64_tr_b16 v[130:131], v170 offset:22528
    v_bitop3_b32 v3, v211, s48, v3 bitop3:0xbe
    v_mul_f32 v230, v230, v220
    v_mfma_f32_16x16x32_bf16 v[84:87], a[52:55], v[112:115], v[84:87]
    buffer_load_dwordx4 a[36:39], v248, s[36:39], s62 offen offset:2048 sc1
    v_mfma_f32_16x16x32_bf16 v[88:91], a[56:59], v[112:115], v[88:91]
    ds_read_b64_tr_b16 v[132:133], v171 offset:20480
    s_waitcnt lgkmcnt(10)
    v_bitop3_b32 v3, v213, s48, v3 bitop3:0xbe
    v_mul_f32 v231, v231, v220
    s_waitcnt lgkmcnt(9)
    v_mfma_f32_16x16x32_bf16 v[92:95], a[48:51], v[116:119], v[92:95]
    s_waitcnt lgkmcnt(3)
    ds_read_b64_tr_b16 v[134:135], v171 offset:22528
    v_bitop3_b32 v3, v215, s48, v3 bitop3:0xbe
    v_mul_f32 v234, v230, v230
    v_mfma_f32_16x16x32_bf16 v[96:99], a[52:55], v[116:119], v[96:99]
    v_cmp_ne_u32 vcc, 0, v3
    s_cbranch_vccnz L_st0_slow
L_st0_back:
    v_mul_f32 v235, v231, v231
    v_lshlrev_b32 v232, 16, v225
    v_mfma_f32_16x16x32_bf16 v[100:103], a[56:59], v[116:119], v[100:103]
    s_add_u32 s50, s8, 98304
    v_pk_fma_f32 v[238:239], v[176:177], v[202:203], v[188:189] op_sel_hi:[1,0,1]
    v_pk_fma_f32 v[240:241], v[178:179], v[202:203], v[190:191] op_sel_hi:[1,0,1]
    v_pk_fma_f32 v[8:9], v[8:9], v[200:201], v[238:239] op_sel_hi:[1,0,1]
    v_pk_fma_f32 v[10:11], v[10:11], v[200:201], v[240:241] op_sel_hi:[1,0,1]
    v_pk_fma_f32 v[242:243], v[180:181], v[202:203], v[192:193] op_sel_hi:[1,0,1]
    v_pk_fma_f32 v[244:245], v[182:183], v[202:203], v[194:195] op_sel_hi:[1,0,1]
    v_pk_fma_f32 v[12:13], v[12:13], v[200:201], v[242:243] op_sel_hi:[1,0,1]
    v_pk_fma_f32 v[14:15], v[14:15], v[200:201], v[244:245] op_sel_hi:[1,0,1]
    v_pk_mul_f32 v[8:9], v[8:9], v[12:13]
    v_pk_mul_f32 v[10:11], v[10:11], v[14:15]
    v_cvt_pk_bf16_f32 v12, v8, v9
    v_cvt_pk_bf16_f32 v13, v10, v11
    v_pk_fma_f32 v[242:243], v[176:177], v[206:207], v[188:189] op_sel_hi:[1,0,1]
    v_pk_fma_f32 v[244:245], v[178:179], v[206:207], v[190:191] op_sel_hi:[1,0,1]
    v_pk_fma_f32 v[20:21], v[20:21], v[204:205], v[242:243] op_sel_hi:[1,0,1]
    v_pk_fma_f32 v[22:23], v[22:23], v[204:205], v[244:245] op_sel_hi:[1,0,1]
    v_pk_fma_f32 v[238:239], v[180:181], v[206:207], v[192:193] op_sel_hi:[1,0,1]
    v_pk_fma_f32 v[240:241], v[182:183], v[206:207], v[194:195] op_sel_hi:[1,0,1]
    v_pk_fma_f32 v[24:25], v[24:25], v[204:205], v[238:239] op_sel_hi:[1,0,1]
    v_pk_fma_f32 v[26:27], v[26:27], v[204:205], v[240:241] op_sel_hi:[1,0,1]
    v_pk_mul_f32 v[20:21], v[20:21], v[24:25]
    v_pk_mul_f32 v[22:23], v[22:23], v[26:27]
    v_cvt_pk_bf16_f32 v14, v20, v21
    v_cvt_pk_bf16_f32 v15, v22, v23
    s_nop 0
    v_permlane16_swap_b32 v12, v14
    v_permlane16_swap_b32 v13, v15
    buffer_store_dwordx4 v[12:15], v173, s[36:39], s8 offen sc1
    v_pk_fma_f32 v[238:239], v[176:177], v[210:211], v[188:189] op_sel_hi:[1,0,1]
    v_pk_fma_f32 v[240:241], v[178:179], v[210:211], v[190:191] op_sel_hi:[1,0,1]
    v_pk_fma_f32 v[32:33], v[32:33], v[208:209], v[238:239] op_sel_hi:[1,0,1]
    v_pk_fma_f32 v[34:35], v[34:35], v[208:209], v[240:241] op_sel_hi:[1,0,1]
    v_pk_fma_f32 v[242:243], v[180:181], v[210:211], v[192:193] op_sel_hi:[1,0,1]
    v_pk_fma_f32 v[244:245], v[182:183], v[210:211], v[194:195] op_sel_hi:[1,0,1]
    v_pk_fma_f32 v[36:37], v[36:37], v[208:209], v[242:243] op_sel_hi:[1,0,1]
    v_pk_fma_f32 v[38:39], v[38:39], v[208:209], v[244:245] op_sel_hi:[1,0,1]
    v_pk_mul_f32 v[32:33], v[32:33], v[36:37]
    v_pk_mul_f32 v[34:35], v[34:35], v[38:39]
    v_cvt_pk_bf16_f32 v36, v32, v33
    v_cvt_pk_bf16_f32 v37, v34, v35
    v_pk_fma_f32 v[242:243], v[176:177], v[214:215], v[188:189] op_sel_hi:[1,0,1]
    v_pk_fma_f32 v[244:245], v[178:179], v[214:215], v[190:191] op_sel_hi:[1,0,1]
    v_pk_fma_f32 v[44:45], v[44:45], v[212:213], v[242:243] op_sel_hi:[1,0,1]
    v_pk_fma_f32 v[46:47], v[46:47], v[212:213], v[244:245] op_sel_hi:[1,0,1]
    v_pk_fma_f32 v[238:239], v[180:181], v[214:215], v[192:193] op_sel_hi:[1,0,1]
    v_pk_fma_f32 v[240:241], v[182:183], v[214:215], v[194:195] op_sel_hi:[1,0,1]
    v_pk_fma_f32 v[48:49], v[48:49], v[212:213], v[238:239] op_sel_hi:[1,0,1]
    v_pk_fma_f32 v[50:51], v[50:51], v[212:213], v[240:241] op_sel_hi:[1,0,1]
    v_pk_mul_f32 v[44:45], v[44:45], v[48:49]
    v_pk_mul_f32 v[46:47], v[46:47], v[50:51]
    v_cvt_pk_bf16_f32 v38, v44, v45
    v_cvt_pk_bf16_f32 v39, v46, v47
    s_nop 0
    v_permlane16_swap_b32 v36, v38
    v_permlane16_swap_b32 v37, v39
    buffer_store_dwordx4 v[36:39], v173, s[36:39], s50 offen sc1
    v_pk_fma_f32 v[238:239], v[184:185], v[202:203], v[196:197] op_sel_hi:[1,0,1]
    v_pk_fma_f32 v[240:241], v[186:187], v[202:203], v[198:199] op_sel_hi:[1,0,1]
    v_pk_fma_f32 v[16:17], v[16:17], v[200:201], v[238:239] op_sel_hi:[1,0,1]
    v_pk_fma_f32 v[18:19], v[18:19], v[200:201], v[240:241] op_sel_hi:[1,0,1]
    v_pk_fma_f32 v[242:243], v[184:185], v[206:207], v[196:197] op_sel_hi:[1,0,1]
    v_pk_fma_f32 v[244:245], v[186:187], v[206:207], v[198:199] op_sel_hi:[1,0,1]
    v_pk_fma_f32 v[28:29], v[28:29], v[204:205], v[242:243] op_sel_hi:[1,0,1]
    v_pk_fma_f32 v[30:31], v[30:31], v[204:205], v[244:245] op_sel_hi:[1,0,1]
    s_nop 0
    v_permlane32_swap_b32 v16, v28
    v_permlane32_swap_b32 v17, v29
    v_permlane32_swap_b32 v18, v30
    v_permlane32_swap_b32 v19, v31
    v_pk_mul_f32 v[16:17], v[16:17], v[28:29]
    v_pk_mul_f32 v[18:19], v[18:19], v[30:31]
    v_cvt_pk_bf16_f32 v8, v16, v17
    v_cvt_pk_bf16_f32 v9, v18, v19
    v_pk_fma_f32 v[238:239], v[184:185], v[210:211], v[196:197] op_sel_hi:[1,0,1]
    v_pk_fma_f32 v[240:241], v[186:187], v[210:211], v[198:199] op_sel_hi:[1,0,1]
    v_pk_fma_f32 v[40:41], v[40:41], v[208:209], v[238:239] op_sel_hi:[1,0,1]
    v_pk_fma_f32 v[42:43], v[42:43], v[208:209], v[240:241] op_sel_hi:[1,0,1]
    v_pk_fma_f32 v[242:243], v[184:185], v[214:215], v[196:197] op_sel_hi:[1,0,1]
    v_pk_fma_f32 v[244:245], v[186:187], v[214:215], v[198:199] op_sel_hi:[1,0,1]
    v_pk_fma_f32 v[52:53], v[52:53], v[212:213], v[242:243] op_sel_hi:[1,0,1]
    v_pk_fma_f32 v[54:55], v[54:55], v[212:213], v[244:245] op_sel_hi:[1,0,1]
    s_nop 0
    v_permlane32_swap_b32 v40, v52
    v_permlane32_swap_b32 v41, v53
    v_permlane32_swap_b32 v42, v54
    v_permlane32_swap_b32 v43, v55
    v_pk_mul_f32 v[40:41], v[40:41], v[52:53]
    v_pk_mul_f32 v[42:43], v[42:43], v[54:55]
    v_cvt_pk_bf16_f32 v10, v40, v41
    v_cvt_pk_bf16_f32 v11, v42, v43
    s_nop 0
    v_permlane16_swap_b32 v8, v10
    v_permlane16_swap_b32 v9, v11
    buffer_store_dwordx4 v[8:11], v174, s[36:39], s8 offen offset:512 sc1
    s_add_u32 s6, s6, 16384
    s_lshl_b32 s76, s72, 4
    s_add_u32 s76, s76, s73
    buffer_load_dwordx4 a[40:43], v248, s[36:39], s62 offen offset:3072 sc1
    v_mfma_f32_16x16x32_bf16 v[56:59], a[60:63], v[120:123], v[56:59]
    s_add_u32 s62, s62, 4096
    ds_read_b64_tr_b16 v[104:105], v168 offset:24576
    v_and_b32 v233, 0xffff0000, v225
    v_mul_f32 v232, v232, v220
    v_mfma_f32_16x16x32_bf16 v[60:63], a[64:67], v[120:123], v[60:63]
    ds_read_b64_tr_b16 v[106:107], v168 offset:26624
    v_mul_f32 v233, v233, v220
    v_mul_f32 v236, v232, v232
    v_mfma_f32_16x16x32_bf16 v[64:67], a[68:71], v[120:123], v[64:67]
    ds_read_b64_tr_b16 v[108:109], v169 offset:24576
    v_mul_f32 v237, v233, v233
    v_lshlrev_b32 v249, 16, v226
    v_mfma_f32_16x16x32_bf16 v[68:71], a[60:63], v[124:127], v[68:71]
    s_and_b32 s50, s3, 1
    s_lshl_b32 s51, s74, 1
    buffer_load_dwordx4 a[44:47], v248, s[36:39], s62 offen offset:0 sc1
    v_mfma_f32_16x16x32_bf16 v[72:75], a[64:67], v[124:127], v[72:75]
    ds_read_b64_tr_b16 v[110:111], v169 offset:26624
    v_and_b32 v250, 0xffff0000, v226
    v_mul_f32 v249, v249, v221
    v_mfma_f32_16x16x32_bf16 v[76:79], a[68:71], v[124:127], v[76:79]
    s_waitcnt lgkmcnt(6)
    ds_read_b64_tr_b16 v[112:113], v170 offset:24576
    v_mul_f32 v250, v250, v221
    v_add_f32 v230, v230, v249
    v_mfma_f32_16x16x32_bf16 v[80:83], a[60:63], v[128:131], v[80:83]
    ds_read_b64_tr_b16 v[114:115], v170 offset:26624
    v_add_f32 v231, v231, v250
    v_fmac_f32 v234, v249, v249
    v_mfma_f32_16x16x32_bf16 v[84:87], a[64:67], v[128:131], v[84:87]
    s_add_u32 s52, s51, s50
    s_mul_i32 s52, s52, 192
    buffer_load_dwordx4 a[48:51], v248, s[36:39], s62 offen offset:1024 sc1
    v_mfma_f32_16x16x32_bf16 v[88:91], a[68:71], v[128:131], v[88:91]
    s_waitcnt lgkmcnt(6)
    ds_read_b64_tr_b16 v[116:117], v171 offset:24576
    v_fmac_f32 v235, v250, v250
    v_lshlrev_b32 v251, 16, v227
    v_mfma_f32_16x16x32_bf16 v[92:95], a[60:63], v[132:135], v[92:95]
    s_waitcnt lgkmcnt(3)
    ds_read_b64_tr_b16 v[118:119], v171 offset:26624
    v_and_b32 v252, 0xffff0000, v227
    v_mul_f32 v251, v251, v221
    v_mfma_f32_16x16x32_bf16 v[96:99], a[64:67], v[132:135], v[96:99]
    v_mul_f32 v252, v252, v221
    v_add_f32 v232, v232, v251
    v_add_f32 v233, v233, v252
    v_mfma_f32_16x16x32_bf16 v[100:103], a[68:71], v[132:135], v[100:103]
    s_mul_i32 s53, s3, 48
    s_add_u32 s52, s52, s53
    buffer_load_dwordx4 a[52:55], v248, s[36:39], s62 offen offset:2048 sc1
    v_mfma_f32_16x16x32_bf16 v[56:59], a[72:75], v[104:107], v[56:59]
    ds_read_b64_tr_b16 v[120:121], v168 offset:28672
    v_fmac_f32 v236, v251, v251
    v_fmac_f32 v237, v252, v252
    v_mfma_f32_16x16x32_bf16 v[60:63], a[76:79], v[104:107], v[60:63]
    ds_read_b64_tr_b16 v[122:123], v168 offset:30720
    v_lshlrev_b32 v249, 16, v228
    v_and_b32 v250, 0xffff0000, v228
    v_mfma_f32_16x16x32_bf16 v[64:67], a[80:83], v[104:107], v[64:67]
    ds_read_b64_tr_b16 v[124:125], v169 offset:28672
    v_mul_f32 v249, v249, v222
    v_mul_f32 v250, v250, v222
    v_mfma_f32_16x16x32_bf16 v[68:71], a[72:75], v[108:111], v[68:71]
    s_lshl_b32 s52, s52, 8
    s_add_u32 s52, s52, 16777216
    buffer_load_dwordx4 a[56:59], v248, s[36:39], s62 offen offset:3072 sc1
    v_mfma_f32_16x16x32_bf16 v[72:75], a[76:79], v[108:111], v[72:75]
    s_add_u32 s62, s62, 4096
    ds_read_b64_tr_b16 v[126:127], v169 offset:30720
    v_add_f32 v230, v230, v249
    v_add_f32 v231, v231, v250
    v_mfma_f32_16x16x32_bf16 v[76:79], a[80:83], v[108:111], v[76:79]
    s_waitcnt lgkmcnt(6)
    ds_read_b64_tr_b16 v[128:129], v170 offset:28672
    v_fmac_f32 v234, v249, v249
    v_fmac_f32 v235, v250, v250
    v_mfma_f32_16x16x32_bf16 v[80:83], a[72:75], v[112:115], v[80:83]
    ds_read_b64_tr_b16 v[130:131], v170 offset:30720
    v_lshlrev_b32 v251, 16, v229
    v_and_b32 v252, 0xffff0000, v229
    v_mfma_f32_16x16x32_bf16 v[84:87], a[76:79], v[112:115], v[84:87]
    buffer_load_dwordx4 a[60:63], v248, s[36:39], s62 offen offset:0 sc1
    v_mfma_f32_16x16x32_bf16 v[88:91], a[80:83], v[112:115], v[88:91]
    s_waitcnt lgkmcnt(6)
    ds_read_b64_tr_b16 v[132:133], v171 offset:28672
    v_mul_f32 v251, v251, v222
    v_mul_f32 v252, v252, v222
    v_mfma_f32_16x16x32_bf16 v[92:95], a[72:75], v[116:119], v[92:95]
    s_waitcnt lgkmcnt(3)
    ds_read_b64_tr_b16 v[134:135], v171 offset:30720
    v_add_f32 v232, v232, v251
    v_add_f32 v233, v233, v252
    v_mfma_f32_16x16x32_bf16 v[96:99], a[76:79], v[116:119], v[96:99]
    v_fmac_f32 v236, v251, v251
    v_fmac_f32 v237, v252, v252
    v_permlane32_swap_b32 v230, v234
    v_mfma_f32_16x16x32_bf16 v[100:103], a[80:83], v[116:119], v[100:103]
    buffer_load_dwordx4 a[64:67], v248, s[36:39], s62 offen offset:1024 sc1
    v_mfma_f32_16x16x32_bf16 v[56:59], a[84:87], v[120:123], v[56:59]
    ds_read_b64_tr_b16 v[104:105], v168 offset:32768
    v_permlane32_swap_b32 v231, v235
    v_permlane32_swap_b32 v232, v236
    v_mfma_f32_16x16x32_bf16 v[60:63], a[88:91], v[120:123], v[60:63]
    ds_read_b64_tr_b16 v[106:107], v168 offset:34816
    v_permlane32_swap_b32 v233, v237
    v_add_f32 v230, v230, v234
    v_mfma_f32_16x16x32_bf16 v[64:67], a[92:95], v[120:123], v[64:67]
    ds_read_b64_tr_b16 v[108:109], v169 offset:32768
    v_add_f32 v231, v231, v235
    v_add_f32 v232, v232, v236
    v_mfma_f32_16x16x32_bf16 v[68:71], a[84:87], v[124:127], v[68:71]
    buffer_load_dwordx4 a[68:71], v248, s[36:39], s62 offen offset:2048 sc1
    v_mfma_f32_16x16x32_bf16 v[72:75], a[88:91], v[124:127], v[72:75]
    s_add_u32 s62, s16, 2
    s_and_b32 s62, s62, 3
    ds_read_b64_tr_b16 v[110:111], v169 offset:34816
    v_add_f32 v233, v233, v237
    v_permlane16_swap_b32 v230, v232
    v_mfma_f32_16x16x32_bf16 v[76:79], a[92:95], v[124:127], v[76:79]
    s_mul_i32 s62, s62, 15360
    ds_read_b64_tr_b16 v[112:113], v170 offset:32768
    v_permlane16_swap_b32 v231, v233
    v_add_f32 v230, v230, v232
    s_waitcnt lgkmcnt(7)
    v_mfma_f32_16x16x32_bf16 v[80:83], a[84:87], v[128:131], v[80:83]
    s_add_u32 s62, s62, s65
    ds_read_b64_tr_b16 v[114:115], v170 offset:34816
    v_add_f32 v231, v231, v233
    v_add_f32_dpp v230, v230, v230 row_ror:8 row_mask:0xf bank_mask:0xf
    v_mfma_f32_16x16x32_bf16 v[84:87], a[88:91], v[128:131], v[84:87]
    buffer_load_dwordx4 a[72:75], v248, s[36:39], s62 offen offset:0 sc1
    v_mfma_f32_16x16x32_bf16 v[88:91], a[92:95], v[128:131], v[88:91]
    s_waitcnt lgkmcnt(6)
    ds_read_b64_tr_b16 v[116:117], v171 offset:32768
    v_add_f32_dpp v231, v231, v231 row_ror:8 row_mask:0xf bank_mask:0xf
    v_add_f32_dpp v230, v230, v230 row_ror:4 row_mask:0xf bank_mask:0xf
    v_mfma_f32_16x16x32_bf16 v[92:95], a[84:87], v[132:135], v[92:95]
    s_waitcnt lgkmcnt(3)
    ds_read_b64_tr_b16 v[118:119], v171 offset:34816
    v_add_f32_dpp v231, v231, v231 row_ror:4 row_mask:0xf bank_mask:0xf
    v_add_f32_dpp v230, v230, v230 row_ror:2 row_mask:0xf bank_mask:0xf
    v_mfma_f32_16x16x32_bf16 v[96:99], a[88:91], v[132:135], v[96:99]
    v_add_f32_dpp v231, v231, v231 row_ror:2 row_mask:0xf bank_mask:0xf
    v_add_f32_dpp v230, v230, v230 row_ror:1 row_mask:0xf bank_mask:0xf
    s_nop 0
    v_add_f32_dpp v231, v231, v231 row_ror:1 row_mask:0xf bank_mask:0xf
    v_mfma_f32_16x16x32_bf16 v[100:103], a[92:95], v[132:135], v[100:103]
    buffer_load_dwordx4 a[76:79], v248, s[36:39], s62 offen offset:1024 sc1
    v_mfma_f32_16x16x32_bf16 v[56:59], a[96:99], v[104:107], v[56:59]
    ds_read_b64_tr_b16 v[120:121], v168 offset:36864
    s_mov_b32 exec_lo, 0x00010001
    s_mov_b32 exec_hi, 0x00010001
    ds_write_b64 v253, v[230:231]
    s_mov_b64 exec, -1
    v_mfma_f32_16x16x32_bf16 v[60:63], a[100:103], v[104:107], v[60:63]
    ds_read_b64_tr_b16 v[122:123], v168 offset:38912
    v_mov_b32 v225, s48
    v_mov_b32 v227, s48
    v_mfma_f32_16x16x32_bf16 v[64:67], a[104:107], v[104:107], v[64:67]
    ds_read_b64_tr_b16 v[124:125], v169 offset:36864
    v_add_u32 v216, s52, v248
    v_mfma_f32_16x16x32_bf16 v[68:71], a[96:99], v[108:111], v[68:71]
    buffer_load_dwordx4 a[80:83], v248, s[36:39], s62 offen offset:2048 sc1
    v_mfma_f32_16x16x32_bf16 v[72:75], a[100:103], v[108:111], v[72:75]
    s_waitcnt vmcnt(11)
    s_barrier
    s_cmp_eq_u32 s3, 0
    s_cbranch_scc0 L_wf23
    s_lshl_b32 s54, s76, 7
    s_add_u32 s54, s54, 23355392
    v_mov_b32 v254, 0
    v_mov_b32 v255, s48
    s_mov_b64 exec, 1
    buffer_store_dword v255, v254, s[36:39], s54 offen sc1
    s_mov_b64 exec, -1
L_wf23:
    ds_read_b64_tr_b16 v[126:127], v169 offset:38912
    v_mfma_f32_16x16x32_bf16 v[76:79], a[104:107], v[108:111], v[76:79]
    s_waitcnt lgkmcnt(3)
    s_barrier
    ds_read_b64_tr_b16 v[128:129], v170 offset:36864
    ds_read2_b32 v[230:231], v2 offset0:0 offset1:4
    v_mfma_f32_16x16x32_bf16 v[80:83], a[96:99], v[112:115], v[80:83]
    ds_read_b64_tr_b16 v[130:131], v170 offset:38912
    ds_read2_b32 v[232:233], v2 offset0:8 offset1:12
    ds_read2_b32 v[234:235], v2 offset0:16 offset1:20
    v_mfma_f32_16x16x32_bf16 v[84:87], a[100:103], v[112:115], v[84:87]
    buffer_load_dwordx4 a[84:87], v248, s[36:39], s62 offen offset:3072 sc1
    v_mfma_f32_16x16x32_bf16 v[88:91], a[104:107], v[112:115], v[88:91]
    s_add_u32 s7, s7, 16384
    ds_read_b64_tr_b16 v[132:133], v171 offset:36864
    ds_read2_b32 v[236:237], v2 offset0:24 offset1:28
    v_mfma_f32_16x16x32_bf16 v[92:95], a[96:99], v[116:119], v[92:95]
    s_waitcnt lgkmcnt(3)
    ds_read_b64_tr_b16 v[134:135], v171 offset:38912
    v_add_u32 v218, 3145728, v216
    v_mfma_f32_16x16x32_bf16 v[96:99], a[100:103], v[116:119], v[96:99]
    s_xor_b32 s50, s50, 1
    s_add_u32 s52, s51, s50
    v_add_u32 v245, s63, v248
    v_mfma_f32_16x16x32_bf16 v[100:103], a[104:107], v[116:119], v[100:103]
    s_mul_i32 s52, s52, 192
    s_add_u32 s52, s52, s53
    v_mfma_f32_16x16x32_bf16 v[56:59], a[108:111], v[120:123], v[56:59]
    s_add_u32 s62, s62, 4096
    ds_read_b64_tr_b16 v[104:105], v168 offset:40960
    v_add_f32 v230, v230, v232
    v_add_f32 v231, v231, v233
    v_mfma_f32_16x16x32_bf16 v[60:63], a[112:115], v[120:123], v[60:63]
    ds_read_b64_tr_b16 v[106:107], v168 offset:43008
    s_waitcnt lgkmcnt(3)
    v_add_f32 v234, v234, v236
    v_add_f32 v235, v235, v237
    v_mfma_f32_16x16x32_bf16 v[64:67], a[116:119], v[120:123], v[64:67]
    ds_read_b64_tr_b16 v[108:109], v169 offset:40960
    v_add_f32 v230, v230, v234
    v_add_f32 v231, v231, v235
    v_mfma_f32_16x16x32_bf16 v[68:71], a[108:111], v[124:127], v[68:71]
    s_lshl_b32 s52, s52, 8
    s_add_u32 s52, s52, 16777216
    buffer_load_dwordx4 a[88:91], v248, s[36:39], s62 offen offset:0 sc1
    v_mfma_f32_16x16x32_bf16 v[72:75], a[112:115], v[124:127], v[72:75]
    ds_read_b64_tr_b16 v[110:111], v169 offset:43008
    v_mul_f32 v230, 0x3acccccd, v230
    v_mul_f32 v234, v230, v230
    v_mfma_f32_16x16x32_bf16 v[76:79], a[116:119], v[124:127], v[76:79]
    ds_read_b64_tr_b16 v[112:113], v170 offset:40960
    v_mov_b32 v224, 0x3acccccd
    v_fma_f32 v231, v231, v224, -v234
    v_mfma_f32_16x16x32_bf16 v[80:83], a[108:111], v[128:131], v[80:83]
    ds_read_b64_tr_b16 v[114:115], v170 offset:43008
    v_max_f32 v231, 0, v231
    v_add_f32 v231, 0x3727c5ac, v231
    v_mfma_f32_16x16x32_bf16 v[84:87], a[112:115], v[128:131], v[84:87]
    buffer_load_dwordx4 a[92:95], v248, s[36:39], s62 offen offset:1024 sc1
    v_mfma_f32_16x16x32_bf16 v[88:91], a[116:119], v[128:131], v[88:91]
    ds_read_b64_tr_b16 v[116:117], v171 offset:40960
    v_rsq_f32 v224, v231
    s_nop 0
    v_mul_f32_e64 v226, -v230, v224
    s_waitcnt lgkmcnt(7)
    v_mfma_f32_16x16x32_bf16 v[92:95], a[108:111], v[132:135], v[92:95]
    s_waitcnt lgkmcnt(3)
    ds_read_b64_tr_b16 v[118:119], v171 offset:43008
    v_add_u32 v217, s52, v248
    v_mfma_f32_16x16x32_bf16 v[96:99], a[112:115], v[132:135], v[96:99]
    s_mov_b64 exec, 0xf
    buffer_store_dwordx4 v[224:227], v248, s[36:39], s7 offen sc1
    s_mov_b64 exec, -1
    v_mfma_f32_16x16x32_bf16 v[100:103], a[116:119], v[132:135], v[100:103]
    s_mul_i32 s58, s75, 327680
    s_lshl_b32 s59, s74, 6
    buffer_load_dwordx4 a[96:99], v248, s[36:39], s62 offen offset:2048 sc1
    v_mfma_f32_16x16x32_bf16 v[56:59], a[120:123], v[104:107], v[56:59]
    s_add_u32 s58, s58, s59
    s_add_u32 s58, s58, 8650752
    ds_read_b64_tr_b16 v[120:121], v168 offset:45056
    v_mfma_f32_16x16x32_bf16 v[60:63], a[124:127], v[104:107], v[60:63]
    s_lshl_b32 s59, s3, 6
    ds_read_b64_tr_b16 v[122:123], v168 offset:47104
    v_add_u32 v252, s59, v1
    v_mfma_f32_16x16x32_bf16 v[64:67], a[128:131], v[104:107], v[64:67]
    ds_read_b64_tr_b16 v[124:125], v169 offset:45056
    v_and_b32 v253, 3, v1
    v_mfma_f32_16x16x32_bf16 v[68:71], a[120:123], v[108:111], v[68:71]
    buffer_load_dwordx4 a[100:103], v248, s[36:39], s62 offen offset:3072 sc1
    v_mfma_f32_16x16x32_bf16 v[72:75], a[124:127], v[108:111], v[72:75]
    s_add_u32 s62, s62, 4096
    ds_read_b64_tr_b16 v[126:127], v169 offset:47104
    v_lshl_add_u32 v253, v253, 4, s58
    v_mfma_f32_16x16x32_bf16 v[76:79], a[128:131], v[108:111], v[76:79]
    s_waitcnt lgkmcnt(6)
    ds_read_b64_tr_b16 v[128:129], v170 offset:45056
    v_lshrrev_b32 v249, 2, v252
    v_mfma_f32_16x16x32_bf16 v[80:83], a[120:123], v[112:115], v[80:83]
    ds_read_b64_tr_b16 v[130:131], v170 offset:47104
    v_mul_u32_u24 v249, 4096, v249
    v_mfma_f32_16x16x32_bf16 v[84:87], a[124:127], v[112:115], v[84:87]
    buffer_load_dwordx4 a[104:107], v248, s[36:39], s62 offen offset:0 sc1
    v_mfma_f32_16x16x32_bf16 v[88:91], a[128:131], v[112:115], v[88:91]
    s_waitcnt lgkmcnt(6)
    ds_read_b64_tr_b16 v[132:133], v171 offset:45056
    v_add_u32 v249, v249, v253
    v_mfma_f32_16x16x32_bf16 v[92:95], a[120:123], v[116:119], v[92:95]
    s_waitcnt lgkmcnt(3)
    ds_read_b64_tr_b16 v[134:135], v171 offset:47104
    v_mov_b32 v250, 261120
    v_mfma_f32_16x16x32_bf16 v[96:99], a[124:127], v[116:119], v[96:99]
    v_mov_b32 v251, 4294902784
    v_add_u32 v219, 3145728, v217
    v_mfma_f32_16x16x32_bf16 v[100:103], a[128:131], v[116:119], v[100:103]
    s_add_u32 s18, s16, 0
    s_and_b32 s18, s18, 3
    s_mul_i32 s18, s18, 3072
    buffer_load_dwordx4 a[108:111], v248, s[36:39], s62 offen offset:1024 sc1
    v_mfma_f32_16x16x32_bf16 v[56:59], a[132:135], v[120:123], v[56:59]
    s_add_u32 s19, s16, 1
    s_and_b32 s19, s19, 3
    ds_read_b64_tr_b16 v[104:105], v168 offset:49152
    v_mfma_f32_16x16x32_bf16 v[60:63], a[136:139], v[120:123], v[60:63]
    s_mul_i32 s19, s19, 3072
    ds_read_b64_tr_b16 v[106:107], v168 offset:51200
    v_mfma_f32_16x16x32_bf16 v[64:67], a[140:143], v[120:123], v[64:67]
    s_add_u32 s20, s16, 2
    s_and_b32 s20, s20, 3
    ds_read_b64_tr_b16 v[108:109], v169 offset:49152
    v_mfma_f32_16x16x32_bf16 v[68:71], a[132:135], v[124:127], v[68:71]
    s_mul_i32 s20, s20, 3072
    s_add_u32 s21, s16, 3
    s_and_b32 s21, s21, 3
    buffer_load_dwordx4 a[112:115], v248, s[36:39], s62 offen offset:2048 sc1
    v_mfma_f32_16x16x32_bf16 v[72:75], a[136:139], v[124:127], v[72:75]
    s_mul_i32 s21, s21, 3072
    ds_read_b64_tr_b16 v[110:111], v169 offset:51200
    v_mfma_f32_16x16x32_bf16 v[76:79], a[140:143], v[124:127], v[76:79]
    s_waitcnt lgkmcnt(6)
    s_lshr_b32 s50, s74, 1
    s_lshl_b32 s50, s50, 2
    ds_read_b64_tr_b16 v[112:113], v170 offset:49152
    v_mfma_f32_16x16x32_bf16 v[80:83], a[132:135], v[128:131], v[80:83]
    s_add_u32 s50, s50, s3
    s_lshl_b32 s50, s50, 9
    ds_read_b64_tr_b16 v[114:115], v170 offset:51200
    v_mfma_f32_16x16x32_bf16 v[84:87], a[136:139], v[128:131], v[84:87]
    s_add_u32 s50, s50, 155648
    buffer_load_dwordx4 a[116:119], v248, s[36:39], s62 offen offset:3072 sc1
    v_mfma_f32_16x16x32_bf16 v[88:91], a[140:143], v[128:131], v[88:91]
    s_waitcnt lgkmcnt(6)
    s_add_u32 s62, s62, 4096
    ds_read_b64_tr_b16 v[116:117], v171 offset:49152
    v_min_u32 v246, 3, v1
    v_mfma_f32_16x16x32_bf16 v[92:95], a[132:135], v[132:135], v[92:95]
    s_waitcnt lgkmcnt(3)
    ds_read_b64_tr_b16 v[118:119], v171 offset:51200
    v_lshlrev_b32 v246, 7, v246
    v_mfma_f32_16x16x32_bf16 v[96:99], a[136:139], v[132:135], v[96:99]
    v_cmp_gt_u32 vcc, 64, v252
    s_nop 1
    v_cndmask_b32 v250, v251, v250, vcc
    v_mfma_f32_16x16x32_bf16 v[100:103], a[140:143], v[132:135], v[100:103]
    buffer_load_dwordx4 a[120:123], v248, s[36:39], s62 offen offset:0 sc1
    v_mfma_f32_16x16x32_bf16 v[56:59], a[144:147], v[104:107], v[56:59]
    ds_read_b64_tr_b16 v[120:121], v168 offset:53248
    v_add_u32 v250, v250, v249
    v_mfma_f32_16x16x32_bf16 v[60:63], a[148:151], v[104:107], v[60:63]
    ds_read_b64_tr_b16 v[122:123], v168 offset:55296
    v_add_u32 v251, 196608, v249
    v_mfma_f32_16x16x32_bf16 v[64:67], a[152:155], v[104:107], v[64:67]
    s_mul_i32 s59, s75, 320
    ds_read_b64_tr_b16 v[124:125], v169 offset:53248
    v_lshl_add_u32 v253, v252, 4, s59
    v_mfma_f32_16x16x32_bf16 v[68:71], a[144:147], v[108:111], v[68:71]
    buffer_load_dwordx4 a[124:127], v248, s[36:39], s62 offen offset:1024 sc1
    v_mfma_f32_16x16x32_bf16 v[72:75], a[148:151], v[108:111], v[72:75]
    ds_read_b64_tr_b16 v[126:127], v169 offset:55296
    v_add_u32 v253, 23142912, v253
    v_mfma_f32_16x16x32_bf16 v[76:79], a[152:155], v[108:111], v[76:79]
    s_waitcnt lgkmcnt(6)
    ds_read_b64_tr_b16 v[128:129], v170 offset:53248
    v_add_u32 v246, s50, v246
    v_mfma_f32_16x16x32_bf16 v[80:83], a[144:147], v[112:115], v[80:83]
    ds_read_b64_tr_b16 v[130:131], v170 offset:55296
    v_mfma_f32_16x16x32_bf16 v[84:87], a[148:151], v[112:115], v[84:87]
    buffer_load_dwordx4 a[128:131], v248, s[36:39], s62 offen offset:2048 sc1
    v_mfma_f32_16x16x32_bf16 v[88:91], a[152:155], v[112:115], v[88:91]
    s_waitcnt lgkmcnt(6)
    s_add_u32 s62, s16, 3
    s_and_b32 s62, s62, 3
    ds_read_b64_tr_b16 v[132:133], v171 offset:53248
    v_mfma_f32_16x16x32_bf16 v[92:95], a[144:147], v[116:119], v[92:95]
    s_waitcnt lgkmcnt(3)
    ds_read_b64_tr_b16 v[134:135], v171 offset:55296
    v_mfma_f32_16x16x32_bf16 v[96:99], a[148:151], v[116:119], v[96:99]
    s_mul_i32 s62, s62, 15360
    v_cmp_lt_u32 vcc, 127, v252
    s_nop 1
    v_cndmask_b32 v251, v251, v253, vcc
    v_mfma_f32_16x16x32_bf16 v[100:103], a[152:155], v[116:119], v[100:103]
    s_add_u32 s62, s62, s65
    buffer_load_dwordx4 a[132:135], v248, s[36:39], s62 offen offset:0 sc1
    v_mfma_f32_16x16x32_bf16 v[56:59], a[156:159], v[120:123], v[56:59]
    ds_read_b64_tr_b16 v[104:105], v168 offset:57344
    v_add_u32 v253, 36032, v253
    v_mfma_f32_16x16x32_bf16 v[60:63], a[160:163], v[120:123], v[60:63]
    ds_read_b64_tr_b16 v[106:107], v168 offset:59392
    v_mfma_f32_16x16x32_bf16 v[64:67], a[164:167], v[120:123], v[64:67]
    ds_read_b64_tr_b16 v[108:109], v169 offset:57344
    v_mfma_f32_16x16x32_bf16 v[68:71], a[156:159], v[124:127], v[68:71]
    buffer_load_dword v244, v246, s[36:39], s17 offen sc1
    v_mfma_f32_16x16x32_bf16 v[72:75], a[160:163], v[124:127], v[72:75]
    ds_read_b64_tr_b16 v[110:111], v169 offset:59392
    v_mfma_f32_16x16x32_bf16 v[76:79], a[164:167], v[124:127], v[76:79]
    s_waitcnt lgkmcnt(6)
    ds_read_b64_tr_b16 v[112:113], v170 offset:57344
    v_mfma_f32_16x16x32_bf16 v[80:83], a[156:159], v[128:131], v[80:83]
    ds_read_b64_tr_b16 v[114:115], v170 offset:59392
    v_mfma_f32_16x16x32_bf16 v[84:87], a[160:163], v[128:131], v[84:87]
    buffer_load_dwordx4 a[136:139], v248, s[36:39], s62 offen offset:1024 sc1
    v_mfma_f32_16x16x32_bf16 v[88:91], a[164:167], v[128:131], v[88:91]
    s_waitcnt lgkmcnt(6)
    ds_read_b64_tr_b16 v[116:117], v171 offset:57344
    v_mfma_f32_16x16x32_bf16 v[92:95], a[156:159], v[132:135], v[92:95]
    s_waitcnt lgkmcnt(3)
    ds_read_b64_tr_b16 v[118:119], v171 offset:59392
    v_mfma_f32_16x16x32_bf16 v[96:99], a[160:163], v[132:135], v[96:99]
    v_cmp_lt_u32 vcc, 147, v252
    s_nop 1
    v_cndmask_b32 v251, v251, v253, vcc
    v_mfma_f32_16x16x32_bf16 v[100:103], a[164:167], v[132:135], v[100:103]
    buffer_load_dwordx4 a[140:143], v248, s[36:39], s62 offen offset:2048 sc1
    v_mfma_f32_16x16x32_bf16 v[56:59], a[168:171], v[104:107], v[56:59]
    ds_read_b64_tr_b16 v[120:121], v168 offset:61440
    v_mov_b32 v253, 268435456
    v_mfma_f32_16x16x32_bf16 v[60:63], a[172:175], v[104:107], v[60:63]
    ds_read_b64_tr_b16 v[122:123], v168 offset:63488
    v_add_u32 v168, 65536, v168
    v_mfma_f32_16x16x32_bf16 v[64:67], a[176:179], v[104:107], v[64:67]
    ds_read_b64_tr_b16 v[124:125], v169 offset:61440
    v_mfma_f32_16x16x32_bf16 v[68:71], a[168:171], v[108:111], v[68:71]
    buffer_load_dwordx4 a[144:147], v248, s[36:39], s62 offen offset:3072 sc1
    v_mfma_f32_16x16x32_bf16 v[72:75], a[172:175], v[108:111], v[72:75]
    s_add_u32 s62, s62, 4096
    ds_read_b64_tr_b16 v[126:127], v169 offset:63488
    v_add_u32 v169, 65536, v169
    v_mfma_f32_16x16x32_bf16 v[76:79], a[176:179], v[108:111], v[76:79]
    s_waitcnt lgkmcnt(6)
    ds_read_b64_tr_b16 v[128:129], v170 offset:61440
    v_mfma_f32_16x16x32_bf16 v[80:83], a[168:171], v[112:115], v[80:83]
    ds_read_b64_tr_b16 v[130:131], v170 offset:63488
    v_add_u32 v170, 65536, v170
    v_mfma_f32_16x16x32_bf16 v[84:87], a[172:175], v[112:115], v[84:87]
    buffer_load_dwordx4 a[148:151], v248, s[36:39], s62 offen offset:0 sc1
    v_mfma_f32_16x16x32_bf16 v[88:91], a[176:179], v[112:115], v[88:91]
    s_waitcnt lgkmcnt(6)
    ds_read_b64_tr_b16 v[132:133], v171 offset:61440
    v_mfma_f32_16x16x32_bf16 v[92:95], a[168:171], v[116:119], v[92:95]
    s_waitcnt lgkmcnt(3)
    ds_read_b64_tr_b16 v[134:135], v171 offset:63488
    v_add_u32 v171, 65536, v171
    v_mfma_f32_16x16x32_bf16 v[96:99], a[172:175], v[116:119], v[96:99]
    s_add_u32 m0, s63, 73728
    v_cmp_lt_u32 vcc, 167, v252
    s_nop 1
    v_cndmask_b32 v251, v251, v253, vcc
    v_mfma_f32_16x16x32_bf16 v[100:103], a[176:179], v[116:119], v[100:103]
    buffer_load_dwordx4 v248, s[36:39], s6 offen sc1 lds
    v_mfma_f32_16x16x32_bf16 v[56:59], a[180:183], v[120:123], v[56:59]
    ds_read_b64_tr_b16 v[104:105], v168 offset:0
    v_mfma_f32_16x16x32_bf16 v[60:63], a[184:187], v[120:123], v[60:63]
    ds_read_b64_tr_b16 v[106:107], v168 offset:2048
    v_mfma_f32_16x16x32_bf16 v[64:67], a[188:191], v[120:123], v[64:67]
    s_add_u32 m0, s63, 61440
    ds_read_b64_tr_b16 v[108:109], v169 offset:0
    v_mfma_f32_16x16x32_bf16 v[68:71], a[180:183], v[124:127], v[68:71]
    buffer_load_dwordx4 v249, s[36:39], 0 offen offset:0 sc1 lds
    v_mfma_f32_16x16x32_bf16 v[72:75], a[184:187], v[124:127], v[72:75]
    ds_read_b64_tr_b16 v[110:111], v169 offset:2048
    v_mfma_f32_16x16x32_bf16 v[76:79], a[188:191], v[124:127], v[76:79]
    s_waitcnt lgkmcnt(6)
    ds_read_b64_tr_b16 v[112:113], v170 offset:0
    v_mfma_f32_16x16x32_bf16 v[80:83], a[180:183], v[128:131], v[80:83]
    s_add_u32 m0, s63, 64512
    ds_read_b64_tr_b16 v[114:115], v170 offset:2048
    s_waitcnt vmcnt(6)
    v_cmp_ne_u32 vcc, s48, v244
    s_cbranch_vccnz L_chk24_slow
L_chk24_back:
    v_mfma_f32_16x16x32_bf16 v[84:87], a[184:187], v[128:131], v[84:87]
    buffer_load_dwordx4 v250, s[36:39], 0 offen offset:1024 sc1 lds
    v_mfma_f32_16x16x32_bf16 v[88:91], a[188:191], v[128:131], v[88:91]
    s_waitcnt lgkmcnt(6)
    ds_read_b64_tr_b16 v[116:117], v171 offset:0
    v_mfma_f32_16x16x32_bf16 v[92:95], a[180:183], v[132:135], v[92:95]
    s_waitcnt lgkmcnt(3)
    ds_read_b64_tr_b16 v[118:119], v171 offset:2048
    v_mfma_f32_16x16x32_bf16 v[96:99], a[184:187], v[132:135], v[96:99]
    s_add_u32 m0, s63, 67584
    v_mfma_f32_16x16x32_bf16 v[100:103], a[188:191], v[132:135], v[100:103]
    buffer_load_dwordx4 v251, s[36:39], 0 offen offset:2048 sc1 lds
    v_mfma_f32_16x16x32_bf16 v[56:59], a[192:195], v[104:107], v[56:59]
    ds_read_b64_tr_b16 v[120:121], v168 offset:4096
    v_mfma_f32_16x16x32_bf16 v[60:63], a[196:199], v[104:107], v[60:63]
    ds_read_b64_tr_b16 v[122:123], v168 offset:6144
    v_mfma_f32_16x16x32_bf16 v[64:67], a[200:203], v[104:107], v[64:67]
    ds_read_b64_tr_b16 v[124:125], v169 offset:4096
    v_mfma_f32_16x16x32_bf16 v[68:71], a[192:195], v[108:111], v[68:71]
    buffer_load_dwordx4 v[8:11], v216, s[36:39], s18 offen offset:0 sc1
    v_mfma_f32_16x16x32_bf16 v[72:75], a[196:199], v[108:111], v[72:75]
    ds_read_b64_tr_b16 v[126:127], v169 offset:6144
    v_mfma_f32_16x16x32_bf16 v[76:79], a[200:203], v[108:111], v[76:79]
    s_waitcnt lgkmcnt(6)
    ds_read_b64_tr_b16 v[128:129], v170 offset:4096
    v_mfma_f32_16x16x32_bf16 v[80:83], a[192:195], v[112:115], v[80:83]
    ds_read_b64_tr_b16 v[130:131], v170 offset:6144
    v_mfma_f32_16x16x32_bf16 v[84:87], a[196:199], v[112:115], v[84:87]
    buffer_load_dwordx4 v[12:15], v216, s[36:39], s18 offen offset:1024 sc1
    v_mfma_f32_16x16x32_bf16 v[88:91], a[200:203], v[112:115], v[88:91]
    s_waitcnt lgkmcnt(6)
    ds_read_b64_tr_b16 v[132:133], v171 offset:4096
    v_mfma_f32_16x16x32_bf16 v[92:95], a[192:195], v[116:119], v[92:95]
    s_waitcnt lgkmcnt(3)
    ds_read_b64_tr_b16 v[134:135], v171 offset:6144
    v_mfma_f32_16x16x32_bf16 v[96:99], a[196:199], v[116:119], v[96:99]
    v_mfma_f32_16x16x32_bf16 v[100:103], a[200:203], v[116:119], v[100:103]
    buffer_load_dwordx4 v[16:19], v216, s[36:39], s18 offen offset:2048 sc1
    v_mfma_f32_16x16x32_bf16 v[56:59], a[204:207], v[120:123], v[56:59]
    ds_read_b64_tr_b16 v[104:105], v168 offset:8192
    v_mfma_f32_16x16x32_bf16 v[60:63], a[208:211], v[120:123], v[60:63]
    ds_read_b64_tr_b16 v[106:107], v168 offset:10240
    v_mfma_f32_16x16x32_bf16 v[64:67], a[212:215], v[120:123], v[64:67]
    ds_read_b64_tr_b16 v[108:109], v169 offset:8192
    v_mfma_f32_16x16x32_bf16 v[68:71], a[204:207], v[124:127], v[68:71]
    buffer_load_dwordx4 v[20:23], v216, s[36:39], s19 offen offset:0 sc1
    v_mfma_f32_16x16x32_bf16 v[72:75], a[208:211], v[124:127], v[72:75]
    ds_read_b64_tr_b16 v[110:111], v169 offset:10240
    v_mfma_f32_16x16x32_bf16 v[76:79], a[212:215], v[124:127], v[76:79]
    s_waitcnt lgkmcnt(6)
    ds_read_b64_tr_b16 v[112:113], v170 offset:8192
    v_mfma_f32_16x16x32_bf16 v[80:83], a[204:207], v[128:131], v[80:83]
    ds_read_b64_tr_b16 v[114:115], v170 offset:10240
    v_mfma_f32_16x16x32_bf16 v[84:87], a[208:211], v[128:131], v[84:87]
    buffer_load_dwordx4 v[24:27], v216, s[36:39], s19 offen offset:1024 sc1
    v_mfma_f32_16x16x32_bf16 v[88:91], a[212:215], v[128:131], v[88:91]
    s_waitcnt lgkmcnt(6)
    ds_read_b64_tr_b16 v[116:117], v171 offset:8192
    v_mfma_f32_16x16x32_bf16 v[92:95], a[204:207], v[132:135], v[92:95]
    s_waitcnt lgkmcnt(3)
    ds_read_b64_tr_b16 v[118:119], v171 offset:10240
    v_mfma_f32_16x16x32_bf16 v[96:99], a[208:211], v[132:135], v[96:99]
    v_mfma_f32_16x16x32_bf16 v[100:103], a[212:215], v[132:135], v[100:103]
    buffer_load_dwordx4 v[28:31], v216, s[36:39], s19 offen offset:2048 sc1
    v_mfma_f32_16x16x32_bf16 v[56:59], a[216:219], v[104:107], v[56:59]
    ds_read_b64_tr_b16 v[120:121], v168 offset:12288
    v_mfma_f32_16x16x32_bf16 v[60:63], a[220:223], v[104:107], v[60:63]
    ds_read_b64_tr_b16 v[122:123], v168 offset:14336
    v_mfma_f32_16x16x32_bf16 v[64:67], a[224:227], v[104:107], v[64:67]
    ds_read_b64_tr_b16 v[124:125], v169 offset:12288
    v_mfma_f32_16x16x32_bf16 v[68:71], a[216:219], v[108:111], v[68:71]
    buffer_load_dwordx4 v[32:35], v216, s[36:39], s20 offen offset:0 sc1
    v_mfma_f32_16x16x32_bf16 v[72:75], a[220:223], v[108:111], v[72:75]
    s_waitcnt vmcnt(10)
    ds_read_b64_tr_b16 v[126:127], v169 offset:14336
    ds_read_b128 v[200:203], v223 offset:0
    v_mfma_f32_16x16x32_bf16 v[76:79], a[224:227], v[108:111], v[76:79]
    s_waitcnt lgkmcnt(7)
    ds_read_b64_tr_b16 v[128:129], v170 offset:12288
    ds_read_b128 v[204:207], v223 offset:256
    v_mfma_f32_16x16x32_bf16 v[80:83], a[216:219], v[112:115], v[80:83]
    ds_read_b64_tr_b16 v[130:131], v170 offset:14336
    ds_read_b128 v[208:211], v223 offset:512
    v_mfma_f32_16x16x32_bf16 v[84:87], a[220:223], v[112:115], v[84:87]
    buffer_load_dwordx4 v[36:39], v216, s[36:39], s20 offen offset:1024 sc1
    v_mfma_f32_16x16x32_bf16 v[88:91], a[224:227], v[112:115], v[88:91]
    s_waitcnt lgkmcnt(9)
    ds_read_b64_tr_b16 v[132:133], v171 offset:12288
    ds_read_b128 v[212:215], v223 offset:768
    v_mfma_f32_16x16x32_bf16 v[92:95], a[216:219], v[116:119], v[92:95]
    s_waitcnt lgkmcnt(3)
    ds_read_b64_tr_b16 v[134:135], v171 offset:14336
    v_mfma_f32_16x16x32_bf16 v[96:99], a[220:223], v[116:119], v[96:99]
    v_mfma_f32_16x16x32_bf16 v[100:103], a[224:227], v[116:119], v[100:103]
    buffer_load_dwordx4 v[40:43], v216, s[36:39], s20 offen offset:2048 sc1
    v_mfma_f32_16x16x32_bf16 v[56:59], a[228:231], v[120:123], v[56:59]
    v_xor_b32 v3, s48, v201
    v_bitop3_b32 v3, v203, s48, v3 bitop3:0xbe
    v_mfma_f32_16x16x32_bf16 v[60:63], a[232:235], v[120:123], v[60:63]
    v_bitop3_b32 v3, v205, s48, v3 bitop3:0xbe
    v_bitop3_b32 v3, v207, s48, v3 bitop3:0xbe
    v_mfma_f32_16x16x32_bf16 v[64:67], a[236:239], v[120:123], v[64:67]
    s_waitcnt lgkmcnt(3)
    v_bitop3_b32 v3, v209, s48, v3 bitop3:0xbe
    v_bitop3_b32 v3, v211, s48, v3 bitop3:0xbe
    v_mfma_f32_16x16x32_bf16 v[68:71], a[228:231], v[124:127], v[68:71]
    buffer_load_dwordx4 a[152:155], v248, s[36:39], s62 offen offset:1024 sc1
    v_mfma_f32_16x16x32_bf16 v[72:75], a[232:235], v[124:127], v[72:75]
    s_waitcnt lgkmcnt(1)
    v_bitop3_b32 v3, v213, s48, v3 bitop3:0xbe
    v_bitop3_b32 v3, v215, s48, v3 bitop3:0xbe
    v_mfma_f32_16x16x32_bf16 v[76:79], a[236:239], v[124:127], v[76:79]
    v_cmp_ne_u32 vcc, 0, v3
    s_cbranch_vccnz L_st1_slow
L_st1_back:
    v_mfma_f32_16x16x32_bf16 v[80:83], a[228:231], v[128:131], v[80:83]
    v_mfma_f32_16x16x32_bf16 v[84:87], a[232:235], v[128:131], v[84:87]
    buffer_load_dwordx4 a[156:159], v248, s[36:39], s62 offen offset:2048 sc1
    v_mfma_f32_16x16x32_bf16 v[88:91], a[236:239], v[128:131], v[88:91]
    s_waitcnt lgkmcnt(0)
    v_mfma_f32_16x16x32_bf16 v[92:95], a[228:231], v[132:135], v[92:95]
    v_mfma_f32_16x16x32_bf16 v[96:99], a[232:235], v[132:135], v[96:99]
    v_mfma_f32_16x16x32_bf16 v[100:103], a[236:239], v[132:135], v[100:103]
L_g1done:
    s_add_u32 s8, s8, 3145728
    s_add_u32 s50, s8, 98304
    v_pk_fma_f32 v[238:239], v[176:177], v[202:203], v[188:189] op_sel_hi:[1,0,1]
    v_pk_fma_f32 v[240:241], v[178:179], v[202:203], v[190:191] op_sel_hi:[1,0,1]
    v_pk_fma_f32 v[56:57], v[56:57], v[200:201], v[238:239] op_sel_hi:[1,0,1]
    v_pk_fma_f32 v[58:59], v[58:59], v[200:201], v[240:241] op_sel_hi:[1,0,1]
    buffer_load_dwordx4 v[44:47], v216, s[36:39], s21 offen offset:0 sc1
    v_pk_fma_f32 v[242:243], v[180:181], v[202:203], v[192:193] op_sel_hi:[1,0,1]
    v_pk_fma_f32 v[244:245], v[182:183], v[202:203], v[194:195] op_sel_hi:[1,0,1]
    v_pk_fma_f32 v[60:61], v[60:61], v[200:201], v[242:243] op_sel_hi:[1,0,1]
    v_pk_fma_f32 v[62:63], v[62:63], v[200:201], v[244:245] op_sel_hi:[1,0,1]
    v_pk_mul_f32 v[56:57], v[56:57], v[60:61]
    v_pk_mul_f32 v[58:59], v[58:59], v[62:63]
    buffer_load_dwordx4 v[48:51], v216, s[36:39], s21 offen offset:1024 sc1
    v_cvt_pk_bf16_f32 v60, v56, v57
    v_cvt_pk_bf16_f32 v61, v58, v59
    v_pk_fma_f32 v[242:243], v[176:177], v[206:207], v[188:189] op_sel_hi:[1,0,1]
    v_pk_fma_f32 v[244:245], v[178:179], v[206:207], v[190:191] op_sel_hi:[1,0,1]
    v_pk_fma_f32 v[68:69], v[68:69], v[204:205], v[242:243] op_sel_hi:[1,0,1]
    v_pk_fma_f32 v[70:71], v[70:71], v[204:205], v[244:245] op_sel_hi:[1,0,1]
    buffer_load_dwordx4 v[52:55], v216, s[36:39], s21 offen offset:2048 sc1
    v_pk_fma_f32 v[238:239], v[180:181], v[206:207], v[192:193] op_sel_hi:[1,0,1]
    v_pk_fma_f32 v[240:241], v[182:183], v[206:207], v[194:195] op_sel_hi:[1,0,1]
    v_pk_fma_f32 v[72:73], v[72:73], v[204:205], v[238:239] op_sel_hi:[1,0,1]
    v_pk_fma_f32 v[74:75], v[74:75], v[204:205], v[240:241] op_sel_hi:[1,0,1]
    v_pk_mul_f32 v[68:69], v[68:69], v[72:73]
    v_pk_mul_f32 v[70:71], v[70:71], v[74:75]
    buffer_load_dwordx4 a[160:163], v248, s[36:39], s62 offen offset:3072 sc1
    s_add_u32 s62, s62, 4096
    v_cvt_pk_bf16_f32 v62, v68, v69
    v_cvt_pk_bf16_f32 v63, v70, v71
    s_nop 0
    v_permlane16_swap_b32 v60, v62
    v_permlane16_swap_b32 v61, v63
    buffer_store_dwordx4 v[60:63], v173, s[36:39], s8 offen sc1
    v_pk_fma_f32 v[238:239], v[176:177], v[210:211], v[188:189] op_sel_hi:[1,0,1]
    buffer_load_dwordx4 a[164:167], v248, s[36:39], s62 offen offset:0 sc1
    v_pk_fma_f32 v[240:241], v[178:179], v[210:211], v[190:191] op_sel_hi:[1,0,1]
    v_pk_fma_f32 v[80:81], v[80:81], v[208:209], v[238:239] op_sel_hi:[1,0,1]
    v_pk_fma_f32 v[82:83], v[82:83], v[208:209], v[240:241] op_sel_hi:[1,0,1]
    v_pk_fma_f32 v[242:243], v[180:181], v[210:211], v[192:193] op_sel_hi:[1,0,1]
    v_pk_fma_f32 v[244:245], v[182:183], v[210:211], v[194:195] op_sel_hi:[1,0,1]
    v_pk_fma_f32 v[84:85], v[84:85], v[208:209], v[242:243] op_sel_hi:[1,0,1]
    buffer_load_dwordx4 a[168:171], v248, s[36:39], s62 offen offset:1024 sc1
    v_pk_fma_f32 v[86:87], v[86:87], v[208:209], v[244:245] op_sel_hi:[1,0,1]
    v_pk_mul_f32 v[80:81], v[80:81], v[84:85]
    v_pk_mul_f32 v[82:83], v[82:83], v[86:87]
    v_cvt_pk_bf16_f32 v84, v80, v81
    v_cvt_pk_bf16_f32 v85, v82, v83
    v_pk_fma_f32 v[242:243], v[176:177], v[214:215], v[188:189] op_sel_hi:[1,0,1]
    v_pk_fma_f32 v[244:245], v[178:179], v[214:215], v[190:191] op_sel_hi:[1,0,1]
    v_pk_fma_f32 v[92:93], v[92:93], v[212:213], v[242:243] op_sel_hi:[1,0,1]
    v_pk_fma_f32 v[94:95], v[94:95], v[212:213], v[244:245] op_sel_hi:[1,0,1]
    v_pk_fma_f32 v[238:239], v[180:181], v[214:215], v[192:193] op_sel_hi:[1,0,1]
    v_pk_fma_f32 v[240:241], v[182:183], v[214:215], v[194:195] op_sel_hi:[1,0,1]
    v_pk_fma_f32 v[96:97], v[96:97], v[212:213], v[238:239] op_sel_hi:[1,0,1]
    v_pk_fma_f32 v[98:99], v[98:99], v[212:213], v[240:241] op_sel_hi:[1,0,1]
    v_pk_mul_f32 v[92:93], v[92:93], v[96:97]
    v_pk_mul_f32 v[94:95], v[94:95], v[98:99]
    v_cvt_pk_bf16_f32 v86, v92, v93
    v_cvt_pk_bf16_f32 v87, v94, v95
    s_nop 0
    v_permlane16_swap_b32 v84, v86
    v_permlane16_swap_b32 v85, v87
    buffer_store_dwordx4 v[84:87], v173, s[36:39], s50 offen sc1
    v_pk_fma_f32 v[238:239], v[184:185], v[202:203], v[196:197] op_sel_hi:[1,0,1]
    v_pk_fma_f32 v[240:241], v[186:187], v[202:203], v[198:199] op_sel_hi:[1,0,1]
    v_pk_fma_f32 v[64:65], v[64:65], v[200:201], v[238:239] op_sel_hi:[1,0,1]
    v_pk_fma_f32 v[66:67], v[66:67], v[200:201], v[240:241] op_sel_hi:[1,0,1]
    v_pk_fma_f32 v[242:243], v[184:185], v[206:207], v[196:197] op_sel_hi:[1,0,1]
    v_pk_fma_f32 v[244:245], v[186:187], v[206:207], v[198:199] op_sel_hi:[1,0,1]
    v_pk_fma_f32 v[76:77], v[76:77], v[204:205], v[242:243] op_sel_hi:[1,0,1]
    v_pk_fma_f32 v[78:79], v[78:79], v[204:205], v[244:245] op_sel_hi:[1,0,1]
    s_nop 0
    v_permlane32_swap_b32 v64, v76
    v_permlane32_swap_b32 v65, v77
    v_permlane32_swap_b32 v66, v78
    v_permlane32_swap_b32 v67, v79
    v_pk_mul_f32 v[64:65], v[64:65], v[76:77]
    v_pk_mul_f32 v[66:67], v[66:67], v[78:79]
    v_cvt_pk_bf16_f32 v56, v64, v65
    v_cvt_pk_bf16_f32 v57, v66, v67
    v_pk_fma_f32 v[238:239], v[184:185], v[210:211], v[196:197] op_sel_hi:[1,0,1]
    v_pk_fma_f32 v[240:241], v[186:187], v[210:211], v[198:199] op_sel_hi:[1,0,1]
    v_pk_fma_f32 v[88:89], v[88:89], v[208:209], v[238:239] op_sel_hi:[1,0,1]
    v_pk_fma_f32 v[90:91], v[90:91], v[208:209], v[240:241] op_sel_hi:[1,0,1]
    v_pk_fma_f32 v[242:243], v[184:185], v[214:215], v[196:197] op_sel_hi:[1,0,1]
    v_pk_fma_f32 v[244:245], v[186:187], v[214:215], v[198:199] op_sel_hi:[1,0,1]
    v_pk_fma_f32 v[100:101], v[100:101], v[212:213], v[242:243] op_sel_hi:[1,0,1]
    v_pk_fma_f32 v[102:103], v[102:103], v[212:213], v[244:245] op_sel_hi:[1,0,1]
    s_nop 0
    v_permlane32_swap_b32 v88, v100
    v_permlane32_swap_b32 v89, v101
    v_permlane32_swap_b32 v90, v102
    v_permlane32_swap_b32 v91, v103
    v_pk_mul_f32 v[88:89], v[88:89], v[100:101]
    v_pk_mul_f32 v[90:91], v[90:91], v[102:103]
    v_cvt_pk_bf16_f32 v58, v88, v89
    v_cvt_pk_bf16_f32 v59, v90, v91
    s_nop 0
    v_permlane16_swap_b32 v56, v58
    v_permlane16_swap_b32 v57, v59
    buffer_store_dwordx4 v[56:59], v174, s[36:39], s8 offen offset:512 sc1
    s_mov_b32 s40, s28
    s_mov_b32 s41, s29
    s_mov_b32 s42, 0x280000
    s_mov_b32 s43, 0x20000
    s_waitcnt vmcnt(19)
    v_mfma_f32_16x16x32_bf16 v[72:75], a[240:243], v[8:11], 0
    buffer_load_dwordx4 a[172:175], v248, s[36:39], s62 offen offset:2048 sc1
    v_mfma_f32_16x16x32_bf16 v[76:79], a[244:247], v[8:11], 0
    s_and_b32 s50, s3, 1
    s_lshr_b32 s51, s3, 1
    v_mfma_f32_16x16x32_bf16 v[80:83], a[248:251], v[8:11], 0
    s_mul_i32 s52, s50, 20480
    s_mul_i32 s53, s3, 5120
    v_add_u32 v223, s53, v248
    v_mfma_f32_16x16x32_bf16 v[84:87], a[252:255], v[8:11], 0
    v_add_u32 v220, s52, v223
    v_add_u32 v222, 40960, v223
    v_mfma_f32_16x16x32_bf16 v[88:91], v[136:139], v[8:11], 0
    s_waitcnt vmcnt(19)
    buffer_load_dwordx4 a[176:179], v248, s[36:39], s62 offen offset:3072 sc1
    v_mfma_f32_16x16x32_bf16 v[72:75], v[140:143], v[12:15], v[72:75]
    s_add_u32 s62, s62, 4096
    s_xor_b32 s52, s50, 1
    s_mul_i32 s52, s52, 20480
    v_mfma_f32_16x16x32_bf16 v[76:79], v[144:147], v[12:15], v[76:79]
    v_add_u32 v221, s52, v223
    v_mfma_f32_16x16x32_bf16 v[80:83], v[148:151], v[12:15], v[80:83]
    s_lshl_b32 s53, s50, 11
    v_add_u32 v226, s53, v248
    v_mfma_f32_16x16x32_bf16 v[84:87], v[152:155], v[12:15], v[84:87]
    buffer_load_dwordx4 a[180:183], v248, s[36:39], s62 offen offset:0 sc1
    v_mfma_f32_16x16x32_bf16 v[88:91], v[156:159], v[12:15], v[88:91]
    s_waitcnt vmcnt(20)
    s_mul_i32 s52, s51, 20480
    v_add_u32 v224, s52, v226
    v_mfma_f32_16x16x32_bf16 v[72:75], v[160:163], v[16:19], v[72:75]
    s_mul_i32 s53, s51, 5120
    s_add_u32 s53, s53, 40960
    v_add_u32 v225, s53, v226
    v_mfma_f32_16x16x32_bf16 v[76:79], v[164:167], v[16:19], v[76:79]
    s_xor_b32 s53, s51, 1
    s_mul_i32 s53, s53, 5120
    v_add_u32 v226, s53, v226
    v_mfma_f32_16x16x32_bf16 v[80:83], a[0:3], v[16:19], v[80:83]
    buffer_load_dwordx4 a[184:187], v248, s[36:39], s62 offen offset:1024 sc1
    v_mfma_f32_16x16x32_bf16 v[84:87], a[4:7], v[16:19], v[84:87]
    s_lshl_b32 s52, s74, 1
    s_add_u32 s52, s52, s51
    v_mfma_f32_16x16x32_bf16 v[88:91], a[8:11], v[16:19], v[88:91]
    s_waitcnt vmcnt(20)
    s_mul_i32 s13, s52, 20480
    s_mul_i32 s53, s75, 160
    v_mfma_f32_16x16x32_bf16 v[72:75], a[12:15], v[20:23], v[72:75]
    s_add_u32 s13, s13, s53
    s_lshl_b32 s53, s50, 6
    v_mfma_f32_16x16x32_bf16 v[76:79], a[16:19], v[20:23], v[76:79]
    buffer_load_dwordx4 a[188:191], v248, s[36:39], s62 offen offset:2048 sc1
    v_mfma_f32_16x16x32_bf16 v[80:83], a[20:23], v[20:23], v[80:83]
    s_add_u32 s13, s13, s53
    s_add_u32 s14, s13, 1310720
    v_lshrrev_b32 v244, 2, v1
    v_mfma_f32_16x16x32_bf16 v[84:87], a[24:27], v[20:23], v[84:87]
    v_lshlrev_b32 v244, 6, v244
    v_and_b32 v2, 3, v1
    v_mfma_f32_16x16x32_bf16 v[88:91], a[28:31], v[20:23], v[88:91]
    s_waitcnt vmcnt(20)
    v_lshl_add_u32 v244, v2, 3, v244
    v_mfma_f32_16x16x32_bf16 v[72:75], a[32:35], v[24:27], v[72:75]
    s_waitcnt lgkmcnt(0)
    s_barrier
    buffer_load_dwordx4 v[104:107], v217, s[36:39], s18 offen offset:0 sc1
    v_mfma_f32_16x16x32_bf16 v[76:79], a[36:39], v[24:27], v[76:79]
    s_lshl_b32 s52, s50, 11
    s_lshl_b32 s53, s51, 5
    v_mfma_f32_16x16x32_bf16 v[80:83], a[40:43], v[24:27], v[80:83]
    s_add_u32 s52, s52, s53
    s_add_u32 s52, s52, 61440
    v_add_u32 v244, s52, v244
    v_mfma_f32_16x16x32_bf16 v[84:87], a[44:47], v[24:27], v[84:87]
    v_and_b32 v245, 48, v1
    v_mfma_f32_16x16x32_bf16 v[88:91], a[48:51], v[24:27], v[88:91]
    s_waitcnt vmcnt(20)
    buffer_load_dwordx4 v[108:111], v217, s[36:39], s18 offen offset:1024 sc1
    v_mfma_f32_16x16x32_bf16 v[72:75], a[52:55], v[28:31], v[72:75]
    s_lshl_b32 s52, s50, 7
    s_add_u32 s52, s52, 71680
    v_add_u32 v245, s52, v245
    v_mfma_f32_16x16x32_bf16 v[76:79], a[56:59], v[28:31], v[76:79]
    v_and_b32 v2, 15, v1
    v_lshrrev_b32 v3, 4, v1
    v_mfma_f32_16x16x32_bf16 v[80:83], a[60:63], v[28:31], v[80:83]
    v_mul_u32_u24 v2, 1280, v2
    v_and_b32 v227, 1, v3
    v_mfma_f32_16x16x32_bf16 v[84:87], a[64:67], v[28:31], v[84:87]
    buffer_load_dwordx4 v[112:115], v217, s[36:39], s18 offen offset:2048 sc1
    v_mfma_f32_16x16x32_bf16 v[88:91], a[68:71], v[28:31], v[88:91]
    s_waitcnt vmcnt(21)
    v_lshl_add_u32 v227, v227, 5, v2
    v_lshl_add_u32 v2, v3, 3, v2
    v_mfma_f32_16x16x32_bf16 v[72:75], a[72:75], v[32:35], v[72:75]
    v_lshrrev_b32 v3, 1, v3
    v_lshl_add_u32 v227, v3, 4, v227
    v_mfma_f32_16x16x32_bf16 v[76:79], a[76:79], v[32:35], v[76:79]
    s_lshr_b32 s50, s74, 1
    s_lshl_b32 s50, s50, 2
    v_mfma_f32_16x16x32_bf16 v[80:83], a[80:83], v[32:35], v[80:83]
    buffer_load_dwordx4 v[116:119], v217, s[36:39], s19 offen offset:0 sc1
    v_mfma_f32_16x16x32_bf16 v[84:87], a[84:87], v[32:35], v[84:87]
    s_add_u32 s50, s50, s3
    s_lshl_b32 s50, s50, 9
    s_add_u32 s50, s50, 188416
    v_mfma_f32_16x16x32_bf16 v[88:91], a[88:91], v[32:35], v[88:91]
    s_waitcnt vmcnt(21)
    v_min_u32 v246, 3, v1
    v_lshlrev_b32 v246, 7, v246
    v_mfma_f32_16x16x32_bf16 v[72:75], a[92:95], v[36:39], v[72:75]
    v_add_u32 v246, s50, v246
    v_mfma_f32_16x16x32_bf16 v[76:79], a[96:99], v[36:39], v[76:79]
    buffer_load_dwordx4 v[120:123], v217, s[36:39], s19 offen offset:1024 sc1
    v_mfma_f32_16x16x32_bf16 v[80:83], a[100:103], v[36:39], v[80:83]
    ds_read_b128 v[92:95], v245 offset:0
    v_mfma_f32_16x16x32_bf16 v[84:87], a[104:107], v[36:39], v[84:87]
    ds_read_b128 v[96:99], v245 offset:64
    v_mfma_f32_16x16x32_bf16 v[88:91], a[108:111], v[36:39], v[88:91]
    s_waitcnt vmcnt(21)
    ds_read_b128 v[100:103], v245 offset:128
    v_mfma_f32_16x16x32_bf16 v[72:75], a[112:115], v[40:43], v[72:75]
    s_waitcnt vmcnt(10)
    s_barrier
    s_cmp_eq_u32 s3, 0
    s_cbranch_scc0 L_wf25
    s_lshl_b32 s54, s76, 7
    s_add_u32 s54, s54, 23388160
    v_mov_b32 v249, 0
    v_mov_b32 v250, s48
    s_mov_b64 exec, 1
    buffer_store_dword v250, v249, s[36:39], s54 offen sc1
    s_mov_b64 exec, -1
L_wf25:
    buffer_load_dwordx4 v[124:127], v217, s[36:39], s19 offen offset:2048 sc1
    v_mfma_f32_16x16x32_bf16 v[76:79], a[116:119], v[40:43], v[76:79]
    ds_read_b128 v[232:235], v245 offset:320
    v_mfma_f32_16x16x32_bf16 v[80:83], a[120:123], v[40:43], v[80:83]
    ds_read_b128 v[236:239], v245 offset:384
    v_mfma_f32_16x16x32_bf16 v[84:87], a[124:127], v[40:43], v[84:87]
    ds_read_b128 v[240:243], v245 offset:448
    v_mfma_f32_16x16x32_bf16 v[88:91], a[128:131], v[40:43], v[88:91]
    buffer_load_dwordx4 v[128:131], v217, s[36:39], s20 offen offset:0 sc1
    v_mfma_f32_16x16x32_bf16 v[72:75], a[132:135], v[44:47], v[72:75]
    ds_read_b64_tr_b16 v[212:213], v244 offset:0
    v_mfma_f32_16x16x32_bf16 v[76:79], a[136:139], v[44:47], v[76:79]
    ds_read_b64_tr_b16 v[214:215], v244 offset:5120
    v_mfma_f32_16x16x32_bf16 v[80:83], a[140:143], v[44:47], v[80:83]
    ds_read_b64_tr_b16 v[252:253], v244 offset:1024
    v_mfma_f32_16x16x32_bf16 v[84:87], a[144:147], v[44:47], v[84:87]
    buffer_load_dwordx4 v[132:135], v217, s[36:39], s20 offen offset:1024 sc1
    v_mfma_f32_16x16x32_bf16 v[88:91], a[148:151], v[44:47], v[88:91]
    ds_read_b64_tr_b16 v[254:255], v244 offset:6144
    v_mfma_f32_16x16x32_bf16 v[72:75], a[152:155], v[48:51], v[72:75]
    ds_read_b64_tr_b16 v[228:229], v244 offset:2048
    v_mfma_f32_16x16x32_bf16 v[76:79], a[156:159], v[48:51], v[76:79]
    ds_read_b64_tr_b16 v[230:231], v244 offset:7168
    s_waitcnt lgkmcnt(5)
    v_lshlrev_b32 v188, 16, v212
    v_mfma_f32_16x16x32_bf16 v[80:83], a[160:163], v[48:51], v[80:83]
    buffer_load_dwordx4 v[56:59], v217, s[36:39], s20 offen offset:2048 sc1
    v_mfma_f32_16x16x32_bf16 v[84:87], a[164:167], v[48:51], v[84:87]
    v_and_b32 v189, 0xffff0000, v212
    v_lshlrev_b32 v190, 16, v213
    v_mfma_f32_16x16x32_bf16 v[88:91], a[168:171], v[48:51], v[88:91]
    s_waitcnt vmcnt(13)
    v_and_b32 v191, 0xffff0000, v213
    v_mul_f32 v188, v188, v232
    v_mfma_f32_16x16x32_bf16 v[72:75], a[172:175], v[52:55], v[72:75]
    s_waitcnt vmcnt(12)
    v_mul_f32 v189, v189, v233
    v_mul_f32 v190, v190, v234
    v_mfma_f32_16x16x32_bf16 v[76:79], a[176:179], v[52:55], v[76:79]
    s_waitcnt vmcnt(11)
    buffer_load_dwordx4 v[60:63], v217, s[36:39], s21 offen offset:0 sc1
    v_mfma_f32_16x16x32_bf16 v[80:83], a[180:183], v[52:55], v[80:83]
    v_mul_f32 v191, v191, v235
    s_waitcnt lgkmcnt(4)
    v_lshlrev_b32 v200, 16, v214
    s_waitcnt vmcnt(11)
    v_mfma_f32_16x16x32_bf16 v[84:87], a[184:187], v[52:55], v[84:87]
    s_waitcnt vmcnt(10)
    v_and_b32 v201, 0xffff0000, v214
    v_lshlrev_b32 v202, 16, v215
    v_mfma_f32_16x16x32_bf16 v[88:91], a[188:191], v[52:55], v[88:91]
    s_waitcnt vmcnt(9)
    v_and_b32 v203, 0xffff0000, v215
    v_mul_f32 v200, v200, v232
    v_mfma_f32_16x16x32_bf16 v[168:171], a[240:243], v[104:107], 0
    buffer_load_dwordx4 v[64:67], v217, s[36:39], s21 offen offset:1024 sc1
    v_mfma_f32_16x16x32_bf16 v[172:175], a[244:247], v[104:107], 0
    v_mul_f32 v201, v201, v233
    v_mul_f32 v202, v202, v234
    v_mfma_f32_16x16x32_bf16 v[176:179], a[248:251], v[104:107], 0
    v_mul_f32 v203, v203, v235
    s_waitcnt lgkmcnt(3)
    v_lshlrev_b32 v192, 16, v252
    v_mfma_f32_16x16x32_bf16 v[180:183], a[252:255], v[104:107], 0
    v_and_b32 v193, 0xffff0000, v252
    v_lshlrev_b32 v194, 16, v253
    v_mfma_f32_16x16x32_bf16 v[184:187], v[136:139], v[104:107], 0
    s_waitcnt vmcnt(9)
    buffer_load_dwordx4 v[68:71], v217, s[36:39], s21 offen offset:2048 sc1
    v_mfma_f32_16x16x32_bf16 v[168:171], v[140:143], v[108:111], v[168:171]
    v_and_b32 v195, 0xffff0000, v253
    v_mul_f32 v192, v192, v236
    v_mfma_f32_16x16x32_bf16 v[172:175], v[144:147], v[108:111], v[172:175]
    v_mul_f32 v193, v193, v237
    v_mul_f32 v194, v194, v238
    v_mfma_f32_16x16x32_bf16 v[176:179], v[148:151], v[108:111], v[176:179]
    v_mul_f32 v195, v195, v239
    s_waitcnt lgkmcnt(2)
    v_lshlrev_b32 v204, 16, v254
    v_mfma_f32_16x16x32_bf16 v[180:183], v[152:155], v[108:111], v[180:183]
    v_and_b32 v205, 0xffff0000, v254
    v_lshlrev_b32 v206, 16, v255
    v_mfma_f32_16x16x32_bf16 v[184:187], v[156:159], v[108:111], v[184:187]
    s_waitcnt vmcnt(9)
    v_and_b32 v207, 0xffff0000, v255
    v_mul_f32 v204, v204, v236
    v_mfma_f32_16x16x32_bf16 v[168:171], v[160:163], v[112:115], v[168:171]
    v_mul_f32 v205, v205, v237
    v_mul_f32 v206, v206, v238
    v_mfma_f32_16x16x32_bf16 v[172:175], v[164:167], v[112:115], v[172:175]
    v_mul_f32 v207, v207, v239
    s_waitcnt lgkmcnt(1)
    v_lshlrev_b32 v196, 16, v228
    v_mfma_f32_16x16x32_bf16 v[176:179], a[0:3], v[112:115], v[176:179]
    v_and_b32 v197, 0xffff0000, v228
    v_lshlrev_b32 v198, 16, v229
    v_mfma_f32_16x16x32_bf16 v[180:183], a[4:7], v[112:115], v[180:183]
    v_and_b32 v199, 0xffff0000, v229
    v_mul_f32 v196, v196, v240
    v_mfma_f32_16x16x32_bf16 v[184:187], a[8:11], v[112:115], v[184:187]
    s_waitcnt vmcnt(8)
    v_mul_f32 v197, v197, v241
    v_mul_f32 v198, v198, v242
    v_mfma_f32_16x16x32_bf16 v[168:171], a[12:15], v[116:119], v[168:171]
    v_mul_f32 v199, v199, v243
    s_waitcnt lgkmcnt(0)
    v_lshlrev_b32 v208, 16, v230
    v_mfma_f32_16x16x32_bf16 v[172:175], a[16:19], v[116:119], v[172:175]
    v_and_b32 v209, 0xffff0000, v230
    v_lshlrev_b32 v210, 16, v231
    v_mfma_f32_16x16x32_bf16 v[176:179], a[20:23], v[116:119], v[176:179]
    v_and_b32 v211, 0xffff0000, v231
    v_mul_f32 v208, v208, v240
    v_mfma_f32_16x16x32_bf16 v[180:183], a[24:27], v[116:119], v[180:183]
    v_mul_f32 v209, v209, v241
    v_mul_f32 v210, v210, v242
    v_mfma_f32_16x16x32_bf16 v[184:187], a[28:31], v[116:119], v[184:187]
    s_waitcnt vmcnt(7)
    ds_write_b128 v220, v[72:75] offset:0
    v_mul_f32 v211, v211, v243
    v_mfma_f32_16x16x32_bf16 v[168:171], a[32:35], v[120:123], v[168:171]
    v_mfma_f32_16x16x32_bf16 v[172:175], a[36:39], v[120:123], v[172:175]
    ds_write_b128 v220, v[76:79] offset:1024
    v_mfma_f32_16x16x32_bf16 v[176:179], a[40:43], v[120:123], v[176:179]
    v_mfma_f32_16x16x32_bf16 v[180:183], a[44:47], v[120:123], v[180:183]
    ds_write_b128 v220, v[80:83] offset:2048
    v_mfma_f32_16x16x32_bf16 v[184:187], a[48:51], v[120:123], v[184:187]
    s_waitcnt vmcnt(6)
    buffer_load_dword v247, v246, s[36:39], s17 offen sc1
    v_mfma_f32_16x16x32_bf16 v[168:171], a[52:55], v[124:127], v[168:171]
    ds_write_b128 v220, v[84:87] offset:3072
    v_mfma_f32_16x16x32_bf16 v[172:175], a[56:59], v[124:127], v[172:175]
    v_mfma_f32_16x16x32_bf16 v[176:179], a[60:63], v[124:127], v[176:179]
    ds_write_b128 v220, v[88:91] offset:4096
    v_mfma_f32_16x16x32_bf16 v[180:183], a[64:67], v[124:127], v[180:183]
    v_mfma_f32_16x16x32_bf16 v[184:187], a[68:71], v[124:127], v[184:187]
    s_waitcnt vmcnt(6)
    v_mfma_f32_16x16x32_bf16 v[168:171], a[72:75], v[128:131], v[168:171]
    v_mfma_f32_16x16x32_bf16 v[172:175], a[76:79], v[128:131], v[172:175]
    v_mfma_f32_16x16x32_bf16 v[176:179], a[80:83], v[128:131], v[176:179]
    v_mfma_f32_16x16x32_bf16 v[180:183], a[84:87], v[128:131], v[180:183]
    v_mfma_f32_16x16x32_bf16 v[184:187], a[88:91], v[128:131], v[184:187]
    s_waitcnt vmcnt(5)
    v_mfma_f32_16x16x32_bf16 v[168:171], a[92:95], v[132:135], v[168:171]
    v_mfma_f32_16x16x32_bf16 v[172:175], a[96:99], v[132:135], v[172:175]
    v_mfma_f32_16x16x32_bf16 v[176:179], a[100:103], v[132:135], v[176:179]
    v_mfma_f32_16x16x32_bf16 v[180:183], a[104:107], v[132:135], v[180:183]
    v_mfma_f32_16x16x32_bf16 v[184:187], a[108:111], v[132:135], v[184:187]
    s_waitcnt vmcnt(4)
    v_mfma_f32_16x16x32_bf16 v[168:171], a[112:115], v[56:59], v[168:171]
    v_mfma_f32_16x16x32_bf16 v[172:175], a[116:119], v[56:59], v[172:175]
    v_mfma_f32_16x16x32_bf16 v[176:179], a[120:123], v[56:59], v[176:179]
    v_mfma_f32_16x16x32_bf16 v[180:183], a[124:127], v[56:59], v[180:183]
    v_mfma_f32_16x16x32_bf16 v[184:187], a[128:131], v[56:59], v[184:187]
    s_waitcnt vmcnt(3)
    v_mfma_f32_16x16x32_bf16 v[168:171], a[132:135], v[60:63], v[168:171]
    v_mfma_f32_16x16x32_bf16 v[172:175], a[136:139], v[60:63], v[172:175]
    v_mfma_f32_16x16x32_bf16 v[176:179], a[140:143], v[60:63], v[176:179]
    v_mfma_f32_16x16x32_bf16 v[180:183], a[144:147], v[60:63], v[180:183]
    s_waitcnt vmcnt(0)
    v_cmp_ne_u32 vcc, s48, v247
    s_cbranch_vccnz L_chk26_slow
L_chk26_back:
    v_mfma_f32_16x16x32_bf16 v[184:187], a[148:151], v[60:63], v[184:187]
    buffer_load_dwordx4 v[8:11], v218, s[36:39], s18 offen offset:0 sc1
    v_mfma_f32_16x16x32_bf16 v[168:171], a[152:155], v[64:67], v[168:171]
    v_mfma_f32_16x16x32_bf16 v[172:175], a[156:159], v[64:67], v[172:175]
    buffer_load_dwordx4 v[12:15], v218, s[36:39], s18 offen offset:1024 sc1
    v_mfma_f32_16x16x32_bf16 v[176:179], a[160:163], v[64:67], v[176:179]
    v_mfma_f32_16x16x32_bf16 v[180:183], a[164:167], v[64:67], v[180:183]
    buffer_load_dwordx4 v[16:19], v218, s[36:39], s18 offen offset:2048 sc1
    v_mfma_f32_16x16x32_bf16 v[184:187], a[168:171], v[64:67], v[184:187]
    v_mfma_f32_16x16x32_bf16 v[168:171], a[172:175], v[68:71], v[168:171]
    buffer_load_dwordx4 v[20:23], v218, s[36:39], s19 offen offset:0 sc1
    v_mfma_f32_16x16x32_bf16 v[172:175], a[176:179], v[68:71], v[172:175]
    v_mfma_f32_16x16x32_bf16 v[176:179], a[180:183], v[68:71], v[176:179]
    buffer_load_dwordx4 v[24:27], v218, s[36:39], s19 offen offset:1024 sc1
    v_mfma_f32_16x16x32_bf16 v[180:183], a[184:187], v[68:71], v[180:183]
    v_mfma_f32_16x16x32_bf16 v[184:187], a[188:191], v[68:71], v[184:187]
    s_waitcnt vmcnt(4)
    buffer_load_dwordx4 v[28:31], v218, s[36:39], s19 offen offset:2048 sc1
    v_mfma_f32_16x16x32_bf16 v[72:75], a[240:243], v[8:11], 0
    v_mfma_f32_16x16x32_bf16 v[76:79], a[244:247], v[8:11], 0
    buffer_load_dwordx4 v[32:35], v218, s[36:39], s20 offen offset:0 sc1
    v_mfma_f32_16x16x32_bf16 v[80:83], a[248:251], v[8:11], 0
    v_mfma_f32_16x16x32_bf16 v[84:87], a[252:255], v[8:11], 0
    buffer_load_dwordx4 v[36:39], v218, s[36:39], s20 offen offset:1024 sc1
    v_mfma_f32_16x16x32_bf16 v[88:91], v[136:139], v[8:11], 0
    s_waitcnt vmcnt(6)
    ds_write_b128 v221, v[168:171] offset:0
    v_mfma_f32_16x16x32_bf16 v[72:75], v[140:143], v[12:15], v[72:75]
    buffer_load_dwordx4 v[40:43], v218, s[36:39], s20 offen offset:2048 sc1
    v_mfma_f32_16x16x32_bf16 v[76:79], v[144:147], v[12:15], v[76:79]
    ds_write_b128 v221, v[172:175] offset:1024
    v_mfma_f32_16x16x32_bf16 v[80:83], v[148:151], v[12:15], v[80:83]
    buffer_load_dwordx4 v[44:47], v218, s[36:39], s21 offen offset:0 sc1
    v_mfma_f32_16x16x32_bf16 v[84:87], v[152:155], v[12:15], v[84:87]
    ds_write_b128 v221, v[176:179] offset:2048
    v_mfma_f32_16x16x32_bf16 v[88:91], v[156:159], v[12:15], v[88:91]
    s_waitcnt vmcnt(7)
    buffer_load_dwordx4 v[48:51], v218, s[36:39], s21 offen offset:1024 sc1
    v_mfma_f32_16x16x32_bf16 v[72:75], v[160:163], v[16:19], v[72:75]
    ds_write_b128 v221, v[180:183] offset:3072
    v_mfma_f32_16x16x32_bf16 v[76:79], v[164:167], v[16:19], v[76:79]
    buffer_load_dwordx4 v[52:55], v218, s[36:39], s21 offen offset:2048 sc1
    v_mfma_f32_16x16x32_bf16 v[80:83], a[0:3], v[16:19], v[80:83]
    ds_write_b128 v221, v[184:187] offset:4096
    v_mfma_f32_16x16x32_bf16 v[84:87], a[4:7], v[16:19], v[84:87]
    buffer_load_dwordx4 v[104:107], v219, s[36:39], s18 offen offset:0 sc1
    v_mfma_f32_16x16x32_bf16 v[88:91], a[8:11], v[16:19], v[88:91]
    s_waitcnt vmcnt(9)
    v_mfma_f32_16x16x32_bf16 v[72:75], a[12:15], v[20:23], v[72:75]
    buffer_load_dwordx4 v[108:111], v219, s[36:39], s18 offen offset:1024 sc1
    v_mfma_f32_16x16x32_bf16 v[76:79], a[16:19], v[20:23], v[76:79]
    v_mfma_f32_16x16x32_bf16 v[80:83], a[20:23], v[20:23], v[80:83]
    buffer_load_dwordx4 v[112:115], v219, s[36:39], s18 offen offset:2048 sc1
    v_mfma_f32_16x16x32_bf16 v[84:87], a[24:27], v[20:23], v[84:87]
    v_mfma_f32_16x16x32_bf16 v[88:91], a[28:31], v[20:23], v[88:91]
    s_waitcnt vmcnt(10)
    buffer_load_dwordx4 v[116:119], v219, s[36:39], s19 offen offset:0 sc1
    v_mfma_f32_16x16x32_bf16 v[72:75], a[32:35], v[24:27], v[72:75]
    s_waitcnt lgkmcnt(0)
    s_barrier
    ds_read_b128 v[232:235], v224 offset:0
    v_mfma_f32_16x16x32_bf16 v[76:79], a[36:39], v[24:27], v[76:79]
    buffer_load_dwordx4 v[120:123], v219, s[36:39], s19 offen offset:1024 sc1
    v_mfma_f32_16x16x32_bf16 v[80:83], a[40:43], v[24:27], v[80:83]
    ds_read_b128 v[236:239], v224 offset:1024
    v_mfma_f32_16x16x32_bf16 v[84:87], a[44:47], v[24:27], v[84:87]
    buffer_load_dwordx4 v[124:127], v219, s[36:39], s19 offen offset:2048 sc1
    v_mfma_f32_16x16x32_bf16 v[88:91], a[48:51], v[24:27], v[88:91]
    s_waitcnt vmcnt(12)
    ds_read_b128 v[240:243], v224 offset:2048
    v_mfma_f32_16x16x32_bf16 v[72:75], a[52:55], v[28:31], v[72:75]
    buffer_load_dwordx4 v[128:131], v219, s[36:39], s20 offen offset:0 sc1
    v_mfma_f32_16x16x32_bf16 v[76:79], a[56:59], v[28:31], v[76:79]
    ds_read_b128 v[212:215], v224 offset:5120
    v_mfma_f32_16x16x32_bf16 v[80:83], a[60:63], v[28:31], v[80:83]
    buffer_load_dwordx4 v[132:135], v219, s[36:39], s20 offen offset:1024 sc1
    v_mfma_f32_16x16x32_bf16 v[84:87], a[64:67], v[28:31], v[84:87]
    ds_read_b128 v[252:255], v224 offset:6144
    v_mfma_f32_16x16x32_bf16 v[88:91], a[68:71], v[28:31], v[88:91]
    s_waitcnt vmcnt(13)
    buffer_load_dwordx4 v[56:59], v219, s[36:39], s20 offen offset:2048 sc1
    v_mfma_f32_16x16x32_bf16 v[72:75], a[72:75], v[32:35], v[72:75]
    ds_read_b128 v[228:231], v224 offset:7168
    v_mfma_f32_16x16x32_bf16 v[76:79], a[76:79], v[32:35], v[76:79]
    buffer_load_dwordx4 v[60:63], v219, s[36:39], s21 offen offset:0 sc1
    v_mfma_f32_16x16x32_bf16 v[80:83], a[80:83], v[32:35], v[80:83]
    v_mfma_f32_16x16x32_bf16 v[84:87], a[84:87], v[32:35], v[84:87]
    buffer_load_dwordx4 v[64:67], v219, s[36:39], s21 offen offset:1024 sc1
    v_mfma_f32_16x16x32_bf16 v[88:91], a[88:91], v[32:35], v[88:91]
    s_waitcnt lgkmcnt(5)
    v_fma_f32 v188, v232, v92, v188
    v_fma_f32 v189, v233, v93, v189
    s_waitcnt vmcnt(15)
    v_mfma_f32_16x16x32_bf16 v[72:75], a[92:95], v[36:39], v[72:75]
    buffer_load_dwordx4 v[68:71], v219, s[36:39], s21 offen offset:2048 sc1
    v_mfma_f32_16x16x32_bf16 v[76:79], a[96:99], v[36:39], v[76:79]
    v_fma_f32 v190, v234, v94, v190
    v_fma_f32 v191, v235, v95, v191
    v_mfma_f32_16x16x32_bf16 v[80:83], a[100:103], v[36:39], v[80:83]
    s_waitcnt lgkmcnt(4)
    v_fma_f32 v192, v236, v96, v192
    v_fma_f32 v193, v237, v97, v193
    v_mfma_f32_16x16x32_bf16 v[84:87], a[104:107], v[36:39], v[84:87]
    v_fma_f32 v194, v238, v98, v194
    v_fma_f32 v195, v239, v99, v195
    v_mfma_f32_16x16x32_bf16 v[88:91], a[108:111], v[36:39], v[88:91]
    s_waitcnt lgkmcnt(3)
    v_fma_f32 v196, v240, v100, v196
    v_fma_f32 v197, v241, v101, v197
    s_waitcnt vmcnt(15)
    v_mfma_f32_16x16x32_bf16 v[72:75], a[112:115], v[40:43], v[72:75]
    v_fma_f32 v198, v242, v102, v198
    v_fma_f32 v199, v243, v103, v199
    v_mfma_f32_16x16x32_bf16 v[76:79], a[116:119], v[40:43], v[76:79]
    ds_read_b128 v[232:235], v224 offset:10240
    v_mfma_f32_16x16x32_bf16 v[80:83], a[120:123], v[40:43], v[80:83]
    ds_read_b128 v[236:239], v224 offset:11264
    v_mfma_f32_16x16x32_bf16 v[84:87], a[124:127], v[40:43], v[84:87]
    ds_read_b128 v[240:243], v224 offset:12288
    s_waitcnt lgkmcnt(5)
    v_fma_f32 v188, v212, v92, v188
    v_mfma_f32_16x16x32_bf16 v[88:91], a[128:131], v[40:43], v[88:91]
    s_waitcnt vmcnt(14)
    v_fma_f32 v189, v213, v93, v189
    v_fma_f32 v190, v214, v94, v190
    v_mfma_f32_16x16x32_bf16 v[72:75], a[132:135], v[44:47], v[72:75]
    v_fma_f32 v191, v215, v95, v191
    s_waitcnt lgkmcnt(4)
    v_fma_f32 v192, v252, v96, v192
    v_mfma_f32_16x16x32_bf16 v[76:79], a[136:139], v[44:47], v[76:79]
    v_fma_f32 v193, v253, v97, v193
    v_fma_f32 v194, v254, v98, v194
    v_mfma_f32_16x16x32_bf16 v[80:83], a[140:143], v[44:47], v[80:83]
    v_fma_f32 v195, v255, v99, v195
    s_waitcnt lgkmcnt(3)
    v_fma_f32 v196, v228, v100, v196
    v_mfma_f32_16x16x32_bf16 v[84:87], a[144:147], v[44:47], v[84:87]
    v_fma_f32 v197, v229, v101, v197
    v_fma_f32 v198, v230, v102, v198
    v_mfma_f32_16x16x32_bf16 v[88:91], a[148:151], v[44:47], v[88:91]
    s_waitcnt vmcnt(13)
    v_fma_f32 v199, v231, v103, v199
    v_mfma_f32_16x16x32_bf16 v[72:75], a[152:155], v[48:51], v[72:75]
    ds_read_b128 v[212:215], v224 offset:15360
    v_mfma_f32_16x16x32_bf16 v[76:79], a[156:159], v[48:51], v[76:79]
    ds_read_b128 v[252:255], v224 offset:16384
    v_mfma_f32_16x16x32_bf16 v[80:83], a[160:163], v[48:51], v[80:83]
    ds_read_b128 v[228:231], v224 offset:17408
    s_waitcnt lgkmcnt(5)
    v_fma_f32 v188, v232, v92, v188
    v_mfma_f32_16x16x32_bf16 v[84:87], a[164:167], v[48:51], v[84:87]
    v_fma_f32 v189, v233, v93, v189
    v_fma_f32 v190, v234, v94, v190
    v_mfma_f32_16x16x32_bf16 v[88:91], a[168:171], v[48:51], v[88:91]
    v_fma_f32 v191, v235, v95, v191
    s_waitcnt lgkmcnt(4)
    v_fma_f32 v192, v236, v96, v192
    s_waitcnt vmcnt(12)
    v_mfma_f32_16x16x32_bf16 v[72:75], a[172:175], v[52:55], v[72:75]
    v_fma_f32 v193, v237, v97, v193
    v_fma_f32 v194, v238, v98, v194
    v_mfma_f32_16x16x32_bf16 v[76:79], a[176:179], v[52:55], v[76:79]
    v_fma_f32 v195, v239, v99, v195
    s_waitcnt lgkmcnt(3)
    v_fma_f32 v196, v240, v100, v196
    v_mfma_f32_16x16x32_bf16 v[80:83], a[180:183], v[52:55], v[80:83]
    v_fma_f32 v197, v241, v101, v197
    v_fma_f32 v198, v242, v102, v198
    v_mfma_f32_16x16x32_bf16 v[84:87], a[184:187], v[52:55], v[84:87]
    v_fma_f32 v199, v243, v103, v199
    s_waitcnt lgkmcnt(2)
    v_fma_f32 v188, v212, v92, v188
    v_mfma_f32_16x16x32_bf16 v[88:91], a[188:191], v[52:55], v[88:91]
    s_waitcnt vmcnt(11)
    v_fma_f32 v189, v213, v93, v189
    v_fma_f32 v190, v214, v94, v190
    v_mfma_f32_16x16x32_bf16 v[168:171], a[240:243], v[104:107], 0
    v_fma_f32 v191, v215, v95, v191
    s_waitcnt lgkmcnt(1)
    v_fma_f32 v192, v252, v96, v192
    v_mfma_f32_16x16x32_bf16 v[172:175], a[244:247], v[104:107], 0
    v_fma_f32 v193, v253, v97, v193
    v_fma_f32 v194, v254, v98, v194
    v_mfma_f32_16x16x32_bf16 v[176:179], a[248:251], v[104:107], 0
    v_fma_f32 v195, v255, v99, v195
    s_waitcnt lgkmcnt(0)
    v_fma_f32 v196, v228, v100, v196
    v_mfma_f32_16x16x32_bf16 v[180:183], a[252:255], v[104:107], 0
    v_fma_f32 v197, v229, v101, v197
    v_fma_f32 v198, v230, v102, v198
    v_mfma_f32_16x16x32_bf16 v[184:187], v[136:139], v[104:107], 0
    s_waitcnt vmcnt(10)
    v_fma_f32 v199, v231, v103, v199
    v_cvt_pk_bf16_f32 v232, v188, v189
    v_mfma_f32_16x16x32_bf16 v[168:171], v[140:143], v[108:111], v[168:171]
    v_cvt_pk_bf16_f32 v233, v190, v191
    v_cvt_pk_bf16_f32 v234, v192, v193
    v_mfma_f32_16x16x32_bf16 v[172:175], v[144:147], v[108:111], v[172:175]
    v_cvt_pk_bf16_f32 v235, v194, v195
    v_cvt_pk_bf16_f32 v236, v196, v197
    v_mfma_f32_16x16x32_bf16 v[176:179], v[148:151], v[108:111], v[176:179]
    ds_write_b128 v222, v[72:75] offset:0
    v_cvt_pk_bf16_f32 v237, v198, v199
    v_mfma_f32_16x16x32_bf16 v[180:183], v[152:155], v[108:111], v[180:183]
    v_permlane16_swap_b32 v232, v234
    v_mfma_f32_16x16x32_bf16 v[184:187], v[156:159], v[108:111], v[184:187]
    s_waitcnt vmcnt(9)
    v_permlane16_swap_b32 v233, v235
    v_mfma_f32_16x16x32_bf16 v[168:171], v[160:163], v[112:115], v[168:171]
    buffer_store_dwordx4 v[232:235], v227, s[40:43], s13 offen
    v_mfma_f32_16x16x32_bf16 v[172:175], v[164:167], v[112:115], v[172:175]
    buffer_store_dwordx2 v[236:237], v2, s[40:43], s13 offen offset:64
    v_mfma_f32_16x16x32_bf16 v[176:179], a[0:3], v[112:115], v[176:179]
    ds_write_b128 v222, v[76:79] offset:1024
    v_mfma_f32_16x16x32_bf16 v[180:183], a[4:7], v[112:115], v[180:183]
    v_mfma_f32_16x16x32_bf16 v[184:187], a[8:11], v[112:115], v[184:187]
    s_waitcnt vmcnt(10)
    ds_write_b128 v222, v[80:83] offset:2048
    v_mfma_f32_16x16x32_bf16 v[168:171], a[12:15], v[116:119], v[168:171]
    v_mfma_f32_16x16x32_bf16 v[172:175], a[16:19], v[116:119], v[172:175]
    ds_write_b128 v222, v[84:87] offset:3072
    v_mfma_f32_16x16x32_bf16 v[176:179], a[20:23], v[116:119], v[176:179]
    v_mfma_f32_16x16x32_bf16 v[180:183], a[24:27], v[116:119], v[180:183]
    ds_write_b128 v222, v[88:91] offset:4096
    v_mfma_f32_16x16x32_bf16 v[184:187], a[28:31], v[116:119], v[184:187]
    s_waitcnt vmcnt(9)
    v_mfma_f32_16x16x32_bf16 v[168:171], a[32:35], v[120:123], v[168:171]
    v_mfma_f32_16x16x32_bf16 v[172:175], a[36:39], v[120:123], v[172:175]
    v_mfma_f32_16x16x32_bf16 v[176:179], a[40:43], v[120:123], v[176:179]
    v_mfma_f32_16x16x32_bf16 v[180:183], a[44:47], v[120:123], v[180:183]
    v_mfma_f32_16x16x32_bf16 v[184:187], a[48:51], v[120:123], v[184:187]
    s_waitcnt vmcnt(8)
    v_mfma_f32_16x16x32_bf16 v[168:171], a[52:55], v[124:127], v[168:171]
    v_mfma_f32_16x16x32_bf16 v[172:175], a[56:59], v[124:127], v[172:175]
    s_waitcnt lgkmcnt(0)
    s_barrier
    ds_read_b128 v[232:235], v225 offset:0
    v_mfma_f32_16x16x32_bf16 v[176:179], a[60:63], v[124:127], v[176:179]
    ds_read_b128 v[236:239], v225 offset:1024
    v_mfma_f32_16x16x32_bf16 v[180:183], a[64:67], v[124:127], v[180:183]
    ds_read_b128 v[240:243], v225 offset:2048
    v_mfma_f32_16x16x32_bf16 v[184:187], a[68:71], v[124:127], v[184:187]
    s_waitcnt vmcnt(7)
    ds_read_b128 v[212:215], v225 offset:10240
    v_mfma_f32_16x16x32_bf16 v[168:171], a[72:75], v[128:131], v[168:171]
    ds_read_b128 v[252:255], v225 offset:11264
    v_mfma_f32_16x16x32_bf16 v[172:175], a[76:79], v[128:131], v[172:175]
    ds_read_b128 v[228:231], v225 offset:12288
    v_mfma_f32_16x16x32_bf16 v[176:179], a[80:83], v[128:131], v[176:179]
    v_mfma_f32_16x16x32_bf16 v[180:183], a[84:87], v[128:131], v[180:183]
    v_mfma_f32_16x16x32_bf16 v[184:187], a[88:91], v[128:131], v[184:187]
    s_waitcnt vmcnt(6)
    v_mfma_f32_16x16x32_bf16 v[168:171], a[92:95], v[132:135], v[168:171]
    s_waitcnt lgkmcnt(5)
    v_fma_f32 v200, v232, v92, v200
    v_fma_f32 v201, v233, v93, v201
    v_mfma_f32_16x16x32_bf16 v[172:175], a[96:99], v[132:135], v[172:175]
    v_fma_f32 v202, v234, v94, v202
    v_fma_f32 v203, v235, v95, v203
    v_mfma_f32_16x16x32_bf16 v[176:179], a[100:103], v[132:135], v[176:179]
    s_waitcnt lgkmcnt(4)
    v_fma_f32 v204, v236, v96, v204
    v_fma_f32 v205, v237, v97, v205
    v_mfma_f32_16x16x32_bf16 v[180:183], a[104:107], v[132:135], v[180:183]
    v_fma_f32 v206, v238, v98, v206
    v_fma_f32 v207, v239, v99, v207
    v_mfma_f32_16x16x32_bf16 v[184:187], a[108:111], v[132:135], v[184:187]
    s_waitcnt lgkmcnt(3)
    v_fma_f32 v208, v240, v100, v208
    v_fma_f32 v209, v241, v101, v209
    s_waitcnt vmcnt(5)
    v_mfma_f32_16x16x32_bf16 v[168:171], a[112:115], v[56:59], v[168:171]
    v_fma_f32 v210, v242, v102, v210
    v_fma_f32 v211, v243, v103, v211
    v_mfma_f32_16x16x32_bf16 v[172:175], a[116:119], v[56:59], v[172:175]
    s_waitcnt lgkmcnt(2)
    v_fma_f32 v200, v212, v92, v200
    v_fma_f32 v201, v213, v93, v201
    v_mfma_f32_16x16x32_bf16 v[176:179], a[120:123], v[56:59], v[176:179]
    v_fma_f32 v202, v214, v94, v202
    v_fma_f32 v203, v215, v95, v203
    v_mfma_f32_16x16x32_bf16 v[180:183], a[124:127], v[56:59], v[180:183]
    s_waitcnt lgkmcnt(1)
    v_fma_f32 v204, v252, v96, v204
    v_fma_f32 v205, v253, v97, v205
    v_mfma_f32_16x16x32_bf16 v[184:187], a[128:131], v[56:59], v[184:187]
    s_waitcnt vmcnt(4)
    v_fma_f32 v206, v254, v98, v206
    v_fma_f32 v207, v255, v99, v207
    v_mfma_f32_16x16x32_bf16 v[168:171], a[132:135], v[60:63], v[168:171]
    s_waitcnt lgkmcnt(0)
    v_fma_f32 v208, v228, v100, v208
    v_fma_f32 v209, v229, v101, v209
    v_mfma_f32_16x16x32_bf16 v[172:175], a[136:139], v[60:63], v[172:175]
    v_fma_f32 v210, v230, v102, v210
    v_fma_f32 v211, v231, v103, v211
    v_mfma_f32_16x16x32_bf16 v[176:179], a[140:143], v[60:63], v[176:179]
    v_mfma_f32_16x16x32_bf16 v[180:183], a[144:147], v[60:63], v[180:183]
    v_mfma_f32_16x16x32_bf16 v[184:187], a[148:151], v[60:63], v[184:187]
    s_waitcnt vmcnt(3)
    v_mfma_f32_16x16x32_bf16 v[168:171], a[152:155], v[64:67], v[168:171]
    v_mfma_f32_16x16x32_bf16 v[172:175], a[156:159], v[64:67], v[172:175]
    v_mfma_f32_16x16x32_bf16 v[176:179], a[160:163], v[64:67], v[176:179]
    v_mfma_f32_16x16x32_bf16 v[180:183], a[164:167], v[64:67], v[180:183]
    v_mfma_f32_16x16x32_bf16 v[184:187], a[168:171], v[64:67], v[184:187]
    s_waitcnt vmcnt(2)
    v_mfma_f32_16x16x32_bf16 v[168:171], a[172:175], v[68:71], v[168:171]
    v_mfma_f32_16x16x32_bf16 v[172:175], a[176:179], v[68:71], v[172:175]
    v_mfma_f32_16x16x32_bf16 v[176:179], a[180:183], v[68:71], v[176:179]
    v_mfma_f32_16x16x32_bf16 v[180:183], a[184:187], v[68:71], v[180:183]
    v_mfma_f32_16x16x32_bf16 v[184:187], a[188:191], v[68:71], v[184:187]
    s_nop 3
    ds_write_b128 v223, v[168:171] offset:0
    ds_write_b128 v223, v[172:175] offset:1024
    ds_write_b128 v223, v[176:179] offset:2048
    ds_write_b128 v223, v[180:183] offset:3072
    ds_write_b128 v223, v[184:187] offset:4096
    s_waitcnt lgkmcnt(0)
    s_barrier
    ds_read_b128 v[232:235], v226 offset:0
    ds_read_b128 v[236:239], v226 offset:1024
    ds_read_b128 v[240:243], v226 offset:2048
    ds_read_b128 v[212:215], v226 offset:10240
    ds_read_b128 v[252:255], v226 offset:11264
    ds_read_b128 v[228:231], v226 offset:12288
    s_waitcnt lgkmcnt(2)
    v_pk_add_f32 v[232:233], v[232:233], v[212:213]
    v_pk_add_f32 v[234:235], v[234:235], v[214:215]
    s_waitcnt lgkmcnt(1)
    v_pk_add_f32 v[236:237], v[236:237], v[252:253]
    v_pk_add_f32 v[238:239], v[238:239], v[254:255]
    s_waitcnt lgkmcnt(0)
    v_pk_add_f32 v[240:241], v[240:241], v[228:229]
    v_pk_add_f32 v[242:243], v[242:243], v[230:231]
    v_pk_fma_f32 v[200:201], v[232:233], v[92:93], v[200:201]
    v_pk_fma_f32 v[202:203], v[234:235], v[94:95], v[202:203]
    v_pk_fma_f32 v[204:205], v[236:237], v[96:97], v[204:205]
    v_pk_fma_f32 v[206:207], v[238:239], v[98:99], v[206:207]
    v_pk_fma_f32 v[208:209], v[240:241], v[100:101], v[208:209]
    v_pk_fma_f32 v[210:211], v[242:243], v[102:103], v[210:211]
    v_cvt_pk_bf16_f32 v232, v200, v201
    v_cvt_pk_bf16_f32 v233, v202, v203
    v_cvt_pk_bf16_f32 v234, v204, v205
    v_cvt_pk_bf16_f32 v235, v206, v207
    v_cvt_pk_bf16_f32 v236, v208, v209
    v_cvt_pk_bf16_f32 v237, v210, v211
    v_permlane16_swap_b32 v232, v234
    v_permlane16_swap_b32 v233, v235
    buffer_store_dwordx4 v[232:235], v227, s[40:43], s14 offen
    buffer_store_dwordx2 v[236:237], v2, s[40:43], s14 offen offset:64
L_end:
    s_endpgm
L_bias:
    s_waitcnt lgkmcnt(0)
    s_mov_b32 s52, 23301888
    v_min_u32 v5, 19, v1
    v_lshlrev_b32 v5, 7, v5
L_poll27:
    buffer_load_dword v2, v5, s[36:39], s52 offen sc1
    s_waitcnt vmcnt(0)
    v_cmp_ne_u32 vcc, s48, v2
    s_cbranch_vccz L_poll27_ok
    s_cmp_eq_u32 s49, 0
    s_cbranch_scc1 L_poll27_ok
    s_sub_u32 s49, s49, 1
    s_sleep 1
    s_branch L_poll27
L_poll27_ok:
    s_mul_i32 s52, s3, 2560
    s_add_u32 m0, s52, 122880
    s_lshl_b32 s52, s34, 7
    v_add_u32 v2, s52, v248
    s_add_u32 s52, s52, 1024
    v_subrev_u32 v5, 2560, v2
    v_min_u32 v2, v2, v5
    v_add_u32 v3, s52, v248
    s_add_u32 s52, s52, 1024
    v_subrev_u32 v5, 2560, v3
    v_min_u32 v3, v3, v5
    v_add_u32 v4, s52, v248
    s_add_u32 s52, s52, 1024
    v_subrev_u32 v5, 2560, v4
    v_min_u32 v4, v4, v5
    s_mov_b32 s52, 23166976
    buffer_load_dwordx4 v2, s[36:39], s52 offen offset:0 sc1 lds
    s_mov_b32 s52, 23165952
    buffer_load_dwordx4 v3, s[36:39], s52 offen offset:1024 sc1 lds
    s_mov_b32 exec_hi, 0
    s_mov_b32 s52, 23164928
    buffer_load_dwordx4 v4, s[36:39], s52 offen offset:2048 sc1 lds
    s_mov_b32 exec_hi, -1
    v_and_b32 v165, 1, v1
    v_lshlrev_b32 v165, 6, v165
    v_and_b32 v166, 48, v1
    s_mul_i32 s57, s3, 2560
    s_add_u32 s57, s57, 122880
    v_add3_u32 v165, v165, v166, s57
    s_barrier
    ds_read_b64_tr_b16 a[96:97], v231 offset:0
    ds_read_b64_tr_b16 a[98:99], v231 offset:3072
    ds_read_b64_tr_b16 a[100:101], v232 offset:6144
    ds_read_b64_tr_b16 a[102:103], v232 offset:9216
    ds_read_b64_tr_b16 a[104:105], v233 offset:0
    ds_read_b64_tr_b16 a[106:107], v233 offset:3072
    ds_read_b64_tr_b16 a[108:109], v231 offset:12288
    ds_read_b64_tr_b16 a[110:111], v231 offset:15360
    ds_read_b64_tr_b16 a[112:113], v232 offset:18432
    ds_read_b64_tr_b16 a[114:115], v232 offset:21504
    ds_read_b64_tr_b16 a[116:117], v233 offset:12288
    ds_read_b64_tr_b16 a[118:119], v233 offset:15360
    s_add_u32 m0, s61, 57344
    s_nop 0
    buffer_load_dwordx4 v228, s[40:43], s64 offen offset:0 lds
    buffer_load_dwordx4 v229, s[40:43], s64 offen offset:1024 lds
    buffer_load_dwordx4 v230, s[40:43], s64 offen offset:2048 lds
    s_add_u32 s64, s64, 98304
    s_sub_u32 s35, s64, 1966080
    s_min_u32 s64, s64, s35
    s_add_u32 m0, s61, 69632
    s_nop 0
    buffer_load_dwordx4 v228, s[40:43], s64 offen offset:0 lds
    buffer_load_dwordx4 v229, s[40:43], s64 offen offset:1024 lds
    buffer_load_dwordx4 v230, s[40:43], s64 offen offset:2048 lds
    s_add_u32 s64, s64, 98304
    s_sub_u32 s35, s64, 1966080
    s_min_u32 s64, s64, s35
    s_waitcnt lgkmcnt(0)
    s_barrier
    ds_read_b64_tr_b16 a[120:121], v231 offset:24576
    ds_read_b64_tr_b16 a[122:123], v231 offset:27648
    ds_read_b64_tr_b16 a[124:125], v232 offset:30720
    ds_read_b64_tr_b16 a[126:127], v232 offset:33792
    ds_read_b64_tr_b16 a[128:129], v233 offset:24576
    ds_read_b64_tr_b16 a[130:131], v233 offset:27648
    ds_read_b64_tr_b16 a[132:133], v231 offset:36864
    ds_read_b64_tr_b16 a[134:135], v231 offset:39936
    ds_read_b64_tr_b16 a[136:137], v232 offset:43008
    ds_read_b64_tr_b16 a[138:139], v232 offset:46080
    ds_read_b64_tr_b16 a[140:141], v233 offset:36864
    ds_read_b64_tr_b16 a[142:143], v233 offset:39936
    s_add_u32 m0, s61, 81920
    s_nop 0
    buffer_load_dwordx4 v228, s[40:43], s64 offen offset:0 lds
    buffer_load_dwordx4 v229, s[40:43], s64 offen offset:1024 lds
    buffer_load_dwordx4 v230, s[40:43], s64 offen offset:2048 lds
    s_add_u32 s64, s64, 98304
    s_sub_u32 s35, s64, 1966080
    s_min_u32 s64, s64, s35
    s_add_u32 m0, s61, 94208
    s_nop 0
    buffer_load_dwordx4 v228, s[40:43], s64 offen offset:0 lds
    buffer_load_dwordx4 v229, s[40:43], s64 offen offset:1024 lds
    buffer_load_dwordx4 v230, s[40:43], s64 offen offset:2048 lds
    s_add_u32 s64, s64, 98304
    s_sub_u32 s35, s64, 1966080
    s_min_u32 s64, s64, s35
    s_waitcnt vmcnt(12)
    ds_read_b128 v[64:67], v165 offset:0
    ds_read_b128 v[68:71], v165 offset:128
    ds_read_b128 v[72:75], v165 offset:256
    ds_read_b128 v[76:79], v165 offset:384
    ds_read_b128 v[80:83], v165 offset:512
    ds_read_b128 v[84:87], v165 offset:640
    ds_read_b128 v[88:91], v165 offset:768
    ds_read_b128 v[92:95], v165 offset:896
    s_waitcnt lgkmcnt(7)
    v_mfma_f32_16x16x32_bf16 v[176:179], a[0:3], v[64:67], 0
    v_mfma_f32_16x16x32_bf16 v[180:183], a[4:7], v[64:67], 0
    v_mfma_f32_16x16x32_bf16 v[184:187], a[8:11], v[64:67], 0
    s_waitcnt lgkmcnt(6)
    v_mfma_f32_16x16x32_bf16 v[176:179], a[12:15], v[68:71], v[176:179]
    v_mfma_f32_16x16x32_bf16 v[180:183], a[16:19], v[68:71], v[180:183]
    v_mfma_f32_16x16x32_bf16 v[184:187], a[20:23], v[68:71], v[184:187]
    s_waitcnt lgkmcnt(5)
    v_mfma_f32_16x16x32_bf16 v[176:179], a[24:27], v[72:75], v[176:179]
    v_mfma_f32_16x16x32_bf16 v[180:183], a[28:31], v[72:75], v[180:183]
    v_mfma_f32_16x16x32_bf16 v[184:187], a[32:35], v[72:75], v[184:187]
    s_waitcnt lgkmcnt(4)
    v_mfma_f32_16x16x32_bf16 v[176:179], a[36:39], v[76:79], v[176:179]
    v_mfma_f32_16x16x32_bf16 v[180:183], a[40:43], v[76:79], v[180:183]
    v_mfma_f32_16x16x32_bf16 v[184:187], a[44:47], v[76:79], v[184:187]
    s_waitcnt lgkmcnt(3)
    v_mfma_f32_16x16x32_bf16 v[176:179], a[48:51], v[80:83], v[176:179]
    v_mfma_f32_16x16x32_bf16 v[180:183], a[52:55], v[80:83], v[180:183]
    v_mfma_f32_16x16x32_bf16 v[184:187], a[56:59], v[80:83], v[184:187]
    s_waitcnt lgkmcnt(2)
    v_mfma_f32_16x16x32_bf16 v[176:179], a[60:63], v[84:87], v[176:179]
    v_mfma_f32_16x16x32_bf16 v[180:183], a[64:67], v[84:87], v[180:183]
    v_mfma_f32_16x16x32_bf16 v[184:187], a[68:71], v[84:87], v[184:187]
    s_waitcnt lgkmcnt(1)
    v_mfma_f32_16x16x32_bf16 v[176:179], a[72:75], v[88:91], v[176:179]
    v_mfma_f32_16x16x32_bf16 v[180:183], a[76:79], v[88:91], v[180:183]
    v_mfma_f32_16x16x32_bf16 v[184:187], a[80:83], v[88:91], v[184:187]
    s_waitcnt lgkmcnt(0)
    v_mfma_f32_16x16x32_bf16 v[176:179], a[84:87], v[92:95], v[176:179]
    v_mfma_f32_16x16x32_bf16 v[180:183], a[88:91], v[92:95], v[180:183]
    v_mfma_f32_16x16x32_bf16 v[184:187], a[92:95], v[92:95], v[184:187]
    s_waitcnt vmcnt(6)
    s_barrier
    ds_read_b64_tr_b16 a[144:145], v237 offset:0
    ds_read_b64_tr_b16 a[146:147], v237 offset:3072
    ds_read_b64_tr_b16 a[148:149], v238 offset:6144
    ds_read_b64_tr_b16 a[150:151], v238 offset:9216
    ds_read_b64_tr_b16 a[152:153], v239 offset:0
    ds_read_b64_tr_b16 a[154:155], v239 offset:3072
    ds_read_b64_tr_b16 a[156:157], v237 offset:12288
    ds_read_b64_tr_b16 a[158:159], v237 offset:15360
    ds_read_b64_tr_b16 a[160:161], v238 offset:18432
    ds_read_b64_tr_b16 a[162:163], v238 offset:21504
    ds_read_b64_tr_b16 a[164:165], v239 offset:12288
    ds_read_b64_tr_b16 a[166:167], v239 offset:15360
    s_add_u32 m0, s61, 8192
    s_nop 0
    buffer_load_dwordx4 v228, s[40:43], s64 offen offset:0 lds
    buffer_load_dwordx4 v229, s[40:43], s64 offen offset:1024 lds
    buffer_load_dwordx4 v230, s[40:43], s64 offen offset:2048 lds
    s_add_u32 s64, s64, 98304
    s_sub_u32 s35, s64, 1966080
    s_min_u32 s64, s64, s35
    s_add_u32 m0, s61, 20480
    s_nop 0
    buffer_load_dwordx4 v228, s[40:43], s64 offen offset:0 lds
    buffer_load_dwordx4 v229, s[40:43], s64 offen offset:1024 lds
    buffer_load_dwordx4 v230, s[40:43], s64 offen offset:2048 lds
    s_add_u32 s64, s64, 98304
    s_sub_u32 s35, s64, 1966080
    s_min_u32 s64, s64, s35
    ds_read_b128 v[64:67], v165 offset:1024
    ds_read_b128 v[68:71], v165 offset:1152
    ds_read_b128 v[72:75], v165 offset:1280
    ds_read_b128 v[76:79], v165 offset:1408
    s_waitcnt lgkmcnt(3)
    v_mfma_f32_16x16x32_bf16 v[176:179], a[96:99], v[64:67], v[176:179]
    v_mfma_f32_16x16x32_bf16 v[180:183], a[100:103], v[64:67], v[180:183]
    v_mfma_f32_16x16x32_bf16 v[184:187], a[104:107], v[64:67], v[184:187]
    s_waitcnt lgkmcnt(2)
    v_mfma_f32_16x16x32_bf16 v[176:179], a[108:111], v[68:71], v[176:179]
    v_mfma_f32_16x16x32_bf16 v[180:183], a[112:115], v[68:71], v[180:183]
    v_mfma_f32_16x16x32_bf16 v[184:187], a[116:119], v[68:71], v[184:187]
    s_waitcnt lgkmcnt(1)
    v_mfma_f32_16x16x32_bf16 v[176:179], a[120:123], v[72:75], v[176:179]
    v_mfma_f32_16x16x32_bf16 v[180:183], a[124:127], v[72:75], v[180:183]
    v_mfma_f32_16x16x32_bf16 v[184:187], a[128:131], v[72:75], v[184:187]
    s_waitcnt lgkmcnt(0)
    v_mfma_f32_16x16x32_bf16 v[176:179], a[132:135], v[76:79], v[176:179]
    v_mfma_f32_16x16x32_bf16 v[180:183], a[136:139], v[76:79], v[180:183]
    v_mfma_f32_16x16x32_bf16 v[184:187], a[140:143], v[76:79], v[184:187]
    s_waitcnt vmcnt(6)
    s_barrier
    ds_read_b64_tr_b16 a[168:169], v237 offset:24576
    ds_read_b64_tr_b16 a[170:171], v237 offset:27648
    ds_read_b64_tr_b16 a[172:173], v238 offset:30720
    ds_read_b64_tr_b16 a[174:175], v238 offset:33792
    ds_read_b64_tr_b16 a[176:177], v239 offset:24576
    ds_read_b64_tr_b16 a[178:179], v239 offset:27648
    ds_read_b64_tr_b16 a[180:181], v237 offset:36864
    ds_read_b64_tr_b16 a[182:183], v237 offset:39936
    ds_read_b64_tr_b16 a[184:185], v238 offset:43008
    ds_read_b64_tr_b16 a[186:187], v238 offset:46080
    ds_read_b64_tr_b16 a[188:189], v239 offset:36864
    ds_read_b64_tr_b16 a[190:191], v239 offset:39936
    s_add_u32 m0, s61, 32768
    s_nop 0
    buffer_load_dwordx4 v228, s[40:43], s64 offen offset:0 lds
    buffer_load_dwordx4 v229, s[40:43], s64 offen offset:1024 lds
    buffer_load_dwordx4 v230, s[40:43], s64 offen offset:2048 lds
    s_add_u32 s64, s64, 98304
    s_sub_u32 s35, s64, 1966080
    s_min_u32 s64, s64, s35
    s_add_u32 m0, s61, 45056
    s_nop 0
    buffer_load_dwordx4 v228, s[40:43], s64 offen offset:0 lds
    buffer_load_dwordx4 v229, s[40:43], s64 offen offset:1024 lds
    buffer_load_dwordx4 v230, s[40:43], s64 offen offset:2048 lds
    s_add_u32 s64, s64, 98304
    s_sub_u32 s35, s64, 1966080
    s_min_u32 s64, s64, s35
    ds_read_b128 v[64:67], v165 offset:1536
    ds_read_b128 v[68:71], v165 offset:1664
    s_waitcnt lgkmcnt(1)
    v_mfma_f32_16x16x32_bf16 v[176:179], a[144:147], v[64:67], v[176:179]
    v_mfma_f32_16x16x32_bf16 v[180:183], a[148:151], v[64:67], v[180:183]
    v_mfma_f32_16x16x32_bf16 v[184:187], a[152:155], v[64:67], v[184:187]
    s_waitcnt lgkmcnt(0)
    v_mfma_f32_16x16x32_bf16 v[176:179], a[156:159], v[68:71], v[176:179]
    v_mfma_f32_16x16x32_bf16 v[180:183], a[160:163], v[68:71], v[180:183]
    v_mfma_f32_16x16x32_bf16 v[184:187], a[164:167], v[68:71], v[184:187]
    s_waitcnt vmcnt(6)
    s_barrier
    ds_read_b64_tr_b16 a[192:193], v231 offset:0
    ds_read_b64_tr_b16 a[194:195], v231 offset:3072
    ds_read_b64_tr_b16 a[196:197], v232 offset:6144
    ds_read_b64_tr_b16 a[198:199], v232 offset:9216
    ds_read_b64_tr_b16 a[200:201], v233 offset:0
    ds_read_b64_tr_b16 a[202:203], v233 offset:3072
    ds_read_b64_tr_b16 a[204:205], v231 offset:12288
    ds_read_b64_tr_b16 a[206:207], v231 offset:15360
    ds_read_b64_tr_b16 a[208:209], v232 offset:18432
    ds_read_b64_tr_b16 a[210:211], v232 offset:21504
    ds_read_b64_tr_b16 a[212:213], v233 offset:12288
    ds_read_b64_tr_b16 a[214:215], v233 offset:15360
    ds_read_b128 v[64:67], v165 offset:1792
    ds_read_b128 v[68:71], v165 offset:1920
    s_waitcnt lgkmcnt(1)
    v_mfma_f32_16x16x32_bf16 v[176:179], a[168:171], v[64:67], v[176:179]
    v_mfma_f32_16x16x32_bf16 v[180:183], a[172:175], v[64:67], v[180:183]
    v_mfma_f32_16x16x32_bf16 v[184:187], a[176:179], v[64:67], v[184:187]
    s_waitcnt lgkmcnt(0)
    v_mfma_f32_16x16x32_bf16 v[176:179], a[180:183], v[68:71], v[176:179]
    v_mfma_f32_16x16x32_bf16 v[180:183], a[184:187], v[68:71], v[180:183]
    v_mfma_f32_16x16x32_bf16 v[184:187], a[188:191], v[68:71], v[184:187]
    s_waitcnt vmcnt(0)
    s_barrier
    ds_read_b64_tr_b16 a[216:217], v231 offset:24576
    ds_read_b64_tr_b16 a[218:219], v231 offset:27648
    ds_read_b64_tr_b16 a[220:221], v232 offset:30720
    ds_read_b64_tr_b16 a[222:223], v232 offset:33792
    ds_read_b64_tr_b16 a[224:225], v233 offset:24576
    ds_read_b64_tr_b16 a[226:227], v233 offset:27648
    ds_read_b64_tr_b16 a[228:229], v231 offset:36864
    ds_read_b64_tr_b16 a[230:231], v231 offset:39936
    ds_read_b64_tr_b16 a[232:233], v232 offset:43008
    ds_read_b64_tr_b16 a[234:235], v232 offset:46080
    ds_read_b64_tr_b16 a[236:237], v233 offset:36864
    ds_read_b64_tr_b16 a[238:239], v233 offset:39936
    ds_read_b128 v[64:67], v165 offset:2048
    ds_read_b128 v[68:71], v165 offset:2176
    s_waitcnt lgkmcnt(1)
    v_mfma_f32_16x16x32_bf16 v[176:179], a[192:195], v[64:67], v[176:179]
    v_mfma_f32_16x16x32_bf16 v[180:183], a[196:199], v[64:67], v[180:183]
    v_mfma_f32_16x16x32_bf16 v[184:187], a[200:203], v[64:67], v[184:187]
    s_waitcnt lgkmcnt(0)
    v_mfma_f32_16x16x32_bf16 v[176:179], a[204:207], v[68:71], v[176:179]
    v_mfma_f32_16x16x32_bf16 v[180:183], a[208:211], v[68:71], v[180:183]
    v_mfma_f32_16x16x32_bf16 v[184:187], a[212:215], v[68:71], v[184:187]
    ds_read_b128 v[64:67], v165 offset:2304
    ds_read_b128 v[68:71], v165 offset:2432
    s_waitcnt lgkmcnt(1)
    v_mfma_f32_16x16x32_bf16 v[176:179], a[216:219], v[64:67], v[176:179]
    v_mfma_f32_16x16x32_bf16 v[180:183], a[220:223], v[64:67], v[180:183]
    v_mfma_f32_16x16x32_bf16 v[184:187], a[224:227], v[64:67], v[184:187]
    s_waitcnt lgkmcnt(0)
    v_mfma_f32_16x16x32_bf16 v[176:179], a[228:231], v[68:71], v[176:179]
    v_mfma_f32_16x16x32_bf16 v[180:183], a[232:235], v[68:71], v[180:183]
    v_mfma_f32_16x16x32_bf16 v[184:187], a[236:239], v[68:71], v[184:187]
    v_and_b32 v90, 1, v1
    v_mul_u32_u24 v90, 192, v90
    v_and_b32 v91, 48, v1
    v_add_u32 v90, v90, v91
    s_mov_b32 exec_lo, 0x00030003
    s_mov_b32 exec_hi, 0x00030003
    buffer_store_dwordx4 v[176:179], v90, s[36:39], s9 offen offset:0 sc1
    buffer_store_dwordx4 v[180:183], v90, s[36:39], s9 offen offset:64 sc1
    buffer_store_dwordx4 v[184:187], v90, s[36:39], s9 offen offset:128 sc1
    s_mov_b64 exec, -1
    s_waitcnt lgkmcnt(0)
    s_barrier
L_poll28:
    buffer_load_dword v223, v219, s[36:39], s17 offen sc1
    s_waitcnt vmcnt(0)
    v_cmp_ne_u32 vcc, s48, v223
    s_cbranch_vccz L_poll28_ok
    s_cmp_eq_u32 s49, 0
    s_cbranch_scc1 L_poll28_ok
    s_sub_u32 s49, s49, 1
    s_sleep 1
    s_branch L_poll28
L_poll28_ok:
    s_barrier
    s_cmp_eq_u32 s3, 0
    s_cbranch_scc0 L_wf29
    s_lshl_b32 s54, s73, 7
    s_add_u32 s54, s54, 23353344
    v_mov_b32 v254, 0
    v_mov_b32 v255, s48
    s_mov_b64 exec, 1
    buffer_store_dword v255, v254, s[36:39], s54 offen sc1
    s_mov_b64 exec, -1
L_wf29:
    s_branch L_prepE
L_id_slow:
    v_or_b32 v242, 15, v242
    s_or_b32 s50, s48, 15
    v_cmp_ne_u32 vcc, s50, v242
    buffer_load_dword v242, v234, s[36:39], s17 offen sc1
    s_waitcnt vmcnt(0)
    s_cbranch_vccz L_id_all
    s_cmp_eq_u32 s49, 0
    s_cbranch_scc1 L_id_all
    s_sub_u32 s49, s49, 1
    s_branch L_id_slow
L_id_all:
    v_cmp_ne_u32 vcc, s30, v242
    s_cmp_eq_u64 vcc, 0
    s_cselect_b32 s30, 1, 0
    s_branch L_id_back
L_kv_far:
    buffer_store_dwordx4 v[96:99], v247, s[36:39], 0 offen offset:128 sc1
    buffer_store_dwordx4 v[100:103], v247, s[36:39], 0 offen offset:0 sc1
    buffer_store_dwordx4 v[104:107], v247, s[36:39], s16 offen offset:128 sc1
    buffer_store_dwordx4 v[108:111], v247, s[36:39], s16 offen offset:0 sc1
    s_waitcnt vmcnt(0)
    s_branch L_kv_back
L_lf2_far:
    s_lshl_b32 s54, s70, 7
    s_add_u32 s54, s54, 23232512
    v_mov_b32 v254, 0
    v_mov_b32 v255, s48
    s_mov_b64 exec, 1
    buffer_store_dword v255, v254, s[36:39], s54 offen sc1
    s_mov_b64 exec, -1
    s_branch L_lf2
L_q_far:
    buffer_store_dwordx4 v[112:115], v245, s[36:39], s55 offen offset:0 sc1
    buffer_store_dwordx4 v[116:119], v245, s[36:39], s55 offen offset:128 sc1
    buffer_store_dwordx4 v[120:123], v245, s[36:39], s56 offen offset:0 sc1
    buffer_store_dwordx4 v[124:127], v245, s[36:39], s56 offen offset:128 sc1
    s_waitcnt vmcnt(0)
    s_branch L_q_back
L_m_slow:
    buffer_load_dwordx2 v[242:243], v239, s[36:39], s69 offen sc1
    s_waitcnt vmcnt(0)
    v_cmp_ne_u32 vcc, s48, v243
    s_cbranch_vccz L_m_back
    s_cmp_eq_u32 s49, 0
    s_cbranch_scc1 L_m_back
    s_sub_u32 s49, s49, 1
    s_branch L_m_slow
L_lf4_far:
    s_lshl_b32 s54, s70, 7
    s_add_u32 s54, s54, 23252992
    v_mov_b32 v254, 0
    v_mov_b32 v255, s48
    s_mov_b64 exec, 1
    buffer_store_dword v255, v254, s[36:39], s54 offen sc1
    s_mov_b64 exec, -1
    s_branch L_lf4
L_st0_slow:
    buffer_load_dwordx4 v[200:203], v175, s[36:39], s6 offen offset:0 sc1
    buffer_load_dwordx4 v[204:207], v175, s[36:39], s6 offen offset:256 sc1
    buffer_load_dwordx4 v[208:211], v175, s[36:39], s6 offen offset:512 sc1
    buffer_load_dwordx4 v[212:215], v175, s[36:39], s6 offen offset:768 sc1
    s_waitcnt vmcnt(3)
    v_xor_b32 v3, s48, v201
    v_bitop3_b32 v3, v203, s48, v3 bitop3:0xbe
    s_waitcnt vmcnt(2)
    v_bitop3_b32 v3, v205, s48, v3 bitop3:0xbe
    v_bitop3_b32 v3, v207, s48, v3 bitop3:0xbe
    s_waitcnt vmcnt(1)
    v_bitop3_b32 v3, v209, s48, v3 bitop3:0xbe
    v_bitop3_b32 v3, v211, s48, v3 bitop3:0xbe
    s_waitcnt vmcnt(0)
    v_bitop3_b32 v3, v213, s48, v3 bitop3:0xbe
    v_bitop3_b32 v3, v215, s48, v3 bitop3:0xbe
    v_cmp_ne_u32 vcc, 0, v3
    s_cbranch_vccz L_st0_back
    s_cmp_eq_u32 s49, 0
    s_cbranch_scc1 L_st0_back
    s_sub_u32 s49, s49, 1
    s_branch L_st0_slow
L_st1_slow:
    buffer_load_dwordx4 v[200:203], v175, s[36:39], s6 offen offset:0 sc1
    buffer_load_dwordx4 v[204:207], v175, s[36:39], s6 offen offset:256 sc1
    buffer_load_dwordx4 v[208:211], v175, s[36:39], s6 offen offset:512 sc1
    buffer_load_dwordx4 v[212:215], v175, s[36:39], s6 offen offset:768 sc1
    s_waitcnt vmcnt(3)
    v_xor_b32 v3, s48, v201
    v_bitop3_b32 v3, v203, s48, v3 bitop3:0xbe
    s_waitcnt vmcnt(2)
    v_bitop3_b32 v3, v205, s48, v3 bitop3:0xbe
    v_bitop3_b32 v3, v207, s48, v3 bitop3:0xbe
    s_waitcnt vmcnt(1)
    v_bitop3_b32 v3, v209, s48, v3 bitop3:0xbe
    v_bitop3_b32 v3, v211, s48, v3 bitop3:0xbe
    s_waitcnt vmcnt(0)
    v_bitop3_b32 v3, v213, s48, v3 bitop3:0xbe
    v_bitop3_b32 v3, v215, s48, v3 bitop3:0xbe
    v_cmp_ne_u32 vcc, 0, v3
    s_cbranch_vccz L_st1_back
    s_cmp_eq_u32 s49, 0
    s_cbranch_scc1 L_st1_back
    s_sub_u32 s49, s49, 1
    s_branch L_st1_slow
L_chk5_slow:
L_poll30:
    buffer_load_dword v240, v238, s[36:39], s17 offen sc1
    s_waitcnt vmcnt(0)
    v_cmp_ne_u32 vcc, s48, v240
    s_cbranch_vccz L_poll30_ok
    s_cmp_eq_u32 s49, 0
    s_cbranch_scc1 L_poll30_ok
    s_sub_u32 s49, s49, 1
    s_sleep 1
    s_branch L_poll30
L_poll30_ok:
    s_branch L_chk5_back
L_chk7_slow:
L_poll31:
    buffer_load_dword v240, v238, s[36:39], s17 offen sc1
    s_waitcnt vmcnt(0)
    v_cmp_ne_u32 vcc, s48, v240
    s_cbranch_vccz L_poll31_ok
    s_cmp_eq_u32 s49, 0
    s_cbranch_scc1 L_poll31_ok
    s_sub_u32 s49, s49, 1
    s_sleep 1
    s_branch L_poll31
L_poll31_ok:
    s_branch L_chk7_back
L_chk8_slow:
L_poll32:
    buffer_load_dword v223, v219, s[36:39], s17 offen sc1
    s_waitcnt vmcnt(0)
    v_cmp_ne_u32 vcc, s48, v223
    s_cbranch_vccz L_poll32_ok
    s_cmp_eq_u32 s49, 0
    s_cbranch_scc1 L_poll32_ok
    s_sub_u32 s49, s49, 1
    s_sleep 1
    s_branch L_poll32
L_poll32_ok:
    s_branch L_chk8_back
L_chk10_slow:
L_poll33:
    buffer_load_dword v244, v243, s[36:39], s58 offen sc1
    s_waitcnt vmcnt(0)
    v_cmp_ne_u32 vcc, s48, v244
    s_cbranch_vccz L_poll33_ok
    s_cmp_eq_u32 s49, 0
    s_cbranch_scc1 L_poll33_ok
    s_sub_u32 s49, s49, 1
    s_sleep 1
    s_branch L_poll33
L_poll33_ok:
    s_branch L_chk10_back
L_chk11_slow:
L_poll34:
    buffer_load_dword v240, v219, s[36:39], s17 offen sc1
    s_waitcnt vmcnt(0)
    v_cmp_ne_u32 vcc, s48, v240
    s_cbranch_vccz L_poll34_ok
    s_cmp_eq_u32 s49, 0
    s_cbranch_scc1 L_poll34_ok
    s_sub_u32 s49, s49, 1
    s_sleep 1
    s_branch L_poll34
L_poll34_ok:
    s_branch L_chk11_back
L_chk12_slow:
L_poll35:
    buffer_load_dword v241, v242, s[36:39], s56 offen sc1
    s_waitcnt vmcnt(0)
    v_cmp_ne_u32 vcc, s48, v241
    s_cbranch_vccz L_poll35_ok
    s_cmp_eq_u32 s49, 0
    s_cbranch_scc1 L_poll35_ok
    s_sub_u32 s49, s49, 1
    s_sleep 1
    s_branch L_poll35
L_poll35_ok:
    s_branch L_chk12_back
L_chk20_slow:
L_poll36:
    buffer_load_dword v244, v243, s[36:39], s58 offen sc1
    s_waitcnt vmcnt(0)
    v_cmp_ne_u32 vcc, s48, v244
    s_cbranch_vccz L_poll36_ok
    s_cmp_eq_u32 s49, 0
    s_cbranch_scc1 L_poll36_ok
    s_sub_u32 s49, s49, 1
    s_sleep 1
    s_branch L_poll36
L_poll36_ok:
    s_branch L_chk20_back
L_chk21_slow:
L_poll37:
    buffer_load_dword v240, v219, s[36:39], s17 offen sc1
    s_waitcnt vmcnt(0)
    v_cmp_ne_u32 vcc, s48, v240
    s_cbranch_vccz L_poll37_ok
    s_cmp_eq_u32 s49, 0
    s_cbranch_scc1 L_poll37_ok
    s_sub_u32 s49, s49, 1
    s_sleep 1
    s_branch L_poll37
L_poll37_ok:
    s_branch L_chk21_back
L_chk22_slow:
L_poll38:
    buffer_load_dword v241, v242, s[36:39], s56 offen sc1
    s_waitcnt vmcnt(0)
    v_cmp_ne_u32 vcc, s48, v241
    s_cbranch_vccz L_poll38_ok
    s_cmp_eq_u32 s49, 0
    s_cbranch_scc1 L_poll38_ok
    s_sub_u32 s49, s49, 1
    s_sleep 1
    s_branch L_poll38
L_poll38_ok:
    s_branch L_chk22_back
L_chk24_slow:
L_poll39:
    buffer_load_dword v244, v246, s[36:39], s17 offen sc1
    s_waitcnt vmcnt(0)
    v_cmp_ne_u32 vcc, s48, v244
    s_cbranch_vccz L_poll39_ok
    s_cmp_eq_u32 s49, 0
    s_cbranch_scc1 L_poll39_ok
    s_sub_u32 s49, s49, 1
    s_sleep 1
    s_branch L_poll39
L_poll39_ok:
    s_branch L_chk24_back
L_chk26_slow:
L_poll40:
    buffer_load_dword v247, v246, s[36:39], s17 offen sc1
    s_waitcnt vmcnt(0)
    v_cmp_ne_u32 vcc, s48, v247
    s_cbranch_vccz L_poll40_ok
    s_cmp_eq_u32 s49, 0
    s_cbranch_scc1 L_poll40_ok
    s_sub_u32 s49, s49, 1
    s_sleep 1
    s_branch L_poll40
L_poll40_ok:
    s_branch L_chk26_back
L_code_end:
.section .rodata,"a"
.p2align 6
.amdhsa_kernel adaLN_cond__ssm_conv_h3__glu_gated_bilinear__prompt_kernel
  .amdhsa_next_free_vgpr 512
  .amdhsa_next_free_sgpr 102
  .amdhsa_accum_offset 256
  .amdhsa_group_segment_fixed_size 0
  .amdhsa_kernarg_size 120
  .amdhsa_user_sgpr_count 2
  .amdhsa_user_sgpr_kernarg_segment_ptr 1
  .amdhsa_system_sgpr_workgroup_id_x 1
.end_amdhsa_kernel
```

```asm
; @launch grid=(256,1,1) block=(256,1,1) lds=163840
.amdgcn_target "amdgcn-amd-amdhsa--gfx950"
.text
.globl adaLN_cond__ssm_conv_h3__glu_gated_bilinear__prompt_kernel
.p2align 8
.type adaLN_cond__ssm_conv_h3__glu_gated_bilinear__prompt_kernel,@function
adaLN_cond__ssm_conv_h3__glu_gated_bilinear__prompt_kernel:
    s_cmp_ge_u32 s2, 256
    s_cbranch_scc1 L_end
    s_load_dwordx16 s[4:19], s[0:1], 0
    s_load_dwordx8 s[20:27], s[0:1], 64
    s_load_dwordx4 s[28:31], s[0:1], 96
    s_load_dwordx2 s[32:33], s[0:1], 112
    v_lshrrev_b32 v1, 6, v0
    s_nop 0
    v_readfirstlane_b32 s3, v1
    v_and_b32 v1, 63, v0
    s_sub_u32 s50, s2, 224
    s_cbranch_scc1 L_nopf
    s_getpc_b64 s[36:37]
L_nopf_pc:
    s_sub_u32 s36, s36, L_nopf_pc-adaLN_cond__ssm_conv_h3__glu_gated_bilinear__prompt_kernel
    s_subb_u32 s37, s37, 0
    s_mov_b32 s38, L_code_end-adaLN_cond__ssm_conv_h3__glu_gated_bilinear__prompt_kernel
    s_mov_b32 s39, 0x20000
    v_lshlrev_b32 v2, 6, v0
    s_lshr_b32 s50, s50, 3
    s_lshl_b32 s50, s50, 14
    buffer_load_dword v243, v2, s[36:39], s50 offen
L_nopf:
    s_mov_b32 s49, 400000
    s_mov_b32 s57, 23461888
    s_and_b32 s50, s2, 7
    s_lshr_b32 s51, s2, 3
    s_lshr_b32 s52, s50, 2
    s_lshl_b32 s52, s52, 3
    s_lshr_b32 s53, s51, 2
    s_add_u32 s72, s52, s53
    s_and_b32 s52, s50, 3
    s_lshl_b32 s52, s52, 2
    s_and_b32 s53, s51, 3
    s_add_u32 s73, s52, s53
    s_and_b32 s75, s51, 7
    s_lshr_b32 s53, s51, 3
    s_lshl_b32 s52, s50, 2
    s_add_u32 s74, s52, s53
    s_lshl_b32 s52, s50, 5
    s_add_u32 s52, s52, s51
    s_lshl_b32 s53, s50, 4
    s_add_u32 s53, s53, s51
    s_add_u32 s53, s53, 32
    s_cmp_lt_u32 s50, 2
    s_cselect_b32 s70, s52, s53
    s_cselect_b32 s35, 0, s51
    s_lshr_b32 s53, s51, 2
    s_mul_i32 s54, s53, 5
    s_lshr_b32 s54, s54, 1
    s_mov_b32 s52, 0
    s_mul_i32 s55, s53, 0
    s_add_u32 s55, s55, 0
    s_cmp_lt_u32 s53, 4
    s_cselect_b32 s52, s55, s52
    s_cmp_lt_u32 s50, 2
    s_cselect_b32 s34, s54, s52
    s_mul_i32 s71, s51, 6
    s_add_u32 s71, s71, s50
    s_sub_u32 s71, s71, 98
    v_lshlrev_b32 v248, 4, v1
    s_lshr_b32 s50, s70, 4
    s_and_b32 s51, s70, 15
    s_mul_i32 s52, s51, 163840
    s_lshl_b32 s53, s50, 7
    s_add_u32 s52, s52, s53
    s_mul_i32 s53, s3, 40960
    s_add_u32 s53, s53, s52
    s_mul_i32 s54, s3, 4352
    s_mov_b32 s42, 2621440
    s_mov_b32 s43, 0x20000
    s_mov_b32 s46, 2621440
    s_mov_b32 s47, 0x20000
    v_lshrrev_b32 v2, 3, v1
    v_and_b32 v4, 3, v2
    v_xor_b32 v4, v4, v1
    v_and_b32 v4, 7, v4
    v_mul_u32_u24 v2, 1280, v2
    v_lshl_add_u32 v3, v4, 4, v2
    s_waitcnt lgkmcnt(0)
    v_mov_b32 v255, s57
    global_load_dword v255, v255, s[32:33] sc1
    s_cmp_ge_u32 s35, 16
    s_cbranch_scc1 L_prep
    s_mov_b32 s40, s6
    s_mov_b32 s41, s7
    s_mov_b32 s44, s8
    s_mov_b32 s45, s9
    s_cmp_eq_u32 s3, 0
    s_cbranch_scc0 L_nohalo
    s_sub_u32 s55, s52, 10240
    v_add_u32 v5, s55, v3
    s_mov_b32 m0, 84992
    s_nop 0
    buffer_load_dwordx4 v5, s[40:43], 0 offen nt lds
L_nohalo:
    s_mov_b32 s55, s53
    s_add_u32 m0, s54, 86080
    s_nop 0
    buffer_load_dwordx4 v3, s[40:43], s55 offen nt lds
    s_add_u32 s55, s55, 10240
    s_add_u32 m0, s54, 87168
    s_nop 0
    buffer_load_dwordx4 v3, s[40:43], s55 offen nt lds
    s_add_u32 s55, s55, 10240
    s_add_u32 m0, s54, 88256
    s_nop 0
    buffer_load_dwordx4 v3, s[40:43], s55 offen nt lds
    s_add_u32 s55, s55, 10240
    s_add_u32 m0, s54, 89344
    s_nop 0
    buffer_load_dwordx4 v3, s[40:43], s55 offen nt lds
    s_mov_b32 s55, s53
    s_add_u32 m0, s54, 103488
    s_nop 0
    buffer_load_dwordx4 v3, s[44:47], s55 offen nt lds
    s_add_u32 s55, s55, 10240
    s_add_u32 m0, s54, 104576
    s_nop 0
    buffer_load_dwordx4 v3, s[44:47], s55 offen nt lds
    s_add_u32 s55, s55, 10240
    s_add_u32 m0, s54, 105664
    s_nop 0
    buffer_load_dwordx4 v3, s[44:47], s55 offen nt lds
    s_add_u32 s55, s55, 10240
    s_add_u32 m0, s54, 106752
    s_nop 0
    buffer_load_dwordx4 v3, s[44:47], s55 offen nt lds
    s_mov_b32 s36, s32
    s_mov_b32 s37, s33
    s_mov_b32 s38, 0x10000000
    s_mov_b32 s39, 0x20000
    s_lshr_b32 s50, s70, 4
    s_lshl_b32 s50, s50, 6
    s_lshl_b32 s55, s3, 4
    s_add_u32 s50, s50, s55
    v_and_b32 v4, 7, v1
    v_add_u32 v4, s50, v4
    v_lshlrev_b32 v5, 3, v4
    global_load_dwordx2 v[48:49], v5, s[10:11]
    global_load_dwordx2 v[50:51], v5, s[10:11] offset:64
    s_and_b32 s51, s70, 15
    s_lshl_b32 s51, s51, 8
    v_mul_u32_u24 v4, 4096, v4
    v_lshrrev_b32 v5, 3, v1
    v_lshl_add_u32 v5, v5, 4, s51
    v_add_u32 v245, v4, v5
    v_sub_u32 v5, 3952, v5
    v_add_u32 v247, v4, v5
    v_bfe_u32 v4, v1, 2, 2
    s_lshl_b32 s55, s3, 1
    v_xor_b32 v5, s55, v4
    v_lshlrev_b32 v4, 7, v4
    v_lshl_add_u32 v4, v5, 4, v4
    v_and_b32 v5, 1, v1
    v_lshl_add_u32 v4, v5, 3, v4
    v_lshrrev_b32 v5, 4, v1
    v_bfe_u32 v244, v1, 1, 1
    v_lshl_add_u32 v5, v5, 1, v244
    v_mul_u32_u24 v5, 1088, v5
    v_add_u32 v244, v4, v5
    v_add_u32 v244, 84992, v244
    v_xor_b32 v246, 16, v244
    s_mov_b32 s16, 32768
    s_lshl_b32 s58, s70, 2
    s_add_u32 s58, s58, s3
    s_lshl_b32 s59, s58, 1
    v_mov_b32 v250, 0
    v_mov_b32 v251, s59
    global_load_short_d16_hi v250, v251, s[14:15]
    s_waitcnt vmcnt(11)
    v_readfirstlane_b32 s48, v255
    s_nop 3
    s_mul_i32 s48, s48, 0x9E3779B1
    s_add_u32 s48, s48, 0x7F4A7C15
    s_and_b32 s48, s48, -16
    s_getreg_b32 s30, hwreg(HW_REG_XCC_ID, 0, 4)
    s_or_b32 s30, s30, s48
    s_cmp_eq_u32 s3, 1
    s_cbranch_scc0 L_id1
    s_lshl_b32 s50, s2, 7
    s_add_u32 s50, s50, 23199744
    v_mov_b32 v254, 0
    v_mov_b32 v255, s30
    s_mov_b64 exec, 1
    buffer_store_dword v255, v254, s[36:39], s50 offen sc1
    s_mov_b64 exec, -1
L_id1:
    s_lshl_b32 s58, s70, 2
    s_add_u32 s58, s58, s3
    s_lshl_b32 s50, s58, 12
    s_mul_i32 s51, s3, 16640
    s_add_u32 m0, s51, 32
    s_mov_b32 s40, s12
    s_mov_b32 s41, s13
    s_mov_b32 s42, 0x280000
    s_mov_b32 s43, 0x20000
    buffer_load_dwordx4 v248, s[40:43], s50 offen offset:0 nt lds
    buffer_load_dwordx4 v248, s[40:43], s50 offen offset:1024 nt lds
    buffer_load_dwordx4 v248, s[40:43], s50 offen offset:2048 nt lds
    buffer_load_dwordx4 v248, s[40:43], s50 offen offset:3072 nt lds
    s_mov_b32 s44, s4
    s_mov_b32 s45, s5
    s_mov_b32 s46, 0x280000
    s_mov_b32 s47, 0x20000
    v_mov_b32 v241, v3
    s_mov_b32 s14, s53
    s_mov_b32 s15, s54
    s_mul_i32 s50, s58, 4096
    v_lshlrev_b32 v2, 7, v1
    v_add_u32 v2, s50, v2
    s_lshr_b32 s50, s70, 4
    s_lshl_b32 s50, s50, 11
    s_add_u32 s51, s50, 23232512
    s_cmp_eq_u32 s3, 2
    s_cselect_b32 s51, s51, 268435456
    s_add_u32 s52, s50, 23252992
    s_cmp_eq_u32 s3, 1
    s_cselect_b32 s51, s52, s51
    s_add_u32 s52, s50, 23425024
    s_cmp_eq_u32 s3, 3
    s_cselect_b32 s50, s52, s51
    v_and_b32 v3, 15, v1
    v_lshl_add_u32 v3, v3, 7, s50
    v_cmp_lt_u32 vcc, 31, v1
    s_nop 1
    v_cndmask_b32 v2, v2, v3, vcc
    buffer_load_dword v235, v2, s[36:39], 0 offen sc1
    s_mul_i32 s51, s3, 16640
    s_add_u32 s51, s51, 0
    v_add_u32 v230, s51, v248
    v_lshrrev_b32 v2, 1, v1
    v_mul_u32_u24 v2, 4160, v2
    v_and_b32 v4, 1, v1
    v_lshl_add_u32 v2, v4, 4, v2
    v_add_u32 v2, s51, v2
    v_mov_b32 v4, 0
    v_mov_b32 v5, 0
    v_mov_b32 v6, 0
    v_mov_b32 v7, 0
    s_mov_b64 exec, 0xff
    ds_write_b128 v2, v[4:7]
    s_mul_i32 s52, s3, 4608
    s_add_u32 s52, s52, 70656
    s_mov_b64 exec, 0x3fffffff
    v_add_u32 v2, s52, v248
    ds_write_b128 v2, v[4:7]
    s_mov_b64 exec, -1
    v_and_b32 v2, 15, v1
    v_lshrrev_b32 v3, 4, v1
    v_add_u32 v231, 1, v2
    v_and_b32 v232, 3, v231
    v_sub_u32 v231, v231, v232
    v_add_u32 v231, 24, v231
    v_lshlrev_b32 v231, 1, v231
    v_mul_u32_u24 v232, 4160, v232
    v_add_u32 v231, v231, v232
    v_lshlrev_b32 v232, 4, v3
    v_sub_u32 v231, v231, v232
    s_mul_i32 s51, s3, 16640
    s_add_u32 s51, s51, 0
    v_add_u32 v231, s51, v231
    v_lshlrev_b32 v2, 5, v2
    v_add_u32 v2, v2, v232
    s_mul_i32 s52, s3, 4608
    s_add_u32 s52, s52, 67088
    v_sub_u32 v232, s52, v2
    s_mov_b32 s17, 23199744
    v_and_b32 v6, 15, v1
    v_lshrrev_b32 v7, 4, v1
    v_lshlrev_b32 v6, 4, v6
    v_lshl_add_u32 v6, v7, 2, v6
    v_lshlrev_b32 v7, 2, v6
    v_add_u32 v7, 84992, v7
    v_lshlrev_b32 v6, 1, v6
    s_lshl_b32 s66, s3, 10
    s_add_u32 s67, s66, 23068672
    s_lshl_b32 s62, s3, 11
    s_add_u32 s50, s62, 93184
    v_add_u32 v249, s50, v6
    v_bfe_u32 v2, v1, 4, 1
    v_mul_u32_u24 v2, 504, v2
    v_add_u32 v6, v6, v2
    s_mul_i32 s65, s58, 4096
    s_add_u32 s65, s65, 2883584
    s_mul_i32 s68, s58, 4224
    s_add_u32 s68, s68, 8650752
    v_and_b32 v238, 7, v1
    v_lshlrev_b32 v238, 7, v238
    s_lshr_b32 s52, s70, 4
    s_lshl_b32 s52, s52, 11
    s_add_u32 s51, s52, 53248
    s_add_u32 s50, s66, 94208
    v_mov_b32 v2, s51
    v_mov_b32 v3, s50
    v_cmp_lt_u32 vcc, 7, v1
    s_nop 1
    v_cndmask_b32 v2, v3, v2, vcc
    v_add_u32 v238, v238, v2
    v_min_u32 v233, 15, v1
    v_lshlrev_b32 v234, 10, v233
    s_and_b32 s51, s2, 135
    s_lshl_b32 s51, s51, 7
    v_add_u32 v234, s51, v234
    v_lshl_add_u32 v233, v233, 7, s52
    v_add_u32 v233, 32768, v233
    v_min_u32 v239, 3, v1
    v_lshlrev_b32 v2, 2, v239
    v_mov_b32 v239, 0x4201
    v_lshrrev_b32 v239, v2, v239
    v_and_b32 v239, 7, v239
    v_mul_u32_u24 v239, 5120, v239
    s_lshl_b32 s69, s58, 3
    s_add_u32 s69, s69, 23560192
    s_and_b32 s50, s3, 1
    s_mul_i32 s50, s50, 49152
    s_mul_i32 s64, s73, 192
    s_add_u32 s64, s64, s50
    s_mul_i32 s50, s34, 98304
    s_add_u32 s64, s64, s50
    s_cmp_ge_u32 s3, 2
    s_cselect_b32 s40, s20, s18
    s_cselect_b32 s41, s21, s19
    s_cselect_b32 s50, 1, 0
    s_mov_b32 s42, 1966080
    s_mov_b32 s43, 0x20000
    s_mul_i32 s61, s3, 3072
    v_add_u32 v2, 0, v1
    v_mul_u32_u24 v3, 171, v2
    v_lshrrev_b32 v3, 11, v3
    v_mul_u32_u24 v4, 12, v3
    v_sub_u32 v4, v2, v4
    v_bfe_u32 v2, v3, 2, 1
    v_lshl_add_u32 v2, v2, 1, s50
    v_xor_b32 v4, v4, v2
    v_mul_u32_u24 v3, 3072, v3
    v_lshl_add_u32 v224, v4, 4, v3
    v_add_u32 v2, 64, v1
    v_mul_u32_u24 v3, 171, v2
    v_lshrrev_b32 v3, 11, v3
    v_mul_u32_u24 v4, 12, v3
    v_sub_u32 v4, v2, v4
    v_bfe_u32 v2, v3, 2, 1
    v_lshl_add_u32 v2, v2, 1, s50
    v_xor_b32 v4, v4, v2
    v_mul_u32_u24 v3, 3072, v3
    v_lshl_add_u32 v225, v4, 4, v3
    v_subrev_u32 v225, 1024, v225
    v_add_u32 v2, 128, v1
    v_mul_u32_u24 v3, 171, v2
    v_lshrrev_b32 v3, 11, v3
    v_mul_u32_u24 v4, 12, v3
    v_sub_u32 v4, v2, v4
    v_bfe_u32 v2, v3, 2, 1
    v_lshl_add_u32 v2, v2, 1, s50
    v_xor_b32 v4, v4, v2
    v_mul_u32_u24 v3, 3072, v3
    v_lshl_add_u32 v226, v4, 4, v3
    v_subrev_u32 v226, 2048, v226
    v_lshrrev_b32 v2, 2, v1
    v_mul_u32_u24 v2, 192, v2
    v_and_b32 v3, 1, v1
    v_lshl_add_u32 v2, v3, 3, v2
    s_mul_i32 s50, s3, 3
    v_bfe_u32 v3, v1, 4, 1
    v_lshlrev_b32 v3, 1, v3
    v_bfe_u32 v4, v1, 1, 1
    v_add_u32 v227, s50, v4
    v_xor_b32 v227, v227, v3
    v_lshl_add_u32 v227, v227, 4, v2
    v_xor_b32 v228, 16, v227
    s_add_u32 s50, s50, 2
    v_xor_b32 v3, v3, v4
    v_xor_b32 v3, s50, v3
    v_lshl_add_u32 v3, v3, 4, v2
    v_mul_u32_u24 v4, 6144, v4
    v_add_u32 v229, v3, v4
    v_add_u32 v227, 102400, v227
    v_add_u32 v228, 102400, v228
    v_add_u32 v229, 102400, v229
    v_lshrrev_b32 v2, 3, v1
    v_bfe_u32 v3, v1, 4, 2
    v_lshlrev_b32 v3, 1, v3
    v_xor_b32 v3, v3, v1
    v_and_b32 v3, 7, v3
    v_mul_u32_u24 v2, 4224, v2
    v_lshl_add_u32 v172, v3, 4, v2
    v_add_u32 v172, 8650752, v172
    v_lshrrev_b32 v2, 2, v1
    v_lshlrev_b32 v2, 7, v2
    v_and_b32 v3, 3, v1
    v_lshl_add_u32 v2, v3, 3, v2
    v_bfe_u32 v3, v1, 3, 2
    v_xor_b32 v168, 0, v3
    v_lshl_add_u32 v168, v168, 5, v2
    v_xor_b32 v169, 1, v3
    v_lshl_add_u32 v169, v169, 5, v2
    v_xor_b32 v170, 2, v3
    v_lshl_add_u32 v170, v170, 5, v2
    v_xor_b32 v171, 3, v3
    v_lshl_add_u32 v171, v171, 5, v2
    v_and_b32 v175, 15, v1
    v_lshlrev_b32 v175, 4, v175
    v_bfe_u32 v2, v1, 4, 1
    v_lshrrev_b32 v3, 5, v1
    v_mul_u32_u24 v173, 51456, v2
    v_lshl_add_u32 v173, v3, 8, v173
    v_add_u32 v173, v173, v175
    v_lshl_add_u32 v2, v2, 1, v3
    v_mul_u32_u24 v174, 51456, v2
    v_add_u32 v174, v174, v175
    v_bfe_u32 v2, v0, 1, 2
    v_lshlrev_b32 v2, 1, v2
    s_lshr_b32 s50, s73, 1
    v_xor_b32 v2, s50, v2
    v_lshlrev_b32 v2, 4, v2
    v_lshl_add_u32 v216, v0, 7, v2
    s_and_b32 s50, s73, 1
    s_lshl_b32 s50, s50, 3
    v_add_u32 v216, s50, v216
    v_add_u32 v217, 0x8000, v216
    v_add_u32 v218, 0x10000, v216
    v_cmp_gt_u32 vcc, 128, v0
    s_nop 1
    v_cndmask_b32 v218, v217, v218, vcc
    v_lshrrev_b32 v2, 1, v1
    v_lshlrev_b32 v2, 9, v2
    v_and_b32 v3, 1, v1
    v_lshl_add_u32 v219, v3, 2, v2
    s_lshl_b32 s50, s3, 7
    s_add_u32 s50, s50, 112640
    v_add_u32 v219, s50, v219
    v_mov_b32 v2, s50
    v_cmp_lt_u32 vcc, 39, v1
    s_nop 1
    v_cndmask_b32 v219, v219, v2, vcc
    s_mov_b32 s17, 23199744
    s_lshl_b32 s77, s34, 7
    v_lshl_add_u32 v220, v0, 2, s77
    v_add_u32 v221, 1024, v220
    v_add_u32 v222, 2048, v220
    v_subrev_u32 v2, 2560, v220
    v_min_u32 v220, v220, v2
    v_subrev_u32 v2, 2560, v221
    v_min_u32 v221, v221, v2
    v_subrev_u32 v2, 2560, v222
    v_min_u32 v222, v222, v2
    v_mov_b32 v2, 0x80000000
    v_cmp_gt_u32 vcc, 128, v0
    s_nop 1
    v_cndmask_b32 v222, v2, v222, vcc
    s_mov_b32 s77, 23183360
    s_waitcnt vmcnt(8)
    s_barrier
    ds_read_b64_tr_b16 v[8:9], v244 offset:512
    ds_read_b64_tr_b16 v[10:11], v244 offset:1088
    ds_read_b64_tr_b16 v[12:13], v244 offset:1600
    ds_read_b64_tr_b16 v[14:15], v244 offset:18496
    ds_read_b64_tr_b16 v[16:17], v244 offset:19008
    ds_read_b64_tr_b16 v[18:19], v244 offset:9216
    ds_read_b64_tr_b16 v[20:21], v244 offset:9792
    ds_read_b64_tr_b16 v[22:23], v244 offset:10304
    ds_read_b64_tr_b16 v[24:25], v244 offset:27200
    ds_read_b64_tr_b16 v[26:27], v244 offset:27712
    ds_read_b64_tr_b16 v[28:29], v246 offset:512
    ds_read_b64_tr_b16 v[30:31], v246 offset:1088
    ds_read_b64_tr_b16 v[32:33], v246 offset:1600
    ds_read_b64_tr_b16 v[34:35], v246 offset:18496
    ds_read_b64_tr_b16 v[36:37], v246 offset:19008
    ds_read_b64_tr_b16 v[38:39], v246 offset:9216
    ds_read_b64_tr_b16 v[40:41], v246 offset:9792
    ds_read_b64_tr_b16 v[42:43], v246 offset:10304
    ds_read_b64_tr_b16 v[44:45], v246 offset:27200
    ds_read_b64_tr_b16 v[46:47], v246 offset:27712
    buffer_load_dword v242, v234, s[36:39], s17 offen sc1
    s_add_u32 m0, s15, 120896
    s_nop 0
    buffer_load_dwordx4 v241, s[44:47], s14 offen lds
    s_add_u32 s14, s14, 10240
    s_add_u32 m0, s15, 121984
    s_nop 0
    buffer_load_dwordx4 v241, s[44:47], s14 offen lds
    s_add_u32 s14, s14, 10240
    s_add_u32 m0, s15, 123072
    s_nop 0
    buffer_load_dwordx4 v241, s[44:47], s14 offen lds
    s_add_u32 s14, s14, 10240
    s_add_u32 m0, s15, 124160
    s_nop 0
    buffer_load_dwordx4 v241, s[44:47], s14 offen lds
    s_waitcnt vmcnt(12)
    v_alignbit_b32 v48, v48, v48, 16
    v_alignbit_b32 v49, v49, v49, 16
    s_waitcnt vmcnt(11)
    v_alignbit_b32 v50, v50, v50, 16
    v_alignbit_b32 v51, v51, v51, 16
    s_waitcnt lgkmcnt(14)
    v_alignbit_b32 v52, v9, v8, 16
    v_alignbit_b32 v53, v10, v9, 16
    v_alignbit_b32 v54, v11, v10, 16
    v_alignbit_b32 v55, v12, v11, 16
    v_alignbit_b32 v56, v13, v12, 16
    v_dot2_f32_bf16 v65, v9, v49, 0
    v_dot2_f32_bf16 v64, v52, v49, 0
    v_dot2_f32_bf16 v67, v10, v49, 0
    v_dot2_f32_bf16 v66, v53, v49, 0
    v_dot2_f32_bf16 v69, v11, v49, 0
    v_dot2_f32_bf16 v68, v54, v49, 0
    v_dot2_f32_bf16 v71, v12, v49, 0
    v_dot2_f32_bf16 v70, v55, v49, 0
    v_dot2_f32_bf16 v65, v10, v48, v65
    v_dot2_f32_bf16 v64, v53, v48, v64
    v_dot2_f32_bf16 v67, v11, v48, v67
    v_dot2_f32_bf16 v66, v54, v48, v66
    v_dot2_f32_bf16 v69, v12, v48, v69
    v_dot2_f32_bf16 v68, v55, v48, v68
    v_dot2_f32_bf16 v71, v13, v48, v71
    v_dot2_f32_bf16 v70, v56, v48, v70
    v_lshlrev_b32 v80, 16, v14
    v_and_b32 v81, 0xffff0000, v14
    v_lshlrev_b32 v82, 16, v15
    v_and_b32 v83, 0xffff0000, v15
    v_lshlrev_b32 v84, 16, v16
    v_and_b32 v85, 0xffff0000, v16
    v_lshlrev_b32 v86, 16, v17
    v_and_b32 v87, 0xffff0000, v17
    v_pk_mul_f32 v[64:65], v[64:65], v[80:81]
    v_pk_mul_f32 v[66:67], v[66:67], v[82:83]
    v_pk_mul_f32 v[68:69], v[68:69], v[84:85]
    v_pk_mul_f32 v[70:71], v[70:71], v[86:87]
    v_cvt_pk_bf16_f32 v96, v71, v70
    v_cvt_pk_bf16_f32 v97, v69, v68
    v_cvt_pk_bf16_f32 v98, v67, v66
    v_cvt_pk_bf16_f32 v99, v65, v64
    buffer_store_dwordx4 v[96:99], v247, s[36:39], 0 offen offset:128
    v_alignbit_b32 v58, v19, v18, 16
    s_waitcnt lgkmcnt(13)
    v_alignbit_b32 v59, v20, v19, 16
    v_alignbit_b32 v60, v21, v20, 16
    s_waitcnt lgkmcnt(12)
    v_alignbit_b32 v61, v22, v21, 16
    v_alignbit_b32 v62, v23, v22, 16
    v_dot2_f32_bf16 v73, v19, v49, 0
    v_dot2_f32_bf16 v72, v58, v49, 0
    v_dot2_f32_bf16 v75, v20, v49, 0
    v_dot2_f32_bf16 v74, v59, v49, 0
    v_dot2_f32_bf16 v77, v21, v49, 0
    v_dot2_f32_bf16 v76, v60, v49, 0
    v_dot2_f32_bf16 v79, v22, v49, 0
    v_dot2_f32_bf16 v78, v61, v49, 0
    v_dot2_f32_bf16 v73, v20, v48, v73
    v_dot2_f32_bf16 v72, v59, v48, v72
    v_dot2_f32_bf16 v75, v21, v48, v75
    v_dot2_f32_bf16 v74, v60, v48, v74
    v_dot2_f32_bf16 v77, v22, v48, v77
    v_dot2_f32_bf16 v76, v61, v48, v76
    v_dot2_f32_bf16 v79, v23, v48, v79
    v_dot2_f32_bf16 v78, v62, v48, v78
    s_waitcnt lgkmcnt(11)
    v_lshlrev_b32 v88, 16, v24
    v_and_b32 v89, 0xffff0000, v24
    v_lshlrev_b32 v90, 16, v25
    v_and_b32 v91, 0xffff0000, v25
    s_waitcnt lgkmcnt(10)
    v_lshlrev_b32 v92, 16, v26
    v_and_b32 v93, 0xffff0000, v26
    v_lshlrev_b32 v94, 16, v27
    v_and_b32 v95, 0xffff0000, v27
    v_pk_mul_f32 v[72:73], v[72:73], v[88:89]
    v_pk_mul_f32 v[74:75], v[74:75], v[90:91]
    v_pk_mul_f32 v[76:77], v[76:77], v[92:93]
    v_pk_mul_f32 v[78:79], v[78:79], v[94:95]
    v_cvt_pk_bf16_f32 v100, v79, v78
    v_cvt_pk_bf16_f32 v101, v77, v76
    v_cvt_pk_bf16_f32 v102, v75, v74
    v_cvt_pk_bf16_f32 v103, v73, v72
    buffer_store_dwordx4 v[100:103], v247, s[36:39], 0 offen offset:0
    s_waitcnt lgkmcnt(9)
    v_alignbit_b32 v52, v29, v28, 16
    s_waitcnt lgkmcnt(8)
    v_alignbit_b32 v53, v30, v29, 16
    v_alignbit_b32 v54, v31, v30, 16
    s_waitcnt lgkmcnt(7)
    v_alignbit_b32 v55, v32, v31, 16
    v_alignbit_b32 v56, v33, v32, 16
    v_dot2_f32_bf16 v65, v29, v51, 0
    v_dot2_f32_bf16 v64, v52, v51, 0
    v_dot2_f32_bf16 v67, v30, v51, 0
    v_dot2_f32_bf16 v66, v53, v51, 0
    v_dot2_f32_bf16 v69, v31, v51, 0
    v_dot2_f32_bf16 v68, v54, v51, 0
    v_dot2_f32_bf16 v71, v32, v51, 0
    v_dot2_f32_bf16 v70, v55, v51, 0
    v_dot2_f32_bf16 v65, v30, v50, v65
    v_dot2_f32_bf16 v64, v53, v50, v64
    v_dot2_f32_bf16 v67, v31, v50, v67
    v_dot2_f32_bf16 v66, v54, v50, v66
    v_dot2_f32_bf16 v69, v32, v50, v69
    v_dot2_f32_bf16 v68, v55, v50, v68
    v_dot2_f32_bf16 v71, v33, v50, v71
    v_dot2_f32_bf16 v70, v56, v50, v70
    s_waitcnt lgkmcnt(6)
    v_lshlrev_b32 v80, 16, v34
    v_and_b32 v81, 0xffff0000, v34
    v_lshlrev_b32 v82, 16, v35
    v_and_b32 v83, 0xffff0000, v35
    s_waitcnt lgkmcnt(5)
    v_lshlrev_b32 v84, 16, v36
    v_and_b32 v85, 0xffff0000, v36
    v_lshlrev_b32 v86, 16, v37
    v_and_b32 v87, 0xffff0000, v37
    v_pk_mul_f32 v[64:65], v[64:65], v[80:81]
    v_pk_mul_f32 v[66:67], v[66:67], v[82:83]
    v_pk_mul_f32 v[68:69], v[68:69], v[84:85]
    v_pk_mul_f32 v[70:71], v[70:71], v[86:87]
    v_cvt_pk_bf16_f32 v104, v71, v70
    v_cvt_pk_bf16_f32 v105, v69, v68
    v_cvt_pk_bf16_f32 v106, v67, v66
    v_cvt_pk_bf16_f32 v107, v65, v64
    buffer_store_dwordx4 v[104:107], v247, s[36:39], s16 offen offset:128
    s_waitcnt lgkmcnt(4)
    v_alignbit_b32 v58, v39, v38, 16
    s_waitcnt lgkmcnt(3)
    v_alignbit_b32 v59, v40, v39, 16
    v_alignbit_b32 v60, v41, v40, 16
    s_waitcnt lgkmcnt(2)
    v_alignbit_b32 v61, v42, v41, 16
    v_alignbit_b32 v62, v43, v42, 16
    v_dot2_f32_bf16 v73, v39, v51, 0
    v_dot2_f32_bf16 v72, v58, v51, 0
    v_dot2_f32_bf16 v75, v40, v51, 0
    v_dot2_f32_bf16 v74, v59, v51, 0
    v_dot2_f32_bf16 v77, v41, v51, 0
    v_dot2_f32_bf16 v76, v60, v51, 0
    v_dot2_f32_bf16 v79, v42, v51, 0
    v_dot2_f32_bf16 v78, v61, v51, 0
    v_dot2_f32_bf16 v73, v40, v50, v73
    v_dot2_f32_bf16 v72, v59, v50, v72
    v_dot2_f32_bf16 v75, v41, v50, v75
    v_dot2_f32_bf16 v74, v60, v50, v74
    v_dot2_f32_bf16 v77, v42, v50, v77
    v_dot2_f32_bf16 v76, v61, v50, v76
    v_dot2_f32_bf16 v79, v43, v50, v79
    v_dot2_f32_bf16 v78, v62, v50, v78
    s_waitcnt lgkmcnt(1)
    v_lshlrev_b32 v88, 16, v44
    v_and_b32 v89, 0xffff0000, v44
    v_lshlrev_b32 v90, 16, v45
    v_and_b32 v91, 0xffff0000, v45
    s_waitcnt lgkmcnt(0)
    v_lshlrev_b32 v92, 16, v46
    v_and_b32 v93, 0xffff0000, v46
    v_lshlrev_b32 v94, 16, v47
    v_and_b32 v95, 0xffff0000, v47
    v_pk_mul_f32 v[72:73], v[72:73], v[88:89]
    v_pk_mul_f32 v[74:75], v[74:75], v[90:91]
    v_pk_mul_f32 v[76:77], v[76:77], v[92:93]
    v_pk_mul_f32 v[78:79], v[78:79], v[94:95]
    v_cvt_pk_bf16_f32 v108, v79, v78
    v_cvt_pk_bf16_f32 v109, v77, v76
    v_cvt_pk_bf16_f32 v110, v75, v74
    v_cvt_pk_bf16_f32 v111, v73, v72
    buffer_store_dwordx4 v[108:111], v247, s[36:39], s16 offen offset:0
    s_waitcnt vmcnt(8)
    v_cmp_ne_u32 vcc, s30, v242
    s_cbranch_vccnz L_id_slow
    s_mov_b32 s30, 1
L_id_back:
    s_cmp_eq_u32 s30, 1
    s_cbranch_scc0 L_kv_far
L_kv_back:
    ds_read_b128 v[128:131], v230 offset:32
    ds_read_b64 v[132:133], v230 offset:48
    ds_read_b128 v[134:137], v230 offset:1056
    ds_read_b64 v[138:139], v230 offset:1072
    ds_read_b128 v[140:143], v230 offset:2080
    ds_read_b64 v[144:145], v230 offset:2096
    ds_read_b128 v[146:149], v230 offset:3104
    ds_read_b64 v[150:151], v230 offset:3120
    s_mov_b64 exec, 1
    s_waitcnt lgkmcnt(7)
    v_lshlrev_b32 v4, 16, v128
    v_alignbit_b32 v5, v129, v128, 16
    ds_write_b32 v230, v4 offset:4188
    ds_write_b32 v230, v128 offset:8348
    ds_write_b32 v230, v4 offset:12504
    ds_write_b32 v230, v5 offset:12508
    s_mov_b64 exec, -1
    v_alignbit_b32 v56, v129, v128, 16
    v_alignbit_b32 v57, v130, v129, 16
    v_alignbit_b32 v58, v131, v130, 16
    s_waitcnt lgkmcnt(10)
    v_alignbit_b32 v59, v132, v131, 16
    v_pk_mov_b32 v[60:61], v[128:129], v[130:131] op_sel:[1,0]
    v_pk_mov_b32 v[62:63], v[130:131], v[132:133] op_sel:[1,0]
    v_alignbit_b32 v64, v130, v129, 16
    v_alignbit_b32 v65, v131, v130, 16
    v_alignbit_b32 v66, v132, v131, 16
    v_alignbit_b32 v67, v133, v132, 16
    ds_write_b128 v230, v[56:59] offset:4192
    ds_write_b128 v230, v[60:63] offset:8352
    ds_write_b128 v230, v[64:67] offset:12512
    s_waitcnt lgkmcnt(12)
    v_alignbit_b32 v68, v135, v134, 16
    v_alignbit_b32 v69, v136, v135, 16
    v_alignbit_b32 v70, v137, v136, 16
    s_waitcnt lgkmcnt(11)
    v_alignbit_b32 v71, v138, v137, 16
    v_pk_mov_b32 v[72:73], v[134:135], v[136:137] op_sel:[1,0]
    v_pk_mov_b32 v[74:75], v[136:137], v[138:139] op_sel:[1,0]
    v_alignbit_b32 v76, v136, v135, 16
    v_alignbit_b32 v77, v137, v136, 16
    v_alignbit_b32 v78, v138, v137, 16
    v_alignbit_b32 v79, v139, v138, 16
    ds_write_b128 v230, v[68:71] offset:5216
    ds_write_b128 v230, v[72:75] offset:9376
    ds_write_b128 v230, v[76:79] offset:13536
    s_waitcnt lgkmcnt(13)
    v_alignbit_b32 v56, v141, v140, 16
    v_alignbit_b32 v57, v142, v141, 16
    v_alignbit_b32 v58, v143, v142, 16
    s_waitcnt lgkmcnt(12)
    v_alignbit_b32 v59, v144, v143, 16
    v_pk_mov_b32 v[60:61], v[140:141], v[142:143] op_sel:[1,0]
    v_pk_mov_b32 v[62:63], v[142:143], v[144:145] op_sel:[1,0]
    v_alignbit_b32 v64, v142, v141, 16
    v_alignbit_b32 v65, v143, v142, 16
    v_alignbit_b32 v66, v144, v143, 16
    v_alignbit_b32 v67, v145, v144, 16
    ds_write_b128 v230, v[56:59] offset:6240
    ds_write_b128 v230, v[60:63] offset:10400
    ds_write_b128 v230, v[64:67] offset:14560
    s_waitcnt lgkmcnt(14)
    v_alignbit_b32 v68, v147, v146, 16
    v_alignbit_b32 v69, v148, v147, 16
    v_alignbit_b32 v70, v149, v148, 16
    s_waitcnt lgkmcnt(13)
    v_alignbit_b32 v71, v150, v149, 16
    v_pk_mov_b32 v[72:73], v[146:147], v[148:149] op_sel:[1,0]
    v_pk_mov_b32 v[74:75], v[148:149], v[150:151] op_sel:[1,0]
    v_alignbit_b32 v76, v148, v147, 16
    v_alignbit_b32 v77, v149, v148, 16
    v_alignbit_b32 v78, v150, v149, 16
    v_alignbit_b32 v79, v151, v150, 16
    ds_write_b128 v230, v[68:71] offset:7264
    ds_write_b128 v230, v[72:75] offset:11424
    ds_write_b128 v230, v[76:79] offset:15584
    s_waitcnt vmcnt(0)
    s_barrier
    s_cmp_eq_u32 s3, 0
    s_cbranch_scc0 L_lf2
    s_cmp_eq_u32 s30, 1
    s_cbranch_scc0 L_lf2_far
    s_lshl_b32 s54, s70, 7
    s_add_u32 s54, s54, 23232512
    v_mov_b32 v254, 0
    v_mov_b32 v255, s48
    s_mov_b64 exec, 1
    buffer_store_dword v255, v254, s[36:39], s54 offen
    s_mov_b64 exec, -1
L_lf2:
    s_mov_b32 s55, 2883584
    s_mov_b32 s56, 2916352
    ds_read_b64_tr_b16 v[112:113], v244 offset:35904
    ds_read_b64_tr_b16 v[114:115], v244 offset:36416
    ds_read_b64_tr_b16 v[116:117], v244 offset:44608
    ds_read_b64_tr_b16 v[118:119], v244 offset:45120
    ds_read_b64_tr_b16 v[120:121], v246 offset:35904
    ds_read_b64_tr_b16 v[122:123], v246 offset:36416
    ds_read_b64_tr_b16 v[124:125], v246 offset:44608
    ds_read_b64_tr_b16 v[126:127], v246 offset:45120
    s_waitcnt lgkmcnt(6)
    buffer_store_dwordx4 v[112:115], v245, s[36:39], s55 offen offset:0
    s_waitcnt lgkmcnt(4)
    buffer_store_dwordx4 v[116:119], v245, s[36:39], s55 offen offset:128
    s_waitcnt lgkmcnt(2)
    buffer_store_dwordx4 v[120:123], v245, s[36:39], s56 offen offset:0
    s_waitcnt lgkmcnt(0)
    buffer_store_dwordx4 v[124:127], v245, s[36:39], s56 offen offset:128
    s_cmp_eq_u32 s30, 1
    s_cbranch_scc0 L_q_far
L_q_back:
    v_lshrrev_b32 v3, 4, v1
    v_lshlrev_b32 v2, 3, v3
    v_and_b32 v3, 15, v1
    v_sub_u32 v2, v2, v3
    v_subrev_u32 v2, 9, v2
    v_and_b32 v3, 1, v2
    v_cmp_eq_u32 vcc, 1, v3
    v_lshrrev_b32 v3, 16, v250
    s_nop 0
    v_cndmask_b32 v3, v3, v250, vcc
    v_lshrrev_b32 v2, 1, v2
    v_cmp_eq_u32 vcc, 0, v2
    s_nop 1
    v_cndmask_b32 v244, 0, v3, vcc
    v_cmp_eq_u32 vcc, 1, v2
    s_nop 1
    v_cndmask_b32 v245, 0, v3, vcc
    v_cmp_eq_u32 vcc, 2, v2
    s_nop 1
    v_cndmask_b32 v246, 0, v3, vcc
    v_cmp_eq_u32 vcc, 3, v2
    s_nop 1
    v_cndmask_b32 v247, 0, v3, vcc
    v_mov_b32 v230, v238
    v_mov_b32 v4, v231
    v_mov_b32 v5, v232
    ds_read_b64 a[128:129], v4 offset:0
    ds_read_b64 a[130:131], v4 offset:8
    ds_read_b64 a[132:133], v4 offset:512
    ds_read_b64 a[134:135], v4 offset:520
    ds_read_b64 a[136:137], v4 offset:1024
    ds_read_b64 a[138:139], v4 offset:1032
    ds_read_b64 a[140:141], v4 offset:1536
    ds_read_b64 a[142:143], v4 offset:1544
    ds_read_b64 a[144:145], v4 offset:64
    ds_read_b64 a[146:147], v4 offset:72
    ds_read_b64 a[148:149], v4 offset:576
    ds_read_b64 a[150:151], v4 offset:584
    ds_read_b64 a[152:153], v4 offset:1088
    ds_read_b64 a[154:155], v4 offset:1096
    ds_read_b64 a[156:157], v4 offset:1600
    ds_read_b64 a[158:159], v4 offset:1608
    ds_read_b64 a[160:161], v4 offset:128
    ds_read_b64 a[162:163], v4 offset:136
    ds_read_b64 a[164:165], v4 offset:640
    ds_read_b64 a[166:167], v4 offset:648
    ds_read_b64 a[168:169], v4 offset:1152
    ds_read_b64 a[170:171], v4 offset:1160
    ds_read_b64 a[172:173], v4 offset:1664
    ds_read_b64 a[174:175], v4 offset:1672
    ds_read_b64 a[176:177], v4 offset:192
    ds_read_b64 a[178:179], v4 offset:200
    ds_read_b64 a[180:181], v4 offset:704
    ds_read_b64 a[182:183], v4 offset:712
    ds_read_b64 a[184:185], v4 offset:1216
    ds_read_b64 a[186:187], v4 offset:1224
    ds_read_b64 a[188:189], v4 offset:1728
    ds_read_b64 a[190:191], v4 offset:1736
    ds_read_b64 a[192:193], v4 offset:256
    ds_read_b64 a[194:195], v4 offset:264
    ds_read_b64 a[196:197], v4 offset:768
    ds_read_b64 a[198:199], v4 offset:776
    ds_read_b64 a[200:201], v4 offset:1280
    ds_read_b64 a[202:203], v4 offset:1288
    ds_read_b64 a[204:205], v4 offset:1792
    ds_read_b64 a[206:207], v4 offset:1800
    ds_read_b64 a[208:209], v4 offset:320
    ds_read_b64 a[210:211], v4 offset:328
    ds_read_b64 a[212:213], v4 offset:832
    ds_read_b64 a[214:215], v4 offset:840
    ds_read_b64 a[216:217], v4 offset:1344
    ds_read_b64 a[218:219], v4 offset:1352
    ds_read_b64 a[220:221], v4 offset:1856
    ds_read_b64 a[222:223], v4 offset:1864
    ds_read_b64 a[224:225], v4 offset:384
    ds_read_b64 a[226:227], v4 offset:392
    ds_read_b64 a[228:229], v4 offset:896
    ds_read_b64 a[230:231], v4 offset:904
    ds_read_b64 a[232:233], v4 offset:1408
    ds_read_b64 a[234:235], v4 offset:1416
    ds_read_b64 a[236:237], v4 offset:1920
    ds_read_b64 a[238:239], v4 offset:1928
    ds_read_b64 a[240:241], v4 offset:448
    ds_read_b64 a[242:243], v4 offset:456
    ds_read_b64 a[244:245], v4 offset:960
    ds_read_b64 a[246:247], v4 offset:968
    ds_read_b64 a[248:249], v4 offset:1472
    ds_read_b64 a[250:251], v4 offset:1480
    ds_read_b64 a[252:253], v4 offset:1984
    ds_read_b64 a[254:255], v4 offset:1992
L_poll3:
    buffer_load_dword v234, v233, s[36:39], s17 offen sc1
    s_waitcnt vmcnt(0)
    v_cmp_ne_u32 vcc, s48, v234
    s_cbranch_vccz L_poll3_ok
    s_cmp_eq_u32 s49, 0
    s_cbranch_scc1 L_poll3_ok
    s_sub_u32 s49, s49, 1
    s_sleep 1
    s_branch L_poll3
L_poll3_ok:
    s_mul_i32 s50, s58, 4096
    s_mul_i32 s52, s3, 4608
    s_add_u32 m0, s52, 66560
    s_nop 0
    buffer_load_dwordx4 v248, s[36:39], s50 offen offset:3072 sc1 lds
    buffer_load_dwordx4 v248, s[36:39], s50 offen offset:2048 sc1 lds
    buffer_load_dwordx4 v248, s[36:39], s50 offen offset:1024 sc1 lds
    buffer_load_dwordx4 v248, s[36:39], s50 offen offset:0 sc1 lds
    s_waitcnt vmcnt(2)
    ds_read_b128 v[104:107], v5 offset:3584
    ds_read_b128 v[108:111], v5 offset:3072
    ds_read_b128 v[112:115], v5 offset:2560
    ds_read_b128 v[116:119], v5 offset:2048
    ds_read_b128 v[136:139], v5 offset:3648
    ds_read_b128 v[140:143], v5 offset:3136
    ds_read_b128 v[144:147], v5 offset:2624
    ds_read_b128 v[148:151], v5 offset:2112
    s_waitcnt lgkmcnt(7)
    v_mfma_f32_16x16x32_bf16 v[8:11], a[128:131], v[104:107], 0
    ds_read_b128 v[120:123], v5 offset:3712
    v_mfma_f32_16x16x32_bf16 v[8:11], v[244:247], v[104:107], v[8:11]
    s_barrier
    s_cmp_eq_u32 s3, 0
    s_cbranch_scc0 L_lf4
    s_cmp_eq_u32 s30, 1
    s_cbranch_scc0 L_lf4_far
    s_lshl_b32 s54, s70, 7
    s_add_u32 s54, s54, 23252992
    v_mov_b32 v254, 0
    v_mov_b32 v255, s48
    s_mov_b64 exec, 1
    buffer_store_dword v255, v254, s[36:39], s54 offen
    s_mov_b64 exec, -1
L_lf4:
    s_waitcnt lgkmcnt(7)
    v_mfma_f32_16x16x32_bf16 v[12:15], a[128:131], v[108:111], 0
    s_add_u32 m0, s61, 139264
    s_nop 0
    buffer_load_dwordx4 v224, s[40:43], s64 offen offset:0 lds
    v_mfma_f32_16x16x32_bf16 v[12:15], v[244:247], v[108:111], v[12:15]
    s_movk_i32 s4, 4096
    ds_read_b128 v[124:127], v5 offset:3200
    v_mfma_f32_16x16x32_bf16 v[12:15], a[132:135], v[104:107], v[12:15]
    s_movk_i32 s5, 8192
    v_mfma_f32_16x16x32_bf16 v[16:19], a[132:135], v[108:111], 0
    s_waitcnt lgkmcnt(7)
    s_add_u32 m0, s61, 139264
    v_mfma_f32_16x16x32_bf16 v[16:19], a[128:131], v[112:115], v[16:19]
    buffer_load_dwordx4 v225, s[40:43], s64 offen offset:1024 lds
    v_mfma_f32_16x16x32_bf16 v[16:19], v[244:247], v[112:115], v[16:19]
    s_lshl_b32 s6, s72, 10
    ds_read_b128 v[128:131], v5 offset:2688
    v_mfma_f32_16x16x32_bf16 v[16:19], a[136:139], v[104:107], v[16:19]
    s_add_u32 s6, s6, 23101440
    v_mfma_f32_16x16x32_bf16 v[20:23], a[132:135], v[112:115], 0
    s_lshl_b32 s7, s73, 6
    v_mfma_f32_16x16x32_bf16 v[20:23], a[136:139], v[108:111], v[20:23]
    s_waitcnt lgkmcnt(7)
    s_add_u32 m0, s61, 139264
    ds_read_b128 v[132:135], v5 offset:2176
    buffer_load_dwordx4 v226, s[40:43], s64 offen offset:2048 lds
    v_mfma_f32_16x16x32_bf16 v[20:23], a[128:131], v[116:119], v[20:23]
    s_add_u32 s64, s64, 98304
    v_mfma_f32_16x16x32_bf16 v[20:23], v[244:247], v[116:119], v[20:23]
    s_sub_u32 s35, s64, 1966080
    v_mfma_f32_16x16x32_bf16 v[20:23], a[140:143], v[104:107], v[20:23]
    s_waitcnt lgkmcnt(4)
    v_mfma_f32_16x16x32_bf16 v[8:11], a[144:147], v[136:139], v[8:11]
    s_min_u32 s64, s64, s35
    s_add_u32 m0, s61, 151552
    ds_read_b128 v[152:155], v5 offset:3776
    buffer_load_dwordx4 v224, s[40:43], s64 offen offset:0 lds
    v_mfma_f32_16x16x32_bf16 v[12:15], a[144:147], v[140:143], v[12:15]
    s_add_u32 s7, s7, s6
    v_mfma_f32_16x16x32_bf16 v[12:15], a[148:151], v[136:139], v[12:15]
    s_mul_i32 s8, s72, 804
    ds_read_b128 v[156:159], v5 offset:3264
    v_mfma_f32_16x16x32_bf16 v[16:19], a[148:151], v[140:143], v[16:19]
    s_add_u32 m0, s61, 151552
    v_mfma_f32_16x16x32_bf16 v[16:19], a[144:147], v[144:147], v[16:19]
    buffer_load_dwordx4 v225, s[40:43], s64 offen offset:1024 lds
    v_mfma_f32_16x16x32_bf16 v[16:19], a[152:155], v[136:139], v[16:19]
    s_mul_i32 s60, s73, 12
    ds_read_b128 v[160:163], v5 offset:2752
    v_mfma_f32_16x16x32_bf16 v[20:23], a[148:151], v[144:147], v[20:23]
    s_add_u32 s8, s8, s60
    v_mfma_f32_16x16x32_bf16 v[20:23], a[152:155], v[140:143], v[20:23]
    s_add_u32 m0, s61, 151552
    ds_read_b128 v[164:167], v5 offset:2240
    v_mfma_f32_16x16x32_bf16 v[20:23], a[144:147], v[148:151], v[20:23]
    buffer_load_dwordx4 v226, s[40:43], s64 offen offset:2048 lds
    v_mfma_f32_16x16x32_bf16 v[20:23], a[156:159], v[136:139], v[20:23]
    s_waitcnt lgkmcnt(4)
    v_mfma_f32_16x16x32_bf16 v[8:11], a[160:163], v[120:123], v[8:11]
    s_add_u32 s64, s64, 98304
    ds_read_b128 v[104:107], v5 offset:3840
    v_mfma_f32_16x16x32_bf16 v[12:15], a[160:163], v[124:127], v[12:15]
    s_sub_u32 s35, s64, 1966080
    v_mfma_f32_16x16x32_bf16 v[12:15], a[164:167], v[120:123], v[12:15]
    s_min_u32 s64, s64, s35
    ds_read_b128 v[108:111], v5 offset:3328
    v_mfma_f32_16x16x32_bf16 v[16:19], a[164:167], v[124:127], v[16:19]
    s_lshr_b32 s60, s73, 2
    v_mfma_f32_16x16x32_bf16 v[16:19], a[160:163], v[128:131], v[16:19]
    s_mul_i32 s60, s60, 2
    v_mfma_f32_16x16x32_bf16 v[16:19], a[168:171], v[120:123], v[16:19]
    s_add_u32 s8, s8, s60
    ds_read_b128 v[112:115], v5 offset:2816
    v_mfma_f32_16x16x32_bf16 v[20:23], a[164:167], v[128:131], v[20:23]
    buffer_load_dword v240, v238, s[36:39], s17 offen sc1
    v_mfma_f32_16x16x32_bf16 v[20:23], a[168:171], v[124:127], v[20:23]
    s_mul_i32 s60, s3, 3
    ds_read_b128 v[116:119], v5 offset:2304
    v_mfma_f32_16x16x32_bf16 v[20:23], a[160:163], v[132:135], v[20:23]
    s_add_u32 s8, s8, s60
    v_mfma_f32_16x16x32_bf16 v[20:23], a[172:175], v[120:123], v[20:23]
    s_waitcnt lgkmcnt(4)
    v_mfma_f32_16x16x32_bf16 v[8:11], a[176:179], v[152:155], v[8:11]
    s_lshl_b32 s8, s8, 8
    ds_read_b128 v[136:139], v5 offset:3904
    v_mfma_f32_16x16x32_bf16 v[12:15], a[176:179], v[156:159], v[12:15]
    s_add_u32 s8, s8, 15728640
    v_mfma_f32_16x16x32_bf16 v[12:15], a[180:183], v[152:155], v[12:15]
    s_lshl_b32 s9, s73, 2
    ds_read_b128 v[140:143], v5 offset:3392
    v_mfma_f32_16x16x32_bf16 v[16:19], a[180:183], v[156:159], v[16:19]
    s_add_u32 s9, s9, s3
    v_mfma_f32_16x16x32_bf16 v[16:19], a[176:179], v[160:163], v[16:19]
    s_mul_i32 s9, s9, 384
    v_mfma_f32_16x16x32_bf16 v[16:19], a[184:187], v[152:155], v[16:19]
    s_add_u32 m0, s61, 102400
    ds_read_b128 v[144:147], v5 offset:2880
    v_mfma_f32_16x16x32_bf16 v[20:23], a[180:183], v[160:163], v[20:23]
    buffer_load_dwordx4 v224, s[40:43], s64 offen offset:0 lds
    v_mfma_f32_16x16x32_bf16 v[20:23], a[184:187], v[156:159], v[20:23]
    s_add_u32 s9, s9, 23527424
    ds_read_b128 v[148:151], v5 offset:2368
    v_mfma_f32_16x16x32_bf16 v[20:23], a[176:179], v[164:167], v[20:23]
    s_mul_i32 s31, s3, 33792
    v_mfma_f32_16x16x32_bf16 v[20:23], a[188:191], v[152:155], v[20:23]
    s_waitcnt lgkmcnt(4)
    v_mfma_f32_16x16x32_bf16 v[8:11], a[192:195], v[104:107], v[8:11]
    s_add_u32 m0, s61, 102400
    ds_read_b128 v[120:123], v5 offset:3968
    buffer_load_dwordx4 v225, s[40:43], s64 offen offset:1024 lds
    v_mfma_f32_16x16x32_bf16 v[12:15], a[192:195], v[108:111], v[12:15]
    s_lshl_b32 s60, s72, 7
    v_mfma_f32_16x16x32_bf16 v[12:15], a[196:199], v[104:107], v[12:15]
    s_add_u32 s31, s31, s60
    ds_read_b128 v[124:127], v5 offset:3456
    v_mfma_f32_16x16x32_bf16 v[16:19], a[196:199], v[108:111], v[16:19]
    s_add_u32 m0, s61, 102400
    v_mfma_f32_16x16x32_bf16 v[16:19], a[192:195], v[112:115], v[16:19]
    buffer_load_dwordx4 v226, s[40:43], s64 offen offset:2048 lds
    v_mfma_f32_16x16x32_bf16 v[16:19], a[200:203], v[104:107], v[16:19]
    s_add_u32 s64, s64, 98304
    ds_read_b128 v[128:131], v5 offset:2944
    v_mfma_f32_16x16x32_bf16 v[20:23], a[196:199], v[112:115], v[20:23]
    s_sub_u32 s35, s64, 1966080
    v_mfma_f32_16x16x32_bf16 v[20:23], a[200:203], v[108:111], v[20:23]
    s_min_u32 s64, s64, s35
    ds_read_b128 v[132:135], v5 offset:2432
    v_mfma_f32_16x16x32_bf16 v[20:23], a[192:195], v[116:119], v[20:23]
    s_add_u32 m0, s61, 114688
    s_nop 0
    buffer_load_dwordx4 v224, s[40:43], s64 offen offset:0 lds
    v_mfma_f32_16x16x32_bf16 v[20:23], a[204:207], v[104:107], v[20:23]
    s_waitcnt lgkmcnt(4)
    v_mfma_f32_16x16x32_bf16 v[8:11], a[208:211], v[136:139], v[8:11]
    s_mul_i32 s60, s34, 135168
    ds_read_b128 v[152:155], v5 offset:4032
    v_mfma_f32_16x16x32_bf16 v[12:15], a[208:211], v[140:143], v[12:15]
    s_add_u32 s10, s31, s60
    v_mfma_f32_16x16x32_bf16 v[12:15], a[212:215], v[136:139], v[12:15]
    s_add_u32 m0, s61, 114688
    ds_read_b128 v[156:159], v5 offset:3520
    buffer_load_dwordx4 v225, s[40:43], s64 offen offset:1024 lds
    v_mfma_f32_16x16x32_bf16 v[16:19], a[212:215], v[140:143], v[16:19]
    s_lshl_b32 s63, s3, 10
    v_mfma_f32_16x16x32_bf16 v[16:19], a[208:211], v[144:147], v[16:19]
    s_add_u32 s11, s10, 135168
    v_mfma_f32_16x16x32_bf16 v[16:19], a[216:219], v[136:139], v[16:19]
    s_sub_u32 s31, s11, 2703360
    ds_read_b128 v[160:163], v5 offset:3008
    v_mfma_f32_16x16x32_bf16 v[20:23], a[212:215], v[144:147], v[20:23]
    s_add_u32 m0, s61, 114688
    s_waitcnt vmcnt(5)
    v_cmp_ne_u32 vcc, s48, v240
    s_cbranch_vccnz L_chk5_slow
L_chk5_back:
    buffer_load_dwordx4 v226, s[40:43], s64 offen offset:2048 lds
    v_mfma_f32_16x16x32_bf16 v[20:23], a[216:219], v[140:143], v[20:23]
    s_add_u32 s64, s64, 98304
    ds_read_b128 v[164:167], v5 offset:2496
    v_mfma_f32_16x16x32_bf16 v[20:23], a[208:211], v[148:151], v[20:23]
    s_sub_u32 s35, s64, 1966080
    v_mfma_f32_16x16x32_bf16 v[20:23], a[220:223], v[136:139], v[20:23]
    s_waitcnt lgkmcnt(4)
    v_mfma_f32_16x16x32_bf16 v[8:11], a[224:227], v[120:123], v[8:11]
    s_min_u32 s64, s64, s35
    s_add_u32 m0, s66, 84992
    ds_read_b128 v[112:115], v5 offset:2560
    buffer_load_dwordx4 v248, s[36:39], s67 offen offset:0 sc1 lds
    v_mfma_f32_16x16x32_bf16 v[12:15], a[224:227], v[124:127], v[12:15]
    s_add_u32 s67, s67, 8192
    v_mfma_f32_16x16x32_bf16 v[12:15], a[228:231], v[120:123], v[12:15]
    s_min_u32 s11, s11, s31
    ds_read_b128 v[116:119], v5 offset:2048
    v_mfma_f32_16x16x32_bf16 v[16:19], a[228:231], v[124:127], v[16:19]
    s_add_u32 m0, s66, 89088
    v_mfma_f32_16x16x32_bf16 v[16:19], a[224:227], v[128:131], v[16:19]
    buffer_load_dwordx4 v248, s[36:39], s67 offen offset:0 sc1 lds
    v_mfma_f32_16x16x32_bf16 v[16:19], a[232:235], v[120:123], v[16:19]
    s_sub_u32 s67, s67, 4096
    ds_read_b128 v[108:111], v5 offset:3072
    v_mfma_f32_16x16x32_bf16 v[20:23], a[228:231], v[128:131], v[20:23]
    s_add_u32 s12, s11, 135168
    v_mfma_f32_16x16x32_bf16 v[20:23], a[232:235], v[124:127], v[20:23]
    s_add_u32 m0, s62, 93184
    ds_read_b128 v[104:107], v5 offset:3584
    v_mfma_f32_16x16x32_bf16 v[20:23], a[224:227], v[132:135], v[20:23]
    buffer_load_dwordx4 v248, s[36:39], s65 offen offset:0 sc1 lds
    v_mfma_f32_16x16x32_bf16 v[20:23], a[236:239], v[120:123], v[20:23]
    s_waitcnt lgkmcnt(4)
    v_mfma_f32_16x16x32_bf16 v[8:11], a[240:243], v[152:155], v[8:11]
    s_sub_u32 s31, s12, 2703360
    ds_read_b128 v[120:123], v5 offset:1536
    ds_read_b64 v[56:57], v4 offset:2048
    v_mfma_f32_16x16x32_bf16 v[12:15], a[240:243], v[156:159], v[12:15]
    s_min_u32 s12, s12, s31
    ds_read_b64 v[58:59], v4 offset:2056
    ds_read_b128 v[124:127], v5 offset:1024
    v_mfma_f32_16x16x32_bf16 v[12:15], a[244:247], v[152:155], v[12:15]
    s_add_u32 m0, s62, 93184
    ds_read_b64 v[60:61], v4 offset:2560
    buffer_load_dwordx4 v248, s[36:39], s65 offen offset:1024 sc1 lds
    v_mfma_f32_16x16x32_bf16 v[16:19], a[244:247], v[156:159], v[16:19]
    s_add_u32 s65, s65, 2048
    ds_read_b64 v[62:63], v4 offset:2568
    v_mfma_f32_16x16x32_bf16 v[16:19], a[240:243], v[160:163], v[16:19]
    s_add_u32 s13, s12, 135168
    ds_read_b128 v[128:131], v5 offset:512
    v_mfma_f32_16x16x32_bf16 v[16:19], a[248:251], v[152:155], v[16:19]
    s_sub_u32 s31, s13, 2703360
    ds_read_b64 v[64:65], v4 offset:3072
    v_mfma_f32_16x16x32_bf16 v[20:23], a[244:247], v[160:163], v[20:23]
    s_add_u32 m0, s61, 126976
    ds_read_b64 v[66:67], v4 offset:3080
    buffer_load_dwordx4 v224, s[40:43], s64 offen offset:0 lds
    v_mfma_f32_16x16x32_bf16 v[20:23], a[248:251], v[156:159], v[20:23]
    s_min_u32 s13, s13, s31
    ds_read_b128 v[132:135], v5 offset:0
    v_mfma_f32_16x16x32_bf16 v[20:23], a[240:243], v[164:167], v[20:23]
    s_add_u32 s14, s13, 135168
    ds_read_b64 v[68:69], v4 offset:3584
    v_mfma_f32_16x16x32_bf16 v[20:23], a[252:255], v[152:155], v[20:23]
    s_waitcnt lgkmcnt(11)
    ds_read_b64 v[70:71], v4 offset:3592
    v_mfma_f32_16x16x32_bf16 v[24:27], a[136:139], v[112:115], 0
    s_add_u32 m0, s61, 126976
    ds_read_b128 v[144:147], v5 offset:2624
    buffer_load_dwordx4 v225, s[40:43], s64 offen offset:1024 lds
    v_mfma_f32_16x16x32_bf16 v[28:31], a[136:139], v[116:119], 0
    s_barrier
    ds_read_b128 v[148:151], v5 offset:2112
    v_mfma_f32_16x16x32_bf16 v[28:31], a[140:143], v[112:115], v[28:31]
    s_sub_u32 s31, s14, 2703360
    ds_read_b64_tr_b16 a[0:1], v227 offset:36864
    v_mfma_f32_16x16x32_bf16 v[32:35], a[140:143], v[116:119], 0
    s_min_u32 s14, s14, s31
    ds_read_b128 v[140:143], v5 offset:3136
    v_mfma_f32_16x16x32_bf16 v[24:27], a[132:135], v[116:119], v[24:27]
    s_add_u32 m0, s61, 126976
    ds_read_b64_tr_b16 a[2:3], v227 offset:39936
    buffer_load_dwordx4 v226, s[40:43], s64 offen offset:2048 lds
    v_mfma_f32_16x16x32_bf16 v[24:27], a[140:143], v[108:111], v[24:27]
    s_waitcnt lgkmcnt(5)
    ds_read_b128 v[152:155], v5 offset:1600
    v_mfma_f32_16x16x32_bf16 v[32:35], a[136:139], v[120:123], v[32:35]
    s_add_u32 s64, s64, 98304
    ds_read_b64_tr_b16 a[4:5], v228 offset:43008
    v_mfma_f32_16x16x32_bf16 v[32:35], v[56:59], v[112:115], v[32:35]
    s_sub_u32 s35, s64, 1966080
    ds_read_b64 v[88:89], v4 offset:2112
    v_mfma_f32_16x16x32_bf16 v[36:39], a[140:143], v[120:123], 0
    s_min_u32 s64, s64, s35
    ds_read_b64 v[90:91], v4 offset:2120
    v_mfma_f32_16x16x32_bf16 v[36:39], v[56:59], v[116:119], v[36:39]
    s_add_u32 s15, s14, 135168
    ds_read_b64_tr_b16 a[6:7], v228 offset:46080
    v_mfma_f32_16x16x32_bf16 v[28:31], a[132:135], v[120:123], v[28:31]
    s_sub_u32 s31, s15, 2703360
    ds_read_b128 v[136:139], v5 offset:3648
    v_mfma_f32_16x16x32_bf16 v[28:31], v[56:59], v[108:111], v[28:31]
    s_min_u32 s15, s15, s31
    ds_read_b64_tr_b16 a[8:9], v229 offset:36864
    v_mfma_f32_16x16x32_bf16 v[24:27], a[128:131], v[120:123], v[24:27]
    s_add_u32 s18, s15, 135168
    ds_read_b128 v[156:159], v5 offset:1088
    v_mfma_f32_16x16x32_bf16 v[24:27], v[244:247], v[120:123], v[24:27]
    s_sub_u32 s31, s18, 2703360
    ds_read_b64_tr_b16 a[10:11], v229 offset:39936
    v_mfma_f32_16x16x32_bf16 v[24:27], v[56:59], v[104:107], v[24:27]
    s_min_u32 s18, s18, s31
    ds_read_b64 v[92:93], v4 offset:2624
    v_mfma_f32_16x16x32_bf16 v[36:39], a[136:139], v[124:127], v[36:39]
    s_add_u32 s19, s18, 135168
    ds_read_b64 v[94:95], v4 offset:2632
    v_mfma_f32_16x16x32_bf16 v[36:39], v[60:63], v[112:115], v[36:39]
    s_sub_u32 s31, s19, 2703360
    v_mfma_f32_16x16x32_bf16 v[32:35], a[132:135], v[124:127], v[32:35]
    s_waitcnt lgkmcnt(2)
    s_barrier
    ds_read_b128 v[160:163], v5 offset:576
    v_mfma_f32_16x16x32_bf16 v[32:35], v[60:63], v[108:111], v[32:35]
    s_add_u32 m0, s61, 139264
    ds_read_b64_tr_b16 a[12:13], v227 offset:49152
    buffer_load_dwordx4 v224, s[40:43], s64 offen offset:0 lds
    v_mfma_f32_16x16x32_bf16 v[28:31], a[128:131], v[124:127], v[28:31]
    s_min_u32 s19, s19, s31
    ds_read_b64 v[96:97], v4 offset:3136
    v_mfma_f32_16x16x32_bf16 v[28:31], v[244:247], v[124:127], v[28:31]
    s_add_u32 s20, s19, 135168
    ds_read_b64_tr_b16 a[14:15], v227 offset:52224
    v_mfma_f32_16x16x32_bf16 v[28:31], v[60:63], v[104:107], v[28:31]
    s_sub_u32 s31, s20, 2703360
    ds_read_b64 v[98:99], v4 offset:3144
    v_mfma_f32_16x16x32_bf16 v[36:39], a[132:135], v[128:131], v[36:39]
    s_add_u32 m0, s61, 139264
    ds_read_b128 v[164:167], v5 offset:64
    buffer_load_dwordx4 v225, s[40:43], s64 offen offset:1024 lds
    v_mfma_f32_16x16x32_bf16 v[36:39], v[64:67], v[108:111], v[36:39]
    s_min_u32 s20, s20, s31
    ds_read_b64_tr_b16 a[16:17], v228 offset:55296
    v_mfma_f32_16x16x32_bf16 v[32:35], a[128:131], v[128:131], v[32:35]
    s_add_u32 s21, s20, 135168
    ds_read_b64 v[100:101], v4 offset:3648
    v_mfma_f32_16x16x32_bf16 v[32:35], v[244:247], v[128:131], v[32:35]
    s_sub_u32 s31, s21, 2703360
    ds_read_b64_tr_b16 a[18:19], v228 offset:58368
    v_mfma_f32_16x16x32_bf16 v[32:35], v[64:67], v[104:107], v[32:35]
    s_add_u32 m0, s61, 139264
    ds_read_b64 v[102:103], v4 offset:3656
    buffer_load_dwordx4 v226, s[40:43], s64 offen offset:2048 lds
    v_mfma_f32_16x16x32_bf16 v[36:39], a[128:131], v[132:135], v[36:39]
    s_add_u32 s64, s64, 98304
    ds_read_b64_tr_b16 a[20:21], v229 offset:49152
    v_mfma_f32_16x16x32_bf16 v[36:39], v[244:247], v[132:135], v[36:39]
    s_sub_u32 s35, s64, 1966080
    ds_read_b64_tr_b16 a[22:23], v229 offset:52224
    v_mfma_f32_16x16x32_bf16 v[36:39], v[68:71], v[104:107], v[36:39]
    v_mfma_f32_16x16x32_bf16 v[24:27], a[152:155], v[144:147], v[24:27]
    s_min_u32 s64, s64, s35
    ds_read_b128 v[112:115], v5 offset:2688
    v_mfma_f32_16x16x32_bf16 v[28:31], a[152:155], v[148:151], v[28:31]
    s_min_u32 s21, s21, s31
    ds_read_b128 v[116:119], v5 offset:2176
    v_mfma_f32_16x16x32_bf16 v[28:31], a[156:159], v[144:147], v[28:31]
    s_waitcnt lgkmcnt(2)
    s_waitcnt vmcnt(13)
    s_barrier
    ds_read_b64_tr_b16 a[24:25], v227 offset:0
    v_mfma_f32_16x16x32_bf16 v[32:35], a[156:159], v[148:151], v[32:35]
    s_add_u32 m0, s61, 151552
    ds_read_b128 v[108:111], v5 offset:3200
    buffer_load_dwordx4 v224, s[40:43], s64 offen offset:0 lds
    v_mfma_f32_16x16x32_bf16 v[24:27], a[148:151], v[148:151], v[24:27]
    s_add_u32 s22, s21, 135168
    ds_read_b128 v[120:123], v5 offset:1664
    v_mfma_f32_16x16x32_bf16 v[24:27], a[156:159], v[140:143], v[24:27]
    s_sub_u32 s31, s22, 2703360
    ds_read_b64_tr_b16 a[26:27], v227 offset:3072
    v_mfma_f32_16x16x32_bf16 v[32:35], a[152:155], v[152:155], v[32:35]
    s_min_u32 s22, s22, s31
    ds_read_b64 v[56:57], v4 offset:2176
    v_mfma_f32_16x16x32_bf16 v[32:35], v[88:91], v[144:147], v[32:35]
    s_add_u32 m0, s61, 151552
    ds_read_b64 v[58:59], v4 offset:2184
    buffer_load_dwordx4 v225, s[40:43], s64 offen offset:1024 lds
    v_mfma_f32_16x16x32_bf16 v[36:39], a[156:159], v[152:155], v[36:39]
    s_add_u32 s23, s22, 135168
    ds_read_b64_tr_b16 a[28:29], v228 offset:6144
    v_mfma_f32_16x16x32_bf16 v[36:39], v[88:91], v[148:151], v[36:39]
    s_sub_u32 s31, s23, 2703360
    ds_read_b128 v[104:107], v5 offset:3712
    v_mfma_f32_16x16x32_bf16 v[28:31], a[148:151], v[152:155], v[28:31]
    s_min_u32 s23, s23, s31
    ds_read_b128 v[124:127], v5 offset:1152
    v_mfma_f32_16x16x32_bf16 v[28:31], v[88:91], v[140:143], v[28:31]
    s_add_u32 m0, s61, 151552
    ds_read_b64_tr_b16 a[30:31], v228 offset:9216
    buffer_load_dwordx4 v226, s[40:43], s64 offen offset:2048 lds
    v_mfma_f32_16x16x32_bf16 v[24:27], a[144:147], v[152:155], v[24:27]
    s_add_u32 s64, s64, 98304
    ds_read_b64 v[60:61], v4 offset:2688
    v_mfma_f32_16x16x32_bf16 v[24:27], v[88:91], v[136:139], v[24:27]
    s_sub_u32 s35, s64, 1966080
    ds_read_b64 v[62:63], v4 offset:2696
    v_mfma_f32_16x16x32_bf16 v[36:39], a[152:155], v[156:159], v[36:39]
    s_min_u32 s64, s64, s35
    ds_read_b64_tr_b16 a[32:33], v229 offset:0
    v_mfma_f32_16x16x32_bf16 v[36:39], v[92:95], v[144:147], v[36:39]
    s_add_u32 s24, s23, 135168
    ds_read_b128 v[128:131], v5 offset:640
    v_mfma_f32_16x16x32_bf16 v[32:35], a[148:151], v[156:159], v[32:35]
    ds_read_b64 v[64:65], v4 offset:3200
    buffer_load_dwordx2 v[242:243], v239, s[36:39], s69 offen sc1
    v_mfma_f32_16x16x32_bf16 v[32:35], v[92:95], v[140:143], v[32:35]
    s_sub_u32 s31, s24, 2703360
    ds_read_b64_tr_b16 a[34:35], v229 offset:3072
    v_mfma_f32_16x16x32_bf16 v[28:31], a[144:147], v[156:159], v[28:31]
    s_min_u32 s24, s24, s31
    ds_read_b64 v[66:67], v4 offset:3208
    v_mfma_f32_16x16x32_bf16 v[28:31], v[92:95], v[136:139], v[28:31]
    s_add_u32 s25, s24, 135168
    ds_read_b128 v[132:135], v5 offset:128
    v_mfma_f32_16x16x32_bf16 v[36:39], a[148:151], v[160:163], v[36:39]
    s_sub_u32 s31, s25, 2703360
    v_mfma_f32_16x16x32_bf16 v[36:39], v[96:99], v[140:143], v[36:39]
    s_min_u32 s25, s25, s31
    ds_read_b64 v[68:69], v4 offset:3712
    v_mfma_f32_16x16x32_bf16 v[32:35], a[144:147], v[160:163], v[32:35]
    s_waitcnt vmcnt(10)
    s_waitcnt lgkmcnt(3)
    s_barrier
    ds_read_b64 v[70:71], v4 offset:3720
    ds_read_b64_tr_b16 a[36:37], v227 offset:12288
    v_mfma_f32_16x16x32_bf16 v[32:35], v[96:99], v[136:139], v[32:35]
    s_add_u32 m0, s61, 102400
    ds_read_b128 v[184:187], v7 offset:0
    ds_read_b64_tr_b16 a[38:39], v227 offset:15360
    buffer_load_dwordx4 v224, s[40:43], s64 offen offset:0 lds
    v_mfma_f32_16x16x32_bf16 v[36:39], a[144:147], v[164:167], v[36:39]
    s_add_u32 s26, s25, 135168
    ds_read_b128 v[200:203], v7 offset:4096
    ds_read_b64_tr_b16 a[40:41], v228 offset:18432
    v_mfma_f32_16x16x32_bf16 v[36:39], v[100:103], v[136:139], v[36:39]
    ds_read_b64 v[176:177], v249 offset:0
    ds_read_b64_tr_b16 a[42:43], v228 offset:21504
    v_mfma_f32_16x16x32_bf16 v[24:27], a[168:171], v[112:115], v[24:27]
    s_sub_u32 s31, s26, 2703360
    ds_read_b128 v[144:147], v5 offset:2752
    ds_read_b64_tr_b16 a[44:45], v229 offset:12288
    v_mfma_f32_16x16x32_bf16 v[28:31], a[168:171], v[116:119], v[28:31]
    s_min_u32 s26, s26, s31
    ds_read_b128 v[148:151], v5 offset:2240
    ds_read_b64_tr_b16 a[46:47], v229 offset:15360
    v_mfma_f32_16x16x32_bf16 v[28:31], a[172:175], v[112:115], v[28:31]
    s_add_u32 m0, s61, 102400
    ds_read_b128 v[188:191], v7 offset:1024
    buffer_load_dwordx4 v225, s[40:43], s64 offen offset:1024 lds
    v_mfma_f32_16x16x32_bf16 v[32:35], a[172:175], v[116:119], v[32:35]
    s_add_u32 s27, s26, 135168
    ds_read_b128 v[140:143], v5 offset:3264
    v_mfma_f32_16x16x32_bf16 v[24:27], a[164:167], v[116:119], v[24:27]
    s_sub_u32 s31, s27, 2703360
    ds_read_b128 v[152:155], v5 offset:1728
    v_mfma_f32_16x16x32_bf16 v[24:27], a[172:175], v[108:111], v[24:27]
    s_min_u32 s27, s27, s31
    ds_read_b128 v[204:207], v7 offset:5120
    v_mfma_f32_16x16x32_bf16 v[32:35], a[168:171], v[120:123], v[32:35]
    s_waitcnt lgkmcnt(4)
    s_waitcnt vmcnt(9)
    s_barrier
    ds_read_b64 v[88:89], v4 offset:2240
    ds_read_b64_tr_b16 a[48:49], v227 offset:24576
    v_mfma_f32_16x16x32_bf16 v[32:35], v[56:59], v[112:115], v[32:35]
    s_add_u32 m0, s61, 102400
    ds_read_b64 v[90:91], v4 offset:2248
    ds_read_b64_tr_b16 a[50:51], v227 offset:27648
    buffer_load_dwordx4 v226, s[40:43], s64 offen offset:2048 lds
    v_mfma_f32_16x16x32_bf16 v[36:39], a[172:175], v[120:123], v[36:39]
    s_add_u32 s64, s64, 98304
    ds_read_b64 v[178:179], v249 offset:512
    ds_read_b64_tr_b16 a[52:53], v228 offset:30720
    v_mfma_f32_16x16x32_bf16 v[36:39], v[56:59], v[116:119], v[36:39]
    s_sub_u32 s35, s64, 1966080
    ds_read_b128 v[136:139], v5 offset:3776
    ds_read_b64_tr_b16 a[54:55], v228 offset:33792
    v_mfma_f32_16x16x32_bf16 v[28:31], a[164:167], v[120:123], v[28:31]
    s_min_u32 s64, s64, s35
    ds_read_b128 v[156:159], v5 offset:1216
    ds_read_b64_tr_b16 a[56:57], v229 offset:24576
    v_mfma_f32_16x16x32_bf16 v[28:31], v[56:59], v[108:111], v[28:31]
    ds_read_b128 v[192:195], v7 offset:2048
    ds_read_b64_tr_b16 a[58:59], v229 offset:27648
    v_mfma_f32_16x16x32_bf16 v[24:27], a[160:163], v[120:123], v[24:27]
    s_add_u32 m0, s61, 114688
    ds_read_b64 v[92:93], v4 offset:2752
    buffer_load_dwordx4 v224, s[40:43], s64 offen offset:0 lds
    v_mfma_f32_16x16x32_bf16 v[24:27], v[56:59], v[104:107], v[24:27]
    s_add_u32 s44, s27, 135168
    ds_read_b64 v[94:95], v4 offset:2760
    v_mfma_f32_16x16x32_bf16 v[36:39], a[168:171], v[124:127], v[36:39]
    s_sub_u32 s31, s44, 2703360
    ds_read_b128 v[208:211], v7 offset:6144
    v_mfma_f32_16x16x32_bf16 v[36:39], v[60:63], v[112:115], v[36:39]
    s_min_u32 s44, s44, s31
    ds_read_b128 v[160:163], v5 offset:704
    v_mfma_f32_16x16x32_bf16 v[32:35], a[164:167], v[124:127], v[32:35]
    s_waitcnt lgkmcnt(4)
    s_waitcnt vmcnt(8)
    s_barrier
    ds_read_b64 v[96:97], v4 offset:3264
    ds_read_b64_tr_b16 a[60:61], v227 offset:36864
    v_mfma_f32_16x16x32_bf16 v[32:35], v[60:63], v[108:111], v[32:35]
    s_add_u32 m0, s61, 114688
    ds_read_b64 v[180:181], v249 offset:1024
    ds_read_b64_tr_b16 a[62:63], v227 offset:39936
    buffer_load_dwordx4 v225, s[40:43], s64 offen offset:1024 lds
    v_mfma_f32_16x16x32_bf16 v[28:31], a[160:163], v[124:127], v[28:31]
    s_add_u32 s45, s44, 135168
    ds_read_b64 v[98:99], v4 offset:3272
    ds_read_b64_tr_b16 a[64:65], v228 offset:43008
    v_mfma_f32_16x16x32_bf16 v[28:31], v[60:63], v[104:107], v[28:31]
    s_sub_u32 s31, s45, 2703360
    ds_read_b128 v[164:167], v5 offset:192
    ds_read_b64_tr_b16 a[66:67], v228 offset:46080
    v_mfma_f32_16x16x32_bf16 v[36:39], a[164:167], v[128:131], v[36:39]
    s_min_u32 s45, s45, s31
    ds_read_b128 v[196:199], v7 offset:3072
    ds_read_b64_tr_b16 a[68:69], v229 offset:36864
    v_mfma_f32_16x16x32_bf16 v[36:39], v[64:67], v[108:111], v[36:39]
    s_add_u32 m0, s61, 114688
    ds_read_b64 v[100:101], v4 offset:3776
    buffer_load_dwordx4 v226, s[40:43], s64 offen offset:2048 lds
    v_mfma_f32_16x16x32_bf16 v[32:35], a[160:163], v[128:131], v[32:35]
    s_add_u32 s64, s64, 98304
    ds_read_b64 v[102:103], v4 offset:3784
    v_mfma_f32_16x16x32_bf16 v[32:35], v[64:67], v[104:107], v[32:35]
    s_sub_u32 s35, s64, 1966080
    ds_read_b128 v[212:215], v7 offset:7168
    v_mfma_f32_16x16x32_bf16 v[36:39], a[160:163], v[132:135], v[36:39]
    s_min_u32 s64, s64, s35
    ds_read_b64 v[182:183], v249 offset:1536
    v_mfma_f32_16x16x32_bf16 v[36:39], v[68:71], v[104:107], v[36:39]
    s_add_u32 m0, s61, 126976
    ds_read_b64_tr_b16 a[70:71], v229 offset:39936
    buffer_load_dwordx4 v224, s[40:43], s64 offen offset:0 lds
    v_mfma_f32_16x16x32_bf16 v[24:27], a[184:187], v[144:147], v[24:27]
    s_add_u32 s46, s45, 135168
    ds_read_b128 v[112:115], v5 offset:2816
    v_mfma_f32_16x16x32_bf16 v[28:31], a[184:187], v[148:151], v[28:31]
    ds_read_b128 v[116:119], v5 offset:2304
    s_waitcnt vmcnt(7)
    v_cmp_ne_u32 vcc, s48, v243
    s_cbranch_vccnz L_m_slow
L_m_back:
    v_readlane_b32 s50, v242, 2
    v_readlane_b32 s51, v242, 3
    v_readlane_b32 s52, v242, 0
    v_readlane_b32 s53, v242, 1
    v_mov_b32 v253, s51
    v_mul_f32 v252, s50, v253
    v_mul_f32 v251, s52, v252
    v_mul_f32 v252, s53, v252
    v_lshlrev_b32 v232, 16, v176
    v_and_b32 v233, 0xffff0000, v176
    v_lshlrev_b32 v234, 16, v177
    v_and_b32 v235, 0xffff0000, v177
    v_pk_fma_f32 v[184:185], v[232:233], v[184:185], v[200:201]
    v_pk_fma_f32 v[186:187], v[234:235], v[186:187], v[202:203]
    v_pk_mul_f32 v[232:233], v[232:233], v[252:253] op_sel:[0,1] op_sel_hi:[1,1]
    v_pk_mul_f32 v[234:235], v[234:235], v[252:253] op_sel:[0,1] op_sel_hi:[1,1]
    v_pk_fma_f32 v[184:185], v[184:185], v[250:251], v[252:253] op_sel:[0,1,0] op_sel_hi:[1,1,0]
    v_pk_fma_f32 v[186:187], v[186:187], v[250:251], v[252:253] op_sel:[0,1,0] op_sel_hi:[1,1,0]
    v_pk_fma_f32 v[184:185], v[8:9], v[184:185], v[232:233]
    v_pk_fma_f32 v[186:187], v[10:11], v[186:187], v[234:235]
    v_cvt_pk_bf16_f32 v200, v184, v185
    v_cvt_pk_bf16_f32 v201, v186, v187
    v_lshlrev_b32 v236, 16, v178
    v_and_b32 v237, 0xffff0000, v178
    v_lshlrev_b32 v238, 16, v179
    v_and_b32 v239, 0xffff0000, v179
    v_pk_fma_f32 v[188:189], v[236:237], v[188:189], v[204:205]
    v_pk_fma_f32 v[190:191], v[238:239], v[190:191], v[206:207]
    v_pk_mul_f32 v[236:237], v[236:237], v[252:253] op_sel:[0,1] op_sel_hi:[1,1]
    v_pk_mul_f32 v[238:239], v[238:239], v[252:253] op_sel:[0,1] op_sel_hi:[1,1]
    v_pk_fma_f32 v[188:189], v[188:189], v[250:251], v[252:253] op_sel:[0,1,0] op_sel_hi:[1,1,0]
    v_pk_fma_f32 v[190:191], v[190:191], v[250:251], v[252:253] op_sel:[0,1,0] op_sel_hi:[1,1,0]
    v_pk_fma_f32 v[188:189], v[12:13], v[188:189], v[236:237]
    v_pk_fma_f32 v[190:191], v[14:15], v[190:191], v[238:239]
    v_cvt_pk_bf16_f32 v202, v188, v189
    v_cvt_pk_bf16_f32 v203, v190, v191
    s_nop 0
    v_permlane16_swap_b32 v200, v202
    v_permlane16_swap_b32 v201, v203
    buffer_store_dwordx4 v[200:203], v6, s[36:39], s68 offen offset:0 sc1
    s_waitcnt lgkmcnt(14)
    v_lshlrev_b32 v232, 16, v180
    v_and_b32 v233, 0xffff0000, v180
    v_lshlrev_b32 v234, 16, v181
    v_and_b32 v235, 0xffff0000, v181
    v_pk_fma_f32 v[192:193], v[232:233], v[192:193], v[208:209]
    v_pk_fma_f32 v[194:195], v[234:235], v[194:195], v[210:211]
    v_pk_mul_f32 v[232:233], v[232:233], v[252:253] op_sel:[0,1] op_sel_hi:[1,1]
    v_pk_mul_f32 v[234:235], v[234:235], v[252:253] op_sel:[0,1] op_sel_hi:[1,1]
    v_pk_fma_f32 v[192:193], v[192:193], v[250:251], v[252:253] op_sel:[0,1,0] op_sel_hi:[1,1,0]
    v_pk_fma_f32 v[194:195], v[194:195], v[250:251], v[252:253] op_sel:[0,1,0] op_sel_hi:[1,1,0]
    v_pk_fma_f32 v[192:193], v[16:17], v[192:193], v[232:233]
    v_pk_fma_f32 v[194:195], v[18:19], v[194:195], v[234:235]
    v_cvt_pk_bf16_f32 v208, v192, v193
    v_cvt_pk_bf16_f32 v209, v194, v195
    s_waitcnt lgkmcnt(3)
    v_lshlrev_b32 v236, 16, v182
    v_and_b32 v237, 0xffff0000, v182
    v_lshlrev_b32 v238, 16, v183
    v_and_b32 v239, 0xffff0000, v183
    v_pk_fma_f32 v[196:197], v[236:237], v[196:197], v[212:213]
    v_pk_fma_f32 v[198:199], v[238:239], v[198:199], v[214:215]
    v_pk_mul_f32 v[236:237], v[236:237], v[252:253] op_sel:[0,1] op_sel_hi:[1,1]
    v_pk_mul_f32 v[238:239], v[238:239], v[252:253] op_sel:[0,1] op_sel_hi:[1,1]
    v_pk_fma_f32 v[196:197], v[196:197], v[250:251], v[252:253] op_sel:[0,1,0] op_sel_hi:[1,1,0]
    v_pk_fma_f32 v[198:199], v[198:199], v[250:251], v[252:253] op_sel:[0,1,0] op_sel_hi:[1,1,0]
    v_pk_fma_f32 v[196:197], v[20:21], v[196:197], v[236:237]
    v_pk_fma_f32 v[198:199], v[22:23], v[198:199], v[238:239]
    v_cvt_pk_bf16_f32 v210, v196, v197
    v_cvt_pk_bf16_f32 v211, v198, v199
    s_nop 0
    v_permlane16_swap_b32 v208, v210
    v_permlane16_swap_b32 v209, v211
    buffer_store_dwordx4 v[208:211], v6, s[36:39], s68 offen offset:1024 sc1
    v_mfma_f32_16x16x32_bf16 v[28:31], a[188:191], v[144:147], v[28:31]
    s_sub_u32 s31, s46, 2703360
    v_mov_b32 v239, 126976
    v_mov_b32 v237, 1024
    v_mfma_f32_16x16x32_bf16 v[32:35], a[188:191], v[148:151], v[32:35]
    s_waitcnt lgkmcnt(2)
    s_barrier
    ds_read_b128 v[108:111], v5 offset:3328
    ds_read_b64_tr_b16 a[72:73], v227 offset:49152
    v_mfma_f32_16x16x32_bf16 v[24:27], a[180:183], v[148:151], v[24:27]
    s_add_u32 m0, s61, 126976
    ds_read_b128 v[120:123], v5 offset:1792
    ds_read_b64_tr_b16 a[74:75], v227 offset:52224
    buffer_load_dwordx4 v225, s[40:43], s64 offen offset:1024 lds
    v_mfma_f32_16x16x32_bf16 v[24:27], a[188:191], v[140:143], v[24:27]
    s_min_u32 s46, s46, s31
    v_cmp_lt_u32 vcc, 7, v1
    s_nop 1
    v_cndmask_b32 v239, v239, v237, vcc
    v_mfma_f32_16x16x32_bf16 v[32:35], a[184:187], v[152:155], v[32:35]
    s_add_u32 s47, s46, 135168
    ds_read_b64 v[56:57], v4 offset:2304
    v_add_u32 v230, v230, v239
    v_mfma_f32_16x16x32_bf16 v[32:35], v[88:91], v[144:147], v[32:35]
    s_sub_u32 s31, s47, 2703360
    ds_read_b64 v[58:59], v4 offset:2312
    v_min_u32 v239, 25, v1
    v_mfma_f32_16x16x32_bf16 v[36:39], a[188:191], v[152:155], v[36:39]
    s_add_u32 m0, s61, 126976
    v_lshlrev_b32 v239, 7, v239
    v_add_u32 v239, 101376, v239
    buffer_load_dwordx4 v226, s[40:43], s64 offen offset:2048 lds
    v_mfma_f32_16x16x32_bf16 v[36:39], v[88:91], v[148:151], v[36:39]
    s_add_u32 s64, s64, 98304
    ds_read_b128 v[104:107], v5 offset:3840
    ds_read_b64_tr_b16 a[76:77], v228 offset:55296
    v_mfma_f32_16x16x32_bf16 v[28:31], a[180:183], v[152:155], v[28:31]
    s_sub_u32 s35, s64, 1966080
    ds_read_b128 v[124:127], v5 offset:1280
    v_mfma_f32_16x16x32_bf16 v[28:31], v[88:91], v[140:143], v[28:31]
    v_cmp_lt_u32 vcc, 15, v1
    s_nop 1
    v_cndmask_b32 v238, v230, v239, vcc
    v_mfma_f32_16x16x32_bf16 v[24:27], a[176:179], v[152:155], v[24:27]
    s_min_u32 s64, s64, s35
    ds_read_b64 v[60:61], v4 offset:2816
    buffer_load_dword v240, v238, s[36:39], s17 offen sc1
    v_mfma_f32_16x16x32_bf16 v[24:27], v[88:91], v[136:139], v[24:27]
    s_min_u32 s47, s47, s31
    ds_read_b64 v[62:63], v4 offset:2824
    v_mfma_f32_16x16x32_bf16 v[36:39], a[184:187], v[156:159], v[36:39]
    ds_read_b64_tr_b16 a[78:79], v228 offset:58368
    v_mfma_f32_16x16x32_bf16 v[36:39], v[92:95], v[144:147], v[36:39]
    s_add_u32 m0, s61, 139264
    ds_read_b128 v[128:131], v5 offset:768
    buffer_load_dwordx4 v224, s[40:43], s64 offen offset:0 lds
    v_mfma_f32_16x16x32_bf16 v[32:35], a[180:183], v[156:159], v[32:35]
    ds_read_b64 v[64:65], v4 offset:3328
    v_mfma_f32_16x16x32_bf16 v[32:35], v[92:95], v[140:143], v[32:35]
    ds_read_b64_tr_b16 a[80:81], v229 offset:49152
    v_mfma_f32_16x16x32_bf16 v[28:31], a[176:179], v[156:159], v[28:31]
    ds_read_b64 v[66:67], v4 offset:3336
    v_mfma_f32_16x16x32_bf16 v[28:31], v[92:95], v[136:139], v[28:31]
    s_add_u32 m0, s61, 139264
    ds_read_b128 v[132:135], v5 offset:256
    buffer_load_dwordx4 v225, s[40:43], s64 offen offset:1024 lds
    v_mfma_f32_16x16x32_bf16 v[36:39], a[180:183], v[160:163], v[36:39]
    ds_read_b64_tr_b16 a[82:83], v229 offset:52224
    v_mfma_f32_16x16x32_bf16 v[36:39], v[96:99], v[140:143], v[36:39]
    s_waitcnt vmcnt(5)
    s_barrier
    s_cmp_eq_u32 s3, 0
    s_cbranch_scc0 L_wf6
    s_and_b32 s54, s70, 1
    s_mul_i32 s54, s54, -60
    v_mov_b32 v254, s54
    s_lshl_b32 s54, s70, 6
    v_add_u32 v254, s54, v254
    s_mov_b32 s54, 23312384
    v_mov_b32 v255, s48
    s_mov_b64 exec, 1
    buffer_store_dword v255, v254, s[36:39], s54 offen sc1
    s_mov_b64 exec, -1
L_wf6:
    ds_read_b64 v[68:69], v4 offset:3840
    v_mfma_f32_16x16x32_bf16 v[32:35], a[176:179], v[160:163], v[32:35]
    s_add_u32 m0, s61, 139264
    ds_read_b64 v[70:71], v4 offset:3848
    v_mfma_f32_16x16x32_bf16 v[32:35], v[96:99], v[136:139], v[32:35]
    buffer_load_dwordx4 v226, s[40:43], s64 offen offset:2048 lds
    v_mfma_f32_16x16x32_bf16 v[36:39], a[176:179], v[164:167], v[36:39]
    s_add_u32 s64, s64, 98304
    s_waitcnt lgkmcnt(2)
    s_barrier
    ds_read_b64_tr_b16 a[84:85], v227 offset:0
    v_mfma_f32_16x16x32_bf16 v[36:39], v[100:103], v[136:139], v[36:39]
    ds_read_b64_tr_b16 a[86:87], v227 offset:3072
    v_mfma_f32_16x16x32_bf16 v[24:27], a[200:203], v[112:115], v[24:27]
    s_sub_u32 s35, s64, 1966080
    ds_read_b128 v[144:147], v5 offset:2880
    v_mfma_f32_16x16x32_bf16 v[28:31], a[200:203], v[116:119], v[28:31]
    s_min_u32 s64, s64, s35
    s_add_u32 m0, s61, 151552
    ds_read_b128 v[148:151], v5 offset:2368
    buffer_load_dwordx4 v224, s[40:43], s64 offen offset:0 lds
    v_mfma_f32_16x16x32_bf16 v[28:31], a[204:207], v[112:115], v[28:31]
    ds_read_b64_tr_b16 a[88:89], v228 offset:6144
    v_mfma_f32_16x16x32_bf16 v[32:35], a[204:207], v[116:119], v[32:35]
    ds_read_b128 v[140:143], v5 offset:3392
    v_mfma_f32_16x16x32_bf16 v[24:27], a[196:199], v[116:119], v[24:27]
    ds_read_b128 v[152:155], v5 offset:1856
    v_mfma_f32_16x16x32_bf16 v[24:27], a[204:207], v[108:111], v[24:27]
    s_add_u32 m0, s61, 151552
    ds_read_b64_tr_b16 a[90:91], v228 offset:9216
    buffer_load_dwordx4 v225, s[40:43], s64 offen offset:1024 lds
    v_mfma_f32_16x16x32_bf16 v[32:35], a[200:203], v[120:123], v[32:35]
    ds_read_b64 v[88:89], v4 offset:2368
    v_mfma_f32_16x16x32_bf16 v[32:35], v[56:59], v[112:115], v[32:35]
    ds_read_b64 v[90:91], v4 offset:2376
    v_mfma_f32_16x16x32_bf16 v[36:39], a[204:207], v[120:123], v[36:39]
    ds_read_b64_tr_b16 a[92:93], v229 offset:0
    v_mfma_f32_16x16x32_bf16 v[36:39], v[56:59], v[116:119], v[36:39]
    s_add_u32 m0, s61, 151552
    ds_read_b128 v[136:139], v5 offset:3904
    buffer_load_dwordx4 v226, s[40:43], s64 offen offset:2048 lds
    v_mfma_f32_16x16x32_bf16 v[28:31], a[196:199], v[120:123], v[28:31]
    s_add_u32 s64, s64, 98304
    ds_read_b128 v[156:159], v5 offset:1344
    v_mfma_f32_16x16x32_bf16 v[28:31], v[56:59], v[108:111], v[28:31]
    s_waitcnt lgkmcnt(13)
    ds_read_b64_tr_b16 a[94:95], v229 offset:3072
    v_mfma_f32_16x16x32_bf16 v[24:27], a[192:195], v[120:123], v[24:27]
    s_sub_u32 s35, s64, 1966080
    ds_read_b64 v[92:93], v4 offset:2880
    v_mfma_f32_16x16x32_bf16 v[24:27], v[56:59], v[104:107], v[24:27]
    s_min_u32 s64, s64, s35
    ds_read_b64 v[94:95], v4 offset:2888
    v_mfma_f32_16x16x32_bf16 v[36:39], a[200:203], v[124:127], v[36:39]
    v_mfma_f32_16x16x32_bf16 v[36:39], v[60:63], v[112:115], v[36:39]
    s_waitcnt lgkmcnt(2)
    s_barrier
    ds_read_b128 v[160:163], v5 offset:832
    s_waitcnt vmcnt(6)
    v_cmp_ne_u32 vcc, s48, v240
    s_cbranch_vccnz L_chk7_slow
L_chk7_back:
    v_mfma_f32_16x16x32_bf16 v[32:35], a[196:199], v[124:127], v[32:35]
    s_add_u32 m0, s66, 84992
    ds_read_b64 v[96:97], v4 offset:3392
    buffer_load_dwordx4 v248, s[36:39], s67 offen offset:0 sc1 lds
    v_mfma_f32_16x16x32_bf16 v[32:35], v[60:63], v[108:111], v[32:35]
    s_add_u32 s67, s67, 8192
    ds_read_b64_tr_b16 a[96:97], v227 offset:12288
    v_mfma_f32_16x16x32_bf16 v[28:31], a[192:195], v[124:127], v[28:31]
    ds_read_b64 v[98:99], v4 offset:3400
    v_mfma_f32_16x16x32_bf16 v[28:31], v[60:63], v[104:107], v[28:31]
    ds_read_b128 v[164:167], v5 offset:320
    v_mfma_f32_16x16x32_bf16 v[36:39], a[196:199], v[128:131], v[36:39]
    s_add_u32 m0, s66, 89088
    ds_read_b64_tr_b16 a[98:99], v227 offset:15360
    buffer_load_dwordx4 v248, s[36:39], s67 offen offset:0 sc1 lds
    v_mfma_f32_16x16x32_bf16 v[36:39], v[64:67], v[108:111], v[36:39]
    s_sub_u32 s67, s67, 4096
    ds_read_b64 v[100:101], v4 offset:3904
    v_mfma_f32_16x16x32_bf16 v[32:35], a[192:195], v[128:131], v[32:35]
    ds_read_b64 v[102:103], v4 offset:3912
    v_mfma_f32_16x16x32_bf16 v[32:35], v[64:67], v[104:107], v[32:35]
    ds_read_b64_tr_b16 a[100:101], v228 offset:18432
    v_mfma_f32_16x16x32_bf16 v[36:39], a[192:195], v[132:135], v[36:39]
    s_add_u32 m0, s62, 93184
    ds_read_b64_tr_b16 a[102:103], v228 offset:21504
    buffer_load_dwordx4 v248, s[36:39], s65 offen offset:0 sc1 lds
    v_mfma_f32_16x16x32_bf16 v[36:39], v[68:71], v[104:107], v[36:39]
    ds_read_b64_tr_b16 a[104:105], v229 offset:12288
    v_mfma_f32_16x16x32_bf16 v[24:27], a[216:219], v[144:147], v[24:27]
    ds_read_b128 v[112:115], v5 offset:2944
    v_mfma_f32_16x16x32_bf16 v[28:31], a[216:219], v[148:151], v[28:31]
    ds_read_b128 v[116:119], v5 offset:2432
    v_mfma_f32_16x16x32_bf16 v[28:31], a[220:223], v[144:147], v[28:31]
    s_add_u32 m0, s62, 93184
    ds_read_b64_tr_b16 a[106:107], v229 offset:15360
    buffer_load_dwordx4 v248, s[36:39], s65 offen offset:1024 sc1 lds
    v_mfma_f32_16x16x32_bf16 v[32:35], a[220:223], v[148:151], v[32:35]
    ds_read_b128 v[108:111], v5 offset:3456
    v_mfma_f32_16x16x32_bf16 v[24:27], a[212:215], v[148:151], v[24:27]
    ds_read_b128 v[120:123], v5 offset:1920
    v_mfma_f32_16x16x32_bf16 v[24:27], a[220:223], v[140:143], v[24:27]
    s_lshl_b32 s65, s75, 2
    s_add_u32 s65, s65, s3
    v_mfma_f32_16x16x32_bf16 v[32:35], a[216:219], v[152:155], v[32:35]
    s_waitcnt lgkmcnt(2)
    s_barrier
    ds_read_b64 v[56:57], v4 offset:2432
    v_mfma_f32_16x16x32_bf16 v[32:35], v[88:91], v[144:147], v[32:35]
    ds_read_b64 v[58:59], v4 offset:2440
    buffer_load_dword v220, v220, s[36:39], s77 offen sc1
    v_mfma_f32_16x16x32_bf16 v[36:39], a[220:223], v[152:155], v[36:39]
    s_mul_i32 s65, s65, 61952
    s_add_u32 s65, s65, 12582912
    ds_read_b64_tr_b16 a[108:109], v227 offset:24576
    v_mfma_f32_16x16x32_bf16 v[36:39], v[88:91], v[148:151], v[36:39]
    ds_read_b128 v[104:107], v5 offset:3968
    buffer_load_dword v221, v221, s[36:39], s77 offen sc1
    v_mfma_f32_16x16x32_bf16 v[28:31], a[212:215], v[152:155], v[28:31]
    s_mov_b32 s16, 0
    s_and_b32 s16, s16, 3
    ds_read_b128 v[124:127], v5 offset:1408
    v_mfma_f32_16x16x32_bf16 v[28:31], v[88:91], v[140:143], v[28:31]
    ds_read_b64_tr_b16 a[110:111], v227 offset:27648
    buffer_load_dword v222, v222, s[36:39], s77 offen sc1
    v_mfma_f32_16x16x32_bf16 v[24:27], a[208:211], v[152:155], v[24:27]
    s_add_u32 s62, s16, 0
    s_and_b32 s62, s62, 3
    ds_read_b64 v[60:61], v4 offset:2944
    v_mfma_f32_16x16x32_bf16 v[24:27], v[88:91], v[136:139], v[24:27]
    s_add_u32 m0, s61, 102400
    ds_read_b64 v[62:63], v4 offset:2952
    buffer_load_dwordx4 v224, s[40:43], s64 offen offset:0 lds
    v_mfma_f32_16x16x32_bf16 v[36:39], a[216:219], v[156:159], v[36:39]
    s_mul_i32 s62, s62, 15360
    s_add_u32 s62, s62, s65
    ds_read_b64_tr_b16 a[112:113], v228 offset:30720
    v_mfma_f32_16x16x32_bf16 v[36:39], v[92:95], v[144:147], v[36:39]
    ds_read_b128 v[128:131], v5 offset:896
    v_mfma_f32_16x16x32_bf16 v[32:35], a[212:215], v[156:159], v[32:35]
    ds_read_b64 v[64:65], v4 offset:3456
    v_mfma_f32_16x16x32_bf16 v[32:35], v[92:95], v[140:143], v[32:35]
    s_add_u32 m0, s61, 102400
    ds_read_b64_tr_b16 a[114:115], v228 offset:33792
    buffer_load_dwordx4 v225, s[40:43], s64 offen offset:1024 lds
    v_mfma_f32_16x16x32_bf16 v[28:31], a[208:211], v[156:159], v[28:31]
    ds_read_b64 v[66:67], v4 offset:3464
    v_mfma_f32_16x16x32_bf16 v[28:31], v[92:95], v[136:139], v[28:31]
    ds_read_b128 v[132:135], v5 offset:384
    v_mfma_f32_16x16x32_bf16 v[36:39], a[212:215], v[160:163], v[36:39]
    ds_read_b64_tr_b16 a[116:117], v229 offset:24576
    v_mfma_f32_16x16x32_bf16 v[36:39], v[96:99], v[140:143], v[36:39]
    s_add_u32 m0, s61, 102400
    ds_read_b64 v[68:69], v4 offset:3968
    buffer_load_dwordx4 v226, s[40:43], s64 offen offset:2048 lds
    v_mfma_f32_16x16x32_bf16 v[32:35], a[208:211], v[160:163], v[32:35]
    s_add_u32 s64, s64, 98304
    ds_read_b64 v[70:71], v4 offset:3976
    v_mfma_f32_16x16x32_bf16 v[32:35], v[96:99], v[136:139], v[32:35]
    s_sub_u32 s35, s64, 1966080
    ds_read_b64_tr_b16 a[118:119], v229 offset:27648
    v_mfma_f32_16x16x32_bf16 v[36:39], a[208:211], v[164:167], v[36:39]
    s_min_u32 s64, s64, s35
    v_mfma_f32_16x16x32_bf16 v[36:39], v[100:103], v[136:139], v[36:39]
    s_waitcnt lgkmcnt(14)
    s_add_u32 m0, s61, 114688
    s_nop 0
    buffer_load_dwordx4 v224, s[40:43], s64 offen offset:0 lds
    v_mfma_f32_16x16x32_bf16 v[24:27], a[232:235], v[112:115], v[24:27]
    ds_read_b128 v[144:147], v5 offset:3008
    v_mfma_f32_16x16x32_bf16 v[28:31], a[232:235], v[116:119], v[28:31]
    s_waitcnt lgkmcnt(1)
    s_waitcnt vmcnt(14)
    s_barrier
    ds_read_b128 v[148:151], v5 offset:2496
    v_mfma_f32_16x16x32_bf16 v[28:31], a[236:239], v[112:115], v[28:31]
    ds_read_b64_tr_b16 a[120:121], v227 offset:36864
    v_mfma_f32_16x16x32_bf16 v[32:35], a[236:239], v[116:119], v[32:35]
    s_add_u32 m0, s61, 114688
    ds_read_b128 v[140:143], v5 offset:3520
    buffer_load_dwordx4 v225, s[40:43], s64 offen offset:1024 lds
    v_mfma_f32_16x16x32_bf16 v[24:27], a[228:231], v[116:119], v[24:27]
    ds_read_b128 v[152:155], v5 offset:1984
    v_mfma_f32_16x16x32_bf16 v[24:27], a[236:239], v[108:111], v[24:27]
    ds_read_b64_tr_b16 a[122:123], v227 offset:39936
    v_mfma_f32_16x16x32_bf16 v[32:35], a[232:235], v[120:123], v[32:35]
    ds_read_b64 v[88:89], v4 offset:2496
    v_mfma_f32_16x16x32_bf16 v[32:35], v[56:59], v[112:115], v[32:35]
    s_add_u32 m0, s61, 114688
    ds_read_b64 v[90:91], v4 offset:2504
    buffer_load_dwordx4 v226, s[40:43], s64 offen offset:2048 lds
    v_mfma_f32_16x16x32_bf16 v[36:39], a[236:239], v[120:123], v[36:39]
    s_add_u32 s64, s64, 98304
    ds_read_b64_tr_b16 a[124:125], v228 offset:43008
    v_mfma_f32_16x16x32_bf16 v[36:39], v[56:59], v[116:119], v[36:39]
    s_sub_u32 s35, s64, 1966080
    ds_read_b128 v[136:139], v5 offset:4032
    v_mfma_f32_16x16x32_bf16 v[28:31], a[228:231], v[120:123], v[28:31]
    s_min_u32 s64, s64, s35
    ds_read_b128 v[156:159], v5 offset:1472
    v_mfma_f32_16x16x32_bf16 v[28:31], v[56:59], v[108:111], v[28:31]
    s_add_u32 m0, s61, 126976
    ds_read_b64_tr_b16 a[126:127], v228 offset:46080
    buffer_load_dwordx4 v224, s[40:43], s64 offen offset:0 lds
    v_mfma_f32_16x16x32_bf16 v[24:27], a[224:227], v[120:123], v[24:27]
    ds_read_b64 v[92:93], v4 offset:3008
    v_mfma_f32_16x16x32_bf16 v[24:27], v[56:59], v[104:107], v[24:27]
    ds_read_b64 v[94:95], v4 offset:3016
    v_mfma_f32_16x16x32_bf16 v[36:39], a[232:235], v[124:127], v[36:39]
    ds_read_b64_tr_b16 a[128:129], v229 offset:36864
    v_mfma_f32_16x16x32_bf16 v[36:39], v[60:63], v[112:115], v[36:39]
    s_add_u32 m0, s61, 126976
    ds_read_b128 v[160:163], v5 offset:960
    buffer_load_dwordx4 v225, s[40:43], s64 offen offset:1024 lds
    v_mfma_f32_16x16x32_bf16 v[32:35], a[228:231], v[124:127], v[32:35]
    ds_read_b64 v[96:97], v4 offset:3520
    v_mfma_f32_16x16x32_bf16 v[32:35], v[60:63], v[108:111], v[32:35]
    ds_read_b64_tr_b16 a[130:131], v229 offset:39936
    v_mfma_f32_16x16x32_bf16 v[28:31], a[224:227], v[124:127], v[28:31]
    ds_read_b64 v[98:99], v4 offset:3528
    v_mfma_f32_16x16x32_bf16 v[28:31], v[60:63], v[104:107], v[28:31]
    s_add_u32 m0, s61, 126976
    ds_read_b128 v[164:167], v5 offset:448
    buffer_load_dwordx4 v226, s[40:43], s64 offen offset:2048 lds
    v_mfma_f32_16x16x32_bf16 v[36:39], a[228:231], v[128:131], v[36:39]
    s_add_u32 s64, s64, 98304
    v_mfma_f32_16x16x32_bf16 v[36:39], v[64:67], v[108:111], v[36:39]
    s_sub_u32 s35, s64, 1966080
    s_waitcnt lgkmcnt(2)
    s_waitcnt vmcnt(16)
    s_barrier
    ds_read_b64 v[100:101], v4 offset:4032
    v_mfma_f32_16x16x32_bf16 v[32:35], a[224:227], v[128:131], v[32:35]
    s_min_u32 s64, s64, s35
    ds_read_b64 v[102:103], v4 offset:4040
    v_mfma_f32_16x16x32_bf16 v[32:35], v[64:67], v[104:107], v[32:35]
    s_add_u32 m0, s61, 139264
    ds_read_b64_tr_b16 a[132:133], v227 offset:49152
    buffer_load_dwordx4 v224, s[40:43], s64 offen offset:0 lds
    v_mfma_f32_16x16x32_bf16 v[36:39], a[224:227], v[132:135], v[36:39]
    ds_read_b64_tr_b16 a[134:135], v227 offset:52224
    v_mfma_f32_16x16x32_bf16 v[36:39], v[68:71], v[104:107], v[36:39]
    ds_read_b64_tr_b16 a[136:137], v228 offset:55296
    v_mfma_f32_16x16x32_bf16 v[24:27], a[248:251], v[144:147], v[24:27]
    s_waitcnt vmcnt(13)
    s_barrier
    ds_read_b64_tr_b16 a[138:139], v228 offset:58368
    ds_read_b64_tr_b16 a[140:141], v229 offset:49152
    v_mfma_f32_16x16x32_bf16 v[28:31], a[248:251], v[148:151], v[28:31]
    ds_read_b128 v[184:187], v7 offset:0
    ds_read_b64_tr_b16 a[142:143], v229 offset:52224
    v_mfma_f32_16x16x32_bf16 v[28:31], a[252:255], v[144:147], v[28:31]
    s_add_u32 m0, s61, 139264
    ds_read_b128 v[200:203], v7 offset:4096
    buffer_load_dwordx4 v225, s[40:43], s64 offen offset:1024 lds
    v_mfma_f32_16x16x32_bf16 v[32:35], a[252:255], v[148:151], v[32:35]
    ds_read_b64 v[176:177], v249 offset:0
    v_mfma_f32_16x16x32_bf16 v[24:27], a[244:247], v[148:151], v[24:27]
    ds_read_b128 v[188:191], v7 offset:1024
    v_mfma_f32_16x16x32_bf16 v[24:27], a[252:255], v[140:143], v[24:27]
    s_waitcnt lgkmcnt(3)
    s_waitcnt vmcnt(8)
    s_barrier
    ds_read_b128 v[204:207], v7 offset:5120
    ds_read_b64_tr_b16 a[144:145], v227 offset:0
    v_mfma_f32_16x16x32_bf16 v[32:35], a[248:251], v[152:155], v[32:35]
    ds_read_b64 v[178:179], v249 offset:512
    ds_read_b64_tr_b16 a[146:147], v227 offset:3072
    buffer_load_dword v223, v219, s[36:39], s17 offen sc1
    v_mfma_f32_16x16x32_bf16 v[32:35], v[88:91], v[144:147], v[32:35]
    ds_read_b128 v[192:195], v7 offset:2048
    ds_read_b64_tr_b16 a[148:149], v228 offset:6144
    v_mfma_f32_16x16x32_bf16 v[36:39], a[252:255], v[152:155], v[36:39]
    ds_read_b128 v[208:211], v7 offset:6144
    ds_read_b64_tr_b16 a[150:151], v228 offset:9216
    v_mfma_f32_16x16x32_bf16 v[36:39], v[88:91], v[148:151], v[36:39]
    s_add_u32 m0, s61, 139264
    ds_read_b64 v[180:181], v249 offset:1024
    buffer_load_dwordx4 v226, s[40:43], s64 offen offset:2048 lds
    v_mfma_f32_16x16x32_bf16 v[28:31], a[244:247], v[152:155], v[28:31]
    s_add_u32 s64, s64, 98304
    ds_read_b128 v[196:199], v7 offset:3072
    v_mfma_f32_16x16x32_bf16 v[28:31], v[88:91], v[140:143], v[28:31]
    ds_read_b128 v[212:215], v7 offset:7168
    v_mfma_f32_16x16x32_bf16 v[24:27], a[240:243], v[152:155], v[24:27]
    s_sub_u32 s35, s64, 1966080
    ds_read_b64 v[182:183], v249 offset:1536
    v_mfma_f32_16x16x32_bf16 v[24:27], v[88:91], v[136:139], v[24:27]
    s_min_u32 s64, s64, s35
    ds_read_b64_tr_b16 a[152:153], v229 offset:0
    v_mfma_f32_16x16x32_bf16 v[36:39], a[248:251], v[156:159], v[36:39]
    ds_read_b64_tr_b16 a[154:155], v229 offset:3072
    v_mfma_f32_16x16x32_bf16 v[36:39], v[92:95], v[144:147], v[36:39]
    v_mfma_f32_16x16x32_bf16 v[32:35], a[244:247], v[156:159], v[32:35]
    v_mfma_f32_16x16x32_bf16 v[32:35], v[92:95], v[140:143], v[32:35]
    v_mfma_f32_16x16x32_bf16 v[28:31], a[240:243], v[156:159], v[28:31]
    v_mfma_f32_16x16x32_bf16 v[28:31], v[92:95], v[136:139], v[28:31]
    v_mfma_f32_16x16x32_bf16 v[36:39], a[244:247], v[160:163], v[36:39]
    v_mfma_f32_16x16x32_bf16 v[36:39], v[96:99], v[140:143], v[36:39]
    v_mfma_f32_16x16x32_bf16 v[32:35], a[240:243], v[160:163], v[32:35]
    v_mfma_f32_16x16x32_bf16 v[32:35], v[96:99], v[136:139], v[32:35]
    v_mfma_f32_16x16x32_bf16 v[36:39], a[240:243], v[164:167], v[36:39]
    s_waitcnt vmcnt(1)
    v_cmp_ne_u32 vcc, s48, v223
    s_cbranch_vccnz L_chk8_slow
L_chk8_back:
    v_mfma_f32_16x16x32_bf16 v[36:39], v[100:103], v[136:139], v[36:39]
L_convend:
    s_waitcnt lgkmcnt(0)
    s_barrier
    s_add_u32 m0, s63, 0
    s_nop 0
    buffer_load_dwordx4 v172, s[36:39], s10 offen sc1 lds
    s_add_u32 m0, s63, 4096
    s_nop 0
    buffer_load_dwordx4 v172, s[36:39], s11 offen sc1 lds
    v_lshlrev_b32 v40, 16, v176
    v_and_b32 v41, 0xffff0000, v176
    v_lshlrev_b32 v42, 16, v177
    v_and_b32 v43, 0xffff0000, v177
    v_pk_fma_f32 v[184:185], v[40:41], v[184:185], v[200:201]
    v_pk_fma_f32 v[186:187], v[42:43], v[186:187], v[202:203]
    v_pk_mul_f32 v[40:41], v[40:41], v[252:253] op_sel:[0,1] op_sel_hi:[1,1]
    v_pk_mul_f32 v[42:43], v[42:43], v[252:253] op_sel:[0,1] op_sel_hi:[1,1]
    v_pk_fma_f32 v[184:185], v[184:185], v[250:251], v[252:253] op_sel:[0,1,0] op_sel_hi:[1,1,0]
    v_pk_fma_f32 v[186:187], v[186:187], v[250:251], v[252:253] op_sel:[0,1,0] op_sel_hi:[1,1,0]
    v_pk_fma_f32 v[184:185], v[24:25], v[184:185], v[40:41]
    v_pk_fma_f32 v[186:187], v[26:27], v[186:187], v[42:43]
    s_add_u32 m0, s63, 8192
    s_nop 0
    buffer_load_dwordx4 v172, s[36:39], s12 offen sc1 lds
    v_cvt_pk_bf16_f32 v200, v184, v185
    v_cvt_pk_bf16_f32 v201, v186, v187
    v_lshlrev_b32 v44, 16, v178
    v_and_b32 v45, 0xffff0000, v178
    v_lshlrev_b32 v46, 16, v179
    v_and_b32 v47, 0xffff0000, v179
    v_pk_fma_f32 v[188:189], v[44:45], v[188:189], v[204:205]
    v_pk_fma_f32 v[190:191], v[46:47], v[190:191], v[206:207]
    v_pk_mul_f32 v[44:45], v[44:45], v[252:253] op_sel:[0,1] op_sel_hi:[1,1]
    v_pk_mul_f32 v[46:47], v[46:47], v[252:253] op_sel:[0,1] op_sel_hi:[1,1]
    v_pk_fma_f32 v[188:189], v[188:189], v[250:251], v[252:253] op_sel:[0,1,0] op_sel_hi:[1,1,0]
    v_pk_fma_f32 v[190:191], v[190:191], v[250:251], v[252:253] op_sel:[0,1,0] op_sel_hi:[1,1,0]
    s_add_u32 m0, s63, 12288
    s_nop 0
    buffer_load_dwordx4 v172, s[36:39], s13 offen sc1 lds
    v_pk_fma_f32 v[188:189], v[28:29], v[188:189], v[44:45]
    v_pk_fma_f32 v[190:191], v[30:31], v[190:191], v[46:47]
    v_cvt_pk_bf16_f32 v202, v188, v189
    v_cvt_pk_bf16_f32 v203, v190, v191
    s_nop 0
    v_permlane16_swap_b32 v200, v202
    v_permlane16_swap_b32 v201, v203
    buffer_store_dwordx4 v[200:203], v6, s[36:39], s68 offen offset:2048 sc1
    v_lshlrev_b32 v40, 16, v180
    v_and_b32 v41, 0xffff0000, v180
    v_lshlrev_b32 v42, 16, v181
    v_and_b32 v43, 0xffff0000, v181
    v_pk_fma_f32 v[192:193], v[40:41], v[192:193], v[208:209]
    s_add_u32 m0, s63, 16384
    s_nop 0
    buffer_load_dwordx4 v172, s[36:39], s14 offen sc1 lds
    v_pk_fma_f32 v[194:195], v[42:43], v[194:195], v[210:211]
    v_pk_mul_f32 v[40:41], v[40:41], v[252:253] op_sel:[0,1] op_sel_hi:[1,1]
    v_pk_mul_f32 v[42:43], v[42:43], v[252:253] op_sel:[0,1] op_sel_hi:[1,1]
    v_pk_fma_f32 v[192:193], v[192:193], v[250:251], v[252:253] op_sel:[0,1,0] op_sel_hi:[1,1,0]
    v_pk_fma_f32 v[194:195], v[194:195], v[250:251], v[252:253] op_sel:[0,1,0] op_sel_hi:[1,1,0]
    v_pk_fma_f32 v[192:193], v[32:33], v[192:193], v[40:41]
    v_pk_fma_f32 v[194:195], v[34:35], v[194:195], v[42:43]
    v_cvt_pk_bf16_f32 v208, v192, v193
    v_cvt_pk_bf16_f32 v209, v194, v195
    v_lshlrev_b32 v44, 16, v182
    v_and_b32 v45, 0xffff0000, v182
    v_lshlrev_b32 v46, 16, v183
    s_add_u32 m0, s63, 20480
    s_nop 0
    buffer_load_dwordx4 v172, s[36:39], s15 offen sc1 lds
    v_and_b32 v47, 0xffff0000, v183
    v_pk_fma_f32 v[196:197], v[44:45], v[196:197], v[212:213]
    v_pk_fma_f32 v[198:199], v[46:47], v[198:199], v[214:215]
    v_pk_mul_f32 v[44:45], v[44:45], v[252:253] op_sel:[0,1] op_sel_hi:[1,1]
    v_pk_mul_f32 v[46:47], v[46:47], v[252:253] op_sel:[0,1] op_sel_hi:[1,1]
    v_pk_fma_f32 v[196:197], v[196:197], v[250:251], v[252:253] op_sel:[0,1,0] op_sel_hi:[1,1,0]
    v_pk_fma_f32 v[198:199], v[198:199], v[250:251], v[252:253] op_sel:[0,1,0] op_sel_hi:[1,1,0]
    v_pk_fma_f32 v[196:197], v[36:37], v[196:197], v[44:45]
    v_pk_fma_f32 v[198:199], v[38:39], v[198:199], v[46:47]
    v_cvt_pk_bf16_f32 v210, v196, v197
    v_cvt_pk_bf16_f32 v211, v198, v199
    s_nop 0
    v_permlane16_swap_b32 v208, v210
    v_permlane16_swap_b32 v209, v211
    buffer_store_dwordx4 v[208:211], v6, s[36:39], s68 offen offset:3072 sc1
    s_waitcnt vmcnt(7)
    s_barrier
    ds_read_b64_tr_b16 v[104:105], v168 offset:0
    ds_read_b64_tr_b16 v[106:107], v168 offset:2048
    ds_read_b64_tr_b16 v[108:109], v169 offset:0
    ds_read_b64_tr_b16 v[110:111], v169 offset:2048
    ds_read_b64_tr_b16 v[112:113], v170 offset:0
    ds_read_b64_tr_b16 v[114:115], v170 offset:2048
    ds_read_b64_tr_b16 v[116:117], v171 offset:0
    ds_read_b64_tr_b16 v[118:119], v171 offset:2048
    s_waitcnt lgkmcnt(6)
    v_mfma_f32_16x16x32_bf16 v[8:11], a[0:3], v[104:107], 0
    s_waitcnt vmcnt(5)
    s_barrier
    ds_read_b64_tr_b16 v[120:121], v168 offset:4096
    v_mfma_f32_16x16x32_bf16 v[12:15], a[4:7], v[104:107], 0
    s_barrier
    ds_read_b64_tr_b16 v[122:123], v168 offset:6144
    v_min_u32 v243, 23, v1
    v_mfma_f32_16x16x32_bf16 v[16:19], a[8:11], v[104:107], 0
    s_waitcnt lgkmcnt(6)
    s_add_u32 m0, s63, 24576
    ds_read_b64_tr_b16 v[124:125], v169 offset:4096
    v_and_b32 v244, 1, v243
    v_mfma_f32_16x16x32_bf16 v[20:23], a[0:3], v[108:111], 0
    buffer_load_dwordx4 v172, s[36:39], s18 offen sc1 lds
    v_mfma_f32_16x16x32_bf16 v[24:27], a[4:7], v[108:111], 0
    ds_read_b64_tr_b16 v[126:127], v169 offset:6144
    v_lshrrev_b32 v243, 1, v243
    v_mfma_f32_16x16x32_bf16 v[28:31], a[8:11], v[108:111], 0
    s_waitcnt lgkmcnt(6)
    ds_read_b64_tr_b16 v[128:129], v170 offset:4096
    v_lshlrev_b32 v243, 7, v243
    v_mfma_f32_16x16x32_bf16 v[32:35], a[0:3], v[112:115], 0
    s_add_u32 m0, s63, 28672
    ds_read_b64_tr_b16 v[130:131], v170 offset:6144
    v_lshl_add_u32 v243, v244, 2, v243
    v_mfma_f32_16x16x32_bf16 v[36:39], a[4:7], v[112:115], 0
    buffer_load_dwordx4 v172, s[36:39], s19 offen sc1 lds
    v_mfma_f32_16x16x32_bf16 v[40:43], a[8:11], v[112:115], 0
    s_mul_i32 s58, s3, 1536
    s_add_u32 s58, s58, 23273472
    ds_read_b64_tr_b16 v[132:133], v171 offset:4096
    ds_read_b64_tr_b16 a[156:157], v227 offset:12288
    s_waitcnt lgkmcnt(8)
    v_mfma_f32_16x16x32_bf16 v[44:47], a[0:3], v[116:119], 0
    s_waitcnt lgkmcnt(3)
    ds_read_b64_tr_b16 v[134:135], v171 offset:6144
    ds_read_b64_tr_b16 a[158:159], v227 offset:15360
    v_mfma_f32_16x16x32_bf16 v[48:51], a[4:7], v[116:119], 0
    s_add_u32 m0, s63, 32768
    ds_read_b64_tr_b16 a[160:161], v228 offset:18432
    ds_read_b64_tr_b16 a[162:163], v228 offset:21504
    v_mfma_f32_16x16x32_bf16 v[52:55], a[8:11], v[116:119], 0
    buffer_load_dwordx4 v172, s[36:39], s20 offen sc1 lds
    v_mfma_f32_16x16x32_bf16 v[8:11], a[12:15], v[120:123], v[8:11]
    ds_read_b64_tr_b16 v[104:105], v168 offset:8192
    ds_read_b64_tr_b16 a[164:165], v229 offset:12288
    v_mfma_f32_16x16x32_bf16 v[12:15], a[16:19], v[120:123], v[12:15]
    ds_read_b64_tr_b16 v[106:107], v168 offset:10240
    ds_read_b64_tr_b16 a[166:167], v229 offset:15360
    v_mfma_f32_16x16x32_bf16 v[16:19], a[20:23], v[120:123], v[16:19]
    s_add_u32 m0, s63, 36864
    ds_read_b64_tr_b16 v[108:109], v169 offset:8192
    v_mfma_f32_16x16x32_bf16 v[20:23], a[12:15], v[124:127], v[20:23]
    buffer_load_dwordx4 v172, s[36:39], s21 offen sc1 lds
    v_mfma_f32_16x16x32_bf16 v[24:27], a[16:19], v[124:127], v[24:27]
    ds_read_b64_tr_b16 v[110:111], v169 offset:10240
    v_mfma_f32_16x16x32_bf16 v[28:31], a[20:23], v[124:127], v[28:31]
    s_waitcnt lgkmcnt(2)
    s_barrier
    ds_read_b64_tr_b16 v[112:113], v170 offset:8192
    ds_read_b64_tr_b16 a[168:169], v227 offset:24576
    v_mfma_f32_16x16x32_bf16 v[32:35], a[12:15], v[128:131], v[32:35]
    ds_read_b64_tr_b16 v[114:115], v170 offset:10240
    ds_read_b64_tr_b16 a[170:171], v227 offset:27648
    v_mfma_f32_16x16x32_bf16 v[36:39], a[16:19], v[128:131], v[36:39]
    buffer_load_dword v244, v243, s[36:39], s58 offen sc1
    v_mfma_f32_16x16x32_bf16 v[40:43], a[20:23], v[128:131], v[40:43]
    ds_read_b64_tr_b16 v[116:117], v171 offset:8192
    ds_read_b64_tr_b16 a[172:173], v228 offset:30720
    v_mfma_f32_16x16x32_bf16 v[44:47], a[12:15], v[132:135], v[44:47]
    s_waitcnt lgkmcnt(3)
    ds_read_b64_tr_b16 v[118:119], v171 offset:10240
    ds_read_b64_tr_b16 a[174:175], v228 offset:33792
    v_mfma_f32_16x16x32_bf16 v[48:51], a[16:19], v[132:135], v[48:51]
    s_add_u32 m0, s63, 40960
    ds_read_b64_tr_b16 a[176:177], v229 offset:24576
    ds_read_b64_tr_b16 a[178:179], v229 offset:27648
    v_mfma_f32_16x16x32_bf16 v[52:55], a[20:23], v[132:135], v[52:55]
    buffer_load_dwordx4 v172, s[36:39], s22 offen sc1 lds
    v_mfma_f32_16x16x32_bf16 v[8:11], a[24:27], v[104:107], v[8:11]
    s_waitcnt vmcnt(7)
    s_barrier
    ds_read_b64_tr_b16 v[120:121], v168 offset:12288
    v_mfma_f32_16x16x32_bf16 v[12:15], a[28:31], v[104:107], v[12:15]
    ds_read_b64_tr_b16 v[122:123], v168 offset:14336
    v_lshrrev_b32 v210, 5, v1
    v_mfma_f32_16x16x32_bf16 v[16:19], a[32:35], v[104:107], v[16:19]
    s_add_u32 m0, s63, 45056
    s_waitcnt lgkmcnt(2)
    s_waitcnt vmcnt(6)
    s_barrier
    s_cmp_eq_u32 s3, 0
    s_cbranch_scc0 L_wf9
    s_and_b32 s54, s70, 1
    s_mul_i32 s54, s54, -60
    v_mov_b32 v254, s54
    s_lshl_b32 s54, s70, 6
    v_add_u32 v254, s54, v254
    s_mov_b32 s54, 23332864
    v_mov_b32 v255, s48
    s_mov_b64 exec, 1
    buffer_store_dword v255, v254, s[36:39], s54 offen sc1
    s_mov_b64 exec, -1
L_wf9:
    ds_read_b64_tr_b16 v[124:125], v169 offset:12288
    ds_read_b64_tr_b16 a[180:181], v227 offset:36864
    v_mfma_f32_16x16x32_bf16 v[20:23], a[24:27], v[108:111], v[20:23]
    buffer_load_dwordx4 v172, s[36:39], s23 offen sc1 lds
    v_mfma_f32_16x16x32_bf16 v[24:27], a[28:31], v[108:111], v[24:27]
    ds_read_b64_tr_b16 v[126:127], v169 offset:14336
    ds_read_b64_tr_b16 a[182:183], v227 offset:39936
    v_mfma_f32_16x16x32_bf16 v[28:31], a[32:35], v[108:111], v[28:31]
    ds_read_b64_tr_b16 v[128:129], v170 offset:12288
    ds_read_b64_tr_b16 a[184:185], v228 offset:43008
    v_mfma_f32_16x16x32_bf16 v[32:35], a[24:27], v[112:115], v[32:35]
    s_add_u32 m0, s63, 49152
    ds_read_b64_tr_b16 v[130:131], v170 offset:14336
    ds_read_b64_tr_b16 a[186:187], v228 offset:46080
    v_mfma_f32_16x16x32_bf16 v[36:39], a[28:31], v[112:115], v[36:39]
    buffer_load_dwordx4 v172, s[36:39], s24 offen sc1 lds
    v_mfma_f32_16x16x32_bf16 v[40:43], a[32:35], v[112:115], v[40:43]
    ds_read_b64_tr_b16 v[132:133], v171 offset:12288
    ds_read_b64_tr_b16 a[188:189], v229 offset:36864
    v_mfma_f32_16x16x32_bf16 v[44:47], a[24:27], v[116:119], v[44:47]
    s_waitcnt lgkmcnt(3)
    ds_read_b64_tr_b16 v[134:135], v171 offset:14336
    ds_read_b64_tr_b16 a[190:191], v229 offset:39936
    v_mfma_f32_16x16x32_bf16 v[48:51], a[28:31], v[116:119], v[48:51]
    s_add_u32 m0, s63, 53248
    v_and_b32 v211, 16, v1
    v_lshl_add_u32 v210, v210, 2, v211
    v_mfma_f32_16x16x32_bf16 v[52:55], a[32:35], v[116:119], v[52:55]
    buffer_load_dwordx4 v172, s[36:39], s25 offen sc1 lds
    v_mfma_f32_16x16x32_bf16 v[8:11], a[36:39], v[120:123], v[8:11]
    s_lshl_b32 s57, s3, 13
    ds_read_b64_tr_b16 v[104:105], v168 offset:16384
    v_add_u32 v210, s57, v210
    v_mfma_f32_16x16x32_bf16 v[12:15], a[40:43], v[120:123], v[12:15]
    ds_read_b64_tr_b16 v[106:107], v168 offset:18432
    v_and_b32 v211, 3, v1
    v_mfma_f32_16x16x32_bf16 v[16:19], a[44:47], v[120:123], v[16:19]
    s_add_u32 m0, s63, 57344
    ds_read_b64_tr_b16 v[108:109], v169 offset:16384
    v_lshlrev_b32 v211, 3, v211
    v_mfma_f32_16x16x32_bf16 v[20:23], a[36:39], v[124:127], v[20:23]
    buffer_load_dwordx4 v172, s[36:39], s26 offen sc1 lds
    v_mfma_f32_16x16x32_bf16 v[24:27], a[40:43], v[124:127], v[24:27]
    ds_read_b64_tr_b16 v[110:111], v169 offset:18432
    v_mfma_f32_16x16x32_bf16 v[28:31], a[44:47], v[124:127], v[28:31]
    ds_read_b64_tr_b16 v[112:113], v170 offset:16384
    v_mfma_f32_16x16x32_bf16 v[32:35], a[36:39], v[128:131], v[32:35]
    s_add_u32 m0, s63, 61440
    ds_read_b64_tr_b16 v[114:115], v170 offset:18432
    v_mfma_f32_16x16x32_bf16 v[36:39], a[40:43], v[128:131], v[36:39]
    buffer_load_dwordx4 v172, s[36:39], s27 offen sc1 lds
    v_mfma_f32_16x16x32_bf16 v[40:43], a[44:47], v[128:131], v[40:43]
    s_waitcnt lgkmcnt(7)
    ds_read_b64_tr_b16 v[116:117], v171 offset:16384
    v_mfma_f32_16x16x32_bf16 v[44:47], a[36:39], v[132:135], v[44:47]
    s_waitcnt lgkmcnt(3)
    ds_read_b64_tr_b16 v[118:119], v171 offset:18432
    v_mfma_f32_16x16x32_bf16 v[48:51], a[40:43], v[132:135], v[48:51]
    s_add_u32 m0, s63, 65536
    v_mfma_f32_16x16x32_bf16 v[52:55], a[44:47], v[132:135], v[52:55]
    buffer_load_dwordx4 v172, s[36:39], s44 offen sc1 lds
    v_mfma_f32_16x16x32_bf16 v[8:11], a[48:51], v[104:107], v[8:11]
    ds_read_b64_tr_b16 v[120:121], v168 offset:20480
    v_mfma_f32_16x16x32_bf16 v[12:15], a[52:55], v[104:107], v[12:15]
    ds_read_b64_tr_b16 v[122:123], v168 offset:22528
    s_waitcnt vmcnt(7)
    v_cmp_ne_u32 vcc, s48, v244
    s_cbranch_vccnz L_chk10_slow
L_chk10_back:
    v_mfma_f32_16x16x32_bf16 v[16:19], a[56:59], v[104:107], v[16:19]
    s_add_u32 m0, s63, 69632
    ds_read_b64_tr_b16 v[124:125], v169 offset:20480
    v_mfma_f32_16x16x32_bf16 v[20:23], a[48:51], v[108:111], v[20:23]
    buffer_load_dwordx4 v172, s[36:39], s45 offen sc1 lds
    v_mfma_f32_16x16x32_bf16 v[24:27], a[52:55], v[108:111], v[24:27]
    ds_read_b64_tr_b16 v[126:127], v169 offset:22528
    v_mfma_f32_16x16x32_bf16 v[28:31], a[56:59], v[108:111], v[28:31]
    s_waitcnt lgkmcnt(6)
    ds_read_b64_tr_b16 v[128:129], v170 offset:20480
    v_mfma_f32_16x16x32_bf16 v[32:35], a[48:51], v[112:115], v[32:35]
    s_add_u32 m0, s63, 73728
    ds_read_b64_tr_b16 v[130:131], v170 offset:22528
    v_mfma_f32_16x16x32_bf16 v[36:39], a[52:55], v[112:115], v[36:39]
    buffer_load_dwordx4 v172, s[36:39], s46 offen sc1 lds
    v_mfma_f32_16x16x32_bf16 v[40:43], a[56:59], v[112:115], v[40:43]
    s_waitcnt lgkmcnt(6)
    ds_read_b64_tr_b16 v[132:133], v171 offset:20480
    v_mfma_f32_16x16x32_bf16 v[44:47], a[48:51], v[116:119], v[44:47]
    s_waitcnt lgkmcnt(3)
    ds_read_b64_tr_b16 v[134:135], v171 offset:22528
    v_mfma_f32_16x16x32_bf16 v[48:51], a[52:55], v[116:119], v[48:51]
    s_add_u32 m0, s63, 77824
    v_mfma_f32_16x16x32_bf16 v[52:55], a[56:59], v[116:119], v[52:55]
    buffer_load_dwordx4 v172, s[36:39], s47 offen sc1 lds
    v_mfma_f32_16x16x32_bf16 v[8:11], a[60:63], v[120:123], v[8:11]
    s_barrier
    ds_read_b64_tr_b16 v[104:105], v168 offset:24576
    v_mfma_f32_16x16x32_bf16 v[12:15], a[64:67], v[120:123], v[12:15]
    ds_read_b64_tr_b16 v[106:107], v168 offset:26624
    v_add_u32 v172, 2048, v172
    v_mfma_f32_16x16x32_bf16 v[16:19], a[68:71], v[120:123], v[16:19]
    s_add_u32 m0, s61, 151552
    ds_read_b64_tr_b16 v[108:109], v169 offset:24576
    v_mfma_f32_16x16x32_bf16 v[20:23], a[60:63], v[124:127], v[20:23]
    buffer_load_dwordx4 v224, s[40:43], s64 offen offset:0 lds
    v_mfma_f32_16x16x32_bf16 v[24:27], a[64:67], v[124:127], v[24:27]
    ds_read_b64_tr_b16 v[110:111], v169 offset:26624
    v_mfma_f32_16x16x32_bf16 v[28:31], a[68:71], v[124:127], v[28:31]
    s_waitcnt lgkmcnt(6)
    ds_read_b64_tr_b16 v[112:113], v170 offset:24576
    v_mfma_f32_16x16x32_bf16 v[32:35], a[60:63], v[128:131], v[32:35]
    s_add_u32 m0, s61, 151552
    ds_read_b64_tr_b16 v[114:115], v170 offset:26624
    v_mfma_f32_16x16x32_bf16 v[36:39], a[64:67], v[128:131], v[36:39]
    buffer_load_dwordx4 v225, s[40:43], s64 offen offset:1024 lds
    v_mfma_f32_16x16x32_bf16 v[40:43], a[68:71], v[128:131], v[40:43]
    s_waitcnt lgkmcnt(6)
    ds_read_b64_tr_b16 v[116:117], v171 offset:24576
    v_mfma_f32_16x16x32_bf16 v[44:47], a[60:63], v[132:135], v[44:47]
    s_waitcnt lgkmcnt(3)
    ds_read_b64_tr_b16 v[118:119], v171 offset:26624
    v_mfma_f32_16x16x32_bf16 v[48:51], a[64:67], v[132:135], v[48:51]
    s_add_u32 m0, s61, 151552
    v_mfma_f32_16x16x32_bf16 v[52:55], a[68:71], v[132:135], v[52:55]
    buffer_load_dwordx4 v226, s[40:43], s64 offen offset:2048 lds
    v_mfma_f32_16x16x32_bf16 v[8:11], a[72:75], v[104:107], v[8:11]
    s_add_u32 s64, s64, 98304
    ds_read_b64_tr_b16 v[120:121], v168 offset:28672
    v_mfma_f32_16x16x32_bf16 v[12:15], a[76:79], v[104:107], v[12:15]
    s_sub_u32 s35, s64, 1966080
    ds_read_b64_tr_b16 v[122:123], v168 offset:30720
    v_mfma_f32_16x16x32_bf16 v[16:19], a[80:83], v[104:107], v[16:19]
    s_min_u32 s64, s64, s35
    ds_read_b64_tr_b16 v[124:125], v169 offset:28672
    v_mfma_f32_16x16x32_bf16 v[20:23], a[72:75], v[108:111], v[20:23]
    s_add_u32 m0, s61, 102400
    s_nop 0
    buffer_load_dwordx4 v224, s[40:43], s64 offen offset:0 lds
    v_mfma_f32_16x16x32_bf16 v[24:27], a[76:79], v[108:111], v[24:27]
    ds_read_b64_tr_b16 v[126:127], v169 offset:30720
    v_mfma_f32_16x16x32_bf16 v[28:31], a[80:83], v[108:111], v[28:31]
    s_waitcnt lgkmcnt(6)
    ds_read_b64_tr_b16 v[128:129], v170 offset:28672
    v_mfma_f32_16x16x32_bf16 v[32:35], a[72:75], v[112:115], v[32:35]
    s_add_u32 m0, s61, 102400
    ds_read_b64_tr_b16 v[130:131], v170 offset:30720
    v_mfma_f32_16x16x32_bf16 v[36:39], a[76:79], v[112:115], v[36:39]
    buffer_load_dwordx4 v225, s[40:43], s64 offen offset:1024 lds
    v_mfma_f32_16x16x32_bf16 v[40:43], a[80:83], v[112:115], v[40:43]
    s_waitcnt lgkmcnt(6)
    ds_read_b64_tr_b16 v[132:133], v171 offset:28672
    v_mfma_f32_16x16x32_bf16 v[44:47], a[72:75], v[116:119], v[44:47]
    s_waitcnt lgkmcnt(3)
    ds_read_b64_tr_b16 v[134:135], v171 offset:30720
    v_mfma_f32_16x16x32_bf16 v[48:51], a[76:79], v[116:119], v[48:51]
    s_add_u32 m0, s61, 102400
    v_mfma_f32_16x16x32_bf16 v[52:55], a[80:83], v[116:119], v[52:55]
    buffer_load_dwordx4 v226, s[40:43], s64 offen offset:2048 lds
    v_mfma_f32_16x16x32_bf16 v[8:11], a[84:87], v[120:123], v[8:11]
    s_add_u32 s64, s64, 98304
    ds_read_b64_tr_b16 v[104:105], v168 offset:32768
    v_mfma_f32_16x16x32_bf16 v[12:15], a[88:91], v[120:123], v[12:15]
    s_sub_u32 s35, s64, 1966080
    ds_read_b64_tr_b16 v[106:107], v168 offset:34816
    v_mfma_f32_16x16x32_bf16 v[16:19], a[92:95], v[120:123], v[16:19]
    s_min_u32 s64, s64, s35
    ds_read_b64_tr_b16 v[108:109], v169 offset:32768
    v_mfma_f32_16x16x32_bf16 v[20:23], a[84:87], v[124:127], v[20:23]
    s_add_u32 m0, s61, 114688
    s_nop 0
    buffer_load_dwordx4 v224, s[40:43], s64 offen offset:0 lds
    v_mfma_f32_16x16x32_bf16 v[24:27], a[88:91], v[124:127], v[24:27]
    ds_read_b64_tr_b16 v[110:111], v169 offset:34816
    v_mfma_f32_16x16x32_bf16 v[28:31], a[92:95], v[124:127], v[28:31]
    s_waitcnt lgkmcnt(6)
    ds_read_b64_tr_b16 v[112:113], v170 offset:32768
    v_mfma_f32_16x16x32_bf16 v[32:35], a[84:87], v[128:131], v[32:35]
    s_add_u32 m0, s61, 114688
    ds_read_b64_tr_b16 v[114:115], v170 offset:34816
    v_lshrrev_b32 v238, 1, v1
    v_mfma_f32_16x16x32_bf16 v[36:39], a[88:91], v[128:131], v[36:39]
    buffer_load_dwordx4 v225, s[40:43], s64 offen offset:1024 lds
    v_mfma_f32_16x16x32_bf16 v[40:43], a[92:95], v[128:131], v[40:43]
    s_waitcnt lgkmcnt(6)
    ds_read_b64_tr_b16 v[116:117], v171 offset:32768
    v_lshlrev_b32 v238, 9, v238
    v_mfma_f32_16x16x32_bf16 v[44:47], a[84:87], v[132:135], v[44:47]
    s_waitcnt lgkmcnt(3)
    ds_read_b64_tr_b16 v[118:119], v171 offset:34816
    v_and_b32 v239, 1, v1
    v_mfma_f32_16x16x32_bf16 v[48:51], a[88:91], v[132:135], v[48:51]
    s_add_u32 m0, s61, 114688
    v_lshl_add_u32 v219, v239, 2, v238
    v_mfma_f32_16x16x32_bf16 v[52:55], a[92:95], v[132:135], v[52:55]
    s_lshl_b32 s55, s3, 7
    s_add_u32 s55, s55, 133120
    buffer_load_dwordx4 v226, s[40:43], s64 offen offset:2048 lds
    v_mfma_f32_16x16x32_bf16 v[8:11], a[96:99], v[104:107], v[8:11]
    s_waitcnt vmcnt(9)
    s_barrier
    ds_read_b64_tr_b16 v[120:121], v168 offset:36864
    v_mfma_f32_16x16x32_bf16 v[12:15], a[100:103], v[104:107], v[12:15]
    s_add_u32 s64, s64, 98304
    ds_read_b64_tr_b16 v[122:123], v168 offset:38912
    v_add_u32 v219, s55, v219
    v_mfma_f32_16x16x32_bf16 v[16:19], a[104:107], v[104:107], v[16:19]
    s_sub_u32 s35, s64, 1966080
    ds_read_b64_tr_b16 v[124:125], v169 offset:36864
    v_lshlrev_b32 v238, 7, v1
    v_mfma_f32_16x16x32_bf16 v[20:23], a[96:99], v[108:111], v[20:23]
    s_min_u32 s64, s64, s35
    s_add_u32 m0, s61, 126976
    s_nop 0
    buffer_load_dwordx4 v224, s[40:43], s64 offen offset:0 lds
    v_mfma_f32_16x16x32_bf16 v[24:27], a[100:103], v[108:111], v[24:27]
    ds_read_b64_tr_b16 v[126:127], v169 offset:38912
    v_add_u32 v238, 99584, v238
    v_mfma_f32_16x16x32_bf16 v[28:31], a[104:107], v[108:111], v[28:31]
    s_lshl_b32 s55, s73, 7
    s_add_u32 s55, s55, 153600
    ds_read_b64_tr_b16 v[128:129], v170 offset:36864
    ds_read_b64 v[200:201], v216
    s_waitcnt lgkmcnt(8)
    v_mfma_f32_16x16x32_bf16 v[32:35], a[96:99], v[112:115], v[32:35]
    s_add_u32 m0, s61, 126976
    ds_read_b64_tr_b16 v[130:131], v170 offset:38912
    v_mov_b32 v239, s55
    v_mfma_f32_16x16x32_bf16 v[36:39], a[100:103], v[112:115], v[36:39]
    buffer_load_dwordx4 v225, s[40:43], s64 offen offset:1024 lds
    v_mfma_f32_16x16x32_bf16 v[40:43], a[104:107], v[112:115], v[40:43]
    s_waitcnt lgkmcnt(7)
    ds_read_b64_tr_b16 v[132:133], v171 offset:36864
    ds_read_b64 v[202:203], v217
    v_mfma_f32_16x16x32_bf16 v[44:47], a[96:99], v[116:119], v[44:47]
    s_waitcnt lgkmcnt(3)
    ds_read_b64_tr_b16 v[134:135], v171 offset:38912
    ds_read_b64 v[204:205], v218
    v_mfma_f32_16x16x32_bf16 v[48:51], a[100:103], v[116:119], v[48:51]
    s_add_u32 m0, s61, 126976
    v_cmp_lt_u32 vcc, 49, v1
    s_nop 1
    v_cndmask_b32 v238, v238, v239, vcc
    v_mfma_f32_16x16x32_bf16 v[52:55], a[104:107], v[116:119], v[52:55]
    buffer_load_dwordx4 v226, s[40:43], s64 offen offset:2048 lds
    v_mfma_f32_16x16x32_bf16 v[8:11], a[108:111], v[120:123], v[8:11]
    s_add_u32 s64, s64, 98304
    s_waitcnt vmcnt(9)
    s_barrier
    ds_read_b64_tr_b16 v[104:105], v168 offset:40960
    ds_read_b64_tr_b16 a[192:193], v227 offset:49152
    v_mfma_f32_16x16x32_bf16 v[12:15], a[112:115], v[120:123], v[12:15]
    s_sub_u32 s35, s64, 1966080
    ds_read_b64_tr_b16 v[106:107], v168 offset:43008
    ds_read_b64_tr_b16 a[194:195], v227 offset:52224
    v_mfma_f32_16x16x32_bf16 v[16:19], a[116:119], v[120:123], v[16:19]
    s_min_u32 s64, s64, s35
    ds_read_b64_tr_b16 v[108:109], v169 offset:40960
    ds_read_b64_tr_b16 a[196:197], v228 offset:55296
    v_lshlrev_b32 v230, 16, v200
    v_mfma_f32_16x16x32_bf16 v[20:23], a[108:111], v[124:127], v[20:23]
    buffer_load_dwordx4 a[240:243], v248, s[36:39], s62 offen offset:0 sc1
    v_mfma_f32_16x16x32_bf16 v[24:27], a[112:115], v[124:127], v[24:27]
    ds_read_b64_tr_b16 v[110:111], v169 offset:43008
    ds_read_b64_tr_b16 a[198:199], v228 offset:58368
    v_and_b32 v231, 0xffff0000, v200
    v_mfma_f32_16x16x32_bf16 v[28:31], a[116:119], v[124:127], v[28:31]
    s_waitcnt lgkmcnt(12)
    ds_read_b64_tr_b16 v[112:113], v170 offset:40960
    ds_read_b64_tr_b16 a[200:201], v229 offset:49152
    v_mul_f32 v230, v230, v220
    v_mfma_f32_16x16x32_bf16 v[32:35], a[108:111], v[128:131], v[32:35]
    ds_read_b64_tr_b16 v[114:115], v170 offset:43008
    ds_read_b64_tr_b16 a[202:203], v229 offset:52224
    v_mul_f32 v231, v231, v220
    v_mfma_f32_16x16x32_bf16 v[36:39], a[112:115], v[128:131], v[36:39]
    buffer_load_dwordx4 a[244:247], v248, s[36:39], s62 offen offset:1024 sc1
    v_mfma_f32_16x16x32_bf16 v[40:43], a[116:119], v[128:131], v[40:43]
    s_waitcnt lgkmcnt(13)
    ds_read_b64_tr_b16 v[116:117], v171 offset:40960
    v_mul_f32 v234, v230, v230
    v_mul_f32 v235, v231, v231
    v_mfma_f32_16x16x32_bf16 v[44:47], a[108:111], v[132:135], v[44:47]
    s_waitcnt lgkmcnt(3)
    ds_read_b64_tr_b16 v[118:119], v171 offset:43008
    v_lshlrev_b32 v232, 16, v201
    v_and_b32 v233, 0xffff0000, v201
    v_mfma_f32_16x16x32_bf16 v[48:51], a[112:115], v[132:135], v[48:51]
    v_cmp_lt_u32 vcc, 39, v1
    s_nop 1
    v_cndmask_b32 v219, v219, v238, vcc
    v_mul_f32 v232, v232, v220
    v_mfma_f32_16x16x32_bf16 v[52:55], a[116:119], v[132:135], v[52:55]
    s_mov_b32 s17, 23199744
    buffer_load_dwordx4 a[248:251], v248, s[36:39], s62 offen offset:2048 sc1
    v_mfma_f32_16x16x32_bf16 v[8:11], a[120:123], v[104:107], v[8:11]
    s_waitcnt lgkmcnt(2)
    s_waitcnt vmcnt(9)
    s_barrier
    ds_read_b64_tr_b16 v[120:121], v168 offset:45056
    ds_read_b64_tr_b16 a[204:205], v227 offset:0
    v_mfma_f32_16x16x32_bf16 v[12:15], a[124:127], v[104:107], v[12:15]
    ds_read_b64_tr_b16 v[122:123], v168 offset:47104
    ds_read_b64_tr_b16 a[206:207], v227 offset:3072
    v_mul_f32 v233, v233, v220
    v_mfma_f32_16x16x32_bf16 v[16:19], a[128:131], v[104:107], v[16:19]
    ds_read_b64_tr_b16 v[124:125], v169 offset:45056
    ds_read_b64_tr_b16 a[208:209], v228 offset:6144
    v_mul_f32 v236, v232, v232
    v_mfma_f32_16x16x32_bf16 v[20:23], a[120:123], v[108:111], v[20:23]
    buffer_load_dwordx4 a[252:255], v248, s[36:39], s62 offen offset:3072 sc1
    v_mfma_f32_16x16x32_bf16 v[24:27], a[124:127], v[108:111], v[24:27]
    s_add_u32 s62, s62, 4096
    ds_read_b64_tr_b16 v[126:127], v169 offset:47104
    ds_read_b64_tr_b16 a[210:211], v228 offset:9216
    v_mul_f32 v237, v233, v233
    v_mfma_f32_16x16x32_bf16 v[28:31], a[128:131], v[108:111], v[28:31]
    ds_read_b64_tr_b16 v[128:129], v170 offset:45056
    ds_read_b64_tr_b16 a[212:213], v229 offset:0
    v_lshlrev_b32 v206, 16, v202
    v_mfma_f32_16x16x32_bf16 v[32:35], a[120:123], v[112:115], v[32:35]
    ds_read_b64_tr_b16 v[130:131], v170 offset:47104
    ds_read_b64_tr_b16 a[214:215], v229 offset:3072
    v_and_b32 v207, 0xffff0000, v202
    v_mfma_f32_16x16x32_bf16 v[36:39], a[124:127], v[112:115], v[36:39]
    buffer_load_dwordx4 v[136:139], v248, s[36:39], s62 offen offset:0 sc1
    v_mfma_f32_16x16x32_bf16 v[40:43], a[128:131], v[112:115], v[40:43]
    s_waitcnt lgkmcnt(12)
    ds_read_b64_tr_b16 v[132:133], v171 offset:45056
    v_mul_f32 v206, v206, v221
    v_mul_f32 v207, v207, v221
    v_mfma_f32_16x16x32_bf16 v[44:47], a[120:123], v[116:119], v[44:47]
    s_waitcnt lgkmcnt(3)
    ds_read_b64_tr_b16 v[134:135], v171 offset:47104
    v_add_f32 v230, v230, v206
    v_add_f32 v231, v231, v207
    v_mfma_f32_16x16x32_bf16 v[48:51], a[124:127], v[116:119], v[48:51]
    v_fmac_f32 v234, v206, v206
    v_fmac_f32 v235, v207, v207
    v_lshlrev_b32 v208, 16, v203
    v_mfma_f32_16x16x32_bf16 v[52:55], a[128:131], v[116:119], v[52:55]
    buffer_load_dword v240, v219, s[36:39], s17 offen sc1
    v_mfma_f32_16x16x32_bf16 v[8:11], a[132:135], v[120:123], v[8:11]
    s_waitcnt lgkmcnt(2)
    s_waitcnt vmcnt(9)
    s_barrier
    ds_read_b64_tr_b16 v[104:105], v168 offset:49152
    ds_read_b64_tr_b16 a[216:217], v227 offset:12288
    v_mfma_f32_16x16x32_bf16 v[12:15], a[136:139], v[120:123], v[12:15]
    ds_read_b64_tr_b16 v[106:107], v168 offset:51200
    ds_read_b64_tr_b16 a[218:219], v227 offset:15360
    v_and_b32 v209, 0xffff0000, v203
    v_mfma_f32_16x16x32_bf16 v[16:19], a[140:143], v[120:123], v[16:19]
    ds_read_b64_tr_b16 v[108:109], v169 offset:49152
    ds_read_b64_tr_b16 a[220:221], v228 offset:18432
    v_mul_f32 v208, v208, v221
    v_mfma_f32_16x16x32_bf16 v[20:23], a[132:135], v[124:127], v[20:23]
    buffer_load_dwordx4 v[140:143], v248, s[36:39], s62 offen offset:1024 sc1
    v_mfma_f32_16x16x32_bf16 v[24:27], a[136:139], v[124:127], v[24:27]
    ds_read_b64_tr_b16 v[110:111], v169 offset:51200
    ds_read_b64_tr_b16 a[222:223], v228 offset:21504
    v_mul_f32 v209, v209, v221
    v_mfma_f32_16x16x32_bf16 v[28:31], a[140:143], v[124:127], v[28:31]
    ds_read_b64_tr_b16 v[112:113], v170 offset:49152
    ds_read_b64_tr_b16 a[224:225], v229 offset:12288
    v_add_f32 v232, v232, v208
    v_mfma_f32_16x16x32_bf16 v[32:35], a[132:135], v[128:131], v[32:35]
    ds_read_b64_tr_b16 v[114:115], v170 offset:51200
    ds_read_b64_tr_b16 a[226:227], v229 offset:15360
    v_add_f32 v233, v233, v209
    v_mfma_f32_16x16x32_bf16 v[36:39], a[136:139], v[128:131], v[36:39]
    buffer_load_dwordx4 v[144:147], v248, s[36:39], s62 offen offset:2048 sc1
    v_mfma_f32_16x16x32_bf16 v[40:43], a[140:143], v[128:131], v[40:43]
    s_waitcnt lgkmcnt(12)
    ds_read_b64_tr_b16 v[116:117], v171 offset:49152
    v_fmac_f32 v236, v208, v208
    v_fmac_f32 v237, v209, v209
    v_mfma_f32_16x16x32_bf16 v[44:47], a[132:135], v[132:135], v[44:47]
    s_waitcnt lgkmcnt(3)
    ds_read_b64_tr_b16 v[118:119], v171 offset:51200
    v_lshlrev_b32 v206, 16, v204
    v_and_b32 v207, 0xffff0000, v204
    v_mfma_f32_16x16x32_bf16 v[48:51], a[136:139], v[132:135], v[48:51]
    v_mul_f32 v206, v206, v222
    v_mul_f32 v207, v207, v222
    v_add_f32 v230, v230, v206
    v_mfma_f32_16x16x32_bf16 v[52:55], a[140:143], v[132:135], v[52:55]
    buffer_load_dwordx4 v[148:151], v248, s[36:39], s62 offen offset:3072 sc1
    v_mfma_f32_16x16x32_bf16 v[8:11], a[144:147], v[104:107], v[8:11]
    s_waitcnt lgkmcnt(2)
    s_waitcnt vmcnt(9)
    s_barrier
    ds_read_b64_tr_b16 v[120:121], v168 offset:53248
    ds_read_b64_tr_b16 a[228:229], v227 offset:24576
    v_mfma_f32_16x16x32_bf16 v[12:15], a[148:151], v[104:107], v[12:15]
    s_add_u32 s62, s62, 4096
    ds_read_b64_tr_b16 v[122:123], v168 offset:55296
    ds_read_b64_tr_b16 a[230:231], v227 offset:27648
    v_add_f32 v231, v231, v207
    v_mfma_f32_16x16x32_bf16 v[16:19], a[152:155], v[104:107], v[16:19]
    ds_read_b64_tr_b16 v[124:125], v169 offset:53248
    ds_read_b64_tr_b16 a[232:233], v228 offset:30720
    v_fmac_f32 v234, v206, v206
    v_mfma_f32_16x16x32_bf16 v[20:23], a[144:147], v[108:111], v[20:23]
    buffer_load_dwordx4 v[152:155], v248, s[36:39], s62 offen offset:0 sc1
    v_mfma_f32_16x16x32_bf16 v[24:27], a[148:151], v[108:111], v[24:27]
    ds_read_b64_tr_b16 v[126:127], v169 offset:55296
    ds_read_b64_tr_b16 a[234:235], v228 offset:33792
    v_fmac_f32 v235, v207, v207
    v_mfma_f32_16x16x32_bf16 v[28:31], a[152:155], v[108:111], v[28:31]
    ds_read_b64_tr_b16 v[128:129], v170 offset:53248
    ds_read_b64_tr_b16 a[236:237], v229 offset:24576
    v_lshlrev_b32 v208, 16, v205
    v_mfma_f32_16x16x32_bf16 v[32:35], a[144:147], v[112:115], v[32:35]
    ds_read_b64_tr_b16 v[130:131], v170 offset:55296
    ds_read_b64_tr_b16 a[238:239], v229 offset:27648
    v_and_b32 v209, 0xffff0000, v205
    v_mfma_f32_16x16x32_bf16 v[36:39], a[148:151], v[112:115], v[36:39]
    buffer_load_dwordx4 v[156:159], v248, s[36:39], s62 offen offset:1024 sc1
    v_mfma_f32_16x16x32_bf16 v[40:43], a[152:155], v[112:115], v[40:43]
    s_waitcnt lgkmcnt(12)
    ds_read_b64_tr_b16 v[132:133], v171 offset:53248
    v_mul_f32 v208, v208, v222
    v_mul_f32 v209, v209, v222
    v_mfma_f32_16x16x32_bf16 v[44:47], a[144:147], v[116:119], v[44:47]
    s_waitcnt lgkmcnt(3)
    ds_read_b64_tr_b16 v[134:135], v171 offset:55296
    v_add_f32 v232, v232, v208
    v_add_f32 v233, v233, v209
    v_mfma_f32_16x16x32_bf16 v[48:51], a[148:151], v[116:119], v[48:51]
    s_waitcnt lgkmcnt(2)
    s_barrier
    v_fmac_f32 v236, v208, v208
    v_fmac_f32 v237, v209, v209
    v_mfma_f32_16x16x32_bf16 v[52:55], a[152:155], v[116:119], v[52:55]
    buffer_load_dwordx4 v[160:163], v248, s[36:39], s62 offen offset:2048 sc1
    v_mfma_f32_16x16x32_bf16 v[8:11], a[156:159], v[120:123], v[8:11]
    ds_read_b64_tr_b16 v[104:105], v168 offset:57344
    v_permlane32_swap_b32 v230, v234
    v_permlane32_swap_b32 v231, v235
    v_mfma_f32_16x16x32_bf16 v[12:15], a[160:163], v[120:123], v[12:15]
    ds_read_b64_tr_b16 v[106:107], v168 offset:59392
    v_permlane32_swap_b32 v232, v236
    v_permlane32_swap_b32 v233, v237
    v_mfma_f32_16x16x32_bf16 v[16:19], a[164:167], v[120:123], v[16:19]
    ds_read_b64_tr_b16 v[108:109], v169 offset:57344
    v_add_f32 v230, v230, v234
    v_add_f32 v231, v231, v235
    v_mfma_f32_16x16x32_bf16 v[20:23], a[156:159], v[124:127], v[20:23]
    buffer_load_dwordx4 v[164:167], v248, s[36:39], s62 offen offset:3072 sc1
    v_mfma_f32_16x16x32_bf16 v[24:27], a[160:163], v[124:127], v[24:27]
    s_add_u32 s62, s62, 4096
    ds_read_b64_tr_b16 v[110:111], v169 offset:59392
    s_waitcnt vmcnt(7)
    v_cmp_ne_u32 vcc, s48, v240
    s_cbranch_vccnz L_chk11_slow
L_chk11_back:
    v_add_f32 v232, v232, v236
    v_mfma_f32_16x16x32_bf16 v[28:31], a[164:167], v[124:127], v[28:31]
    ds_read_b64_tr_b16 v[112:113], v170 offset:57344
    v_add_f32 v233, v233, v237
    v_permlane16_swap_b32 v230, v232
    v_mfma_f32_16x16x32_bf16 v[32:35], a[156:159], v[128:131], v[32:35]
    s_add_u32 m0, s63, 81920
    ds_read_b64_tr_b16 v[114:115], v170 offset:59392
    v_permlane16_swap_b32 v231, v233
    v_add_f32 v230, v230, v232
    v_mfma_f32_16x16x32_bf16 v[36:39], a[160:163], v[128:131], v[36:39]
    buffer_load_dwordx4 v172, s[36:39], s10 offen sc1 lds
    v_mfma_f32_16x16x32_bf16 v[40:43], a[164:167], v[128:131], v[40:43]
    s_waitcnt lgkmcnt(6)
    ds_read_b64_tr_b16 v[116:117], v171 offset:57344
    v_add_f32 v231, v231, v233
    v_add_f32_dpp v230, v230, v230 row_ror:8 row_mask:0xf bank_mask:0xf
    v_mfma_f32_16x16x32_bf16 v[44:47], a[156:159], v[132:135], v[44:47]
    s_waitcnt lgkmcnt(3)
    ds_read_b64_tr_b16 v[118:119], v171 offset:59392
    v_add_f32_dpp v231, v231, v231 row_ror:8 row_mask:0xf bank_mask:0xf
    v_add_f32_dpp v230, v230, v230 row_ror:4 row_mask:0xf bank_mask:0xf
    v_mfma_f32_16x16x32_bf16 v[48:51], a[160:163], v[132:135], v[48:51]
    s_add_u32 m0, s63, 86016
    v_add_f32_dpp v231, v231, v231 row_ror:4 row_mask:0xf bank_mask:0xf
    v_add_f32_dpp v230, v230, v230 row_ror:2 row_mask:0xf bank_mask:0xf
    s_nop 0
    v_add_f32_dpp v231, v231, v231 row_ror:2 row_mask:0xf bank_mask:0xf
    v_mfma_f32_16x16x32_bf16 v[52:55], a[164:167], v[132:135], v[52:55]
    buffer_load_dwordx4 v172, s[36:39], s11 offen sc1 lds
    v_mfma_f32_16x16x32_bf16 v[8:11], a[168:171], v[104:107], v[8:11]
    ds_read_b64_tr_b16 v[120:121], v168 offset:61440
    v_add_f32_dpp v230, v230, v230 row_ror:1 row_mask:0xf bank_mask:0xf
    v_add_f32_dpp v231, v231, v231 row_ror:1 row_mask:0xf bank_mask:0xf
    v_mfma_f32_16x16x32_bf16 v[12:15], a[172:175], v[104:107], v[12:15]
    ds_read_b64_tr_b16 v[122:123], v168 offset:63488
    v_add_u32 v168, 65536, v168
    v_mfma_f32_16x16x32_bf16 v[16:19], a[176:179], v[104:107], v[16:19]
    s_add_u32 m0, s63, 90112
    ds_read_b64_tr_b16 v[124:125], v169 offset:61440
    s_mov_b32 exec_lo, 0x00010001
    s_mov_b32 exec_hi, 0x00010001
    ds_write2_b32 v210, v230, v231 offset0:0 offset1:2
    s_mov_b64 exec, -1
    v_mfma_f32_16x16x32_bf16 v[20:23], a[168:171], v[108:111], v[20:23]
    buffer_load_dwordx4 v172, s[36:39], s12 offen sc1 lds
    v_mfma_f32_16x16x32_bf16 v[24:27], a[172:175], v[108:111], v[24:27]
    ds_read_b64_tr_b16 v[126:127], v169 offset:63488
    v_add_u32 v169, 65536, v169
    v_mov_b32 v213, s48
    v_mfma_f32_16x16x32_bf16 v[28:31], a[176:179], v[108:111], v[28:31]
    s_waitcnt lgkmcnt(7)
    ds_read_b64_tr_b16 v[128:129], v170 offset:61440
    v_mov_b32 v215, s48
    v_mfma_f32_16x16x32_bf16 v[32:35], a[168:171], v[112:115], v[32:35]
    s_add_u32 m0, s63, 94208
    ds_read_b64_tr_b16 v[130:131], v170 offset:63488
    v_add_u32 v170, 65536, v170
    v_mfma_f32_16x16x32_bf16 v[36:39], a[172:175], v[112:115], v[36:39]
    buffer_load_dwordx4 v172, s[36:39], s13 offen sc1 lds
    v_mfma_f32_16x16x32_bf16 v[40:43], a[176:179], v[112:115], v[40:43]
    s_waitcnt lgkmcnt(7)
    ds_read_b64_tr_b16 v[132:133], v171 offset:61440
    v_mfma_f32_16x16x32_bf16 v[44:47], a[168:171], v[116:119], v[44:47]
    s_waitcnt lgkmcnt(3)
    ds_read_b64_tr_b16 v[134:135], v171 offset:63488
    v_add_u32 v171, 65536, v171
    v_mfma_f32_16x16x32_bf16 v[48:51], a[172:175], v[116:119], v[48:51]
    s_add_u32 m0, s63, 98304
    v_mfma_f32_16x16x32_bf16 v[52:55], a[176:179], v[116:119], v[52:55]
    buffer_load_dwordx4 v172, s[36:39], s14 offen sc1 lds
    v_mfma_f32_16x16x32_bf16 v[8:11], a[180:183], v[120:123], v[8:11]
    s_barrier
    ds_read_b64_tr_b16 v[104:105], v168 offset:0
    ds_read_b64 v[230:231], v211 offset:0
    v_mfma_f32_16x16x32_bf16 v[12:15], a[184:187], v[120:123], v[12:15]
    ds_read_b64_tr_b16 v[106:107], v168 offset:2048
    ds_read_b64 v[232:233], v211 offset:8192
    ds_read_b64 v[234:235], v211 offset:16384
    v_mfma_f32_16x16x32_bf16 v[16:19], a[188:191], v[120:123], v[16:19]
    s_add_u32 m0, s63, 102400
    ds_read_b64_tr_b16 v[108:109], v169 offset:0
    ds_read_b64 v[236:237], v211 offset:24576
    v_mfma_f32_16x16x32_bf16 v[20:23], a[180:183], v[124:127], v[20:23]
    buffer_load_dwordx4 v172, s[36:39], s15 offen sc1 lds
    v_mfma_f32_16x16x32_bf16 v[24:27], a[184:187], v[124:127], v[24:27]
    ds_read_b64_tr_b16 v[110:111], v169 offset:2048
    v_mfma_f32_16x16x32_bf16 v[28:31], a[188:191], v[124:127], v[28:31]
    s_waitcnt lgkmcnt(10)
    ds_read_b64_tr_b16 v[112:113], v170 offset:0
    v_mfma_f32_16x16x32_bf16 v[32:35], a[180:183], v[128:131], v[32:35]
    s_add_u32 m0, s63, 106496
    ds_read_b64_tr_b16 v[114:115], v170 offset:2048
    s_waitcnt lgkmcnt(6)
    v_add_f32 v230, v230, v232
    v_add_f32 v231, v231, v233
    v_mfma_f32_16x16x32_bf16 v[36:39], a[184:187], v[128:131], v[36:39]
    buffer_load_dwordx4 v172, s[36:39], s18 offen sc1 lds
    v_mfma_f32_16x16x32_bf16 v[40:43], a[188:191], v[128:131], v[40:43]
    ds_read_b64_tr_b16 v[116:117], v171 offset:0
    s_waitcnt lgkmcnt(4)
    v_add_f32 v234, v234, v236
    v_add_f32 v235, v235, v237
    v_mfma_f32_16x16x32_bf16 v[44:47], a[180:183], v[132:135], v[44:47]
    s_waitcnt lgkmcnt(3)
    ds_read_b64_tr_b16 v[118:119], v171 offset:2048
    v_add_f32 v230, v230, v234
    v_add_f32 v231, v231, v235
    v_mfma_f32_16x16x32_bf16 v[48:51], a[184:187], v[132:135], v[48:51]
    s_add_u32 m0, s63, 110592
    v_mul_f32 v230, 0x3acccccd, v230
    v_mul_f32 v234, v230, v230
    v_mov_b32 v212, 0x3acccccd
    v_mfma_f32_16x16x32_bf16 v[52:55], a[188:191], v[132:135], v[52:55]
    buffer_load_dwordx4 v172, s[36:39], s19 offen sc1 lds
    v_mfma_f32_16x16x32_bf16 v[8:11], a[192:195], v[104:107], v[8:11]
    ds_read_b64_tr_b16 v[120:121], v168 offset:4096
    v_fma_f32 v231, v231, v212, -v234
    v_max_f32 v231, 0, v231
    v_mfma_f32_16x16x32_bf16 v[12:15], a[196:199], v[104:107], v[12:15]
    ds_read_b64_tr_b16 v[122:123], v168 offset:6144
    v_add_f32 v231, 0x3727c5ac, v231
    v_rsq_f32 v212, v231
    v_mfma_f32_16x16x32_bf16 v[16:19], a[200:203], v[104:107], v[16:19]
    s_add_u32 m0, s63, 114688
    ds_read_b64_tr_b16 v[124:125], v169 offset:4096
    v_mul_f32_e64 v214, -v230, v212
    v_mfma_f32_16x16x32_bf16 v[20:23], a[192:195], v[108:111], v[20:23]
    buffer_load_dwordx4 v172, s[36:39], s20 offen sc1 lds
    v_mfma_f32_16x16x32_bf16 v[24:27], a[196:199], v[108:111], v[24:27]
    ds_read_b64_tr_b16 v[126:127], v169 offset:6144
    v_mfma_f32_16x16x32_bf16 v[28:31], a[200:203], v[108:111], v[28:31]
    s_waitcnt lgkmcnt(6)
    ds_read_b64_tr_b16 v[128:129], v170 offset:4096
    v_mfma_f32_16x16x32_bf16 v[32:35], a[192:195], v[112:115], v[32:35]
    s_add_u32 m0, s63, 118784
    ds_read_b64_tr_b16 v[130:131], v170 offset:6144
    v_mfma_f32_16x16x32_bf16 v[36:39], a[196:199], v[112:115], v[36:39]
    buffer_load_dwordx4 v172, s[36:39], s21 offen sc1 lds
    v_mfma_f32_16x16x32_bf16 v[40:43], a[200:203], v[112:115], v[40:43]
    s_waitcnt lgkmcnt(6)
    ds_read_b64_tr_b16 v[132:133], v171 offset:4096
    v_mfma_f32_16x16x32_bf16 v[44:47], a[192:195], v[116:119], v[44:47]
    s_waitcnt lgkmcnt(3)
    ds_read_b64_tr_b16 v[134:135], v171 offset:6144
    v_mfma_f32_16x16x32_bf16 v[48:51], a[196:199], v[116:119], v[48:51]
    s_add_u32 m0, s63, 122880
    s_mov_b64 exec, 0xf
    buffer_store_dwordx4 v[212:215], v248, s[36:39], s7 offen sc1
    s_mov_b64 exec, -1
    v_mfma_f32_16x16x32_bf16 v[52:55], a[200:203], v[116:119], v[52:55]
    buffer_load_dwordx4 v172, s[36:39], s22 offen sc1 lds
    v_mfma_f32_16x16x32_bf16 v[8:11], a[204:207], v[120:123], v[8:11]
    ds_read_b64_tr_b16 v[104:105], v168 offset:8192
    v_mfma_f32_16x16x32_bf16 v[12:15], a[208:211], v[120:123], v[12:15]
    ds_read_b64_tr_b16 v[106:107], v168 offset:10240
    v_mfma_f32_16x16x32_bf16 v[16:19], a[212:215], v[120:123], v[16:19]
    s_add_u32 m0, s63, 126976
    ds_read_b64_tr_b16 v[108:109], v169 offset:8192
    v_mfma_f32_16x16x32_bf16 v[20:23], a[204:207], v[124:127], v[20:23]
    buffer_load_dwordx4 v172, s[36:39], s23 offen sc1 lds
    v_mfma_f32_16x16x32_bf16 v[24:27], a[208:211], v[124:127], v[24:27]
    ds_read_b64_tr_b16 v[110:111], v169 offset:10240
    v_mfma_f32_16x16x32_bf16 v[28:31], a[212:215], v[124:127], v[28:31]
    s_waitcnt lgkmcnt(6)
    ds_read_b64_tr_b16 v[112:113], v170 offset:8192
    v_mfma_f32_16x16x32_bf16 v[32:35], a[204:207], v[128:131], v[32:35]
    s_add_u32 m0, s63, 131072
    ds_read_b64_tr_b16 v[114:115], v170 offset:10240
    v_mfma_f32_16x16x32_bf16 v[36:39], a[208:211], v[128:131], v[36:39]
    buffer_load_dwordx4 v172, s[36:39], s24 offen sc1 lds
    v_mfma_f32_16x16x32_bf16 v[40:43], a[212:215], v[128:131], v[40:43]
    s_waitcnt lgkmcnt(6)
    ds_read_b64_tr_b16 v[116:117], v171 offset:8192
    v_mfma_f32_16x16x32_bf16 v[44:47], a[204:207], v[132:135], v[44:47]
    s_waitcnt lgkmcnt(3)
    ds_read_b64_tr_b16 v[118:119], v171 offset:10240
    v_mfma_f32_16x16x32_bf16 v[48:51], a[208:211], v[132:135], v[48:51]
    s_add_u32 m0, s63, 135168
    v_mfma_f32_16x16x32_bf16 v[52:55], a[212:215], v[132:135], v[52:55]
    buffer_load_dwordx4 v172, s[36:39], s25 offen sc1 lds
    v_mfma_f32_16x16x32_bf16 v[8:11], a[216:219], v[104:107], v[8:11]
    ds_read_b64_tr_b16 v[120:121], v168 offset:12288
    v_mfma_f32_16x16x32_bf16 v[12:15], a[220:223], v[104:107], v[12:15]
    ds_read_b64_tr_b16 v[122:123], v168 offset:14336
    v_add_u32 v168, 16384, v168
    v_mfma_f32_16x16x32_bf16 v[16:19], a[224:227], v[104:107], v[16:19]
    s_add_u32 m0, s63, 139264
    ds_read_b64_tr_b16 v[124:125], v169 offset:12288
    v_mfma_f32_16x16x32_bf16 v[20:23], a[216:219], v[108:111], v[20:23]
    buffer_load_dwordx4 v172, s[36:39], s26 offen sc1 lds
    v_mfma_f32_16x16x32_bf16 v[24:27], a[220:223], v[108:111], v[24:27]
    ds_read_b64_tr_b16 v[126:127], v169 offset:14336
    v_add_u32 v169, 16384, v169
    v_mfma_f32_16x16x32_bf16 v[28:31], a[224:227], v[108:111], v[28:31]
    s_waitcnt lgkmcnt(6)
    ds_read_b64_tr_b16 v[128:129], v170 offset:12288
    v_mfma_f32_16x16x32_bf16 v[32:35], a[216:219], v[112:115], v[32:35]
    s_add_u32 m0, s63, 143360
    ds_read_b64_tr_b16 v[130:131], v170 offset:14336
    v_add_u32 v170, 16384, v170
    v_mfma_f32_16x16x32_bf16 v[36:39], a[220:223], v[112:115], v[36:39]
    buffer_load_dwordx4 v172, s[36:39], s27 offen sc1 lds
    v_mfma_f32_16x16x32_bf16 v[40:43], a[224:227], v[112:115], v[40:43]
    s_waitcnt lgkmcnt(6)
    ds_read_b64_tr_b16 v[132:133], v171 offset:12288
    v_mfma_f32_16x16x32_bf16 v[44:47], a[216:219], v[116:119], v[44:47]
    s_waitcnt lgkmcnt(3)
    ds_read_b64_tr_b16 v[134:135], v171 offset:14336
    v_add_u32 v171, 16384, v171
    v_mfma_f32_16x16x32_bf16 v[48:51], a[220:223], v[116:119], v[48:51]
    s_add_u32 m0, s63, 147456
    v_mfma_f32_16x16x32_bf16 v[52:55], a[224:227], v[116:119], v[52:55]
    buffer_load_dwordx4 v172, s[36:39], s44 offen sc1 lds
    v_mfma_f32_16x16x32_bf16 v[8:11], a[228:231], v[120:123], v[8:11]
    s_waitcnt vmcnt(13)
    s_barrier
    ds_read_b64_tr_b16 v[104:105], v168 offset:0
    v_mfma_f32_16x16x32_bf16 v[12:15], a[232:235], v[120:123], v[12:15]
    ds_read_b64_tr_b16 v[106:107], v168 offset:2048
    v_mfma_f32_16x16x32_bf16 v[16:19], a[236:239], v[120:123], v[16:19]
    s_add_u32 m0, s63, 151552
    ds_read_b64_tr_b16 v[108:109], v169 offset:0
    v_mfma_f32_16x16x32_bf16 v[20:23], a[228:231], v[124:127], v[20:23]
    buffer_load_dwordx4 v172, s[36:39], s45 offen sc1 lds
    v_mfma_f32_16x16x32_bf16 v[24:27], a[232:235], v[124:127], v[24:27]
    ds_read_b64_tr_b16 v[110:111], v169 offset:2048
    v_mfma_f32_16x16x32_bf16 v[28:31], a[236:239], v[124:127], v[28:31]
    s_waitcnt lgkmcnt(6)
    ds_read_b64_tr_b16 v[112:113], v170 offset:0
    v_mfma_f32_16x16x32_bf16 v[32:35], a[228:231], v[128:131], v[32:35]
    s_add_u32 m0, s63, 155648
    ds_read_b64_tr_b16 v[114:115], v170 offset:2048
    v_mfma_f32_16x16x32_bf16 v[36:39], a[232:235], v[128:131], v[36:39]
    buffer_load_dwordx4 v172, s[36:39], s46 offen sc1 lds
    v_mfma_f32_16x16x32_bf16 v[40:43], a[236:239], v[128:131], v[40:43]
    s_waitcnt lgkmcnt(6)
    ds_read_b64_tr_b16 v[116:117], v171 offset:0
    v_mfma_f32_16x16x32_bf16 v[44:47], a[228:231], v[132:135], v[44:47]
    s_waitcnt lgkmcnt(3)
    ds_read_b64_tr_b16 v[118:119], v171 offset:2048
    v_mfma_f32_16x16x32_bf16 v[48:51], a[232:235], v[132:135], v[48:51]
    v_mfma_f32_16x16x32_bf16 v[52:55], a[236:239], v[132:135], v[52:55]
    s_branch L_passB
L_prep:
    s_mov_b32 s36, s32
    s_mov_b32 s37, s33
    s_mov_b32 s38, 0x10000000
    s_mov_b32 s39, 0x20000
    s_lshr_b32 s50, s2, 4
    s_sub_u32 s50, s50, 8
    s_mul_i32 s50, s50, 6
    s_and_b32 s51, s2, 7
    s_add_u32 s50, s50, s51
    s_sub_u32 s50, s50, 2
    s_lshl_b32 s50, s50, 1
    s_bfe_u32 s51, s2, 0x10003
    s_add_u32 s70, s50, s51
    s_cmp_lt_u32 s71, 32
    s_cbranch_scc1 L_p_q
    s_sub_u32 s76, s71, 32
    s_sub_u32 s50, s76, 30
    s_cmp_lt_u32 s50, 10
    s_cselect_b32 s51, 10, 0
    s_sub_u32 s50, s76, 40
    s_cmp_lt_u32 s50, 10
    s_cselect_b32 s51, -10, s51
    s_add_u32 s76, s76, s51
    v_min_u32 v2, 39, v1
    s_mul_i32 s50, s3, 320
    v_lshl_add_u32 v60, v2, 3, s50
    global_load_dwordx2 v[62:63], v60, s[24:25]
    s_and_b32 s50, s3, 1
    s_mul_i32 s50, s50, 49152
    s_mul_i32 s64, s73, 192
    s_add_u32 s64, s64, s50
    s_mul_i32 s50, s34, 98304
    s_add_u32 s64, s64, s50
    s_cmp_ge_u32 s3, 2
    s_cselect_b32 s40, s20, s18
    s_cselect_b32 s41, s21, s19
    s_cselect_b32 s50, 1, 0
    s_mov_b32 s42, 1966080
    s_mov_b32 s43, 0x20000
    s_mul_i32 s61, s3, 3072
    v_add_u32 v2, 0, v1
    v_mul_u32_u24 v3, 171, v2
    v_lshrrev_b32 v3, 11, v3
    v_mul_u32_u24 v4, 12, v3
    v_sub_u32 v4, v2, v4
    v_bfe_u32 v2, v3, 2, 1
    v_lshl_add_u32 v2, v2, 1, s50
    v_xor_b32 v4, v4, v2
    v_mul_u32_u24 v3, 3072, v3
    v_lshl_add_u32 v228, v4, 4, v3
    v_add_u32 v2, 64, v1
    v_mul_u32_u24 v3, 171, v2
    v_lshrrev_b32 v3, 11, v3
    v_mul_u32_u24 v4, 12, v3
    v_sub_u32 v4, v2, v4
    v_bfe_u32 v2, v3, 2, 1
    v_lshl_add_u32 v2, v2, 1, s50
    v_xor_b32 v4, v4, v2
    v_mul_u32_u24 v3, 3072, v3
    v_lshl_add_u32 v229, v4, 4, v3
    v_subrev_u32 v229, 1024, v229
    v_add_u32 v2, 128, v1
    v_mul_u32_u24 v3, 171, v2
    v_lshrrev_b32 v3, 11, v3
    v_mul_u32_u24 v4, 12, v3
    v_sub_u32 v4, v2, v4
    v_bfe_u32 v2, v3, 2, 1
    v_lshl_add_u32 v2, v2, 1, s50
    v_xor_b32 v4, v4, v2
    v_mul_u32_u24 v3, 3072, v3
    v_lshl_add_u32 v230, v4, 4, v3
    v_subrev_u32 v230, 2048, v230
    v_lshrrev_b32 v2, 2, v1
    v_mul_u32_u24 v2, 192, v2
    v_and_b32 v3, 1, v1
    v_lshl_add_u32 v2, v3, 3, v2
    s_mul_i32 s50, s3, 3
    v_bfe_u32 v3, v1, 4, 1
    v_lshlrev_b32 v3, 1, v3
    v_bfe_u32 v4, v1, 1, 1
    v_add_u32 v231, s50, v4
    v_xor_b32 v231, v231, v3
    v_lshl_add_u32 v231, v231, 4, v2
    v_xor_b32 v232, 16, v231
    s_add_u32 s50, s50, 2
    v_xor_b32 v3, v3, v4
    v_xor_b32 v3, s50, v3
    v_lshl_add_u32 v3, v3, 4, v2
    v_mul_u32_u24 v4, 6144, v4
    v_add_u32 v233, v3, v4
    v_bfe_u32 v2, v1, 4, 1
    v_bfe_u32 v3, v1, 2, 2
    v_lshl_add_u32 v3, v2, 3, v3
    v_mul_u32_u24 v3, 1280, v3
    v_and_b32 v28, 3, v1
    v_lshl_add_u32 v3, v28, 3, v3
    v_lshrrev_b32 v29, 5, v1
    v_mul_u32_u24 v28, 160, v29
    s_mul_i32 s50, s3, 320
    s_add_u32 s50, s50, 140288
    v_add3_u32 v28, v28, v3, s50
    v_mul_u32_u24 v29, 247808, v29
    v_and_b32 v2, 31, v1
    v_lshl_add_u32 v29, v2, 4, v29
    s_lshr_b32 s50, s70, 1
    s_mov_b32 s51, 0x15555556
    s_mul_hi_u32 s51, s50, s51
    s_mul_i32 s52, s51, 12
    s_sub_u32 s52, s50, s52
    s_lshl_b32 s50, s3, 3
    s_add_u32 s50, s50, s51
    s_mul_i32 s50, s50, 61952
    s_mul_i32 s52, s52, 5120
    s_add_u32 s50, s50, s52
    s_and_b32 s51, s70, 1
    s_lshl_b32 s51, s51, 9
    s_add_u32 s50, s50, s51
    s_add_u32 s68, s50, 12582912
    s_add_u32 s69, s68, 4096
    s_waitcnt vmcnt(1)
    v_readfirstlane_b32 s48, v255
    s_nop 3
    s_mul_i32 s48, s48, 0x9E3779B1
    s_add_u32 s48, s48, 0x7F4A7C15
    s_and_b32 s48, s48, -16
    s_getreg_b32 s30, hwreg(HW_REG_XCC_ID, 0, 4)
    s_or_b32 s30, s30, s48
    s_cmp_eq_u32 s3, 1
    s_cbranch_scc0 L_id12
    s_lshl_b32 s50, s2, 7
    s_add_u32 s50, s50, 23199744
    v_mov_b32 v254, 0
    v_mov_b32 v255, s30
    s_mov_b64 exec, 1
    buffer_store_dword v255, v254, s[36:39], s50 offen sc1
    s_mov_b64 exec, -1
L_id12:
    s_mul_i32 s60, s3, 21760
    s_add_u32 s60, s60, 0
    s_mov_b32 s50, 0xbfb8aa3b
    s_waitcnt vmcnt(0)
    v_lshlrev_b32 v64, 16, v62
    v_and_b32 v65, 0xffff0000, v62
    v_lshlrev_b32 v66, 16, v63
    v_and_b32 v67, 0xffff0000, v63
    v_mul_f32 v68, s50, v64
    v_mul_f32 v69, s50, v65
    v_mul_f32 v70, s50, v66
    v_mul_f32 v71, s50, v67
    v_exp_f32 v68, v68
    v_exp_f32 v69, v69
    v_exp_f32 v70, v70
    v_exp_f32 v71, v71
    v_add_f32 v68, 1.0, v68
    v_add_f32 v69, 1.0, v69
    v_add_f32 v70, 1.0, v70
    v_add_f32 v71, 1.0, v71
    v_rcp_f32 v68, v68
    v_rcp_f32 v69, v69
    v_rcp_f32 v70, v70
    v_rcp_f32 v71, v71
    v_mul_f32 v64, v64, v68
    v_mul_f32 v65, v65, v69
    v_mul_f32 v66, v66, v70
    v_mul_f32 v67, v67, v71
    v_cvt_pk_bf16_f32 v62, v64, v65
    v_cvt_pk_bf16_f32 v63, v66, v67
    v_add_u32 v60, 87040, v60
    ds_write_b64 v60, v[62:63]
    s_mov_b32 s50, 0
    v_bfe_u32 v2, v1, 2, 2
    v_bfe_u32 v4, v1, 1, 1
    v_lshl_add_u32 v4, s50, 1, v4
    v_and_b32 v64, 2, v2
    v_xor_b32 v4, v4, v64
    v_lshlrev_b32 v2, 7, v2
    v_lshl_add_u32 v2, v4, 4, v2
    v_and_b32 v4, 1, v1
    v_lshl_add_u32 v2, v4, 3, v2
    v_lshrrev_b32 v4, 4, v1
    v_mul_u32_u24 v4, 1088, v4
    v_add_u32 v64, v2, v4
    v_xor_b32 v65, 32, v64
    v_add_u32 v64, s60, v64
    v_add_u32 v65, s60, v65
    v_and_b32 v66, 48, v1
    s_mul_i32 s50, s3, 320
    s_add_u32 s50, s50, 87040
    v_add_u32 v66, s50, v66
    ds_read_b128 v[72:75], v66 offset:0
    ds_read_b128 v[76:79], v66 offset:64
    ds_read_b128 v[80:83], v66 offset:128
    ds_read_b128 v[84:87], v66 offset:192
    ds_read_b128 v[88:91], v66 offset:256
    s_mov_b32 s44, s26
    s_mov_b32 s45, s27
    s_mov_b32 s46, 0x4b0000
    s_mov_b32 s47, 0x20000
    v_lshrrev_b32 v2, 3, v1
    v_and_b32 v4, 2, v2
    v_xor_b32 v4, v4, v1
    v_and_b32 v4, 7, v4
    v_mul_u32_u24 v2, 7680, v2
    v_lshl_add_u32 v61, v4, 4, v2
    s_mul_i32 s59, s3, 1228800
    s_lshl_b32 s50, s76, 7
    s_add_u32 s59, s59, s50
    s_cmp_lt_u32 s76, 60
    s_cselect_b32 s59, s59, 4915200
    s_add_u32 m0, s60, 0
    s_nop 0
    buffer_load_dwordx4 v61, s[44:47], s59 offen nt lds
    s_add_u32 s59, s59, 61440
    s_add_u32 m0, s60, 1088
    s_nop 0
    buffer_load_dwordx4 v61, s[44:47], s59 offen nt lds
    s_add_u32 s59, s59, 61440
    s_add_u32 m0, s60, 2176
    s_nop 0
    buffer_load_dwordx4 v61, s[44:47], s59 offen nt lds
    s_add_u32 s59, s59, 61440
    s_add_u32 m0, s60, 3264
    s_nop 0
    buffer_load_dwordx4 v61, s[44:47], s59 offen nt lds
    s_add_u32 s59, s59, 61440
    s_add_u32 m0, s60, 4352
    s_nop 0
    buffer_load_dwordx4 v61, s[44:47], s59 offen nt lds
    s_add_u32 s59, s59, 61440
    s_add_u32 m0, s60, 5440
    s_nop 0
    buffer_load_dwordx4 v61, s[44:47], s59 offen nt lds
    s_add_u32 s59, s59, 61440
    s_add_u32 m0, s60, 6528
    s_nop 0
    buffer_load_dwordx4 v61, s[44:47], s59 offen nt lds
    s_add_u32 s59, s59, 61440
    s_add_u32 m0, s60, 7616
    s_nop 0
    buffer_load_dwordx4 v61, s[44:47], s59 offen nt lds
    s_add_u32 s59, s59, 61440
    s_add_u32 m0, s60, 8704
    s_nop 0
    buffer_load_dwordx4 v61, s[44:47], s59 offen nt lds
    s_add_u32 s59, s59, 61440
    s_add_u32 m0, s60, 9792
    s_nop 0
    buffer_load_dwordx4 v61, s[44:47], s59 offen nt lds
    s_add_u32 s59, s59, 61440
    s_cmp_eq_u32 s3, 3
    s_cbranch_scc0 L_ftstm
    s_lshl_b32 s50, s71, 12
    s_add_u32 s51, s50, 23199744
    s_add_u32 s52, s50, 22806528
    s_cmp_lt_u32 s71, 64
    s_cselect_b32 s51, s51, s52
    s_add_u32 s52, s50, 23199744
    s_cmp_lt_u32 s71, 80
    s_cselect_b32 s51, s51, s52
    v_and_b32 v2, 31, v1
    v_lshlrev_b32 v2, 7, v2
    buffer_load_dword v205, v2, s[36:39], s51 offen
L_ftstm:
    s_mov_b32 s66, s22
    s_mov_b32 s67, s23
    v_lshrrev_b32 v2, 3, v1
    v_bfe_u32 v3, v1, 4, 2
    v_lshlrev_b32 v3, 1, v3
    v_xor_b32 v3, v3, v1
    v_and_b32 v3, 7, v3
    v_mul_u32_u24 v2, 4224, v2
    v_lshl_add_u32 v172, v3, 4, v2
    v_add_u32 v172, 8650752, v172
    v_lshrrev_b32 v2, 2, v1
    v_lshlrev_b32 v2, 7, v2
    v_and_b32 v3, 3, v1
    v_lshl_add_u32 v2, v3, 3, v2
    v_bfe_u32 v3, v1, 3, 2
    v_xor_b32 v168, 0, v3
    v_lshl_add_u32 v168, v168, 5, v2
    v_xor_b32 v169, 1, v3
    v_lshl_add_u32 v169, v169, 5, v2
    v_xor_b32 v170, 2, v3
    v_lshl_add_u32 v170, v170, 5, v2
    v_xor_b32 v171, 3, v3
    v_lshl_add_u32 v171, v171, 5, v2
    v_and_b32 v175, 15, v1
    v_lshlrev_b32 v175, 4, v175
    v_bfe_u32 v2, v1, 4, 1
    v_lshrrev_b32 v3, 5, v1
    v_mul_u32_u24 v173, 51456, v2
    v_lshl_add_u32 v173, v3, 8, v173
    v_add_u32 v173, v173, v175
    v_lshl_add_u32 v2, v2, 1, v3
    v_mul_u32_u24 v174, 51456, v2
    v_add_u32 v174, v174, v175
    v_bfe_u32 v2, v0, 1, 2
    v_lshlrev_b32 v2, 1, v2
    s_lshr_b32 s50, s73, 1
    v_xor_b32 v2, s50, v2
    v_lshlrev_b32 v2, 4, v2
    v_lshl_add_u32 v216, v0, 7, v2
    s_and_b32 s50, s73, 1
    s_lshl_b32 s50, s50, 3
    v_add_u32 v216, s50, v216
    v_add_u32 v217, 0x8000, v216
    v_add_u32 v218, 0x10000, v216
    v_cmp_gt_u32 vcc, 128, v0
    s_nop 1
    v_cndmask_b32 v218, v217, v218, vcc
    v_lshrrev_b32 v2, 1, v1
    v_lshlrev_b32 v2, 9, v2
    v_and_b32 v3, 1, v1
    v_lshl_add_u32 v219, v3, 2, v2
    s_lshl_b32 s50, s3, 7
    s_add_u32 s50, s50, 112640
    v_add_u32 v219, s50, v219
    v_min_u32 v2, 49, v1
    v_lshlrev_b32 v2, 7, v2
    v_add_u32 v2, 98304, v2
    v_cmp_lt_u32 vcc, 39, v1
    s_nop 1
    v_cndmask_b32 v219, v219, v2, vcc
    s_mov_b32 s17, 23199744
    s_lshl_b32 s77, s34, 7
    v_lshl_add_u32 v220, v0, 2, s77
    v_add_u32 v221, 1024, v220
    v_add_u32 v222, 2048, v220
    v_subrev_u32 v2, 2560, v220
    v_min_u32 v220, v220, v2
    v_subrev_u32 v2, 2560, v221
    v_min_u32 v221, v221, v2
    v_subrev_u32 v2, 2560, v222
    v_min_u32 v222, v222, v2
    v_mov_b32 v2, 0x80000000
    v_cmp_gt_u32 vcc, 128, v0
    s_nop 1
    v_cndmask_b32 v222, v2, v222, vcc
    s_mov_b32 s77, 23183360
    s_lshl_b32 s65, s75, 2
    s_add_u32 s65, s65, s3
    s_mul_i32 s65, s65, 61952
    s_add_u32 s65, s65, 12582912
    s_mov_b32 s16, 0
    s_and_b32 s16, s16, 3
    s_add_u32 s62, s16, 0
    s_and_b32 s62, s62, 3
    s_mul_i32 s62, s62, 15360
    s_add_u32 s62, s62, s65
    s_movk_i32 s4, 4096
    s_movk_i32 s5, 8192
    s_lshl_b32 s6, s72, 10
    s_add_u32 s6, s6, 23101440
    s_lshl_b32 s7, s73, 6
    s_add_u32 s7, s7, s6
    s_mul_i32 s8, s72, 804
    s_mul_i32 s50, s73, 12
    s_add_u32 s8, s8, s50
    s_lshr_b32 s50, s73, 2
    s_mul_i32 s50, s50, 2
    s_add_u32 s8, s8, s50
    s_mul_i32 s50, s3, 3
    s_add_u32 s8, s8, s50
    s_lshl_b32 s8, s8, 8
    s_add_u32 s8, s8, 15728640
    s_lshl_b32 s9, s73, 2
    s_add_u32 s9, s9, s3
    s_mul_i32 s9, s9, 384
    s_add_u32 s9, s9, 23527424
    s_mul_i32 s51, s3, 33792
    s_lshl_b32 s50, s72, 7
    s_add_u32 s51, s51, s50
    s_mul_i32 s50, s34, 135168
    s_add_u32 s10, s51, s50
    s_lshl_b32 s63, s3, 10
    s_add_u32 s11, s10, 135168
    s_sub_u32 s51, s11, 2703360
    s_min_u32 s11, s11, s51
    s_add_u32 s12, s11, 135168
    s_sub_u32 s51, s12, 2703360
    s_min_u32 s12, s12, s51
    s_add_u32 s13, s12, 135168
    s_sub_u32 s51, s13, 2703360
    s_min_u32 s13, s13, s51
    s_add_u32 s14, s13, 135168
    s_sub_u32 s51, s14, 2703360
    s_min_u32 s14, s14, s51
    s_add_u32 s15, s14, 135168
    s_sub_u32 s51, s15, 2703360
    s_min_u32 s15, s15, s51
    s_add_u32 s18, s15, 135168
    s_sub_u32 s51, s18, 2703360
    s_min_u32 s18, s18, s51
    s_add_u32 s19, s18, 135168
    s_sub_u32 s51, s19, 2703360
    s_min_u32 s19, s19, s51
    s_add_u32 s20, s19, 135168
    s_sub_u32 s51, s20, 2703360
    s_min_u32 s20, s20, s51
    s_add_u32 s21, s20, 135168
    s_sub_u32 s51, s21, 2703360
    s_min_u32 s21, s21, s51
    s_add_u32 s22, s21, 135168
    s_sub_u32 s51, s22, 2703360
    s_min_u32 s22, s22, s51
    s_add_u32 s23, s22, 135168
    s_sub_u32 s51, s23, 2703360
    s_min_u32 s23, s23, s51
    s_add_u32 s24, s23, 135168
    s_sub_u32 s51, s24, 2703360
    s_min_u32 s24, s24, s51
    s_add_u32 s25, s24, 135168
    s_sub_u32 s51, s25, 2703360
    s_min_u32 s25, s25, s51
    s_add_u32 s26, s25, 135168
    s_sub_u32 s51, s26, 2703360
    s_min_u32 s26, s26, s51
    s_add_u32 s27, s26, 135168
    s_sub_u32 s51, s27, 2703360
    s_min_u32 s27, s27, s51
    s_add_u32 m0, s60, 10880
    s_nop 0
    buffer_load_dwordx4 v61, s[44:47], s59 offen nt lds
    s_add_u32 s59, s59, 61440
    s_add_u32 m0, s60, 11968
    s_nop 0
    buffer_load_dwordx4 v61, s[44:47], s59 offen nt lds
    s_add_u32 s59, s59, 61440
    s_add_u32 m0, s60, 13056
    s_nop 0
    buffer_load_dwordx4 v61, s[44:47], s59 offen nt lds
    s_add_u32 s59, s59, 61440
    s_add_u32 m0, s60, 14144
    s_nop 0
    buffer_load_dwordx4 v61, s[44:47], s59 offen nt lds
    s_add_u32 s59, s59, 61440
    s_add_u32 m0, s60, 15232
    s_nop 0
    buffer_load_dwordx4 v61, s[44:47], s59 offen nt lds
    s_add_u32 s59, s59, 61440
    s_add_u32 m0, s60, 16320
    s_nop 0
    buffer_load_dwordx4 v61, s[44:47], s59 offen nt lds
    s_add_u32 s59, s59, 61440
    s_add_u32 m0, s60, 17408
    s_nop 0
    buffer_load_dwordx4 v61, s[44:47], s59 offen nt lds
    s_add_u32 s59, s59, 61440
    s_add_u32 m0, s60, 18496
    s_nop 0
    buffer_load_dwordx4 v61, s[44:47], s59 offen nt lds
    s_add_u32 s59, s59, 61440
    s_add_u32 m0, s60, 19584
    s_nop 0
    buffer_load_dwordx4 v61, s[44:47], s59 offen nt lds
    s_add_u32 s59, s59, 61440
    s_add_u32 m0, s60, 20672
    s_nop 0
    buffer_load_dwordx4 v61, s[44:47], s59 offen nt lds
    s_mov_b32 s44, s66
    s_mov_b32 s45, s67
    s_mov_b32 s46, 0x1e0000
    s_mov_b32 s47, 0x20000
    s_mul_i32 s52, s70, 20480
    s_mul_i32 s53, s3, 5120
    s_add_u32 s52, s52, s53
    s_add_u32 m0, s53, 140288
    s_nop 0
    buffer_load_dwordx4 v248, s[44:47], s52 offen offset:0 nt lds
    buffer_load_dwordx4 v248, s[44:47], s52 offen offset:1024 nt lds
    buffer_load_dwordx4 v248, s[44:47], s52 offen offset:2048 nt lds
    buffer_load_dwordx4 v248, s[44:47], s52 offen offset:3072 nt lds
    s_add_u32 m0, s53, 144384
    s_add_u32 s52, s52, 4096
    buffer_load_dwordx4 v248, s[44:47], s52 offen offset:0 nt lds
    s_add_u32 s44, s27, 135168
    s_sub_u32 s51, s44, 2703360
    s_min_u32 s44, s44, s51
    s_add_u32 s45, s44, 135168
    s_sub_u32 s51, s45, 2703360
    s_min_u32 s45, s45, s51
    s_add_u32 s46, s45, 135168
    s_sub_u32 s51, s46, 2703360
    s_min_u32 s46, s46, s51
    s_add_u32 s47, s46, 135168
    s_sub_u32 s51, s47, 2703360
    s_min_u32 s47, s47, s51
    s_lshr_b32 s50, s2, 3
    s_and_b32 s50, s50, 15
    s_lshl_b32 s50, s50, 1
    s_and_b32 s51, s3, 1
    s_add_u32 s50, s50, s51
    s_mul_i32 s50, s50, 61440
    s_lshr_b32 s51, s73, 2
    s_mul_i32 s51, s51, 768
    s_add_u32 s50, s50, s51
    s_add_u32 s50, s50, 0
    v_add_u32 v2, 0, v1
    v_min_u32 v2, 119, v2
    v_mul_u32_u24 v3, 10923, v2
    v_lshrrev_b32 v3, 16, v3
    v_mul_u32_u24 v4, 6, v3
    v_sub_u32 v4, v2, v4
    v_mul_u32_u24 v3, 3072, v3
    v_lshl_add_u32 v2, v4, 7, v3
    buffer_load_dword v200, v2, s[40:43], s50 offen
    v_add_u32 v2, 64, v1
    v_min_u32 v2, 119, v2
    v_mul_u32_u24 v3, 10923, v2
    v_lshrrev_b32 v3, 16, v3
    v_mul_u32_u24 v4, 6, v3
    v_sub_u32 v4, v2, v4
    v_mul_u32_u24 v3, 3072, v3
    v_lshl_add_u32 v2, v4, 7, v3
    buffer_load_dword v201, v2, s[40:43], s50 offen
    s_waitcnt vmcnt(23)
    ds_read_b64_tr_b16 v[112:113], v64 offset:0
    ds_read_b64_tr_b16 v[114:115], v64 offset:512
    ds_read_b64_tr_b16 v[116:117], v65 offset:0
    ds_read_b64_tr_b16 v[118:119], v65 offset:512
    ds_read_b64_tr_b16 v[120:121], v64 offset:64
    ds_read_b64_tr_b16 v[122:123], v64 offset:576
    ds_read_b64_tr_b16 v[124:125], v65 offset:64
    ds_read_b64_tr_b16 v[126:127], v65 offset:576
    s_waitcnt lgkmcnt(6)
    v_mfma_f32_16x16x32_bf16 v[96:99], v[112:115], v[72:75], 0
    s_waitcnt lgkmcnt(4)
    v_mfma_f32_16x16x32_bf16 v[100:103], v[116:119], v[72:75], 0
    s_waitcnt lgkmcnt(2)
    v_mfma_f32_16x16x32_bf16 v[104:107], v[120:123], v[72:75], 0
    s_waitcnt lgkmcnt(0)
    v_mfma_f32_16x16x32_bf16 v[108:111], v[124:127], v[72:75], 0
    s_waitcnt vmcnt(19)
    ds_read_b64_tr_b16 v[128:129], v64 offset:4352
    ds_read_b64_tr_b16 v[130:131], v64 offset:4864
    ds_read_b64_tr_b16 v[132:133], v65 offset:4352
    ds_read_b64_tr_b16 v[134:135], v65 offset:4864
    ds_read_b64_tr_b16 v[136:137], v64 offset:4416
    ds_read_b64_tr_b16 v[138:139], v64 offset:4928
    ds_read_b64_tr_b16 v[140:141], v65 offset:4416
    ds_read_b64_tr_b16 v[142:143], v65 offset:4928
    s_waitcnt lgkmcnt(6)
    v_mfma_f32_16x16x32_bf16 v[96:99], v[128:131], v[76:79], v[96:99]
    s_waitcnt lgkmcnt(4)
    v_mfma_f32_16x16x32_bf16 v[100:103], v[132:135], v[76:79], v[100:103]
    s_waitcnt lgkmcnt(2)
    v_mfma_f32_16x16x32_bf16 v[104:107], v[136:139], v[76:79], v[104:107]
    s_waitcnt lgkmcnt(0)
    v_mfma_f32_16x16x32_bf16 v[108:111], v[140:143], v[76:79], v[108:111]
    s_waitcnt vmcnt(15)
    ds_read_b64_tr_b16 v[112:113], v64 offset:8704
    ds_read_b64_tr_b16 v[114:115], v64 offset:9216
    ds_read_b64_tr_b16 v[116:117], v65 offset:8704
    ds_read_b64_tr_b16 v[118:119], v65 offset:9216
    ds_read_b64_tr_b16 v[120:121], v64 offset:8768
    ds_read_b64_tr_b16 v[122:123], v64 offset:9280
    ds_read_b64_tr_b16 v[124:125], v65 offset:8768
    ds_read_b64_tr_b16 v[126:127], v65 offset:9280
    s_waitcnt lgkmcnt(6)
    v_mfma_f32_16x16x32_bf16 v[96:99], v[112:115], v[80:83], v[96:99]
    s_waitcnt lgkmcnt(4)
    v_mfma_f32_16x16x32_bf16 v[100:103], v[116:119], v[80:83], v[100:103]
    s_waitcnt lgkmcnt(2)
    v_mfma_f32_16x16x32_bf16 v[104:107], v[120:123], v[80:83], v[104:107]
    s_waitcnt lgkmcnt(0)
    v_mfma_f32_16x16x32_bf16 v[108:111], v[124:127], v[80:83], v[108:111]
    s_waitcnt vmcnt(11)
    ds_read_b64_tr_b16 v[128:129], v64 offset:13056
    ds_read_b64_tr_b16 v[130:131], v64 offset:13568
    ds_read_b64_tr_b16 v[132:133], v65 offset:13056
    ds_read_b64_tr_b16 v[134:135], v65 offset:13568
    ds_read_b64_tr_b16 v[136:137], v64 offset:13120
    ds_read_b64_tr_b16 v[138:139], v64 offset:13632
    ds_read_b64_tr_b16 v[140:141], v65 offset:13120
    ds_read_b64_tr_b16 v[142:143], v65 offset:13632
    s_waitcnt lgkmcnt(6)
    v_mfma_f32_16x16x32_bf16 v[96:99], v[128:131], v[84:87], v[96:99]
    s_waitcnt lgkmcnt(4)
    v_mfma_f32_16x16x32_bf16 v[100:103], v[132:135], v[84:87], v[100:103]
    s_waitcnt lgkmcnt(2)
    v_mfma_f32_16x16x32_bf16 v[104:107], v[136:139], v[84:87], v[104:107]
    s_waitcnt lgkmcnt(0)
    v_mfma_f32_16x16x32_bf16 v[108:111], v[140:143], v[84:87], v[108:111]
    s_waitcnt vmcnt(7)
    ds_read_b64_tr_b16 v[112:113], v64 offset:17408
    ds_read_b64_tr_b16 v[114:115], v64 offset:17920
    ds_read_b64_tr_b16 v[116:117], v65 offset:17408
    ds_read_b64_tr_b16 v[118:119], v65 offset:17920
    ds_read_b64_tr_b16 v[120:121], v64 offset:17472
    ds_read_b64_tr_b16 v[122:123], v64 offset:17984
    ds_read_b64_tr_b16 v[124:125], v65 offset:17472
    ds_read_b64_tr_b16 v[126:127], v65 offset:17984
    s_waitcnt lgkmcnt(6)
    v_mfma_f32_16x16x32_bf16 v[96:99], v[112:115], v[88:91], v[96:99]
    s_waitcnt lgkmcnt(4)
    v_mfma_f32_16x16x32_bf16 v[100:103], v[116:119], v[88:91], v[100:103]
    s_waitcnt lgkmcnt(2)
    v_mfma_f32_16x16x32_bf16 v[104:107], v[120:123], v[88:91], v[104:107]
    s_waitcnt lgkmcnt(0)
    v_mfma_f32_16x16x32_bf16 v[108:111], v[124:127], v[88:91], v[108:111]
    v_and_b32 v2, 48, v1
    s_lshl_b32 s50, s3, 8
    s_add_u32 s50, s50, 88320
    v_add_u32 v2, s50, v2
    v_lshlrev_b32 v3, 2, v1
    v_add_u32 v3, 88320, v3
    s_mov_b32 exec_lo, 0x00010001
    s_mov_b32 exec_hi, 0x00010001
    ds_write_b128 v2, v[96:99] offset:0
    ds_write_b128 v2, v[100:103] offset:64
    ds_write_b128 v2, v[104:107] offset:128
    ds_write_b128 v2, v[108:111] offset:192
    s_mov_b64 exec, -1
    s_waitcnt lgkmcnt(0)
    s_barrier
    ds_read_b32 v80, v3 offset:0
    ds_read_b32 v81, v3 offset:256
    ds_read_b32 v82, v3 offset:512
    ds_read_b32 v83, v3 offset:768
    s_waitcnt lgkmcnt(2)
    v_add_f32 v80, v80, v81
    s_waitcnt lgkmcnt(0)
    v_add_f32 v82, v82, v83
    v_add_f32 v80, v80, v82
    s_cmp_eq_u32 s3, 0
    s_cbranch_scc0 L_mod_done
    s_cmp_lt_u32 s76, 60
    s_cbranch_scc0 L_mod_done
    v_lshlrev_b32 v2, 2, v1
    s_mov_b32 s50, 429496730
    s_mul_hi_u32 s51, s76, s50
    s_mul_i32 s52, s51, 10
    s_sub_u32 s52, s76, s52
    v_cvt_pk_bf16_f32 v3, v80, v80
    v_lshlrev_b32 v3, 16, v3
    v_add_f32 v4, 1.0, v3
    v_cvt_pk_bf16_f32 v4, v4, v4
    v_lshlrev_b32 v4, 16, v4
    s_cmp_eq_u32 s51, 1
    s_cselect_b64 vcc, -1, 0
    s_cmp_eq_u32 s51, 4
    s_cselect_b64 vcc, -1, vcc
    v_cndmask_b32 v4, v3, v4, vcc
    s_cselect_b64 s[54:55], -1, 0
    v_cmp_eq_f32 vcc, 0, v4
    s_and_b64 vcc, vcc, s[54:55]
    v_mov_b32 v3, 0x2b800000
    v_cndmask_b32 v4, v4, v3, vcc
    v_mov_b32 v5, s48
    v_lshlrev_b32 v6, 3, v1
    s_lshl_b32 s53, s76, 9
    s_add_u32 s53, s53, 23560192
    buffer_store_dwordx2 v[4:5], v6, s[36:39], s53 offen sc1
    s_cmp_eq_u32 s51, 4
    s_cbranch_scc0 L_mod_noicb
    v_rcp_f32 v3, v4
    s_lshl_b32 s53, s52, 8
    s_add_u32 s53, s53, 23183360
    v_fma_f32 v5, -v4, v3, 1.0
    v_fmac_f32 v3, v5, v3
    buffer_store_dword v3, v2, s[36:39], s53 offen sc1
L_mod_noicb:
    s_lshl_b32 s53, s76, 8
    s_add_u32 s53, s53, 23134208
    buffer_store_dword v4, v2, s[36:39], s53 offen sc1
    s_sub_u32 s53, s51, 3
    s_cmp_lt_u32 s53, 2
    s_cbranch_scc0 L_mod_done
    v_mov_b32_dpp v3, v4 quad_perm:[1,0,3,2] row_mask:0xf bank_mask:0xf
    v_lshrrev_b32 v5, 16, v4
    v_or_b32 v5, v5, v3
    v_lshrrev_b32 v6, 5, v1
    v_lshlrev_b32 v6, 7, v6
    v_bfe_u32 v7, v1, 2, 2
    v_lshl_add_u32 v6, v7, 4, v6
    v_bfe_u32 v7, v1, 4, 1
    v_lshl_add_u32 v6, v7, 3, v6
    v_and_b32 v7, 2, v1
    v_lshl_add_u32 v6, v7, 1, v6
    s_xor_b32 s53, s53, 1
    s_lshl_b32 s53, s53, 6
    s_lshl_b32 s52, s52, 8
    s_add_u32 s53, s53, s52
    s_add_u32 s53, s53, 23166976
    s_mov_b32 exec_lo, 0x55555555
    s_mov_b32 exec_hi, 0x55555555
    buffer_store_dword v5, v6, s[36:39], s53 offen sc1
    s_mov_b64 exec, -1
L_mod_done:
    s_waitcnt vmcnt(0)
    s_barrier
    s_cmp_lt_u32 s76, 60
    s_cbranch_scc0 L_nofp2
    s_cmp_eq_u32 s3, 0
    s_cbranch_scc0 L_wf13
    s_lshl_b32 s54, s76, 7
    s_add_u32 s54, s54, 23298048
    v_mov_b32 v254, 0
    v_mov_b32 v255, s48
    s_mov_b64 exec, 1
    buffer_store_dword v255, v254, s[36:39], s54 offen sc1
    s_mov_b64 exec, -1
L_wf13:
L_nofp2:
    ds_read_b64_tr_b16 v[32:33], v28 offset:0
    ds_read_b64_tr_b16 v[34:35], v28 offset:5120
    ds_read_b64_tr_b16 v[36:37], v28 offset:32
    ds_read_b64_tr_b16 v[38:39], v28 offset:5152
    ds_read_b64_tr_b16 v[40:41], v28 offset:64
    ds_read_b64_tr_b16 v[42:43], v28 offset:5184
    ds_read_b64_tr_b16 v[44:45], v28 offset:96
    ds_read_b64_tr_b16 v[46:47], v28 offset:5216
    ds_read_b64_tr_b16 v[48:49], v28 offset:128
    ds_read_b64_tr_b16 v[50:51], v28 offset:5248
    s_waitcnt lgkmcnt(8)
    buffer_store_dwordx4 v[32:35], v29, s[36:39], s68 offen offset:0 sc1
    s_waitcnt lgkmcnt(6)
    buffer_store_dwordx4 v[36:39], v29, s[36:39], s68 offen offset:1024 sc1
    s_waitcnt lgkmcnt(4)
    buffer_store_dwordx4 v[40:43], v29, s[36:39], s68 offen offset:2048 sc1
    s_waitcnt lgkmcnt(2)
    buffer_store_dwordx4 v[44:47], v29, s[36:39], s68 offen offset:3072 sc1
    s_waitcnt lgkmcnt(0)
    buffer_store_dwordx4 v[48:51], v29, s[36:39], s69 offen offset:0 sc1
    v_add_u32 v231, 8192, v231
    v_add_u32 v237, 49152, v231
    v_add_u32 v232, 8192, v232
    v_add_u32 v238, 49152, v232
    v_add_u32 v233, 8192, v233
    v_add_u32 v239, 49152, v233
    s_add_u32 m0, s61, 8192
    s_nop 0
    buffer_load_dwordx4 v228, s[40:43], s64 offen offset:0 lds
    buffer_load_dwordx4 v229, s[40:43], s64 offen offset:1024 lds
    buffer_load_dwordx4 v230, s[40:43], s64 offen offset:2048 lds
    s_add_u32 s64, s64, 98304
    s_sub_u32 s35, s64, 1966080
    s_min_u32 s64, s64, s35
    s_add_u32 m0, s61, 20480
    s_nop 0
    buffer_load_dwordx4 v228, s[40:43], s64 offen offset:0 lds
    buffer_load_dwordx4 v229, s[40:43], s64 offen offset:1024 lds
    buffer_load_dwordx4 v230, s[40:43], s64 offen offset:2048 lds
    s_add_u32 s64, s64, 98304
    s_sub_u32 s35, s64, 1966080
    s_min_u32 s64, s64, s35
    s_add_u32 m0, s61, 32768
    s_nop 0
    buffer_load_dwordx4 v228, s[40:43], s64 offen offset:0 lds
    buffer_load_dwordx4 v229, s[40:43], s64 offen offset:1024 lds
    buffer_load_dwordx4 v230, s[40:43], s64 offen offset:2048 lds
    s_add_u32 s64, s64, 98304
    s_sub_u32 s35, s64, 1966080
    s_min_u32 s64, s64, s35
    s_add_u32 m0, s61, 45056
    s_nop 0
    buffer_load_dwordx4 v228, s[40:43], s64 offen offset:0 lds
    buffer_load_dwordx4 v229, s[40:43], s64 offen offset:1024 lds
    buffer_load_dwordx4 v230, s[40:43], s64 offen offset:2048 lds
    s_add_u32 s64, s64, 98304
    s_sub_u32 s35, s64, 1966080
    s_min_u32 s64, s64, s35
    s_branch L_p_w
L_p_q:
    s_and_b32 s50, s3, 1
    s_mul_i32 s50, s50, 49152
    s_mul_i32 s64, s73, 192
    s_add_u32 s64, s64, s50
    s_mul_i32 s50, s34, 98304
    s_add_u32 s64, s64, s50
    s_cmp_ge_u32 s3, 2
    s_cselect_b32 s40, s20, s18
    s_cselect_b32 s41, s21, s19
    s_cselect_b32 s50, 1, 0
    s_mov_b32 s42, 1966080
    s_mov_b32 s43, 0x20000
    s_mul_i32 s61, s3, 3072
    v_add_u32 v2, 0, v1
    v_mul_u32_u24 v3, 171, v2
    v_lshrrev_b32 v3, 11, v3
    v_mul_u32_u24 v4, 12, v3
    v_sub_u32 v4, v2, v4
    v_bfe_u32 v2, v3, 2, 1
    v_lshl_add_u32 v2, v2, 1, s50
    v_xor_b32 v4, v4, v2
    v_mul_u32_u24 v3, 3072, v3
    v_lshl_add_u32 v228, v4, 4, v3
    v_add_u32 v2, 64, v1
    v_mul_u32_u24 v3, 171, v2
    v_lshrrev_b32 v3, 11, v3
    v_mul_u32_u24 v4, 12, v3
    v_sub_u32 v4, v2, v4
    v_bfe_u32 v2, v3, 2, 1
    v_lshl_add_u32 v2, v2, 1, s50
    v_xor_b32 v4, v4, v2
    v_mul_u32_u24 v3, 3072, v3
    v_lshl_add_u32 v229, v4, 4, v3
    v_subrev_u32 v229, 1024, v229
    v_add_u32 v2, 128, v1
    v_mul_u32_u24 v3, 171, v2
    v_lshrrev_b32 v3, 11, v3
    v_mul_u32_u24 v4, 12, v3
    v_sub_u32 v4, v2, v4
    v_bfe_u32 v2, v3, 2, 1
    v_lshl_add_u32 v2, v2, 1, s50
    v_xor_b32 v4, v4, v2
    v_mul_u32_u24 v3, 3072, v3
    v_lshl_add_u32 v230, v4, 4, v3
    v_subrev_u32 v230, 2048, v230
    v_lshrrev_b32 v2, 2, v1
    v_mul_u32_u24 v2, 192, v2
    v_and_b32 v3, 1, v1
    v_lshl_add_u32 v2, v3, 3, v2
    s_mul_i32 s50, s3, 3
    v_bfe_u32 v3, v1, 4, 1
    v_lshlrev_b32 v3, 1, v3
    v_bfe_u32 v4, v1, 1, 1
    v_add_u32 v231, s50, v4
    v_xor_b32 v231, v231, v3
    v_lshl_add_u32 v231, v231, 4, v2
    v_xor_b32 v232, 16, v231
    s_add_u32 s50, s50, 2
    v_xor_b32 v3, v3, v4
    v_xor_b32 v3, s50, v3
    v_lshl_add_u32 v3, v3, 4, v2
    v_mul_u32_u24 v4, 6144, v4
    v_add_u32 v233, v3, v4
    s_waitcnt vmcnt(0)
    v_readfirstlane_b32 s48, v255
    s_nop 3
    s_mul_i32 s48, s48, 0x9E3779B1
    s_add_u32 s48, s48, 0x7F4A7C15
    s_and_b32 s48, s48, -16
    s_getreg_b32 s30, hwreg(HW_REG_XCC_ID, 0, 4)
    s_or_b32 s30, s30, s48
    s_cmp_eq_u32 s3, 1
    s_cbranch_scc0 L_id14
    s_lshl_b32 s50, s2, 7
    s_add_u32 s50, s50, 23199744
    v_mov_b32 v254, 0
    v_mov_b32 v255, s30
    s_mov_b64 exec, 1
    buffer_store_dword v255, v254, s[36:39], s50 offen sc1
    s_mov_b64 exec, -1
L_id14:
    s_mov_b32 s44, s4
    s_mov_b32 s45, s5
    s_mov_b32 s46, 0x280000
    s_mov_b32 s47, 0x20000
    s_lshl_b32 s50, s71, 2
    s_add_u32 s50, s50, s3
    s_mul_i32 s56, s50, 10240
    v_lshrrev_b32 v2, 4, v1
    v_mul_u32_u24 v2, 1280, v2
    v_and_b32 v3, 15, v1
    v_lshl_add_u32 v31, v3, 4, v2
    buffer_load_dwordx4 v[64:67], v31, s[44:47], s56 offen offset:0
    buffer_load_dwordx4 v[68:71], v31, s[44:47], s56 offen offset:256
    buffer_load_dwordx4 v[72:75], v31, s[44:47], s56 offen offset:512
    buffer_load_dwordx4 v[76:79], v31, s[44:47], s56 offen offset:768
    buffer_load_dwordx4 v[80:83], v31, s[44:47], s56 offen offset:1024
    s_add_u32 s56, s56, 5120
    buffer_load_dwordx4 v[84:87], v31, s[44:47], s56 offen offset:0
    buffer_load_dwordx4 v[88:91], v31, s[44:47], s56 offen offset:256
    buffer_load_dwordx4 v[92:95], v31, s[44:47], s56 offen offset:512
    buffer_load_dwordx4 v[96:99], v31, s[44:47], s56 offen offset:768
    buffer_load_dwordx4 v[100:103], v31, s[44:47], s56 offen offset:1024
    s_add_u32 s56, s56, 1305600
    s_cmp_eq_u32 s3, 3
    s_cbranch_scc0 L_ftsts
    s_lshl_b32 s50, s71, 12
    s_add_u32 s51, s50, 23199744
    s_add_u32 s52, s50, 22806528
    s_cmp_lt_u32 s71, 64
    s_cselect_b32 s51, s51, s52
    s_add_u32 s52, s50, 23199744
    s_cmp_lt_u32 s71, 80
    s_cselect_b32 s51, s51, s52
    v_and_b32 v2, 31, v1
    v_lshlrev_b32 v2, 7, v2
    buffer_load_dword v205, v2, s[36:39], s51 offen
L_ftsts:
    s_lshr_b32 s50, s2, 3
    s_and_b32 s50, s50, 15
    s_lshl_b32 s50, s50, 1
    s_and_b32 s51, s3, 1
    s_add_u32 s50, s50, s51
    s_mul_i32 s50, s50, 61440
    s_lshr_b32 s51, s73, 2
    s_mul_i32 s51, s51, 768
    s_add_u32 s50, s50, s51
    s_add_u32 s50, s50, 0
    v_add_u32 v2, 0, v1
    v_min_u32 v2, 119, v2
    v_mul_u32_u24 v3, 10923, v2
    v_lshrrev_b32 v3, 16, v3
    v_mul_u32_u24 v4, 6, v3
    v_sub_u32 v4, v2, v4
    v_mul_u32_u24 v3, 3072, v3
    v_lshl_add_u32 v2, v4, 7, v3
    buffer_load_dword v200, v2, s[40:43], s50 offen
    v_add_u32 v2, 64, v1
    v_min_u32 v2, 119, v2
    v_mul_u32_u24 v3, 10923, v2
    v_lshrrev_b32 v3, 16, v3
    v_mul_u32_u24 v4, 6, v3
    v_sub_u32 v4, v2, v4
    v_mul_u32_u24 v3, 3072, v3
    v_lshl_add_u32 v2, v4, 7, v3
    buffer_load_dword v201, v2, s[40:43], s50 offen
    v_bfe_u32 v2, v1, 4, 1
    v_bfe_u32 v3, v1, 2, 2
    v_lshl_add_u32 v3, v2, 3, v3
    v_mul_u32_u24 v3, 1280, v3
    v_and_b32 v28, 3, v1
    v_lshl_add_u32 v3, v28, 3, v3
    v_lshrrev_b32 v29, 5, v1
    v_mul_u32_u24 v28, 160, v29
    s_mul_i32 s50, s3, 320
    s_add_u32 s50, s50, 140288
    v_add3_u32 v28, v28, v3, s50
    v_mul_u32_u24 v29, 247808, v29
    v_and_b32 v2, 31, v1
    v_lshl_add_u32 v29, v2, 4, v29
    s_lshr_b32 s50, s70, 1
    s_mov_b32 s51, 0x15555556
    s_mul_hi_u32 s51, s50, s51
    s_mul_i32 s52, s51, 12
    s_sub_u32 s52, s50, s52
    s_lshl_b32 s50, s3, 3
    s_add_u32 s50, s50, s51
    s_mul_i32 s50, s50, 61952
    s_mul_i32 s52, s52, 5120
    s_add_u32 s50, s50, s52
    s_and_b32 s51, s70, 1
    s_lshl_b32 s51, s51, 9
    s_add_u32 s50, s50, s51
    s_add_u32 s68, s50, 12582912
    s_add_u32 s69, s68, 4096
    s_mov_b32 s66, s22
    s_mov_b32 s67, s23
    v_lshrrev_b32 v2, 3, v1
    v_bfe_u32 v3, v1, 4, 2
    v_lshlrev_b32 v3, 1, v3
    v_xor_b32 v3, v3, v1
    v_and_b32 v3, 7, v3
    v_mul_u32_u24 v2, 4224, v2
    v_lshl_add_u32 v172, v3, 4, v2
    v_add_u32 v172, 8650752, v172
    v_lshrrev_b32 v2, 2, v1
    v_lshlrev_b32 v2, 7, v2
    v_and_b32 v3, 3, v1
    v_lshl_add_u32 v2, v3, 3, v2
    v_bfe_u32 v3, v1, 3, 2
    v_xor_b32 v168, 0, v3
    v_lshl_add_u32 v168, v168, 5, v2
    v_xor_b32 v169, 1, v3
    v_lshl_add_u32 v169, v169, 5, v2
    v_xor_b32 v170, 2, v3
    v_lshl_add_u32 v170, v170, 5, v2
    v_xor_b32 v171, 3, v3
    v_lshl_add_u32 v171, v171, 5, v2
    v_and_b32 v175, 15, v1
    v_lshlrev_b32 v175, 4, v175
    v_bfe_u32 v2, v1, 4, 1
    v_lshrrev_b32 v3, 5, v1
    v_mul_u32_u24 v173, 51456, v2
    v_lshl_add_u32 v173, v3, 8, v173
    v_add_u32 v173, v173, v175
    v_lshl_add_u32 v2, v2, 1, v3
    v_mul_u32_u24 v174, 51456, v2
    v_add_u32 v174, v174, v175
    v_bfe_u32 v2, v0, 1, 2
    v_lshlrev_b32 v2, 1, v2
    s_lshr_b32 s50, s73, 1
    v_xor_b32 v2, s50, v2
    v_lshlrev_b32 v2, 4, v2
    v_lshl_add_u32 v216, v0, 7, v2
    s_and_b32 s50, s73, 1
    s_lshl_b32 s50, s50, 3
    v_add_u32 v216, s50, v216
    v_add_u32 v217, 0x8000, v216
    v_add_u32 v218, 0x10000, v216
    v_cmp_gt_u32 vcc, 128, v0
    s_nop 1
    v_cndmask_b32 v218, v217, v218, vcc
    v_lshrrev_b32 v2, 1, v1
    v_lshlrev_b32 v2, 9, v2
    v_and_b32 v3, 1, v1
    v_lshl_add_u32 v219, v3, 2, v2
    s_lshl_b32 s50, s3, 7
    s_add_u32 s50, s50, 112640
    v_add_u32 v219, s50, v219
    v_min_u32 v2, 49, v1
    v_lshlrev_b32 v2, 7, v2
    v_add_u32 v2, 98304, v2
    v_cmp_lt_u32 vcc, 39, v1
    s_nop 1
    v_cndmask_b32 v219, v219, v2, vcc
    s_mov_b32 s17, 23199744
    s_lshl_b32 s77, s34, 7
    v_lshl_add_u32 v220, v0, 2, s77
    v_add_u32 v221, 1024, v220
    v_add_u32 v222, 2048, v220
    v_subrev_u32 v2, 2560, v220
    v_min_u32 v220, v220, v2
    v_subrev_u32 v2, 2560, v221
    v_min_u32 v221, v221, v2
    v_subrev_u32 v2, 2560, v222
    v_min_u32 v222, v222, v2
    v_mov_b32 v2, 0x80000000
    v_cmp_gt_u32 vcc, 128, v0
    s_nop 1
    v_cndmask_b32 v222, v2, v222, vcc
    s_mov_b32 s77, 23183360
    s_lshl_b32 s65, s75, 2
    s_add_u32 s65, s65, s3
    s_mul_i32 s65, s65, 61952
    s_add_u32 s65, s65, 12582912
    s_mov_b32 s16, 0
    s_and_b32 s16, s16, 3
    s_add_u32 s62, s16, 0
    s_and_b32 s62, s62, 3
    s_mul_i32 s62, s62, 15360
    s_add_u32 s62, s62, s65
    s_movk_i32 s4, 4096
    s_movk_i32 s5, 8192
    s_lshl_b32 s6, s72, 10
    s_add_u32 s6, s6, 23101440
    s_lshl_b32 s7, s73, 6
    s_add_u32 s7, s7, s6
    s_mul_i32 s8, s72, 804
    s_mul_i32 s50, s73, 12
    s_add_u32 s8, s8, s50
    s_lshr_b32 s50, s73, 2
    s_mul_i32 s50, s50, 2
    s_add_u32 s8, s8, s50
    s_mul_i32 s50, s3, 3
    s_add_u32 s8, s8, s50
    s_lshl_b32 s8, s8, 8
    s_add_u32 s8, s8, 15728640
    s_lshl_b32 s9, s73, 2
    s_add_u32 s9, s9, s3
    s_mul_i32 s9, s9, 384
    s_add_u32 s9, s9, 23527424
    s_mul_i32 s51, s3, 33792
    s_lshl_b32 s50, s72, 7
    s_add_u32 s51, s51, s50
    s_mul_i32 s50, s34, 135168
    s_add_u32 s10, s51, s50
    s_lshl_b32 s63, s3, 10
    s_add_u32 s11, s10, 135168
    s_sub_u32 s51, s11, 2703360
    s_min_u32 s11, s11, s51
    s_add_u32 s12, s11, 135168
    s_sub_u32 s51, s12, 2703360
    s_min_u32 s12, s12, s51
    s_add_u32 s13, s12, 135168
    s_sub_u32 s51, s13, 2703360
    s_min_u32 s13, s13, s51
    s_add_u32 s14, s13, 135168
    s_sub_u32 s51, s14, 2703360
    s_min_u32 s14, s14, s51
    s_add_u32 s15, s14, 135168
    s_sub_u32 s51, s15, 2703360
    s_min_u32 s15, s15, s51
    s_add_u32 s18, s15, 135168
    s_sub_u32 s51, s18, 2703360
    s_min_u32 s18, s18, s51
    s_add_u32 s19, s18, 135168
    s_sub_u32 s51, s19, 2703360
    s_min_u32 s19, s19, s51
    s_add_u32 s20, s19, 135168
    s_sub_u32 s51, s20, 2703360
    s_min_u32 s20, s20, s51
    s_add_u32 s21, s20, 135168
    s_sub_u32 s51, s21, 2703360
    s_min_u32 s21, s21, s51
    s_add_u32 s22, s21, 135168
    s_sub_u32 s51, s22, 2703360
    s_min_u32 s22, s22, s51
    s_add_u32 s23, s22, 135168
    s_sub_u32 s51, s23, 2703360
    s_min_u32 s23, s23, s51
    s_add_u32 s24, s23, 135168
    s_sub_u32 s51, s24, 2703360
    s_min_u32 s24, s24, s51
    s_add_u32 s25, s24, 135168
    s_sub_u32 s51, s25, 2703360
    s_min_u32 s25, s25, s51
    s_add_u32 s26, s25, 135168
    s_sub_u32 s51, s26, 2703360
    s_min_u32 s26, s26, s51
    s_add_u32 s27, s26, 135168
    s_sub_u32 s51, s27, 2703360
    s_min_u32 s27, s27, s51
    v_lshrrev_b32 v2, 4, v1
    v_and_b32 v3, 15, v1
    v_lshl_add_u32 v2, v3, 2, v2
    v_lshlrev_b32 v30, 2, v2
    s_lshl_b32 s57, s71, 2
    s_add_u32 s57, s57, s3
    s_lshl_b32 s57, s57, 5
    s_add_u32 s57, s57, 23068672
    s_mov_b32 s55, 0x3f803f80
    v_mov_b32 v180, 0
    v_mov_b32 v181, 0
    v_mov_b32 v182, 0
    v_mov_b32 v183, 0
    s_waitcnt vmcnt(11)
    v_dot2_f32_bf16 v180, v64, s55, v180
    v_dot2_f32_bf16 v182, v64, v64, v182
    s_waitcnt vmcnt(6)
    v_dot2_f32_bf16 v181, v84, s55, v181
    v_dot2_f32_bf16 v183, v84, v84, v183
    v_dot2_f32_bf16 v180, v65, s55, v180
    v_dot2_f32_bf16 v182, v65, v65, v182
    v_dot2_f32_bf16 v181, v85, s55, v181
    v_dot2_f32_bf16 v183, v85, v85, v183
    v_dot2_f32_bf16 v180, v66, s55, v180
    v_dot2_f32_bf16 v182, v66, v66, v182
    v_dot2_f32_bf16 v181, v86, s55, v181
    v_dot2_f32_bf16 v183, v86, v86, v183
    v_dot2_f32_bf16 v180, v67, s55, v180
    v_dot2_f32_bf16 v182, v67, v67, v182
    v_dot2_f32_bf16 v181, v87, s55, v181
    v_dot2_f32_bf16 v183, v87, v87, v183
    v_dot2_f32_bf16 v180, v68, s55, v180
    v_dot2_f32_bf16 v182, v68, v68, v182
    s_waitcnt vmcnt(5)
    v_dot2_f32_bf16 v181, v88, s55, v181
    v_dot2_f32_bf16 v183, v88, v88, v183
    v_dot2_f32_bf16 v180, v69, s55, v180
    v_dot2_f32_bf16 v182, v69, v69, v182
    v_dot2_f32_bf16 v181, v89, s55, v181
    v_dot2_f32_bf16 v183, v89, v89, v183
    v_dot2_f32_bf16 v180, v70, s55, v180
    v_dot2_f32_bf16 v182, v70, v70, v182
    v_dot2_f32_bf16 v181, v90, s55, v181
    v_dot2_f32_bf16 v183, v90, v90, v183
    v_dot2_f32_bf16 v180, v71, s55, v180
    v_dot2_f32_bf16 v182, v71, v71, v182
    v_dot2_f32_bf16 v181, v91, s55, v181
    v_dot2_f32_bf16 v183, v91, v91, v183
    v_dot2_f32_bf16 v180, v72, s55, v180
    v_dot2_f32_bf16 v182, v72, v72, v182
    s_waitcnt vmcnt(4)
    v_dot2_f32_bf16 v181, v92, s55, v181
    v_dot2_f32_bf16 v183, v92, v92, v183
    v_dot2_f32_bf16 v180, v73, s55, v180
    v_dot2_f32_bf16 v182, v73, v73, v182
    v_dot2_f32_bf16 v181, v93, s55, v181
    v_dot2_f32_bf16 v183, v93, v93, v183
    v_dot2_f32_bf16 v180, v74, s55, v180
    v_dot2_f32_bf16 v182, v74, v74, v182
    v_dot2_f32_bf16 v181, v94, s55, v181
    v_dot2_f32_bf16 v183, v94, v94, v183
    v_dot2_f32_bf16 v180, v75, s55, v180
    v_dot2_f32_bf16 v182, v75, v75, v182
    v_dot2_f32_bf16 v181, v95, s55, v181
    v_dot2_f32_bf16 v183, v95, v95, v183
    v_dot2_f32_bf16 v180, v76, s55, v180
    v_dot2_f32_bf16 v182, v76, v76, v182
    s_waitcnt vmcnt(3)
    v_dot2_f32_bf16 v181, v96, s55, v181
    v_dot2_f32_bf16 v183, v96, v96, v183
    v_dot2_f32_bf16 v180, v77, s55, v180
    v_dot2_f32_bf16 v182, v77, v77, v182
    v_dot2_f32_bf16 v181, v97, s55, v181
    v_dot2_f32_bf16 v183, v97, v97, v183
    v_dot2_f32_bf16 v180, v78, s55, v180
    v_dot2_f32_bf16 v182, v78, v78, v182
    v_dot2_f32_bf16 v181, v98, s55, v181
    v_dot2_f32_bf16 v183, v98, v98, v183
    v_dot2_f32_bf16 v180, v79, s55, v180
    v_dot2_f32_bf16 v182, v79, v79, v182
    v_dot2_f32_bf16 v181, v99, s55, v181
    v_dot2_f32_bf16 v183, v99, v99, v183
    v_dot2_f32_bf16 v180, v80, s55, v180
    v_dot2_f32_bf16 v182, v80, v80, v182
    s_waitcnt vmcnt(2)
    v_dot2_f32_bf16 v181, v100, s55, v181
    v_dot2_f32_bf16 v183, v100, v100, v183
    v_dot2_f32_bf16 v180, v81, s55, v180
    v_dot2_f32_bf16 v182, v81, v81, v182
    v_dot2_f32_bf16 v181, v101, s55, v181
    v_dot2_f32_bf16 v183, v101, v101, v183
    v_dot2_f32_bf16 v180, v82, s55, v180
    v_dot2_f32_bf16 v182, v82, v82, v182
    v_dot2_f32_bf16 v181, v102, s55, v181
    v_dot2_f32_bf16 v183, v102, v102, v183
    v_dot2_f32_bf16 v180, v83, s55, v180
    v_dot2_f32_bf16 v182, v83, v83, v182
    v_dot2_f32_bf16 v181, v103, s55, v181
    v_dot2_f32_bf16 v183, v103, v103, v183
    v_add_f32_dpp v180, v180, v180 row_ror:8 row_mask:0xf bank_mask:0xf
    s_nop 0
    v_add_f32_dpp v181, v181, v181 row_ror:8 row_mask:0xf bank_mask:0xf
    v_add_f32_dpp v182, v182, v182 row_ror:8 row_mask:0xf bank_mask:0xf
    v_add_f32_dpp v183, v183, v183 row_ror:8 row_mask:0xf bank_mask:0xf
    v_add_f32_dpp v180, v180, v180 row_ror:4 row_mask:0xf bank_mask:0xf
    v_add_f32_dpp v181, v181, v181 row_ror:4 row_mask:0xf bank_mask:0xf
    v_add_f32_dpp v182, v182, v182 row_ror:4 row_mask:0xf bank_mask:0xf
    v_add_f32_dpp v183, v183, v183 row_ror:4 row_mask:0xf bank_mask:0xf
    v_add_f32_dpp v180, v180, v180 row_ror:2 row_mask:0xf bank_mask:0xf
    v_add_f32_dpp v181, v181, v181 row_ror:2 row_mask:0xf bank_mask:0xf
    v_add_f32_dpp v182, v182, v182 row_ror:2 row_mask:0xf bank_mask:0xf
    v_add_f32_dpp v183, v183, v183 row_ror:2 row_mask:0xf bank_mask:0xf
    v_add_f32_dpp v180, v180, v180 row_ror:1 row_mask:0xf bank_mask:0xf
    v_add_f32_dpp v181, v181, v181 row_ror:1 row_mask:0xf bank_mask:0xf
    v_add_f32_dpp v182, v182, v182 row_ror:1 row_mask:0xf bank_mask:0xf
    v_add_f32_dpp v183, v183, v183 row_ror:1 row_mask:0xf bank_mask:0xf
    v_and_b32 v3, 15, v1
    v_cmp_eq_u32 vcc, 1, v3
    s_nop 1
    v_cndmask_b32 v180, v180, v181, vcc
    v_cndmask_b32 v182, v182, v183, vcc
    v_mul_f32 v180, 0x3acccccd, v180
    v_mul_f32 v186, v180, v180
    v_mov_b32 v184, 0x3acccccd
    v_fma_f32 v182, v182, v184, -v186
    v_max_f32 v182, 0, v182
    v_add_f32 v182, 0x3727c5ac, v182
    v_rsq_f32 v184, v182
    s_nop 0
    v_mul_f32_e64 v185, -v180, v184
    s_add_u32 s51, s57, 8192
    s_mov_b32 exec_lo, 0x00030003
    s_mov_b32 exec_hi, 0x00030003
    buffer_store_dword v184, v30, s[36:39], s57 offen sc1
    buffer_store_dword v185, v30, s[36:39], s51 offen sc1
    s_mov_b64 exec, -1
    s_add_u32 s57, s57, 4096
    buffer_load_dwordx4 v[104:107], v31, s[44:47], s56 offen offset:0
    buffer_load_dwordx4 v[108:111], v31, s[44:47], s56 offen offset:256
    buffer_load_dwordx4 v[112:115], v31, s[44:47], s56 offen offset:512
    buffer_load_dwordx4 v[116:119], v31, s[44:47], s56 offen offset:768
    buffer_load_dwordx4 v[120:123], v31, s[44:47], s56 offen offset:1024
    s_add_u32 s56, s56, 5120
    buffer_load_dwordx4 v[124:127], v31, s[44:47], s56 offen offset:0
    buffer_load_dwordx4 v[128:131], v31, s[44:47], s56 offen offset:256
    buffer_load_dwordx4 v[132:135], v31, s[44:47], s56 offen offset:512
    buffer_load_dwordx4 v[136:139], v31, s[44:47], s56 offen offset:768
    buffer_load_dwordx4 v[140:143], v31, s[44:47], s56 offen offset:1024
    s_mov_b32 s44, s66
    s_mov_b32 s45, s67
    s_mov_b32 s46, 0x1e0000
    s_mov_b32 s47, 0x20000
    s_mul_i32 s52, s70, 20480
    s_mul_i32 s53, s3, 5120
    s_add_u32 s52, s52, s53
    s_add_u32 m0, s53, 140288
    s_nop 0
    buffer_load_dwordx4 v248, s[44:47], s52 offen offset:0 nt lds
    buffer_load_dwordx4 v248, s[44:47], s52 offen offset:1024 nt lds
    buffer_load_dwordx4 v248, s[44:47], s52 offen offset:2048 nt lds
    buffer_load_dwordx4 v248, s[44:47], s52 offen offset:3072 nt lds
    s_add_u32 m0, s53, 144384
    s_add_u32 s52, s52, 4096
    buffer_load_dwordx4 v248, s[44:47], s52 offen offset:0 nt lds
    s_add_u32 s44, s27, 135168
    s_sub_u32 s51, s44, 2703360
    s_min_u32 s44, s44, s51
    s_add_u32 s45, s44, 135168
    s_sub_u32 s51, s45, 2703360
    s_min_u32 s45, s45, s51
    s_add_u32 s46, s45, 135168
    s_sub_u32 s51, s46, 2703360
    s_min_u32 s46, s46, s51
    s_add_u32 s47, s46, 135168
    s_sub_u32 s51, s47, 2703360
    s_min_u32 s47, s47, s51
    s_waitcnt vmcnt(15)
    s_barrier
    s_cmp_eq_u32 s3, 0
    s_cbranch_scc0 L_wf15
    s_lshl_b32 s54, s71, 7
    s_add_u32 s54, s54, 23293952
    v_mov_b32 v254, 0
    v_mov_b32 v255, s48
    s_mov_b64 exec, 1
    buffer_store_dword v255, v254, s[36:39], s54 offen sc1
    s_mov_b64 exec, -1
L_wf15:
    v_mov_b32 v188, 0
    v_mov_b32 v189, 0
    v_mov_b32 v190, 0
    v_mov_b32 v191, 0
    s_waitcnt vmcnt(14)
    v_dot2_f32_bf16 v188, v104, s55, v188
    v_dot2_f32_bf16 v190, v104, v104, v190
    s_waitcnt vmcnt(9)
    v_dot2_f32_bf16 v189, v124, s55, v189
    v_dot2_f32_bf16 v191, v124, v124, v191
    v_dot2_f32_bf16 v188, v105, s55, v188
    v_dot2_f32_bf16 v190, v105, v105, v190
    v_dot2_f32_bf16 v189, v125, s55, v189
    v_dot2_f32_bf16 v191, v125, v125, v191
    v_dot2_f32_bf16 v188, v106, s55, v188
    v_dot2_f32_bf16 v190, v106, v106, v190
    v_dot2_f32_bf16 v189, v126, s55, v189
    v_dot2_f32_bf16 v191, v126, v126, v191
    v_dot2_f32_bf16 v188, v107, s55, v188
    v_dot2_f32_bf16 v190, v107, v107, v190
    v_dot2_f32_bf16 v189, v127, s55, v189
    v_dot2_f32_bf16 v191, v127, v127, v191
    v_dot2_f32_bf16 v188, v108, s55, v188
    v_dot2_f32_bf16 v190, v108, v108, v190
    s_waitcnt vmcnt(8)
    v_dot2_f32_bf16 v189, v128, s55, v189
    v_dot2_f32_bf16 v191, v128, v128, v191
    v_dot2_f32_bf16 v188, v109, s55, v188
    v_dot2_f32_bf16 v190, v109, v109, v190
    v_dot2_f32_bf16 v189, v129, s55, v189
    v_dot2_f32_bf16 v191, v129, v129, v191
    v_dot2_f32_bf16 v188, v110, s55, v188
    v_dot2_f32_bf16 v190, v110, v110, v190
    v_dot2_f32_bf16 v189, v130, s55, v189
    v_dot2_f32_bf16 v191, v130, v130, v191
    v_dot2_f32_bf16 v188, v111, s55, v188
    v_dot2_f32_bf16 v190, v111, v111, v190
    v_dot2_f32_bf16 v189, v131, s55, v189
    v_dot2_f32_bf16 v191, v131, v131, v191
    v_dot2_f32_bf16 v188, v112, s55, v188
    v_dot2_f32_bf16 v190, v112, v112, v190
    s_waitcnt vmcnt(7)
    v_dot2_f32_bf16 v189, v132, s55, v189
    v_dot2_f32_bf16 v191, v132, v132, v191
    v_dot2_f32_bf16 v188, v113, s55, v188
    v_dot2_f32_bf16 v190, v113, v113, v190
    v_dot2_f32_bf16 v189, v133, s55, v189
    v_dot2_f32_bf16 v191, v133, v133, v191
    v_dot2_f32_bf16 v188, v114, s55, v188
    v_dot2_f32_bf16 v190, v114, v114, v190
    v_dot2_f32_bf16 v189, v134, s55, v189
    v_dot2_f32_bf16 v191, v134, v134, v191
    v_dot2_f32_bf16 v188, v115, s55, v188
    v_dot2_f32_bf16 v190, v115, v115, v190
    v_dot2_f32_bf16 v189, v135, s55, v189
    v_dot2_f32_bf16 v191, v135, v135, v191
    v_dot2_f32_bf16 v188, v116, s55, v188
    v_dot2_f32_bf16 v190, v116, v116, v190
    s_waitcnt vmcnt(6)
    v_dot2_f32_bf16 v189, v136, s55, v189
    v_dot2_f32_bf16 v191, v136, v136, v191
    v_dot2_f32_bf16 v188, v117, s55, v188
    v_dot2_f32_bf16 v190, v117, v117, v190
    v_dot2_f32_bf16 v189, v137, s55, v189
    v_dot2_f32_bf16 v191, v137, v137, v191
    v_dot2_f32_bf16 v188, v118, s55, v188
    v_dot2_f32_bf16 v190, v118, v118, v190
    v_dot2_f32_bf16 v189, v138, s55, v189
    v_dot2_f32_bf16 v191, v138, v138, v191
    v_dot2_f32_bf16 v188, v119, s55, v188
    v_dot2_f32_bf16 v190, v119, v119, v190
    v_dot2_f32_bf16 v189, v139, s55, v189
    v_dot2_f32_bf16 v191, v139, v139, v191
    v_dot2_f32_bf16 v188, v120, s55, v188
    v_dot2_f32_bf16 v190, v120, v120, v190
    s_waitcnt vmcnt(5)
    v_dot2_f32_bf16 v189, v140, s55, v189
    v_dot2_f32_bf16 v191, v140, v140, v191
    v_dot2_f32_bf16 v188, v121, s55, v188
    v_dot2_f32_bf16 v190, v121, v121, v190
    v_dot2_f32_bf16 v189, v141, s55, v189
    v_dot2_f32_bf16 v191, v141, v141, v191
    v_dot2_f32_bf16 v188, v122, s55, v188
    v_dot2_f32_bf16 v190, v122, v122, v190
    v_dot2_f32_bf16 v189, v142, s55, v189
    v_dot2_f32_bf16 v191, v142, v142, v191
    v_dot2_f32_bf16 v188, v123, s55, v188
    v_dot2_f32_bf16 v190, v123, v123, v190
    v_dot2_f32_bf16 v189, v143, s55, v189
    v_dot2_f32_bf16 v191, v143, v143, v191
    v_add_f32_dpp v188, v188, v188 row_ror:8 row_mask:0xf bank_mask:0xf
    s_nop 0
    v_add_f32_dpp v189, v189, v189 row_ror:8 row_mask:0xf bank_mask:0xf
    v_add_f32_dpp v190, v190, v190 row_ror:8 row_mask:0xf bank_mask:0xf
    v_add_f32_dpp v191, v191, v191 row_ror:8 row_mask:0xf bank_mask:0xf
    v_add_f32_dpp v188, v188, v188 row_ror:4 row_mask:0xf bank_mask:0xf
    v_add_f32_dpp v189, v189, v189 row_ror:4 row_mask:0xf bank_mask:0xf
    v_add_f32_dpp v190, v190, v190 row_ror:4 row_mask:0xf bank_mask:0xf
    v_add_f32_dpp v191, v191, v191 row_ror:4 row_mask:0xf bank_mask:0xf
    v_add_f32_dpp v188, v188, v188 row_ror:2 row_mask:0xf bank_mask:0xf
    v_add_f32_dpp v189, v189, v189 row_ror:2 row_mask:0xf bank_mask:0xf
    v_add_f32_dpp v190, v190, v190 row_ror:2 row_mask:0xf bank_mask:0xf
    v_add_f32_dpp v191, v191, v191 row_ror:2 row_mask:0xf bank_mask:0xf
    v_add_f32_dpp v188, v188, v188 row_ror:1 row_mask:0xf bank_mask:0xf
    v_add_f32_dpp v189, v189, v189 row_ror:1 row_mask:0xf bank_mask:0xf
    v_add_f32_dpp v190, v190, v190 row_ror:1 row_mask:0xf bank_mask:0xf
    v_add_f32_dpp v191, v191, v191 row_ror:1 row_mask:0xf bank_mask:0xf
    v_and_b32 v3, 15, v1
    v_cmp_eq_u32 vcc, 1, v3
    s_nop 1
    v_cndmask_b32 v188, v188, v189, vcc
    v_cndmask_b32 v190, v190, v191, vcc
    v_mul_f32 v188, 0x3acccccd, v188
    v_mul_f32 v194, v188, v188
    v_mov_b32 v192, 0x3acccccd
    v_fma_f32 v190, v190, v192, -v194
    v_max_f32 v190, 0, v190
    v_add_f32 v190, 0x3727c5ac, v190
    v_rsq_f32 v192, v190
    s_nop 0
    v_mul_f32_e64 v193, -v188, v192
    s_add_u32 s51, s57, 8192
    s_mov_b32 exec_lo, 0x00030003
    s_mov_b32 exec_hi, 0x00030003
    buffer_store_dword v192, v30, s[36:39], s57 offen sc1
    buffer_store_dword v193, v30, s[36:39], s51 offen sc1
    s_mov_b64 exec, -1
    s_add_u32 s57, s57, 4096
    s_waitcnt vmcnt(2)
    s_barrier
    ds_read_b64_tr_b16 v[32:33], v28 offset:0
    ds_read_b64_tr_b16 v[34:35], v28 offset:5120
    ds_read_b64_tr_b16 v[36:37], v28 offset:32
    ds_read_b64_tr_b16 v[38:39], v28 offset:5152
    ds_read_b64_tr_b16 v[40:41], v28 offset:64
    ds_read_b64_tr_b16 v[42:43], v28 offset:5184
    ds_read_b64_tr_b16 v[44:45], v28 offset:96
    ds_read_b64_tr_b16 v[46:47], v28 offset:5216
    ds_read_b64_tr_b16 v[48:49], v28 offset:128
    ds_read_b64_tr_b16 v[50:51], v28 offset:5248
    s_waitcnt lgkmcnt(8)
    buffer_store_dwordx4 v[32:35], v29, s[36:39], s68 offen offset:0 sc1
    s_waitcnt lgkmcnt(6)
    buffer_store_dwordx4 v[36:39], v29, s[36:39], s68 offen offset:1024 sc1
    s_waitcnt lgkmcnt(4)
    buffer_store_dwordx4 v[40:43], v29, s[36:39], s68 offen offset:2048 sc1
    s_waitcnt lgkmcnt(2)
    buffer_store_dwordx4 v[44:47], v29, s[36:39], s68 offen offset:3072 sc1
    s_waitcnt lgkmcnt(0)
    buffer_store_dwordx4 v[48:51], v29, s[36:39], s69 offen offset:0 sc1
    v_add_u32 v231, 8192, v231
    v_add_u32 v237, 49152, v231
    v_add_u32 v232, 8192, v232
    v_add_u32 v238, 49152, v232
    v_add_u32 v233, 8192, v233
    v_add_u32 v239, 49152, v233
    s_add_u32 m0, s61, 8192
    s_nop 0
    buffer_load_dwordx4 v228, s[40:43], s64 offen offset:0 lds
    buffer_load_dwordx4 v229, s[40:43], s64 offen offset:1024 lds
    buffer_load_dwordx4 v230, s[40:43], s64 offen offset:2048 lds
    s_add_u32 s64, s64, 98304
    s_sub_u32 s35, s64, 1966080
    s_min_u32 s64, s64, s35
    s_add_u32 m0, s61, 20480
    s_nop 0
    buffer_load_dwordx4 v228, s[40:43], s64 offen offset:0 lds
    buffer_load_dwordx4 v229, s[40:43], s64 offen offset:1024 lds
    buffer_load_dwordx4 v230, s[40:43], s64 offen offset:2048 lds
    s_add_u32 s64, s64, 98304
    s_sub_u32 s35, s64, 1966080
    s_min_u32 s64, s64, s35
    s_add_u32 m0, s61, 32768
    s_nop 0
    buffer_load_dwordx4 v228, s[40:43], s64 offen offset:0 lds
    buffer_load_dwordx4 v229, s[40:43], s64 offen offset:1024 lds
    buffer_load_dwordx4 v230, s[40:43], s64 offen offset:2048 lds
    s_add_u32 s64, s64, 98304
    s_sub_u32 s35, s64, 1966080
    s_min_u32 s64, s64, s35
    s_add_u32 m0, s61, 45056
    s_nop 0
    buffer_load_dwordx4 v228, s[40:43], s64 offen offset:0 lds
    buffer_load_dwordx4 v229, s[40:43], s64 offen offset:1024 lds
    buffer_load_dwordx4 v230, s[40:43], s64 offen offset:2048 lds
    s_add_u32 s64, s64, 98304
    s_sub_u32 s35, s64, 1966080
    s_min_u32 s64, s64, s35
    s_waitcnt vmcnt(17)
    s_barrier
    s_cmp_eq_u32 s3, 0
    s_cbranch_scc0 L_wf16
    s_lshl_b32 s54, s71, 7
    s_add_u32 s54, s54, 23420928
    v_mov_b32 v254, 0
    v_mov_b32 v255, s48
    s_mov_b64 exec, 1
    buffer_store_dword v255, v254, s[36:39], s54 offen sc1
    s_mov_b64 exec, -1
L_wf16:
L_p_w:
    s_waitcnt vmcnt(6)
    s_barrier
    ds_read_b64_tr_b16 a[0:1], v231 offset:0
    ds_read_b64_tr_b16 a[2:3], v231 offset:3072
    ds_read_b64_tr_b16 a[4:5], v232 offset:6144
    ds_read_b64_tr_b16 a[6:7], v232 offset:9216
    ds_read_b64_tr_b16 a[8:9], v233 offset:0
    ds_read_b64_tr_b16 a[10:11], v233 offset:3072
    ds_read_b64_tr_b16 a[12:13], v231 offset:12288
    ds_read_b64_tr_b16 a[14:15], v231 offset:15360
    ds_read_b64_tr_b16 a[16:17], v232 offset:18432
    ds_read_b64_tr_b16 a[18:19], v232 offset:21504
    ds_read_b64_tr_b16 a[20:21], v233 offset:12288
    ds_read_b64_tr_b16 a[22:23], v233 offset:15360
    s_add_u32 m0, s61, 57344
    s_nop 0
    buffer_load_dwordx4 v228, s[40:43], s64 offen offset:0 lds
    buffer_load_dwordx4 v229, s[40:43], s64 offen offset:1024 lds
    buffer_load_dwordx4 v230, s[40:43], s64 offen offset:2048 lds
    s_add_u32 s64, s64, 98304
    s_sub_u32 s35, s64, 1966080
    s_min_u32 s64, s64, s35
    s_add_u32 m0, s61, 69632
    s_nop 0
    buffer_load_dwordx4 v228, s[40:43], s64 offen offset:0 lds
    buffer_load_dwordx4 v229, s[40:43], s64 offen offset:1024 lds
    buffer_load_dwordx4 v230, s[40:43], s64 offen offset:2048 lds
    s_add_u32 s64, s64, 98304
    s_sub_u32 s35, s64, 1966080
    s_min_u32 s64, s64, s35
    s_cmp_eq_u32 s3, 0
    s_cbranch_scc0 L_wf17
    s_and_b32 s54, s70, 1
    s_mul_i32 s54, s54, -60
    v_mov_b32 v254, s54
    s_lshl_b32 s54, s70, 6
    v_add_u32 v254, s54, v254
    s_mov_b32 s54, 23273472
    v_mov_b32 v255, s48
    s_mov_b64 exec, 1
    buffer_store_dword v255, v254, s[36:39], s54 offen sc1
    s_mov_b64 exec, -1
L_wf17:
    s_waitcnt vmcnt(6)
    s_waitcnt lgkmcnt(0)
    s_barrier
    ds_read_b64_tr_b16 a[24:25], v231 offset:24576
    ds_read_b64_tr_b16 a[26:27], v231 offset:27648
    ds_read_b64_tr_b16 a[28:29], v232 offset:30720
    ds_read_b64_tr_b16 a[30:31], v232 offset:33792
    ds_read_b64_tr_b16 a[32:33], v233 offset:24576
    ds_read_b64_tr_b16 a[34:35], v233 offset:27648
    ds_read_b64_tr_b16 a[36:37], v231 offset:36864
    ds_read_b64_tr_b16 a[38:39], v231 offset:39936
    ds_read_b64_tr_b16 a[40:41], v232 offset:43008
    ds_read_b64_tr_b16 a[42:43], v232 offset:46080
    ds_read_b64_tr_b16 a[44:45], v233 offset:36864
    ds_read_b64_tr_b16 a[46:47], v233 offset:39936
    s_add_u32 m0, s61, 81920
    s_nop 0
    buffer_load_dwordx4 v228, s[40:43], s64 offen offset:0 lds
    buffer_load_dwordx4 v229, s[40:43], s64 offen offset:1024 lds
    buffer_load_dwordx4 v230, s[40:43], s64 offen offset:2048 lds
    s_add_u32 s64, s64, 98304
    s_sub_u32 s35, s64, 1966080
    s_min_u32 s64, s64, s35
    s_add_u32 m0, s61, 94208
    s_nop 0
    buffer_load_dwordx4 v228, s[40:43], s64 offen offset:0 lds
    buffer_load_dwordx4 v229, s[40:43], s64 offen offset:1024 lds
    buffer_load_dwordx4 v230, s[40:43], s64 offen offset:2048 lds
    s_add_u32 s64, s64, 98304
    s_sub_u32 s35, s64, 1966080
    s_min_u32 s64, s64, s35
    s_waitcnt vmcnt(6)
    s_waitcnt lgkmcnt(0)
    s_barrier
    ds_read_b64_tr_b16 a[48:49], v237 offset:0
    ds_read_b64_tr_b16 a[50:51], v237 offset:3072
    ds_read_b64_tr_b16 a[52:53], v238 offset:6144
    ds_read_b64_tr_b16 a[54:55], v238 offset:9216
    ds_read_b64_tr_b16 a[56:57], v239 offset:0
    ds_read_b64_tr_b16 a[58:59], v239 offset:3072
    ds_read_b64_tr_b16 a[60:61], v237 offset:12288
    ds_read_b64_tr_b16 a[62:63], v237 offset:15360
    ds_read_b64_tr_b16 a[64:65], v238 offset:18432
    ds_read_b64_tr_b16 a[66:67], v238 offset:21504
    ds_read_b64_tr_b16 a[68:69], v239 offset:12288
    ds_read_b64_tr_b16 a[70:71], v239 offset:15360
    s_add_u32 m0, s61, 8192
    s_nop 0
    buffer_load_dwordx4 v228, s[40:43], s64 offen offset:0 lds
    buffer_load_dwordx4 v229, s[40:43], s64 offen offset:1024 lds
    buffer_load_dwordx4 v230, s[40:43], s64 offen offset:2048 lds
    s_add_u32 s64, s64, 98304
    s_sub_u32 s35, s64, 1966080
    s_min_u32 s64, s64, s35
    s_add_u32 m0, s61, 20480
    s_nop 0
    buffer_load_dwordx4 v228, s[40:43], s64 offen offset:0 lds
    buffer_load_dwordx4 v229, s[40:43], s64 offen offset:1024 lds
    buffer_load_dwordx4 v230, s[40:43], s64 offen offset:2048 lds
    s_add_u32 s64, s64, 98304
    s_sub_u32 s35, s64, 1966080
    s_min_u32 s64, s64, s35
    s_cmp_eq_u32 s72, 12
    s_cbranch_scc1 L_bias
    s_waitcnt vmcnt(6)
    s_waitcnt lgkmcnt(0)
    s_barrier
    ds_read_b64_tr_b16 a[72:73], v237 offset:24576
    ds_read_b64_tr_b16 a[74:75], v237 offset:27648
    ds_read_b64_tr_b16 a[76:77], v238 offset:30720
    ds_read_b64_tr_b16 a[78:79], v238 offset:33792
    ds_read_b64_tr_b16 a[80:81], v239 offset:24576
    ds_read_b64_tr_b16 a[82:83], v239 offset:27648
    ds_read_b64_tr_b16 a[84:85], v237 offset:36864
    ds_read_b64_tr_b16 a[86:87], v237 offset:39936
    ds_read_b64_tr_b16 a[88:89], v238 offset:43008
    ds_read_b64_tr_b16 a[90:91], v238 offset:46080
    ds_read_b64_tr_b16 a[92:93], v239 offset:36864
    ds_read_b64_tr_b16 a[94:95], v239 offset:39936
    s_add_u32 m0, s61, 32768
    s_nop 0
    buffer_load_dwordx4 v228, s[40:43], s64 offen offset:0 lds
    buffer_load_dwordx4 v229, s[40:43], s64 offen offset:1024 lds
    buffer_load_dwordx4 v230, s[40:43], s64 offen offset:2048 lds
    s_add_u32 s64, s64, 98304
    s_sub_u32 s35, s64, 1966080
    s_min_u32 s64, s64, s35
    s_add_u32 m0, s61, 45056
    s_nop 0
    buffer_load_dwordx4 v228, s[40:43], s64 offen offset:0 lds
    buffer_load_dwordx4 v229, s[40:43], s64 offen offset:1024 lds
    buffer_load_dwordx4 v230, s[40:43], s64 offen offset:2048 lds
    s_add_u32 s64, s64, 98304
    s_sub_u32 s35, s64, 1966080
    s_min_u32 s64, s64, s35
    s_waitcnt vmcnt(6)
    s_waitcnt lgkmcnt(0)
    s_barrier
    ds_read_b64_tr_b16 a[96:97], v231 offset:0
    ds_read_b64_tr_b16 a[98:99], v231 offset:3072
    ds_read_b64_tr_b16 a[100:101], v232 offset:6144
    ds_read_b64_tr_b16 a[102:103], v232 offset:9216
    ds_read_b64_tr_b16 a[104:105], v233 offset:0
    ds_read_b64_tr_b16 a[106:107], v233 offset:3072
    ds_read_b64_tr_b16 a[108:109], v231 offset:12288
    ds_read_b64_tr_b16 a[110:111], v231 offset:15360
    ds_read_b64_tr_b16 a[112:113], v232 offset:18432
    ds_read_b64_tr_b16 a[114:115], v232 offset:21504
    ds_read_b64_tr_b16 a[116:117], v233 offset:12288
    ds_read_b64_tr_b16 a[118:119], v233 offset:15360
    s_add_u32 m0, s61, 57344
    s_nop 0
    buffer_load_dwordx4 v228, s[40:43], s64 offen offset:0 lds
    buffer_load_dwordx4 v229, s[40:43], s64 offen offset:1024 lds
    buffer_load_dwordx4 v230, s[40:43], s64 offen offset:2048 lds
    s_add_u32 s64, s64, 98304
    s_sub_u32 s35, s64, 1966080
    s_min_u32 s64, s64, s35
    s_add_u32 m0, s61, 69632
    s_nop 0
    buffer_load_dwordx4 v228, s[40:43], s64 offen offset:0 lds
    buffer_load_dwordx4 v229, s[40:43], s64 offen offset:1024 lds
    buffer_load_dwordx4 v230, s[40:43], s64 offen offset:2048 lds
    s_add_u32 s64, s64, 98304
    s_sub_u32 s35, s64, 1966080
    s_min_u32 s64, s64, s35
    s_waitcnt vmcnt(6)
    s_waitcnt lgkmcnt(0)
    s_barrier
    ds_read_b64_tr_b16 a[120:121], v231 offset:24576
    ds_read_b64_tr_b16 a[122:123], v231 offset:27648
    ds_read_b64_tr_b16 a[124:125], v232 offset:30720
    ds_read_b64_tr_b16 a[126:127], v232 offset:33792
    ds_read_b64_tr_b16 a[128:129], v233 offset:24576
    ds_read_b64_tr_b16 a[130:131], v233 offset:27648
    ds_read_b64_tr_b16 a[132:133], v231 offset:36864
    ds_read_b64_tr_b16 a[134:135], v231 offset:39936
    ds_read_b64_tr_b16 a[136:137], v232 offset:43008
    ds_read_b64_tr_b16 a[138:139], v232 offset:46080
    ds_read_b64_tr_b16 a[140:141], v233 offset:36864
    ds_read_b64_tr_b16 a[142:143], v233 offset:39936
    s_add_u32 m0, s61, 81920
    s_nop 0
    buffer_load_dwordx4 v228, s[40:43], s64 offen offset:0 lds
    buffer_load_dwordx4 v229, s[40:43], s64 offen offset:1024 lds
    buffer_load_dwordx4 v230, s[40:43], s64 offen offset:2048 lds
    s_add_u32 s64, s64, 98304
    s_sub_u32 s35, s64, 1966080
    s_min_u32 s64, s64, s35
    s_add_u32 m0, s61, 94208
    s_nop 0
    buffer_load_dwordx4 v228, s[40:43], s64 offen offset:0 lds
    buffer_load_dwordx4 v229, s[40:43], s64 offen offset:1024 lds
    buffer_load_dwordx4 v230, s[40:43], s64 offen offset:2048 lds
    s_add_u32 s64, s64, 98304
    s_sub_u32 s35, s64, 1966080
    s_min_u32 s64, s64, s35
    s_waitcnt vmcnt(6)
    s_waitcnt lgkmcnt(0)
    s_barrier
    ds_read_b64_tr_b16 a[144:145], v237 offset:0
    ds_read_b64_tr_b16 a[146:147], v237 offset:3072
    ds_read_b64_tr_b16 a[148:149], v238 offset:6144
    ds_read_b64_tr_b16 a[150:151], v238 offset:9216
    ds_read_b64_tr_b16 a[152:153], v239 offset:0
    ds_read_b64_tr_b16 a[154:155], v239 offset:3072
    ds_read_b64_tr_b16 a[156:157], v237 offset:12288
    ds_read_b64_tr_b16 a[158:159], v237 offset:15360
    ds_read_b64_tr_b16 a[160:161], v238 offset:18432
    ds_read_b64_tr_b16 a[162:163], v238 offset:21504
    ds_read_b64_tr_b16 a[164:165], v239 offset:12288
    ds_read_b64_tr_b16 a[166:167], v239 offset:15360
    s_add_u32 m0, s61, 8192
    s_nop 0
    buffer_load_dwordx4 v228, s[40:43], s64 offen offset:0 lds
    buffer_load_dwordx4 v229, s[40:43], s64 offen offset:1024 lds
    buffer_load_dwordx4 v230, s[40:43], s64 offen offset:2048 lds
    s_add_u32 s64, s64, 98304
    s_sub_u32 s35, s64, 1966080
    s_min_u32 s64, s64, s35
    s_add_u32 m0, s61, 20480
    s_nop 0
    buffer_load_dwordx4 v228, s[40:43], s64 offen offset:0 lds
    buffer_load_dwordx4 v229, s[40:43], s64 offen offset:1024 lds
    buffer_load_dwordx4 v230, s[40:43], s64 offen offset:2048 lds
    s_add_u32 s64, s64, 98304
    s_sub_u32 s35, s64, 1966080
    s_min_u32 s64, s64, s35
    s_waitcnt vmcnt(6)
    s_waitcnt lgkmcnt(0)
    s_barrier
    ds_read_b64_tr_b16 a[168:169], v237 offset:24576
    ds_read_b64_tr_b16 a[170:171], v237 offset:27648
    ds_read_b64_tr_b16 a[172:173], v238 offset:30720
    ds_read_b64_tr_b16 a[174:175], v238 offset:33792
    ds_read_b64_tr_b16 a[176:177], v239 offset:24576
    ds_read_b64_tr_b16 a[178:179], v239 offset:27648
    ds_read_b64_tr_b16 a[180:181], v237 offset:36864
    ds_read_b64_tr_b16 a[182:183], v237 offset:39936
    ds_read_b64_tr_b16 a[184:185], v238 offset:43008
    ds_read_b64_tr_b16 a[186:187], v238 offset:46080
    ds_read_b64_tr_b16 a[188:189], v239 offset:36864
    ds_read_b64_tr_b16 a[190:191], v239 offset:39936
    s_add_u32 m0, s61, 32768
    s_nop 0
    buffer_load_dwordx4 v228, s[40:43], s64 offen offset:0 lds
    buffer_load_dwordx4 v229, s[40:43], s64 offen offset:1024 lds
    buffer_load_dwordx4 v230, s[40:43], s64 offen offset:2048 lds
    s_add_u32 s64, s64, 98304
    s_sub_u32 s35, s64, 1966080
    s_min_u32 s64, s64, s35
    s_add_u32 m0, s61, 45056
    s_nop 0
    buffer_load_dwordx4 v228, s[40:43], s64 offen offset:0 lds
    buffer_load_dwordx4 v229, s[40:43], s64 offen offset:1024 lds
    buffer_load_dwordx4 v230, s[40:43], s64 offen offset:2048 lds
    s_add_u32 s64, s64, 98304
    s_sub_u32 s35, s64, 1966080
    s_min_u32 s64, s64, s35
    s_waitcnt vmcnt(6)
    s_waitcnt lgkmcnt(0)
    s_barrier
    ds_read_b64_tr_b16 a[192:193], v231 offset:0
    ds_read_b64_tr_b16 a[194:195], v231 offset:3072
    ds_read_b64_tr_b16 a[196:197], v232 offset:6144
    ds_read_b64_tr_b16 a[198:199], v232 offset:9216
    ds_read_b64_tr_b16 a[200:201], v233 offset:0
    ds_read_b64_tr_b16 a[202:203], v233 offset:3072
    ds_read_b64_tr_b16 a[204:205], v231 offset:12288
    ds_read_b64_tr_b16 a[206:207], v231 offset:15360
    ds_read_b64_tr_b16 a[208:209], v232 offset:18432
    ds_read_b64_tr_b16 a[210:211], v232 offset:21504
    ds_read_b64_tr_b16 a[212:213], v233 offset:12288
    ds_read_b64_tr_b16 a[214:215], v233 offset:15360
    s_waitcnt vmcnt(0)
    s_waitcnt lgkmcnt(0)
    s_barrier
    ds_read_b64_tr_b16 a[216:217], v231 offset:24576
    ds_read_b64_tr_b16 a[218:219], v231 offset:27648
    ds_read_b64_tr_b16 a[220:221], v232 offset:30720
    ds_read_b64_tr_b16 a[222:223], v232 offset:33792
    ds_read_b64_tr_b16 a[224:225], v233 offset:24576
    ds_read_b64_tr_b16 a[226:227], v233 offset:27648
    ds_read_b64_tr_b16 a[228:229], v231 offset:36864
    ds_read_b64_tr_b16 a[230:231], v231 offset:39936
    ds_read_b64_tr_b16 a[232:233], v232 offset:43008
    ds_read_b64_tr_b16 a[234:235], v232 offset:46080
    ds_read_b64_tr_b16 a[236:237], v233 offset:36864
    ds_read_b64_tr_b16 a[238:239], v233 offset:39936
    s_waitcnt lgkmcnt(0)
    s_barrier
    s_cmp_eq_u32 s2, 255
    s_cbranch_scc0 L_biasdone
    v_lshlrev_b32 v5, 7, v0
L_ep:
    buffer_load_dword v2, v5, s[36:39], s17 offen sc1
    s_waitcnt vmcnt(0)
    v_and_b32 v2, -16, v2
    v_cmp_ne_u32 vcc, s48, v2
    s_cbranch_vccz L_ep_ok
    s_cmp_eq_u32 s49, 0
    s_cbranch_scc1 L_ep_ok
    s_sub_u32 s49, s49, 1
    s_branch L_ep
L_ep_ok:
    s_barrier
    s_cmp_eq_u32 s3, 0
    s_cbranch_scc0 L_biasdone
    s_mov_b32 s50, 23461888
    v_mov_b32 v2, 0
    v_mov_b32 v3, s48
    s_mov_b64 exec, 1
    buffer_store_dword v3, v2, s[36:39], s50 offen sc1
    s_mov_b64 exec, -1
L_biasdone:
L_prepA:
L_poll18:
    buffer_load_dword v223, v219, s[36:39], s17 offen sc1
    s_waitcnt vmcnt(0)
    v_cmp_ne_u32 vcc, s48, v223
    s_cbranch_vccz L_poll18_ok
    s_cmp_eq_u32 s49, 0
    s_cbranch_scc1 L_poll18_ok
    s_sub_u32 s49, s49, 1
    s_sleep 1
    s_branch L_poll18
L_poll18_ok:
L_prepE:
    s_add_u32 m0, s63, 0
    s_nop 0
    buffer_load_dwordx4 v172, s[36:39], s10 offen sc1 lds
    s_add_u32 m0, s63, 4096
    s_nop 0
    buffer_load_dwordx4 v172, s[36:39], s11 offen sc1 lds
    s_add_u32 m0, s63, 8192
    s_nop 0
    buffer_load_dwordx4 v172, s[36:39], s12 offen sc1 lds
    s_add_u32 m0, s63, 12288
    s_nop 0
    buffer_load_dwordx4 v172, s[36:39], s13 offen sc1 lds
    s_add_u32 m0, s63, 16384
    s_nop 0
    buffer_load_dwordx4 v172, s[36:39], s14 offen sc1 lds
    s_add_u32 m0, s63, 20480
    s_nop 0
    buffer_load_dwordx4 v172, s[36:39], s15 offen sc1 lds
    buffer_load_dword v220, v220, s[36:39], s77 offen sc1
    buffer_load_dword v221, v221, s[36:39], s77 offen sc1
    buffer_load_dword v222, v222, s[36:39], s77 offen sc1
    s_waitcnt vmcnt(8)
    s_barrier
    ds_read_b64_tr_b16 v[104:105], v168 offset:0
    ds_read_b64_tr_b16 v[106:107], v168 offset:2048
    ds_read_b64_tr_b16 v[108:109], v169 offset:0
    ds_read_b64_tr_b16 v[110:111], v169 offset:2048
    ds_read_b64_tr_b16 v[112:113], v170 offset:0
    ds_read_b64_tr_b16 v[114:115], v170 offset:2048
    ds_read_b64_tr_b16 v[116:117], v171 offset:0
    ds_read_b64_tr_b16 v[118:119], v171 offset:2048
    s_waitcnt lgkmcnt(6)
    v_mfma_f32_16x16x32_bf16 v[8:11], a[0:3], v[104:107], 0
    s_waitcnt vmcnt(6)
    s_barrier
    ds_read_b64_tr_b16 v[120:121], v168 offset:4096
    v_mfma_f32_16x16x32_bf16 v[12:15], a[4:7], v[104:107], 0
    ds_read_b64_tr_b16 v[122:123], v168 offset:6144
    v_min_u32 v243, 23, v1
    v_mfma_f32_16x16x32_bf16 v[16:19], a[8:11], v[104:107], 0
    s_waitcnt lgkmcnt(6)
    s_add_u32 m0, s63, 24576
    ds_read_b64_tr_b16 v[124:125], v169 offset:4096
    v_and_b32 v244, 1, v243
    v_mfma_f32_16x16x32_bf16 v[20:23], a[0:3], v[108:111], 0
    buffer_load_dwordx4 v172, s[36:39], s18 offen sc1 lds
    v_mfma_f32_16x16x32_bf16 v[24:27], a[4:7], v[108:111], 0
    ds_read_b64_tr_b16 v[126:127], v169 offset:6144
    v_lshrrev_b32 v243, 1, v243
    v_mfma_f32_16x16x32_bf16 v[28:31], a[8:11], v[108:111], 0
    s_waitcnt lgkmcnt(6)
    ds_read_b64_tr_b16 v[128:129], v170 offset:4096
    v_lshlrev_b32 v243, 7, v243
    v_mfma_f32_16x16x32_bf16 v[32:35], a[0:3], v[112:115], 0
    s_add_u32 m0, s63, 28672
    ds_read_b64_tr_b16 v[130:131], v170 offset:6144
    v_lshl_add_u32 v243, v244, 2, v243
    v_mfma_f32_16x16x32_bf16 v[36:39], a[4:7], v[112:115], 0
    buffer_load_dwordx4 v172, s[36:39], s19 offen sc1 lds
    v_mfma_f32_16x16x32_bf16 v[40:43], a[8:11], v[112:115], 0
    s_waitcnt lgkmcnt(6)
    s_mul_i32 s58, s3, 1536
    s_add_u32 s58, s58, 23273472
    ds_read_b64_tr_b16 v[132:133], v171 offset:4096
    v_mfma_f32_16x16x32_bf16 v[44:47], a[0:3], v[116:119], 0
    s_waitcnt lgkmcnt(3)
    ds_read_b64_tr_b16 v[134:135], v171 offset:6144
    v_mfma_f32_16x16x32_bf16 v[48:51], a[4:7], v[116:119], 0
    s_add_u32 m0, s63, 32768
    v_mfma_f32_16x16x32_bf16 v[52:55], a[8:11], v[116:119], 0
    buffer_load_dwordx4 v172, s[36:39], s20 offen sc1 lds
    v_mfma_f32_16x16x32_bf16 v[8:11], a[12:15], v[120:123], v[8:11]
    ds_read_b64_tr_b16 v[104:105], v168 offset:8192
    v_mfma_f32_16x16x32_bf16 v[12:15], a[16:19], v[120:123], v[12:15]
    ds_read_b64_tr_b16 v[106:107], v168 offset:10240
    v_mfma_f32_16x16x32_bf16 v[16:19], a[20:23], v[120:123], v[16:19]
    s_add_u32 m0, s63, 36864
    ds_read_b64_tr_b16 v[108:109], v169 offset:8192
    v_mfma_f32_16x16x32_bf16 v[20:23], a[12:15], v[124:127], v[20:23]
    buffer_load_dwordx4 v172, s[36:39], s21 offen sc1 lds
    v_mfma_f32_16x16x32_bf16 v[24:27], a[16:19], v[124:127], v[24:27]
    ds_read_b64_tr_b16 v[110:111], v169 offset:10240
    v_mfma_f32_16x16x32_bf16 v[28:31], a[20:23], v[124:127], v[28:31]
    s_waitcnt lgkmcnt(6)
    ds_read_b64_tr_b16 v[112:113], v170 offset:8192
    v_mfma_f32_16x16x32_bf16 v[32:35], a[12:15], v[128:131], v[32:35]
    ds_read_b64_tr_b16 v[114:115], v170 offset:10240
    v_mfma_f32_16x16x32_bf16 v[36:39], a[16:19], v[128:131], v[36:39]
    buffer_load_dword v244, v243, s[36:39], s58 offen sc1
    v_mfma_f32_16x16x32_bf16 v[40:43], a[20:23], v[128:131], v[40:43]
    s_waitcnt lgkmcnt(6)
    ds_read_b64_tr_b16 v[116:117], v171 offset:8192
    v_lshrrev_b32 v210, 5, v1
    v_mfma_f32_16x16x32_bf16 v[44:47], a[12:15], v[132:135], v[44:47]
    s_waitcnt lgkmcnt(3)
    ds_read_b64_tr_b16 v[118:119], v171 offset:10240
    v_and_b32 v211, 16, v1
    v_mfma_f32_16x16x32_bf16 v[48:51], a[16:19], v[132:135], v[48:51]
    s_add_u32 m0, s63, 40960
    v_lshl_add_u32 v210, v210, 2, v211
    v_mfma_f32_16x16x32_bf16 v[52:55], a[20:23], v[132:135], v[52:55]
    buffer_load_dwordx4 v172, s[36:39], s22 offen sc1 lds
    v_mfma_f32_16x16x32_bf16 v[8:11], a[24:27], v[104:107], v[8:11]
    s_waitcnt vmcnt(9)
    s_barrier
    ds_read_b64_tr_b16 v[120:121], v168 offset:12288
    v_mfma_f32_16x16x32_bf16 v[12:15], a[28:31], v[104:107], v[12:15]
    s_lshl_b32 s57, s3, 13
    ds_read_b64_tr_b16 v[122:123], v168 offset:14336
    v_add_u32 v210, s57, v210
    v_mfma_f32_16x16x32_bf16 v[16:19], a[32:35], v[104:107], v[16:19]
    s_add_u32 m0, s63, 45056
    ds_read_b64_tr_b16 v[124:125], v169 offset:12288
    v_and_b32 v211, 3, v1
    v_mfma_f32_16x16x32_bf16 v[20:23], a[24:27], v[108:111], v[20:23]
    buffer_load_dwordx4 v172, s[36:39], s23 offen sc1 lds
    v_mfma_f32_16x16x32_bf16 v[24:27], a[28:31], v[108:111], v[24:27]
    ds_read_b64_tr_b16 v[126:127], v169 offset:14336
    v_lshlrev_b32 v211, 3, v211
    v_mfma_f32_16x16x32_bf16 v[28:31], a[32:35], v[108:111], v[28:31]
    s_waitcnt lgkmcnt(6)
    ds_read_b64_tr_b16 v[128:129], v170 offset:12288
    v_mfma_f32_16x16x32_bf16 v[32:35], a[24:27], v[112:115], v[32:35]
    s_add_u32 m0, s63, 49152
    ds_read_b64_tr_b16 v[130:131], v170 offset:14336
    v_mfma_f32_16x16x32_bf16 v[36:39], a[28:31], v[112:115], v[36:39]
    buffer_load_dwordx4 v172, s[36:39], s24 offen sc1 lds
    v_mfma_f32_16x16x32_bf16 v[40:43], a[32:35], v[112:115], v[40:43]
    s_waitcnt lgkmcnt(6)
    ds_read_b64_tr_b16 v[132:133], v171 offset:12288
    v_mfma_f32_16x16x32_bf16 v[44:47], a[24:27], v[116:119], v[44:47]
    s_waitcnt lgkmcnt(3)
    ds_read_b64_tr_b16 v[134:135], v171 offset:14336
    v_mfma_f32_16x16x32_bf16 v[48:51], a[28:31], v[116:119], v[48:51]
    s_add_u32 m0, s63, 53248
    v_mfma_f32_16x16x32_bf16 v[52:55], a[32:35], v[116:119], v[52:55]
    buffer_load_dwordx4 v172, s[36:39], s25 offen sc1 lds
    v_mfma_f32_16x16x32_bf16 v[8:11], a[36:39], v[120:123], v[8:11]
    ds_read_b64_tr_b16 v[104:105], v168 offset:16384
    v_mfma_f32_16x16x32_bf16 v[12:15], a[40:43], v[120:123], v[12:15]
    ds_read_b64_tr_b16 v[106:107], v168 offset:18432
    v_mfma_f32_16x16x32_bf16 v[16:19], a[44:47], v[120:123], v[16:19]
    s_add_u32 m0, s63, 57344
    ds_read_b64_tr_b16 v[108:109], v169 offset:16384
    v_mfma_f32_16x16x32_bf16 v[20:23], a[36:39], v[124:127], v[20:23]
    buffer_load_dwordx4 v172, s[36:39], s26 offen sc1 lds
    v_mfma_f32_16x16x32_bf16 v[24:27], a[40:43], v[124:127], v[24:27]
    ds_read_b64_tr_b16 v[110:111], v169 offset:18432
    v_mfma_f32_16x16x32_bf16 v[28:31], a[44:47], v[124:127], v[28:31]
    s_waitcnt lgkmcnt(6)
    ds_read_b64_tr_b16 v[112:113], v170 offset:16384
    v_mfma_f32_16x16x32_bf16 v[32:35], a[36:39], v[128:131], v[32:35]
    s_add_u32 m0, s63, 61440
    ds_read_b64_tr_b16 v[114:115], v170 offset:18432
    v_mfma_f32_16x16x32_bf16 v[36:39], a[40:43], v[128:131], v[36:39]
    buffer_load_dwordx4 v172, s[36:39], s27 offen sc1 lds
    v_mfma_f32_16x16x32_bf16 v[40:43], a[44:47], v[128:131], v[40:43]
    s_waitcnt lgkmcnt(6)
    ds_read_b64_tr_b16 v[116:117], v171 offset:16384
    v_mfma_f32_16x16x32_bf16 v[44:47], a[36:39], v[132:135], v[44:47]
    s_waitcnt lgkmcnt(3)
    ds_read_b64_tr_b16 v[118:119], v171 offset:18432
    v_mfma_f32_16x16x32_bf16 v[48:51], a[40:43], v[132:135], v[48:51]
    s_add_u32 m0, s63, 65536
    v_mfma_f32_16x16x32_bf16 v[52:55], a[44:47], v[132:135], v[52:55]
    buffer_load_dwordx4 v172, s[36:39], s44 offen sc1 lds
    v_mfma_f32_16x16x32_bf16 v[8:11], a[48:51], v[104:107], v[8:11]
    ds_read_b64_tr_b16 v[120:121], v168 offset:20480
    v_mfma_f32_16x16x32_bf16 v[12:15], a[52:55], v[104:107], v[12:15]
    ds_read_b64_tr_b16 v[122:123], v168 offset:22528
    s_waitcnt vmcnt(7)
    v_cmp_ne_u32 vcc, s48, v244
    s_cbranch_vccnz L_chk19_slow
L_chk19_back:
    v_mfma_f32_16x16x32_bf16 v[16:19], a[56:59], v[104:107], v[16:19]
    s_add_u32 m0, s63, 69632
    ds_read_b64_tr_b16 v[124:125], v169 offset:20480
    v_mfma_f32_16x16x32_bf16 v[20:23], a[48:51], v[108:111], v[20:23]
    buffer_load_dwordx4 v172, s[36:39], s45 offen sc1 lds
    v_mfma_f32_16x16x32_bf16 v[24:27], a[52:55], v[108:111], v[24:27]
    ds_read_b64_tr_b16 v[126:127], v169 offset:22528
    v_mfma_f32_16x16x32_bf16 v[28:31], a[56:59], v[108:111], v[28:31]
    s_waitcnt lgkmcnt(6)
    ds_read_b64_tr_b16 v[128:129], v170 offset:20480
    v_mfma_f32_16x16x32_bf16 v[32:35], a[48:51], v[112:115], v[32:35]
    s_add_u32 m0, s63, 73728
    ds_read_b64_tr_b16 v[130:131], v170 offset:22528
    v_mfma_f32_16x16x32_bf16 v[36:39], a[52:55], v[112:115], v[36:39]
    buffer_load_dwordx4 v172, s[36:39], s46 offen sc1 lds
    v_mfma_f32_16x16x32_bf16 v[40:43], a[56:59], v[112:115], v[40:43]
    s_waitcnt lgkmcnt(6)
    ds_read_b64_tr_b16 v[132:133], v171 offset:20480
    v_mfma_f32_16x16x32_bf16 v[44:47], a[48:51], v[116:119], v[44:47]
    s_waitcnt lgkmcnt(3)
    ds_read_b64_tr_b16 v[134:135], v171 offset:22528
    v_mfma_f32_16x16x32_bf16 v[48:51], a[52:55], v[116:119], v[48:51]
    s_add_u32 m0, s63, 77824
    v_mfma_f32_16x16x32_bf16 v[52:55], a[56:59], v[116:119], v[52:55]
    buffer_load_dwordx4 v172, s[36:39], s47 offen sc1 lds
    v_mfma_f32_16x16x32_bf16 v[8:11], a[60:63], v[120:123], v[8:11]
    s_barrier
    ds_read_b64_tr_b16 v[104:105], v168 offset:24576
    v_mfma_f32_16x16x32_bf16 v[12:15], a[64:67], v[120:123], v[12:15]
    ds_read_b64_tr_b16 v[106:107], v168 offset:26624
    v_add_u32 v172, 2048, v172
    v_mfma_f32_16x16x32_bf16 v[16:19], a[68:71], v[120:123], v[16:19]
    ds_read_b64_tr_b16 v[108:109], v169 offset:24576
    v_mfma_f32_16x16x32_bf16 v[20:23], a[60:63], v[124:127], v[20:23]
    buffer_load_dwordx4 a[240:243], v248, s[36:39], s62 offen offset:0 sc1
    v_mfma_f32_16x16x32_bf16 v[24:27], a[64:67], v[124:127], v[24:27]
    ds_read_b64_tr_b16 v[110:111], v169 offset:26624
    v_mfma_f32_16x16x32_bf16 v[28:31], a[68:71], v[124:127], v[28:31]
    s_waitcnt lgkmcnt(6)
    ds_read_b64_tr_b16 v[112:113], v170 offset:24576
    v_mfma_f32_16x16x32_bf16 v[32:35], a[60:63], v[128:131], v[32:35]
    ds_read_b64_tr_b16 v[114:115], v170 offset:26624
    v_mfma_f32_16x16x32_bf16 v[36:39], a[64:67], v[128:131], v[36:39]
    buffer_load_dwordx4 a[244:247], v248, s[36:39], s62 offen offset:1024 sc1
    v_mfma_f32_16x16x32_bf16 v[40:43], a[68:71], v[128:131], v[40:43]
    s_waitcnt lgkmcnt(6)
    ds_read_b64_tr_b16 v[116:117], v171 offset:24576
    v_mfma_f32_16x16x32_bf16 v[44:47], a[60:63], v[132:135], v[44:47]
    s_waitcnt lgkmcnt(3)
    ds_read_b64_tr_b16 v[118:119], v171 offset:26624
    v_mfma_f32_16x16x32_bf16 v[48:51], a[64:67], v[132:135], v[48:51]
    v_mfma_f32_16x16x32_bf16 v[52:55], a[68:71], v[132:135], v[52:55]
    buffer_load_dwordx4 a[248:251], v248, s[36:39], s62 offen offset:2048 sc1
    v_mfma_f32_16x16x32_bf16 v[8:11], a[72:75], v[104:107], v[8:11]
    ds_read_b64_tr_b16 v[120:121], v168 offset:28672
    v_mfma_f32_16x16x32_bf16 v[12:15], a[76:79], v[104:107], v[12:15]
    ds_read_b64_tr_b16 v[122:123], v168 offset:30720
    v_mfma_f32_16x16x32_bf16 v[16:19], a[80:83], v[104:107], v[16:19]
    ds_read_b64_tr_b16 v[124:125], v169 offset:28672
    v_mfma_f32_16x16x32_bf16 v[20:23], a[72:75], v[108:111], v[20:23]
    buffer_load_dwordx4 a[252:255], v248, s[36:39], s62 offen offset:3072 sc1
    v_mfma_f32_16x16x32_bf16 v[24:27], a[76:79], v[108:111], v[24:27]
    s_add_u32 s62, s62, 4096
    ds_read_b64_tr_b16 v[126:127], v169 offset:30720
    v_mfma_f32_16x16x32_bf16 v[28:31], a[80:83], v[108:111], v[28:31]
    s_waitcnt lgkmcnt(6)
    ds_read_b64_tr_b16 v[128:129], v170 offset:28672
    v_mfma_f32_16x16x32_bf16 v[32:35], a[72:75], v[112:115], v[32:35]
    ds_read_b64_tr_b16 v[130:131], v170 offset:30720
    v_mfma_f32_16x16x32_bf16 v[36:39], a[76:79], v[112:115], v[36:39]
    buffer_load_dwordx4 v[136:139], v248, s[36:39], s62 offen offset:0 sc1
    v_mfma_f32_16x16x32_bf16 v[40:43], a[80:83], v[112:115], v[40:43]
    s_waitcnt lgkmcnt(6)
    ds_read_b64_tr_b16 v[132:133], v171 offset:28672
    v_mfma_f32_16x16x32_bf16 v[44:47], a[72:75], v[116:119], v[44:47]
    s_waitcnt lgkmcnt(3)
    ds_read_b64_tr_b16 v[134:135], v171 offset:30720
    v_mfma_f32_16x16x32_bf16 v[48:51], a[76:79], v[116:119], v[48:51]
    v_mfma_f32_16x16x32_bf16 v[52:55], a[80:83], v[116:119], v[52:55]
    buffer_load_dwordx4 v[140:143], v248, s[36:39], s62 offen offset:1024 sc1
    v_mfma_f32_16x16x32_bf16 v[8:11], a[84:87], v[120:123], v[8:11]
    ds_read_b64_tr_b16 v[104:105], v168 offset:32768
    v_mfma_f32_16x16x32_bf16 v[12:15], a[88:91], v[120:123], v[12:15]
    ds_read_b64_tr_b16 v[106:107], v168 offset:34816
    v_mfma_f32_16x16x32_bf16 v[16:19], a[92:95], v[120:123], v[16:19]
    ds_read_b64_tr_b16 v[108:109], v169 offset:32768
    v_mfma_f32_16x16x32_bf16 v[20:23], a[84:87], v[124:127], v[20:23]
    buffer_load_dwordx4 v[144:147], v248, s[36:39], s62 offen offset:2048 sc1
    v_mfma_f32_16x16x32_bf16 v[24:27], a[88:91], v[124:127], v[24:27]
    ds_read_b64_tr_b16 v[110:111], v169 offset:34816
    v_mfma_f32_16x16x32_bf16 v[28:31], a[92:95], v[124:127], v[28:31]
    s_waitcnt lgkmcnt(6)
    ds_read_b64_tr_b16 v[112:113], v170 offset:32768
    v_mfma_f32_16x16x32_bf16 v[32:35], a[84:87], v[128:131], v[32:35]
    ds_read_b64_tr_b16 v[114:115], v170 offset:34816
    v_lshrrev_b32 v238, 1, v1
    v_mfma_f32_16x16x32_bf16 v[36:39], a[88:91], v[128:131], v[36:39]
    buffer_load_dwordx4 v[148:151], v248, s[36:39], s62 offen offset:3072 sc1
    v_mfma_f32_16x16x32_bf16 v[40:43], a[92:95], v[128:131], v[40:43]
    s_waitcnt lgkmcnt(6)
    s_add_u32 s62, s62, 4096
    ds_read_b64_tr_b16 v[116:117], v171 offset:32768
    v_lshlrev_b32 v238, 9, v238
    v_mfma_f32_16x16x32_bf16 v[44:47], a[84:87], v[132:135], v[44:47]
    s_waitcnt lgkmcnt(3)
    ds_read_b64_tr_b16 v[118:119], v171 offset:34816
    v_and_b32 v239, 1, v1
    v_mfma_f32_16x16x32_bf16 v[48:51], a[88:91], v[132:135], v[48:51]
    v_lshl_add_u32 v219, v239, 2, v238
    v_mfma_f32_16x16x32_bf16 v[52:55], a[92:95], v[132:135], v[52:55]
    s_lshl_b32 s55, s3, 7
    s_add_u32 s55, s55, 133120
    buffer_load_dwordx4 v[152:155], v248, s[36:39], s62 offen offset:0 sc1
    v_mfma_f32_16x16x32_bf16 v[8:11], a[96:99], v[104:107], v[8:11]
    s_waitcnt vmcnt(9)
    s_barrier
    ds_read_b64_tr_b16 v[120:121], v168 offset:36864
    v_mfma_f32_16x16x32_bf16 v[12:15], a[100:103], v[104:107], v[12:15]
    ds_read_b64_tr_b16 v[122:123], v168 offset:38912
    v_add_u32 v219, s55, v219
    v_mfma_f32_16x16x32_bf16 v[16:19], a[104:107], v[104:107], v[16:19]
    ds_read_b64_tr_b16 v[124:125], v169 offset:36864
    v_lshlrev_b32 v238, 7, v1
    v_mfma_f32_16x16x32_bf16 v[20:23], a[96:99], v[108:111], v[20:23]
    buffer_load_dwordx4 v[156:159], v248, s[36:39], s62 offen offset:1024 sc1
    v_mfma_f32_16x16x32_bf16 v[24:27], a[100:103], v[108:111], v[24:27]
    ds_read_b64_tr_b16 v[126:127], v169 offset:38912
    v_add_u32 v238, 99584, v238
    v_mfma_f32_16x16x32_bf16 v[28:31], a[104:107], v[108:111], v[28:31]
    s_lshl_b32 s55, s73, 7
    s_add_u32 s55, s55, 153600
    ds_read_b64_tr_b16 v[128:129], v170 offset:36864
    ds_read_b64 v[200:201], v216
    s_waitcnt lgkmcnt(8)
    v_mfma_f32_16x16x32_bf16 v[32:35], a[96:99], v[112:115], v[32:35]
    ds_read_b64_tr_b16 v[130:131], v170 offset:38912
    v_mov_b32 v239, s55
    v_mfma_f32_16x16x32_bf16 v[36:39], a[100:103], v[112:115], v[36:39]
    buffer_load_dwordx4 v[160:163], v248, s[36:39], s62 offen offset:2048 sc1
    v_mfma_f32_16x16x32_bf16 v[40:43], a[104:107], v[112:115], v[40:43]
    s_waitcnt lgkmcnt(7)
    ds_read_b64_tr_b16 v[132:133], v171 offset:36864
    ds_read_b64 v[202:203], v217
    v_mfma_f32_16x16x32_bf16 v[44:47], a[96:99], v[116:119], v[44:47]
    s_waitcnt lgkmcnt(3)
    ds_read_b64_tr_b16 v[134:135], v171 offset:38912
    ds_read_b64 v[204:205], v218
    v_mfma_f32_16x16x32_bf16 v[48:51], a[100:103], v[116:119], v[48:51]
    v_cmp_lt_u32 vcc, 49, v1
    s_nop 1
    v_cndmask_b32 v238, v238, v239, vcc
    v_mfma_f32_16x16x32_bf16 v[52:55], a[104:107], v[116:119], v[52:55]
    buffer_load_dwordx4 v[164:167], v248, s[36:39], s62 offen offset:3072 sc1
    v_mfma_f32_16x16x32_bf16 v[8:11], a[108:111], v[120:123], v[8:11]
    s_add_u32 s62, s62, 4096
    ds_read_b64_tr_b16 v[104:105], v168 offset:40960
    v_mfma_f32_16x16x32_bf16 v[12:15], a[112:115], v[120:123], v[12:15]
    ds_read_b64_tr_b16 v[106:107], v168 offset:43008
    v_mfma_f32_16x16x32_bf16 v[16:19], a[116:119], v[120:123], v[16:19]
    ds_read_b64_tr_b16 v[108:109], v169 offset:40960
    v_lshlrev_b32 v230, 16, v200
    v_and_b32 v231, 0xffff0000, v200
    v_mfma_f32_16x16x32_bf16 v[20:23], a[108:111], v[124:127], v[20:23]
    v_mul_f32 v230, v230, v220
    v_mul_f32 v231, v231, v220
    v_mul_f32 v234, v230, v230
    v_mfma_f32_16x16x32_bf16 v[24:27], a[112:115], v[124:127], v[24:27]
    ds_read_b64_tr_b16 v[110:111], v169 offset:43008
    v_mul_f32 v235, v231, v231
    v_lshlrev_b32 v232, 16, v201
    v_mfma_f32_16x16x32_bf16 v[28:31], a[116:119], v[124:127], v[28:31]
    s_waitcnt lgkmcnt(8)
    ds_read_b64_tr_b16 v[112:113], v170 offset:40960
    v_and_b32 v233, 0xffff0000, v201
    v_mul_f32 v232, v232, v220
    v_mfma_f32_16x16x32_bf16 v[32:35], a[108:111], v[128:131], v[32:35]
    ds_read_b64_tr_b16 v[114:115], v170 offset:43008
    v_mul_f32 v233, v233, v220
    v_mul_f32 v236, v232, v232
    v_mfma_f32_16x16x32_bf16 v[36:39], a[112:115], v[128:131], v[36:39]
    v_mul_f32 v237, v233, v233
    s_waitcnt lgkmcnt(8)
    v_lshlrev_b32 v206, 16, v202
    v_and_b32 v207, 0xffff0000, v202
    v_mfma_f32_16x16x32_bf16 v[40:43], a[116:119], v[128:131], v[40:43]
    s_waitcnt lgkmcnt(7)
    ds_read_b64_tr_b16 v[116:117], v171 offset:40960
    v_mul_f32 v206, v206, v221
    v_mul_f32 v207, v207, v221
    v_mfma_f32_16x16x32_bf16 v[44:47], a[108:111], v[132:135], v[44:47]
    s_waitcnt lgkmcnt(3)
    ds_read_b64_tr_b16 v[118:119], v171 offset:43008
    v_add_f32 v230, v230, v206
    v_add_f32 v231, v231, v207
    v_mfma_f32_16x16x32_bf16 v[48:51], a[112:115], v[132:135], v[48:51]
    v_cmp_lt_u32 vcc, 39, v1
    s_nop 1
    v_cndmask_b32 v219, v219, v238, vcc
    v_fmac_f32 v234, v206, v206
    v_mfma_f32_16x16x32_bf16 v[52:55], a[116:119], v[132:135], v[52:55]
    s_mov_b32 s17, 23199744
    v_fmac_f32 v235, v207, v207
    v_lshlrev_b32 v208, 16, v203
    v_and_b32 v209, 0xffff0000, v203
    v_mfma_f32_16x16x32_bf16 v[8:11], a[120:123], v[104:107], v[8:11]
    ds_read_b64_tr_b16 v[120:121], v168 offset:45056
    v_mul_f32 v208, v208, v221
    v_mul_f32 v209, v209, v221
    v_mfma_f32_16x16x32_bf16 v[12:15], a[124:127], v[104:107], v[12:15]
    ds_read_b64_tr_b16 v[122:123], v168 offset:47104
    v_add_f32 v232, v232, v208
    v_add_f32 v233, v233, v209
    v_mfma_f32_16x16x32_bf16 v[16:19], a[128:131], v[104:107], v[16:19]
    ds_read_b64_tr_b16 v[124:125], v169 offset:45056
    v_fmac_f32 v236, v208, v208
    v_fmac_f32 v237, v209, v209
    v_mfma_f32_16x16x32_bf16 v[20:23], a[120:123], v[108:111], v[20:23]
    v_lshlrev_b32 v206, 16, v204
    v_and_b32 v207, 0xffff0000, v204
    v_mul_f32 v206, v206, v222
    v_mfma_f32_16x16x32_bf16 v[24:27], a[124:127], v[108:111], v[24:27]
    ds_read_b64_tr_b16 v[126:127], v169 offset:47104
    v_mul_f32 v207, v207, v222
    v_add_f32 v230, v230, v206
    v_mfma_f32_16x16x32_bf16 v[28:31], a[128:131], v[108:111], v[28:31]
    s_waitcnt lgkmcnt(6)
    ds_read_b64_tr_b16 v[128:129], v170 offset:45056
    v_add_f32 v231, v231, v207
    v_fmac_f32 v234, v206, v206
    v_mfma_f32_16x16x32_bf16 v[32:35], a[120:123], v[112:115], v[32:35]
    ds_read_b64_tr_b16 v[130:131], v170 offset:47104
    v_fmac_f32 v235, v207, v207
    v_lshlrev_b32 v208, 16, v205
    v_mfma_f32_16x16x32_bf16 v[36:39], a[124:127], v[112:115], v[36:39]
    v_and_b32 v209, 0xffff0000, v205
    v_mul_f32 v208, v208, v222
    v_mul_f32 v209, v209, v222
    v_mfma_f32_16x16x32_bf16 v[40:43], a[128:131], v[112:115], v[40:43]
    s_waitcnt lgkmcnt(6)
    ds_read_b64_tr_b16 v[132:133], v171 offset:45056
    v_add_f32 v232, v232, v208
    v_add_f32 v233, v233, v209
    v_mfma_f32_16x16x32_bf16 v[44:47], a[120:123], v[116:119], v[44:47]
    s_waitcnt lgkmcnt(3)
    ds_read_b64_tr_b16 v[134:135], v171 offset:47104
    v_fmac_f32 v236, v208, v208
    v_fmac_f32 v237, v209, v209
    v_mfma_f32_16x16x32_bf16 v[48:51], a[124:127], v[116:119], v[48:51]
    v_permlane32_swap_b32 v230, v234
    v_permlane32_swap_b32 v231, v235
    v_permlane32_swap_b32 v232, v236
    v_mfma_f32_16x16x32_bf16 v[52:55], a[128:131], v[116:119], v[52:55]
    buffer_load_dword v240, v219, s[36:39], s17 offen sc1
    v_mfma_f32_16x16x32_bf16 v[8:11], a[132:135], v[120:123], v[8:11]
    ds_read_b64_tr_b16 v[104:105], v168 offset:49152
    v_permlane32_swap_b32 v233, v237
    v_add_f32 v230, v230, v234
    v_mfma_f32_16x16x32_bf16 v[12:15], a[136:139], v[120:123], v[12:15]
    ds_read_b64_tr_b16 v[106:107], v168 offset:51200
    v_add_f32 v231, v231, v235
    v_add_f32 v232, v232, v236
    v_mfma_f32_16x16x32_bf16 v[16:19], a[140:143], v[120:123], v[16:19]
    ds_read_b64_tr_b16 v[108:109], v169 offset:49152
    v_add_f32 v233, v233, v237
    v_permlane16_swap_b32 v230, v232
    v_mfma_f32_16x16x32_bf16 v[20:23], a[132:135], v[124:127], v[20:23]
    v_permlane16_swap_b32 v231, v233
    v_add_f32 v230, v230, v232
    v_add_f32 v231, v231, v233
    v_mfma_f32_16x16x32_bf16 v[24:27], a[136:139], v[124:127], v[24:27]
    ds_read_b64_tr_b16 v[110:111], v169 offset:51200
    v_add_f32_dpp v230, v230, v230 row_ror:8 row_mask:0xf bank_mask:0xf
    v_add_f32_dpp v231, v231, v231 row_ror:8 row_mask:0xf bank_mask:0xf
    v_mfma_f32_16x16x32_bf16 v[28:31], a[140:143], v[124:127], v[28:31]
    s_waitcnt lgkmcnt(6)
    ds_read_b64_tr_b16 v[112:113], v170 offset:49152
    v_add_f32_dpp v230, v230, v230 row_ror:4 row_mask:0xf bank_mask:0xf
    v_add_f32_dpp v231, v231, v231 row_ror:4 row_mask:0xf bank_mask:0xf
    v_mfma_f32_16x16x32_bf16 v[32:35], a[132:135], v[128:131], v[32:35]
    ds_read_b64_tr_b16 v[114:115], v170 offset:51200
    v_add_f32_dpp v230, v230, v230 row_ror:2 row_mask:0xf bank_mask:0xf
    v_add_f32_dpp v231, v231, v231 row_ror:2 row_mask:0xf bank_mask:0xf
    v_mfma_f32_16x16x32_bf16 v[36:39], a[136:139], v[128:131], v[36:39]
    v_add_f32_dpp v230, v230, v230 row_ror:1 row_mask:0xf bank_mask:0xf
    v_add_f32_dpp v231, v231, v231 row_ror:1 row_mask:0xf bank_mask:0xf
    v_mfma_f32_16x16x32_bf16 v[40:43], a[140:143], v[128:131], v[40:43]
    ds_read_b64_tr_b16 v[116:117], v171 offset:49152
    s_mov_b32 exec_lo, 0x00010001
    s_mov_b32 exec_hi, 0x00010001
    ds_write2_b32 v210, v230, v231 offset0:0 offset1:2
    s_mov_b64 exec, -1
    s_waitcnt lgkmcnt(8)
    v_mfma_f32_16x16x32_bf16 v[44:47], a[132:135], v[132:135], v[44:47]
    s_waitcnt lgkmcnt(3)
    ds_read_b64_tr_b16 v[118:119], v171 offset:51200
    v_mov_b32 v213, s48
    v_mov_b32 v215, s48
    v_mfma_f32_16x16x32_bf16 v[48:51], a[136:139], v[132:135], v[48:51]
    v_mfma_f32_16x16x32_bf16 v[52:55], a[140:143], v[132:135], v[52:55]
    v_mfma_f32_16x16x32_bf16 v[8:11], a[144:147], v[104:107], v[8:11]
    ds_read_b64_tr_b16 v[120:121], v168 offset:53248
    v_mfma_f32_16x16x32_bf16 v[12:15], a[148:151], v[104:107], v[12:15]
    s_waitcnt lgkmcnt(2)
    s_barrier
    ds_read_b64_tr_b16 v[122:123], v168 offset:55296
    ds_read_b64 v[230:231], v211 offset:0
    v_mfma_f32_16x16x32_bf16 v[16:19], a[152:155], v[104:107], v[16:19]
    ds_read_b64_tr_b16 v[124:125], v169 offset:53248
    ds_read_b64 v[232:233], v211 offset:8192
    ds_read_b64 v[234:235], v211 offset:16384
    v_mfma_f32_16x16x32_bf16 v[20:23], a[144:147], v[108:111], v[20:23]
    ds_read_b64 v[236:237], v211 offset:24576
    v_mfma_f32_16x16x32_bf16 v[24:27], a[148:151], v[108:111], v[24:27]
    ds_read_b64_tr_b16 v[126:127], v169 offset:55296
    v_mfma_f32_16x16x32_bf16 v[28:31], a[152:155], v[108:111], v[28:31]
    ds_read_b64_tr_b16 v[128:129], v170 offset:53248
    v_mfma_f32_16x16x32_bf16 v[32:35], a[144:147], v[112:115], v[32:35]
    ds_read_b64_tr_b16 v[130:131], v170 offset:55296
    v_mfma_f32_16x16x32_bf16 v[36:39], a[148:151], v[112:115], v[36:39]
    s_waitcnt lgkmcnt(5)
    v_add_f32 v230, v230, v232
    v_add_f32 v231, v231, v233
    s_waitcnt lgkmcnt(3)
    v_add_f32 v234, v234, v236
    v_mfma_f32_16x16x32_bf16 v[40:43], a[152:155], v[112:115], v[40:43]
    ds_read_b64_tr_b16 v[132:133], v171 offset:53248
    v_add_f32 v235, v235, v237
    v_add_f32 v230, v230, v234
    v_mfma_f32_16x16x32_bf16 v[44:47], a[144:147], v[116:119], v[44:47]
    s_waitcnt lgkmcnt(3)
    ds_read_b64_tr_b16 v[134:135], v171 offset:55296
    v_add_f32 v231, v231, v235
    v_mul_f32 v230, 0x3acccccd, v230
    v_mfma_f32_16x16x32_bf16 v[48:51], a[148:151], v[116:119], v[48:51]
    v_mul_f32 v234, v230, v230
    v_mov_b32 v212, 0x3acccccd
    v_fma_f32 v231, v231, v212, -v234
    v_mfma_f32_16x16x32_bf16 v[52:55], a[152:155], v[116:119], v[52:55]
    v_max_f32 v231, 0, v231
    v_add_f32 v231, 0x3727c5ac, v231
    v_rsq_f32 v212, v231
    v_mfma_f32_16x16x32_bf16 v[8:11], a[156:159], v[120:123], v[8:11]
    ds_read_b64_tr_b16 v[104:105], v168 offset:57344
    v_mul_f32_e64 v214, -v230, v212
    v_mfma_f32_16x16x32_bf16 v[12:15], a[160:163], v[120:123], v[12:15]
    ds_read_b64_tr_b16 v[106:107], v168 offset:59392
    v_mfma_f32_16x16x32_bf16 v[16:19], a[164:167], v[120:123], v[16:19]
    ds_read_b64_tr_b16 v[108:109], v169 offset:57344
    v_mfma_f32_16x16x32_bf16 v[20:23], a[156:159], v[124:127], v[20:23]
    s_mov_b64 exec, 0xf
    buffer_store_dwordx4 v[212:215], v248, s[36:39], s7 offen sc1
    s_mov_b64 exec, -1
    v_mfma_f32_16x16x32_bf16 v[24:27], a[160:163], v[124:127], v[24:27]
    ds_read_b64_tr_b16 v[110:111], v169 offset:59392
    s_waitcnt vmcnt(0)
    v_cmp_ne_u32 vcc, s48, v240
    s_cbranch_vccnz L_chk20_slow
L_chk20_back:
    v_mfma_f32_16x16x32_bf16 v[28:31], a[164:167], v[124:127], v[28:31]
    s_waitcnt lgkmcnt(6)
    ds_read_b64_tr_b16 v[112:113], v170 offset:57344
    v_mfma_f32_16x16x32_bf16 v[32:35], a[156:159], v[128:131], v[32:35]
    s_add_u32 m0, s63, 81920
    ds_read_b64_tr_b16 v[114:115], v170 offset:59392
    v_mfma_f32_16x16x32_bf16 v[36:39], a[160:163], v[128:131], v[36:39]
    buffer_load_dwordx4 v172, s[36:39], s10 offen sc1 lds
    v_mfma_f32_16x16x32_bf16 v[40:43], a[164:167], v[128:131], v[40:43]
    s_waitcnt lgkmcnt(6)
    ds_read_b64_tr_b16 v[116:117], v171 offset:57344
    v_mfma_f32_16x16x32_bf16 v[44:47], a[156:159], v[132:135], v[44:47]
    s_waitcnt lgkmcnt(3)
    ds_read_b64_tr_b16 v[118:119], v171 offset:59392
    v_mfma_f32_16x16x32_bf16 v[48:51], a[160:163], v[132:135], v[48:51]
    s_add_u32 m0, s63, 86016
    v_mfma_f32_16x16x32_bf16 v[52:55], a[164:167], v[132:135], v[52:55]
    buffer_load_dwordx4 v172, s[36:39], s11 offen sc1 lds
    v_mfma_f32_16x16x32_bf16 v[8:11], a[168:171], v[104:107], v[8:11]
    ds_read_b64_tr_b16 v[120:121], v168 offset:61440
    v_mfma_f32_16x16x32_bf16 v[12:15], a[172:175], v[104:107], v[12:15]
    ds_read_b64_tr_b16 v[122:123], v168 offset:63488
    v_add_u32 v168, 65536, v168
    v_mfma_f32_16x16x32_bf16 v[16:19], a[176:179], v[104:107], v[16:19]
    s_add_u32 m0, s63, 90112
    ds_read_b64_tr_b16 v[124:125], v169 offset:61440
    v_mfma_f32_16x16x32_bf16 v[20:23], a[168:171], v[108:111], v[20:23]
    buffer_load_dwordx4 v172, s[36:39], s12 offen sc1 lds
    v_mfma_f32_16x16x32_bf16 v[24:27], a[172:175], v[108:111], v[24:27]
    ds_read_b64_tr_b16 v[126:127], v169 offset:63488
    v_add_u32 v169, 65536, v169
    v_mfma_f32_16x16x32_bf16 v[28:31], a[176:179], v[108:111], v[28:31]
    s_waitcnt lgkmcnt(6)
    ds_read_b64_tr_b16 v[128:129], v170 offset:61440
    v_mfma_f32_16x16x32_bf16 v[32:35], a[168:171], v[112:115], v[32:35]
    s_add_u32 m0, s63, 94208
    ds_read_b64_tr_b16 v[130:131], v170 offset:63488
    v_add_u32 v170, 65536, v170
    v_mfma_f32_16x16x32_bf16 v[36:39], a[172:175], v[112:115], v[36:39]
    buffer_load_dwordx4 v172, s[36:39], s13 offen sc1 lds
    v_mfma_f32_16x16x32_bf16 v[40:43], a[176:179], v[112:115], v[40:43]
    s_waitcnt lgkmcnt(6)
    ds_read_b64_tr_b16 v[132:133], v171 offset:61440
    v_mfma_f32_16x16x32_bf16 v[44:47], a[168:171], v[116:119], v[44:47]
    s_waitcnt lgkmcnt(3)
    ds_read_b64_tr_b16 v[134:135], v171 offset:63488
    v_add_u32 v171, 65536, v171
    v_mfma_f32_16x16x32_bf16 v[48:51], a[172:175], v[116:119], v[48:51]
    s_add_u32 m0, s63, 98304
    v_mfma_f32_16x16x32_bf16 v[52:55], a[176:179], v[116:119], v[52:55]
    buffer_load_dwordx4 v172, s[36:39], s14 offen sc1 lds
    v_mfma_f32_16x16x32_bf16 v[8:11], a[180:183], v[120:123], v[8:11]
    ds_read_b64_tr_b16 v[104:105], v168 offset:0
    v_mfma_f32_16x16x32_bf16 v[12:15], a[184:187], v[120:123], v[12:15]
    ds_read_b64_tr_b16 v[106:107], v168 offset:2048
    v_mfma_f32_16x16x32_bf16 v[16:19], a[188:191], v[120:123], v[16:19]
    s_add_u32 m0, s63, 102400
    ds_read_b64_tr_b16 v[108:109], v169 offset:0
    v_mfma_f32_16x16x32_bf16 v[20:23], a[180:183], v[124:127], v[20:23]
    buffer_load_dwordx4 v172, s[36:39], s15 offen sc1 lds
    v_mfma_f32_16x16x32_bf16 v[24:27], a[184:187], v[124:127], v[24:27]
    ds_read_b64_tr_b16 v[110:111], v169 offset:2048
    v_mfma_f32_16x16x32_bf16 v[28:31], a[188:191], v[124:127], v[28:31]
    s_waitcnt lgkmcnt(6)
    ds_read_b64_tr_b16 v[112:113], v170 offset:0
    v_mfma_f32_16x16x32_bf16 v[32:35], a[180:183], v[128:131], v[32:35]
    s_add_u32 m0, s63, 106496
    ds_read_b64_tr_b16 v[114:115], v170 offset:2048
    v_mfma_f32_16x16x32_bf16 v[36:39], a[184:187], v[128:131], v[36:39]
    buffer_load_dwordx4 v172, s[36:39], s18 offen sc1 lds
    v_mfma_f32_16x16x32_bf16 v[40:43], a[188:191], v[128:131], v[40:43]
    s_waitcnt lgkmcnt(6)
    ds_read_b64_tr_b16 v[116:117], v171 offset:0
    v_mfma_f32_16x16x32_bf16 v[44:47], a[180:183], v[132:135], v[44:47]
    s_waitcnt lgkmcnt(3)
    ds_read_b64_tr_b16 v[118:119], v171 offset:2048
    v_mfma_f32_16x16x32_bf16 v[48:51], a[184:187], v[132:135], v[48:51]
    s_add_u32 m0, s63, 110592
    v_mfma_f32_16x16x32_bf16 v[52:55], a[188:191], v[132:135], v[52:55]
    buffer_load_dwordx4 v172, s[36:39], s19 offen sc1 lds
    v_mfma_f32_16x16x32_bf16 v[8:11], a[192:195], v[104:107], v[8:11]
    ds_read_b64_tr_b16 v[120:121], v168 offset:4096
    v_mfma_f32_16x16x32_bf16 v[12:15], a[196:199], v[104:107], v[12:15]
    ds_read_b64_tr_b16 v[122:123], v168 offset:6144
    v_mfma_f32_16x16x32_bf16 v[16:19], a[200:203], v[104:107], v[16:19]
    s_add_u32 m0, s63, 114688
    ds_read_b64_tr_b16 v[124:125], v169 offset:4096
    v_mfma_f32_16x16x32_bf16 v[20:23], a[192:195], v[108:111], v[20:23]
    buffer_load_dwordx4 v172, s[36:39], s20 offen sc1 lds
    v_mfma_f32_16x16x32_bf16 v[24:27], a[196:199], v[108:111], v[24:27]
    ds_read_b64_tr_b16 v[126:127], v169 offset:6144
    v_mfma_f32_16x16x32_bf16 v[28:31], a[200:203], v[108:111], v[28:31]
    s_waitcnt lgkmcnt(6)
    ds_read_b64_tr_b16 v[128:129], v170 offset:4096
    v_mfma_f32_16x16x32_bf16 v[32:35], a[192:195], v[112:115], v[32:35]
    s_add_u32 m0, s63, 118784
    ds_read_b64_tr_b16 v[130:131], v170 offset:6144
    v_mfma_f32_16x16x32_bf16 v[36:39], a[196:199], v[112:115], v[36:39]
    buffer_load_dwordx4 v172, s[36:39], s21 offen sc1 lds
    v_mfma_f32_16x16x32_bf16 v[40:43], a[200:203], v[112:115], v[40:43]
    s_waitcnt lgkmcnt(6)
    ds_read_b64_tr_b16 v[132:133], v171 offset:4096
    v_mfma_f32_16x16x32_bf16 v[44:47], a[192:195], v[116:119], v[44:47]
    s_waitcnt lgkmcnt(3)
    ds_read_b64_tr_b16 v[134:135], v171 offset:6144
    v_mfma_f32_16x16x32_bf16 v[48:51], a[196:199], v[116:119], v[48:51]
    s_add_u32 m0, s63, 122880
    v_mfma_f32_16x16x32_bf16 v[52:55], a[200:203], v[116:119], v[52:55]
    buffer_load_dwordx4 v172, s[36:39], s22 offen sc1 lds
    v_mfma_f32_16x16x32_bf16 v[8:11], a[204:207], v[120:123], v[8:11]
    ds_read_b64_tr_b16 v[104:105], v168 offset:8192
    v_mfma_f32_16x16x32_bf16 v[12:15], a[208:211], v[120:123], v[12:15]
    ds_read_b64_tr_b16 v[106:107], v168 offset:10240
    v_mfma_f32_16x16x32_bf16 v[16:19], a[212:215], v[120:123], v[16:19]
    s_add_u32 m0, s63, 126976
    ds_read_b64_tr_b16 v[108:109], v169 offset:8192
    v_mfma_f32_16x16x32_bf16 v[20:23], a[204:207], v[124:127], v[20:23]
    buffer_load_dwordx4 v172, s[36:39], s23 offen sc1 lds
    v_mfma_f32_16x16x32_bf16 v[24:27], a[208:211], v[124:127], v[24:27]
    ds_read_b64_tr_b16 v[110:111], v169 offset:10240
    v_mfma_f32_16x16x32_bf16 v[28:31], a[212:215], v[124:127], v[28:31]
    s_waitcnt lgkmcnt(6)
    ds_read_b64_tr_b16 v[112:113], v170 offset:8192
    v_mfma_f32_16x16x32_bf16 v[32:35], a[204:207], v[128:131], v[32:35]
    s_add_u32 m0, s63, 131072
    ds_read_b64_tr_b16 v[114:115], v170 offset:10240
    v_mfma_f32_16x16x32_bf16 v[36:39], a[208:211], v[128:131], v[36:39]
    buffer_load_dwordx4 v172, s[36:39], s24 offen sc1 lds
    v_mfma_f32_16x16x32_bf16 v[40:43], a[212:215], v[128:131], v[40:43]
    s_waitcnt lgkmcnt(6)
    ds_read_b64_tr_b16 v[116:117], v171 offset:8192
    v_mfma_f32_16x16x32_bf16 v[44:47], a[204:207], v[132:135], v[44:47]
    s_waitcnt lgkmcnt(3)
    ds_read_b64_tr_b16 v[118:119], v171 offset:10240
    v_mfma_f32_16x16x32_bf16 v[48:51], a[208:211], v[132:135], v[48:51]
    s_add_u32 m0, s63, 135168
    v_mfma_f32_16x16x32_bf16 v[52:55], a[212:215], v[132:135], v[52:55]
    buffer_load_dwordx4 v172, s[36:39], s25 offen sc1 lds
    v_mfma_f32_16x16x32_bf16 v[8:11], a[216:219], v[104:107], v[8:11]
    ds_read_b64_tr_b16 v[120:121], v168 offset:12288
    v_mfma_f32_16x16x32_bf16 v[12:15], a[220:223], v[104:107], v[12:15]
    ds_read_b64_tr_b16 v[122:123], v168 offset:14336
    v_add_u32 v168, 16384, v168
    v_mfma_f32_16x16x32_bf16 v[16:19], a[224:227], v[104:107], v[16:19]
    s_add_u32 m0, s63, 139264
    ds_read_b64_tr_b16 v[124:125], v169 offset:12288
    v_mfma_f32_16x16x32_bf16 v[20:23], a[216:219], v[108:111], v[20:23]
    buffer_load_dwordx4 v172, s[36:39], s26 offen sc1 lds
    v_mfma_f32_16x16x32_bf16 v[24:27], a[220:223], v[108:111], v[24:27]
    ds_read_b64_tr_b16 v[126:127], v169 offset:14336
    v_add_u32 v169, 16384, v169
    v_mfma_f32_16x16x32_bf16 v[28:31], a[224:227], v[108:111], v[28:31]
    s_waitcnt lgkmcnt(6)
    ds_read_b64_tr_b16 v[128:129], v170 offset:12288
    v_mfma_f32_16x16x32_bf16 v[32:35], a[216:219], v[112:115], v[32:35]
    s_add_u32 m0, s63, 143360
    ds_read_b64_tr_b16 v[130:131], v170 offset:14336
    v_add_u32 v170, 16384, v170
    v_mfma_f32_16x16x32_bf16 v[36:39], a[220:223], v[112:115], v[36:39]
    buffer_load_dwordx4 v172, s[36:39], s27 offen sc1 lds
    v_mfma_f32_16x16x32_bf16 v[40:43], a[224:227], v[112:115], v[40:43]
    s_waitcnt lgkmcnt(6)
    ds_read_b64_tr_b16 v[132:133], v171 offset:12288
    v_mfma_f32_16x16x32_bf16 v[44:47], a[216:219], v[116:119], v[44:47]
    s_waitcnt lgkmcnt(3)
    ds_read_b64_tr_b16 v[134:135], v171 offset:14336
    v_add_u32 v171, 16384, v171
    v_mfma_f32_16x16x32_bf16 v[48:51], a[220:223], v[116:119], v[48:51]
    s_add_u32 m0, s63, 147456
    v_mfma_f32_16x16x32_bf16 v[52:55], a[224:227], v[116:119], v[52:55]
    buffer_load_dwordx4 v172, s[36:39], s44 offen sc1 lds
    v_mfma_f32_16x16x32_bf16 v[8:11], a[228:231], v[120:123], v[8:11]
    s_waitcnt vmcnt(13)
    s_barrier
    ds_read_b64_tr_b16 v[104:105], v168 offset:0
    v_mfma_f32_16x16x32_bf16 v[12:15], a[232:235], v[120:123], v[12:15]
    ds_read_b64_tr_b16 v[106:107], v168 offset:2048
    v_mfma_f32_16x16x32_bf16 v[16:19], a[236:239], v[120:123], v[16:19]
    s_add_u32 m0, s63, 151552
    ds_read_b64_tr_b16 v[108:109], v169 offset:0
    v_mfma_f32_16x16x32_bf16 v[20:23], a[228:231], v[124:127], v[20:23]
    buffer_load_dwordx4 v172, s[36:39], s45 offen sc1 lds
    v_mfma_f32_16x16x32_bf16 v[24:27], a[232:235], v[124:127], v[24:27]
    ds_read_b64_tr_b16 v[110:111], v169 offset:2048
    v_mfma_f32_16x16x32_bf16 v[28:31], a[236:239], v[124:127], v[28:31]
    s_waitcnt lgkmcnt(6)
    ds_read_b64_tr_b16 v[112:113], v170 offset:0
    v_mfma_f32_16x16x32_bf16 v[32:35], a[228:231], v[128:131], v[32:35]
    s_add_u32 m0, s63, 155648
    ds_read_b64_tr_b16 v[114:115], v170 offset:2048
    v_mfma_f32_16x16x32_bf16 v[36:39], a[232:235], v[128:131], v[36:39]
    buffer_load_dwordx4 v172, s[36:39], s46 offen sc1 lds
    v_mfma_f32_16x16x32_bf16 v[40:43], a[236:239], v[128:131], v[40:43]
    s_waitcnt lgkmcnt(6)
    ds_read_b64_tr_b16 v[116:117], v171 offset:0
    v_mfma_f32_16x16x32_bf16 v[44:47], a[228:231], v[132:135], v[44:47]
    s_waitcnt lgkmcnt(3)
    ds_read_b64_tr_b16 v[118:119], v171 offset:2048
    v_mfma_f32_16x16x32_bf16 v[48:51], a[232:235], v[132:135], v[48:51]
    v_mfma_f32_16x16x32_bf16 v[52:55], a[236:239], v[132:135], v[52:55]
L_passB:
    v_mfma_f32_16x16x32_bf16 v[56:59], a[0:3], v[104:107], 0
    s_add_u32 s59, s63, 73728
    ds_read_b64_tr_b16 v[120:121], v168 offset:4096
    v_add_u32 v223, s59, v175
    v_mfma_f32_16x16x32_bf16 v[60:63], a[4:7], v[104:107], 0
    ds_read_b64_tr_b16 v[122:123], v168 offset:6144
    v_and_b32 v247, 48, v1
    v_mfma_f32_16x16x32_bf16 v[64:67], a[8:11], v[104:107], 0
    s_add_u32 m0, s63, 159744
    s_add_u32 s59, s63, 77824
    ds_read_b64_tr_b16 v[124:125], v169 offset:4096
    v_mfma_f32_16x16x32_bf16 v[68:71], a[0:3], v[108:111], 0
    buffer_load_dwordx4 v172, s[36:39], s47 offen sc1 lds
    v_mfma_f32_16x16x32_bf16 v[72:75], a[4:7], v[108:111], 0
    ds_read_b64_tr_b16 v[126:127], v169 offset:6144
    v_add_u32 v247, s59, v247
    v_mfma_f32_16x16x32_bf16 v[76:79], a[8:11], v[108:111], 0
    s_waitcnt lgkmcnt(6)
    ds_read_b64_tr_b16 v[128:129], v170 offset:4096
    v_add_u32 v216, 81920, v216
    v_mfma_f32_16x16x32_bf16 v[80:83], a[0:3], v[112:115], 0
    s_add_u32 m0, s63, 77824
    ds_read_b64_tr_b16 v[130:131], v170 offset:6144
    v_add_u32 v217, 81920, v217
    v_mfma_f32_16x16x32_bf16 v[84:87], a[4:7], v[112:115], 0
    buffer_load_dwordx4 v248, s[36:39], s9 offen sc1 lds
    v_mfma_f32_16x16x32_bf16 v[88:91], a[8:11], v[112:115], 0
    s_waitcnt lgkmcnt(6)
    ds_read_b64_tr_b16 v[132:133], v171 offset:4096
    v_add_u32 v218, 81920, v218
    v_mfma_f32_16x16x32_bf16 v[92:95], a[0:3], v[116:119], 0
    s_waitcnt lgkmcnt(3)
    ds_read_b64_tr_b16 v[134:135], v171 offset:6144
    v_lshrrev_b32 v253, 5, v1
    v_mfma_f32_16x16x32_bf16 v[96:99], a[4:7], v[116:119], 0
    v_and_b32 v2, 16, v1
    v_lshl_add_u32 v253, v253, 2, v2
    v_mfma_f32_16x16x32_bf16 v[100:103], a[8:11], v[116:119], 0
    s_lshl_b32 s57, s3, 13
    v_mfma_f32_16x16x32_bf16 v[56:59], a[12:15], v[120:123], v[56:59]
    ds_read_b64_tr_b16 v[104:105], v168 offset:8192
    v_add_u32 v253, s57, v253
    v_mfma_f32_16x16x32_bf16 v[60:63], a[16:19], v[120:123], v[60:63]
    ds_read_b64_tr_b16 v[106:107], v168 offset:10240
    v_and_b32 v2, 3, v1
    v_mfma_f32_16x16x32_bf16 v[64:67], a[20:23], v[120:123], v[64:67]
    ds_read_b64_tr_b16 v[108:109], v169 offset:8192
    v_lshlrev_b32 v2, 3, v2
    v_mfma_f32_16x16x32_bf16 v[68:71], a[12:15], v[124:127], v[68:71]
    buffer_load_dwordx4 a[0:3], v248, s[36:39], s62 offen offset:0 sc1
    v_mfma_f32_16x16x32_bf16 v[72:75], a[16:19], v[124:127], v[72:75]
    ds_read_b64_tr_b16 v[110:111], v169 offset:10240
    v_mfma_f32_16x16x32_bf16 v[76:79], a[20:23], v[124:127], v[76:79]
    s_waitcnt lgkmcnt(6)
    ds_read_b64_tr_b16 v[112:113], v170 offset:8192
    v_mfma_f32_16x16x32_bf16 v[80:83], a[12:15], v[128:131], v[80:83]
    ds_read_b64_tr_b16 v[114:115], v170 offset:10240
    v_mfma_f32_16x16x32_bf16 v[84:87], a[16:19], v[128:131], v[84:87]
    buffer_load_dwordx4 a[4:7], v248, s[36:39], s62 offen offset:1024 sc1
    v_mfma_f32_16x16x32_bf16 v[88:91], a[20:23], v[128:131], v[88:91]
    s_waitcnt lgkmcnt(6)
    ds_read_b64_tr_b16 v[116:117], v171 offset:8192
    v_mfma_f32_16x16x32_bf16 v[92:95], a[12:15], v[132:135], v[92:95]
    s_waitcnt lgkmcnt(3)
    ds_read_b64_tr_b16 v[118:119], v171 offset:10240
    v_mfma_f32_16x16x32_bf16 v[96:99], a[16:19], v[132:135], v[96:99]
    s_add_u32 m0, s63, 73728
    v_mfma_f32_16x16x32_bf16 v[100:103], a[20:23], v[132:135], v[100:103]
    buffer_load_dwordx4 v248, s[36:39], s6 offen sc1 lds
    v_mfma_f32_16x16x32_bf16 v[56:59], a[24:27], v[104:107], v[56:59]
    ds_read_b64_tr_b16 v[120:121], v168 offset:12288
    v_mfma_f32_16x16x32_bf16 v[60:63], a[28:31], v[104:107], v[60:63]
    ds_read_b64_tr_b16 v[122:123], v168 offset:14336
    v_mfma_f32_16x16x32_bf16 v[64:67], a[32:35], v[104:107], v[64:67]
    ds_read_b64_tr_b16 v[124:125], v169 offset:12288
    v_mfma_f32_16x16x32_bf16 v[68:71], a[24:27], v[108:111], v[68:71]
    buffer_load_dwordx4 a[8:11], v248, s[36:39], s62 offen offset:2048 sc1
    v_mfma_f32_16x16x32_bf16 v[72:75], a[28:31], v[108:111], v[72:75]
    s_add_u32 s62, s16, 1
    s_and_b32 s62, s62, 3
    ds_read_b64_tr_b16 v[126:127], v169 offset:14336
    v_mfma_f32_16x16x32_bf16 v[76:79], a[32:35], v[108:111], v[76:79]
    s_waitcnt lgkmcnt(6)
    s_mul_i32 s62, s62, 15360
    ds_read_b64_tr_b16 v[128:129], v170 offset:12288
    v_mfma_f32_16x16x32_bf16 v[80:83], a[24:27], v[112:115], v[80:83]
    s_add_u32 s62, s62, s65
    ds_read_b64_tr_b16 v[130:131], v170 offset:14336
    v_mfma_f32_16x16x32_bf16 v[84:87], a[28:31], v[112:115], v[84:87]
    buffer_load_dwordx4 a[12:15], v248, s[36:39], s62 offen offset:0 sc1
    v_mfma_f32_16x16x32_bf16 v[88:91], a[32:35], v[112:115], v[88:91]
    s_waitcnt vmcnt(5)
    ds_read_b64_tr_b16 v[132:133], v171 offset:12288
    ds_read_b128 v[176:179], v247 offset:0
    s_waitcnt lgkmcnt(8)
    v_mfma_f32_16x16x32_bf16 v[92:95], a[24:27], v[116:119], v[92:95]
    s_waitcnt lgkmcnt(3)
    ds_read_b64_tr_b16 v[134:135], v171 offset:14336
    ds_read_b128 v[180:183], v247 offset:64
    v_mfma_f32_16x16x32_bf16 v[96:99], a[28:31], v[116:119], v[96:99]
    ds_read_b128 v[184:187], v247 offset:128
    ds_read_b128 v[188:191], v247 offset:192
    v_mfma_f32_16x16x32_bf16 v[100:103], a[32:35], v[116:119], v[100:103]
    buffer_load_dwordx4 a[16:19], v248, s[36:39], s62 offen offset:1024 sc1
    v_mfma_f32_16x16x32_bf16 v[56:59], a[36:39], v[120:123], v[56:59]
    s_barrier
    ds_read_b64_tr_b16 v[104:105], v168 offset:16384
    ds_read_b128 v[192:195], v247 offset:256
    v_mfma_f32_16x16x32_bf16 v[60:63], a[40:43], v[120:123], v[60:63]
    ds_read_b64_tr_b16 v[106:107], v168 offset:18432
    ds_read_b128 v[196:199], v247 offset:320
    v_mfma_f32_16x16x32_bf16 v[64:67], a[44:47], v[120:123], v[64:67]
    ds_read_b64_tr_b16 v[108:109], v169 offset:16384
    ds_read_b64 v[224:225], v216
    v_mfma_f32_16x16x32_bf16 v[68:71], a[36:39], v[124:127], v[68:71]
    buffer_load_dwordx4 a[20:23], v248, s[36:39], s62 offen offset:2048 sc1
    v_mfma_f32_16x16x32_bf16 v[72:75], a[40:43], v[124:127], v[72:75]
    s_waitcnt vmcnt(4)
    ds_read_b64_tr_b16 v[110:111], v169 offset:18432
    ds_read_b128 v[200:203], v223 offset:0
    v_mfma_f32_16x16x32_bf16 v[76:79], a[44:47], v[124:127], v[76:79]
    s_waitcnt lgkmcnt(12)
    ds_read_b64_tr_b16 v[112:113], v170 offset:16384
    ds_read_b128 v[204:207], v223 offset:256
    v_mfma_f32_16x16x32_bf16 v[80:83], a[36:39], v[128:131], v[80:83]
    ds_read_b64_tr_b16 v[114:115], v170 offset:18432
    ds_read_b128 v[208:211], v223 offset:512
    v_mfma_f32_16x16x32_bf16 v[84:87], a[40:43], v[128:131], v[84:87]
    buffer_load_dwordx4 a[24:27], v248, s[36:39], s62 offen offset:3072 sc1
    v_mfma_f32_16x16x32_bf16 v[88:91], a[44:47], v[128:131], v[88:91]
    s_waitcnt lgkmcnt(12)
    s_add_u32 s62, s62, 4096
    ds_read_b64_tr_b16 v[116:117], v171 offset:16384
    ds_read_b128 v[212:215], v223 offset:768
    v_mfma_f32_16x16x32_bf16 v[92:95], a[36:39], v[132:135], v[92:95]
    s_waitcnt lgkmcnt(3)
    ds_read_b64_tr_b16 v[118:119], v171 offset:18432
    ds_read_b64 v[226:227], v217
    v_mfma_f32_16x16x32_bf16 v[96:99], a[40:43], v[132:135], v[96:99]
    ds_read_b64 v[228:229], v218
    v_mfma_f32_16x16x32_bf16 v[100:103], a[44:47], v[132:135], v[100:103]
    buffer_load_dwordx4 a[28:31], v248, s[36:39], s62 offen offset:0 sc1
    v_mfma_f32_16x16x32_bf16 v[56:59], a[48:51], v[104:107], v[56:59]
    ds_read_b64_tr_b16 v[120:121], v168 offset:20480
    v_xor_b32 v3, s48, v201
    v_mfma_f32_16x16x32_bf16 v[60:63], a[52:55], v[104:107], v[60:63]
    ds_read_b64_tr_b16 v[122:123], v168 offset:22528
    v_bitop3_b32 v3, v203, s48, v3 bitop3:0xbe
    v_mfma_f32_16x16x32_bf16 v[64:67], a[56:59], v[104:107], v[64:67]
    ds_read_b64_tr_b16 v[124:125], v169 offset:20480
    v_bitop3_b32 v3, v205, s48, v3 bitop3:0xbe
    v_mfma_f32_16x16x32_bf16 v[68:71], a[48:51], v[108:111], v[68:71]
    buffer_load_dwordx4 a[32:35], v248, s[36:39], s62 offen offset:1024 sc1
    v_mfma_f32_16x16x32_bf16 v[72:75], a[52:55], v[108:111], v[72:75]
    ds_read_b64_tr_b16 v[126:127], v169 offset:22528
    v_bitop3_b32 v3, v207, s48, v3 bitop3:0xbe
    v_lshlrev_b32 v230, 16, v224
    v_mfma_f32_16x16x32_bf16 v[76:79], a[56:59], v[108:111], v[76:79]
    ds_read_b64_tr_b16 v[128:129], v170 offset:20480
    s_waitcnt lgkmcnt(10)
    v_bitop3_b32 v3, v209, s48, v3 bitop3:0xbe
    v_and_b32 v231, 0xffff0000, v224
    v_mfma_f32_16x16x32_bf16 v[80:83], a[48:51], v[112:115], v[80:83]
    ds_read_b64_tr_b16 v[130:131], v170 offset:22528
    v_bitop3_b32 v3, v211, s48, v3 bitop3:0xbe
    v_mul_f32 v230, v230, v220
    v_mfma_f32_16x16x32_bf16 v[84:87], a[52:55], v[112:115], v[84:87]
    buffer_load_dwordx4 a[36:39], v248, s[36:39], s62 offen offset:2048 sc1
    v_mfma_f32_16x16x32_bf16 v[88:91], a[56:59], v[112:115], v[88:91]
    ds_read_b64_tr_b16 v[132:133], v171 offset:20480
    s_waitcnt lgkmcnt(10)
    v_bitop3_b32 v3, v213, s48, v3 bitop3:0xbe
    v_mul_f32 v231, v231, v220
    s_waitcnt lgkmcnt(9)
    v_mfma_f32_16x16x32_bf16 v[92:95], a[48:51], v[116:119], v[92:95]
    s_waitcnt lgkmcnt(3)
    ds_read_b64_tr_b16 v[134:135], v171 offset:22528
    v_bitop3_b32 v3, v215, s48, v3 bitop3:0xbe
    v_mul_f32 v234, v230, v230
    v_mfma_f32_16x16x32_bf16 v[96:99], a[52:55], v[116:119], v[96:99]
    v_cmp_ne_u32 vcc, 0, v3
    s_cbranch_vccnz L_st0_slow
L_st0_back:
    v_mul_f32 v235, v231, v231
    v_lshlrev_b32 v232, 16, v225
    v_mfma_f32_16x16x32_bf16 v[100:103], a[56:59], v[116:119], v[100:103]
    s_add_u32 s50, s8, 102912
    v_pk_fma_f32 v[238:239], v[176:177], v[202:203], v[188:189] op_sel_hi:[1,0,1]
    v_pk_fma_f32 v[240:241], v[178:179], v[202:203], v[190:191] op_sel_hi:[1,0,1]
    v_pk_fma_f32 v[8:9], v[8:9], v[200:201], v[238:239] op_sel_hi:[1,0,1]
    v_pk_fma_f32 v[10:11], v[10:11], v[200:201], v[240:241] op_sel_hi:[1,0,1]
    v_pk_fma_f32 v[242:243], v[180:181], v[202:203], v[192:193] op_sel_hi:[1,0,1]
    v_pk_fma_f32 v[244:245], v[182:183], v[202:203], v[194:195] op_sel_hi:[1,0,1]
    v_pk_fma_f32 v[12:13], v[12:13], v[200:201], v[242:243] op_sel_hi:[1,0,1]
    v_pk_fma_f32 v[14:15], v[14:15], v[200:201], v[244:245] op_sel_hi:[1,0,1]
    v_pk_mul_f32 v[8:9], v[8:9], v[12:13]
    v_pk_mul_f32 v[10:11], v[10:11], v[14:15]
    v_cvt_pk_bf16_f32 v12, v8, v9
    v_cvt_pk_bf16_f32 v13, v10, v11
    v_pk_fma_f32 v[242:243], v[176:177], v[206:207], v[188:189] op_sel_hi:[1,0,1]
    v_pk_fma_f32 v[244:245], v[178:179], v[206:207], v[190:191] op_sel_hi:[1,0,1]
    v_pk_fma_f32 v[20:21], v[20:21], v[204:205], v[242:243] op_sel_hi:[1,0,1]
    v_pk_fma_f32 v[22:23], v[22:23], v[204:205], v[244:245] op_sel_hi:[1,0,1]
    v_pk_fma_f32 v[238:239], v[180:181], v[206:207], v[192:193] op_sel_hi:[1,0,1]
    v_pk_fma_f32 v[240:241], v[182:183], v[206:207], v[194:195] op_sel_hi:[1,0,1]
    v_pk_fma_f32 v[24:25], v[24:25], v[204:205], v[238:239] op_sel_hi:[1,0,1]
    v_pk_fma_f32 v[26:27], v[26:27], v[204:205], v[240:241] op_sel_hi:[1,0,1]
    v_pk_mul_f32 v[20:21], v[20:21], v[24:25]
    v_pk_mul_f32 v[22:23], v[22:23], v[26:27]
    v_cvt_pk_bf16_f32 v14, v20, v21
    v_cvt_pk_bf16_f32 v15, v22, v23
    s_nop 0
    v_permlane16_swap_b32 v12, v14
    v_permlane16_swap_b32 v13, v15
    buffer_store_dwordx4 v[12:15], v173, s[36:39], s8 offen sc1
    v_pk_fma_f32 v[238:239], v[176:177], v[210:211], v[188:189] op_sel_hi:[1,0,1]
    v_pk_fma_f32 v[240:241], v[178:179], v[210:211], v[190:191] op_sel_hi:[1,0,1]
    v_pk_fma_f32 v[32:33], v[32:33], v[208:209], v[238:239] op_sel_hi:[1,0,1]
    v_pk_fma_f32 v[34:35], v[34:35], v[208:209], v[240:241] op_sel_hi:[1,0,1]
    v_pk_fma_f32 v[242:243], v[180:181], v[210:211], v[192:193] op_sel_hi:[1,0,1]
    v_pk_fma_f32 v[244:245], v[182:183], v[210:211], v[194:195] op_sel_hi:[1,0,1]
    v_pk_fma_f32 v[36:37], v[36:37], v[208:209], v[242:243] op_sel_hi:[1,0,1]
    v_pk_fma_f32 v[38:39], v[38:39], v[208:209], v[244:245] op_sel_hi:[1,0,1]
    v_pk_mul_f32 v[32:33], v[32:33], v[36:37]
    v_pk_mul_f32 v[34:35], v[34:35], v[38:39]
    v_cvt_pk_bf16_f32 v36, v32, v33
    v_cvt_pk_bf16_f32 v37, v34, v35
    v_pk_fma_f32 v[242:243], v[176:177], v[214:215], v[188:189] op_sel_hi:[1,0,1]
    v_pk_fma_f32 v[244:245], v[178:179], v[214:215], v[190:191] op_sel_hi:[1,0,1]
    v_pk_fma_f32 v[44:45], v[44:45], v[212:213], v[242:243] op_sel_hi:[1,0,1]
    v_pk_fma_f32 v[46:47], v[46:47], v[212:213], v[244:245] op_sel_hi:[1,0,1]
    v_pk_fma_f32 v[238:239], v[180:181], v[214:215], v[192:193] op_sel_hi:[1,0,1]
    v_pk_fma_f32 v[240:241], v[182:183], v[214:215], v[194:195] op_sel_hi:[1,0,1]
    v_pk_fma_f32 v[48:49], v[48:49], v[212:213], v[238:239] op_sel_hi:[1,0,1]
    v_pk_fma_f32 v[50:51], v[50:51], v[212:213], v[240:241] op_sel_hi:[1,0,1]
    v_pk_mul_f32 v[44:45], v[44:45], v[48:49]
    v_pk_mul_f32 v[46:47], v[46:47], v[50:51]
    v_cvt_pk_bf16_f32 v38, v44, v45
    v_cvt_pk_bf16_f32 v39, v46, v47
    s_nop 0
    v_permlane16_swap_b32 v36, v38
    v_permlane16_swap_b32 v37, v39
    buffer_store_dwordx4 v[36:39], v173, s[36:39], s50 offen sc1
    v_pk_fma_f32 v[238:239], v[184:185], v[202:203], v[196:197] op_sel_hi:[1,0,1]
    v_pk_fma_f32 v[240:241], v[186:187], v[202:203], v[198:199] op_sel_hi:[1,0,1]
    v_pk_fma_f32 v[16:17], v[16:17], v[200:201], v[238:239] op_sel_hi:[1,0,1]
    v_pk_fma_f32 v[18:19], v[18:19], v[200:201], v[240:241] op_sel_hi:[1,0,1]
    v_pk_fma_f32 v[242:243], v[184:185], v[206:207], v[196:197] op_sel_hi:[1,0,1]
    v_pk_fma_f32 v[244:245], v[186:187], v[206:207], v[198:199] op_sel_hi:[1,0,1]
    v_pk_fma_f32 v[28:29], v[28:29], v[204:205], v[242:243] op_sel_hi:[1,0,1]
    v_pk_fma_f32 v[30:31], v[30:31], v[204:205], v[244:245] op_sel_hi:[1,0,1]
    s_nop 0
    v_permlane32_swap_b32 v16, v28
    v_permlane32_swap_b32 v17, v29
    v_permlane32_swap_b32 v18, v30
    v_permlane32_swap_b32 v19, v31
    v_pk_mul_f32 v[16:17], v[16:17], v[28:29]
    v_pk_mul_f32 v[18:19], v[18:19], v[30:31]
    v_cvt_pk_bf16_f32 v8, v16, v17
    v_cvt_pk_bf16_f32 v9, v18, v19
    v_pk_fma_f32 v[238:239], v[184:185], v[210:211], v[196:197] op_sel_hi:[1,0,1]
    v_pk_fma_f32 v[240:241], v[186:187], v[210:211], v[198:199] op_sel_hi:[1,0,1]
    v_pk_fma_f32 v[40:41], v[40:41], v[208:209], v[238:239] op_sel_hi:[1,0,1]
    v_pk_fma_f32 v[42:43], v[42:43], v[208:209], v[240:241] op_sel_hi:[1,0,1]
    v_pk_fma_f32 v[242:243], v[184:185], v[214:215], v[196:197] op_sel_hi:[1,0,1]
    v_pk_fma_f32 v[244:245], v[186:187], v[214:215], v[198:199] op_sel_hi:[1,0,1]
    v_pk_fma_f32 v[52:53], v[52:53], v[212:213], v[242:243] op_sel_hi:[1,0,1]
    v_pk_fma_f32 v[54:55], v[54:55], v[212:213], v[244:245] op_sel_hi:[1,0,1]
    s_nop 0
    v_permlane32_swap_b32 v40, v52
    v_permlane32_swap_b32 v41, v53
    v_permlane32_swap_b32 v42, v54
    v_permlane32_swap_b32 v43, v55
    v_pk_mul_f32 v[40:41], v[40:41], v[52:53]
    v_pk_mul_f32 v[42:43], v[42:43], v[54:55]
    v_cvt_pk_bf16_f32 v10, v40, v41
    v_cvt_pk_bf16_f32 v11, v42, v43
    s_nop 0
    v_permlane16_swap_b32 v8, v10
    v_permlane16_swap_b32 v9, v11
    buffer_store_dwordx4 v[8:11], v174, s[36:39], s8 offen offset:512 sc1
    s_add_u32 s6, s6, 16384
    s_lshl_b32 s76, s72, 4
    s_add_u32 s76, s76, s73
    buffer_load_dwordx4 a[40:43], v248, s[36:39], s62 offen offset:3072 sc1
    v_mfma_f32_16x16x32_bf16 v[56:59], a[60:63], v[120:123], v[56:59]
    s_add_u32 s62, s62, 4096
    ds_read_b64_tr_b16 v[104:105], v168 offset:24576
    v_and_b32 v233, 0xffff0000, v225
    v_mul_f32 v232, v232, v220
    v_mfma_f32_16x16x32_bf16 v[60:63], a[64:67], v[120:123], v[60:63]
    ds_read_b64_tr_b16 v[106:107], v168 offset:26624
    v_mul_f32 v233, v233, v220
    v_mul_f32 v236, v232, v232
    v_mfma_f32_16x16x32_bf16 v[64:67], a[68:71], v[120:123], v[64:67]
    ds_read_b64_tr_b16 v[108:109], v169 offset:24576
    v_mul_f32 v237, v233, v233
    v_lshlrev_b32 v249, 16, v226
    v_mfma_f32_16x16x32_bf16 v[68:71], a[60:63], v[124:127], v[68:71]
    s_and_b32 s50, s3, 1
    s_lshl_b32 s51, s74, 1
    buffer_load_dwordx4 a[44:47], v248, s[36:39], s62 offen offset:0 sc1
    v_mfma_f32_16x16x32_bf16 v[72:75], a[64:67], v[124:127], v[72:75]
    ds_read_b64_tr_b16 v[110:111], v169 offset:26624
    v_and_b32 v250, 0xffff0000, v226
    v_mul_f32 v249, v249, v221
    v_mfma_f32_16x16x32_bf16 v[76:79], a[68:71], v[124:127], v[76:79]
    s_waitcnt lgkmcnt(6)
    ds_read_b64_tr_b16 v[112:113], v170 offset:24576
    v_mul_f32 v250, v250, v221
    v_add_f32 v230, v230, v249
    v_mfma_f32_16x16x32_bf16 v[80:83], a[60:63], v[128:131], v[80:83]
    ds_read_b64_tr_b16 v[114:115], v170 offset:26624
    v_add_f32 v231, v231, v250
    v_fmac_f32 v234, v249, v249
    v_mfma_f32_16x16x32_bf16 v[84:87], a[64:67], v[128:131], v[84:87]
    s_add_u32 s52, s51, s50
    s_mul_i32 s52, s52, 201
    buffer_load_dwordx4 a[48:51], v248, s[36:39], s62 offen offset:1024 sc1
    v_mfma_f32_16x16x32_bf16 v[88:91], a[68:71], v[128:131], v[88:91]
    s_waitcnt lgkmcnt(6)
    ds_read_b64_tr_b16 v[116:117], v171 offset:24576
    v_fmac_f32 v235, v250, v250
    v_lshlrev_b32 v251, 16, v227
    v_mfma_f32_16x16x32_bf16 v[92:95], a[60:63], v[132:135], v[92:95]
    s_waitcnt lgkmcnt(3)
    ds_read_b64_tr_b16 v[118:119], v171 offset:26624
    v_and_b32 v252, 0xffff0000, v227
    v_mul_f32 v251, v251, v221
    v_mfma_f32_16x16x32_bf16 v[96:99], a[64:67], v[132:135], v[96:99]
    v_mul_f32 v252, v252, v221
    v_add_f32 v232, v232, v251
    v_add_f32 v233, v233, v252
    v_mfma_f32_16x16x32_bf16 v[100:103], a[68:71], v[132:135], v[100:103]
    s_mul_i32 s53, s3, 50
    s_add_u32 s52, s52, s53
    buffer_load_dwordx4 a[52:55], v248, s[36:39], s62 offen offset:2048 sc1
    v_mfma_f32_16x16x32_bf16 v[56:59], a[72:75], v[104:107], v[56:59]
    ds_read_b64_tr_b16 v[120:121], v168 offset:28672
    v_fmac_f32 v236, v251, v251
    v_fmac_f32 v237, v252, v252
    v_mfma_f32_16x16x32_bf16 v[60:63], a[76:79], v[104:107], v[60:63]
    ds_read_b64_tr_b16 v[122:123], v168 offset:30720
    v_lshlrev_b32 v249, 16, v228
    v_and_b32 v250, 0xffff0000, v228
    v_mfma_f32_16x16x32_bf16 v[64:67], a[80:83], v[104:107], v[64:67]
    ds_read_b64_tr_b16 v[124:125], v169 offset:28672
    v_mul_f32 v249, v249, v222
    v_mul_f32 v250, v250, v222
    v_mfma_f32_16x16x32_bf16 v[68:71], a[72:75], v[108:111], v[68:71]
    s_lshl_b32 s52, s52, 8
    s_add_u32 s52, s52, 15728640
    buffer_load_dwordx4 a[56:59], v248, s[36:39], s62 offen offset:3072 sc1
    v_mfma_f32_16x16x32_bf16 v[72:75], a[76:79], v[108:111], v[72:75]
    s_add_u32 s62, s62, 4096
    ds_read_b64_tr_b16 v[126:127], v169 offset:30720
    v_add_f32 v230, v230, v249
    v_add_f32 v231, v231, v250
    v_mfma_f32_16x16x32_bf16 v[76:79], a[80:83], v[108:111], v[76:79]
    s_waitcnt lgkmcnt(6)
    ds_read_b64_tr_b16 v[128:129], v170 offset:28672
    v_fmac_f32 v234, v249, v249
    v_fmac_f32 v235, v250, v250
    v_mfma_f32_16x16x32_bf16 v[80:83], a[72:75], v[112:115], v[80:83]
    ds_read_b64_tr_b16 v[130:131], v170 offset:30720
    v_lshlrev_b32 v251, 16, v229
    v_and_b32 v252, 0xffff0000, v229
    v_mfma_f32_16x16x32_bf16 v[84:87], a[76:79], v[112:115], v[84:87]
    buffer_load_dwordx4 a[60:63], v248, s[36:39], s62 offen offset:0 sc1
    v_mfma_f32_16x16x32_bf16 v[88:91], a[80:83], v[112:115], v[88:91]
    s_waitcnt lgkmcnt(6)
    ds_read_b64_tr_b16 v[132:133], v171 offset:28672
    v_mul_f32 v251, v251, v222
    v_mul_f32 v252, v252, v222
    v_mfma_f32_16x16x32_bf16 v[92:95], a[72:75], v[116:119], v[92:95]
    s_waitcnt lgkmcnt(3)
    ds_read_b64_tr_b16 v[134:135], v171 offset:30720
    v_add_f32 v232, v232, v251
    v_add_f32 v233, v233, v252
    v_mfma_f32_16x16x32_bf16 v[96:99], a[76:79], v[116:119], v[96:99]
    v_fmac_f32 v236, v251, v251
    v_fmac_f32 v237, v252, v252
    v_permlane32_swap_b32 v230, v234
    v_mfma_f32_16x16x32_bf16 v[100:103], a[80:83], v[116:119], v[100:103]
    buffer_load_dwordx4 a[64:67], v248, s[36:39], s62 offen offset:1024 sc1
    v_mfma_f32_16x16x32_bf16 v[56:59], a[84:87], v[120:123], v[56:59]
    ds_read_b64_tr_b16 v[104:105], v168 offset:32768
    v_permlane32_swap_b32 v231, v235
    v_permlane32_swap_b32 v232, v236
    v_mfma_f32_16x16x32_bf16 v[60:63], a[88:91], v[120:123], v[60:63]
    ds_read_b64_tr_b16 v[106:107], v168 offset:34816
    v_permlane32_swap_b32 v233, v237
    v_add_f32 v230, v230, v234
    v_mfma_f32_16x16x32_bf16 v[64:67], a[92:95], v[120:123], v[64:67]
    ds_read_b64_tr_b16 v[108:109], v169 offset:32768
    v_add_f32 v231, v231, v235
    v_add_f32 v232, v232, v236
    v_mfma_f32_16x16x32_bf16 v[68:71], a[84:87], v[124:127], v[68:71]
    buffer_load_dwordx4 a[68:71], v248, s[36:39], s62 offen offset:2048 sc1
    v_mfma_f32_16x16x32_bf16 v[72:75], a[88:91], v[124:127], v[72:75]
    s_add_u32 s62, s16, 2
    s_and_b32 s62, s62, 3
    ds_read_b64_tr_b16 v[110:111], v169 offset:34816
    v_add_f32 v233, v233, v237
    v_permlane16_swap_b32 v230, v232
    v_mfma_f32_16x16x32_bf16 v[76:79], a[92:95], v[124:127], v[76:79]
    s_mul_i32 s62, s62, 15360
    ds_read_b64_tr_b16 v[112:113], v170 offset:32768
    v_permlane16_swap_b32 v231, v233
    v_add_f32 v230, v230, v232
    s_waitcnt lgkmcnt(7)
    v_mfma_f32_16x16x32_bf16 v[80:83], a[84:87], v[128:131], v[80:83]
    s_add_u32 s62, s62, s65
    ds_read_b64_tr_b16 v[114:115], v170 offset:34816
    v_add_f32 v231, v231, v233
    v_add_f32_dpp v230, v230, v230 row_ror:8 row_mask:0xf bank_mask:0xf
    v_mfma_f32_16x16x32_bf16 v[84:87], a[88:91], v[128:131], v[84:87]
    buffer_load_dwordx4 a[72:75], v248, s[36:39], s62 offen offset:0 sc1
    v_mfma_f32_16x16x32_bf16 v[88:91], a[92:95], v[128:131], v[88:91]
    s_waitcnt lgkmcnt(6)
    ds_read_b64_tr_b16 v[116:117], v171 offset:32768
    v_add_f32_dpp v231, v231, v231 row_ror:8 row_mask:0xf bank_mask:0xf
    v_add_f32_dpp v230, v230, v230 row_ror:4 row_mask:0xf bank_mask:0xf
    v_mfma_f32_16x16x32_bf16 v[92:95], a[84:87], v[132:135], v[92:95]
    s_waitcnt lgkmcnt(3)
    ds_read_b64_tr_b16 v[118:119], v171 offset:34816
    v_add_f32_dpp v231, v231, v231 row_ror:4 row_mask:0xf bank_mask:0xf
    v_add_f32_dpp v230, v230, v230 row_ror:2 row_mask:0xf bank_mask:0xf
    v_mfma_f32_16x16x32_bf16 v[96:99], a[88:91], v[132:135], v[96:99]
    v_add_f32_dpp v231, v231, v231 row_ror:2 row_mask:0xf bank_mask:0xf
    v_add_f32_dpp v230, v230, v230 row_ror:1 row_mask:0xf bank_mask:0xf
    s_nop 0
    v_add_f32_dpp v231, v231, v231 row_ror:1 row_mask:0xf bank_mask:0xf
    v_mfma_f32_16x16x32_bf16 v[100:103], a[92:95], v[132:135], v[100:103]
    buffer_load_dwordx4 a[76:79], v248, s[36:39], s62 offen offset:1024 sc1
    v_mfma_f32_16x16x32_bf16 v[56:59], a[96:99], v[104:107], v[56:59]
    ds_read_b64_tr_b16 v[120:121], v168 offset:36864
    s_mov_b32 exec_lo, 0x00010001
    s_mov_b32 exec_hi, 0x00010001
    ds_write2_b32 v253, v230, v231 offset0:0 offset1:2
    s_mov_b64 exec, -1
    v_mfma_f32_16x16x32_bf16 v[60:63], a[100:103], v[104:107], v[60:63]
    ds_read_b64_tr_b16 v[122:123], v168 offset:38912
    v_mov_b32 v225, s48
    v_mov_b32 v227, s48
    v_mfma_f32_16x16x32_bf16 v[64:67], a[104:107], v[104:107], v[64:67]
    ds_read_b64_tr_b16 v[124:125], v169 offset:36864
    v_add_u32 v216, s52, v248
    v_mfma_f32_16x16x32_bf16 v[68:71], a[96:99], v[108:111], v[68:71]
    buffer_load_dwordx4 a[80:83], v248, s[36:39], s62 offen offset:2048 sc1
    v_mfma_f32_16x16x32_bf16 v[72:75], a[100:103], v[108:111], v[72:75]
    s_waitcnt vmcnt(11)
    s_barrier
    s_cmp_eq_u32 s3, 0
    s_cbranch_scc0 L_wf21
    s_lshl_b32 s54, s76, 7
    s_add_u32 s54, s54, 23355392
    v_mov_b32 v254, 0
    v_mov_b32 v255, s48
    s_mov_b64 exec, 1
    buffer_store_dword v255, v254, s[36:39], s54 offen sc1
    s_mov_b64 exec, -1
L_wf21:
    ds_read_b64_tr_b16 v[126:127], v169 offset:38912
    v_mfma_f32_16x16x32_bf16 v[76:79], a[104:107], v[108:111], v[76:79]
    s_waitcnt lgkmcnt(3)
    s_barrier
    ds_read_b64_tr_b16 v[128:129], v170 offset:36864
    ds_read_b64 v[230:231], v2 offset:0
    v_mfma_f32_16x16x32_bf16 v[80:83], a[96:99], v[112:115], v[80:83]
    ds_read_b64_tr_b16 v[130:131], v170 offset:38912
    ds_read_b64 v[232:233], v2 offset:8192
    ds_read_b64 v[234:235], v2 offset:16384
    v_mfma_f32_16x16x32_bf16 v[84:87], a[100:103], v[112:115], v[84:87]
    buffer_load_dwordx4 a[84:87], v248, s[36:39], s62 offen offset:3072 sc1
    v_mfma_f32_16x16x32_bf16 v[88:91], a[104:107], v[112:115], v[88:91]
    s_add_u32 s7, s7, 16384
    ds_read_b64_tr_b16 v[132:133], v171 offset:36864
    ds_read_b64 v[236:237], v2 offset:24576
    v_mfma_f32_16x16x32_bf16 v[92:95], a[96:99], v[116:119], v[92:95]
    s_waitcnt lgkmcnt(3)
    ds_read_b64_tr_b16 v[134:135], v171 offset:38912
    v_add_u32 v218, 3293184, v216
    v_mfma_f32_16x16x32_bf16 v[96:99], a[100:103], v[116:119], v[96:99]
    s_xor_b32 s50, s50, 1
    s_add_u32 s52, s51, s50
    v_add_u32 v245, s63, v248
    v_mfma_f32_16x16x32_bf16 v[100:103], a[104:107], v[116:119], v[100:103]
    s_mul_i32 s52, s52, 201
    s_add_u32 s52, s52, s53
    v_mfma_f32_16x16x32_bf16 v[56:59], a[108:111], v[120:123], v[56:59]
    s_add_u32 s62, s62, 4096
    ds_read_b64_tr_b16 v[104:105], v168 offset:40960
    v_add_f32 v230, v230, v232
    v_add_f32 v231, v231, v233
    v_mfma_f32_16x16x32_bf16 v[60:63], a[112:115], v[120:123], v[60:63]
    ds_read_b64_tr_b16 v[106:107], v168 offset:43008
    s_waitcnt lgkmcnt(3)
    v_add_f32 v234, v234, v236
    v_add_f32 v235, v235, v237
    v_mfma_f32_16x16x32_bf16 v[64:67], a[116:119], v[120:123], v[64:67]
    ds_read_b64_tr_b16 v[108:109], v169 offset:40960
    v_add_f32 v230, v230, v234
    v_add_f32 v231, v231, v235
    v_mfma_f32_16x16x32_bf16 v[68:71], a[108:111], v[124:127], v[68:71]
    s_lshl_b32 s52, s52, 8
    s_add_u32 s52, s52, 15728640
    buffer_load_dwordx4 a[88:91], v248, s[36:39], s62 offen offset:0 sc1
    v_mfma_f32_16x16x32_bf16 v[72:75], a[112:115], v[124:127], v[72:75]
    ds_read_b64_tr_b16 v[110:111], v169 offset:43008
    v_mul_f32 v230, 0x3acccccd, v230
    v_mul_f32 v234, v230, v230
    v_mfma_f32_16x16x32_bf16 v[76:79], a[116:119], v[124:127], v[76:79]
    ds_read_b64_tr_b16 v[112:113], v170 offset:40960
    v_mov_b32 v224, 0x3acccccd
    v_fma_f32 v231, v231, v224, -v234
    v_mfma_f32_16x16x32_bf16 v[80:83], a[108:111], v[128:131], v[80:83]
    ds_read_b64_tr_b16 v[114:115], v170 offset:43008
    v_max_f32 v231, 0, v231
    v_add_f32 v231, 0x3727c5ac, v231
    v_mfma_f32_16x16x32_bf16 v[84:87], a[112:115], v[128:131], v[84:87]
    buffer_load_dwordx4 a[92:95], v248, s[36:39], s62 offen offset:1024 sc1
    v_mfma_f32_16x16x32_bf16 v[88:91], a[116:119], v[128:131], v[88:91]
    ds_read_b64_tr_b16 v[116:117], v171 offset:40960
    v_rsq_f32 v224, v231
    s_nop 0
    v_mul_f32_e64 v226, -v230, v224
    s_waitcnt lgkmcnt(7)
    v_mfma_f32_16x16x32_bf16 v[92:95], a[108:111], v[132:135], v[92:95]
    s_waitcnt lgkmcnt(3)
    ds_read_b64_tr_b16 v[118:119], v171 offset:43008
    v_add_u32 v217, s52, v248
    v_mfma_f32_16x16x32_bf16 v[96:99], a[112:115], v[132:135], v[96:99]
    s_mov_b64 exec, 0xf
    buffer_store_dwordx4 v[224:227], v248, s[36:39], s7 offen sc1
    s_mov_b64 exec, -1
    v_mfma_f32_16x16x32_bf16 v[100:103], a[116:119], v[132:135], v[100:103]
    s_mul_i32 s58, s75, 337920
    s_lshl_b32 s59, s74, 6
    buffer_load_dwordx4 a[96:99], v248, s[36:39], s62 offen offset:2048 sc1
    v_mfma_f32_16x16x32_bf16 v[56:59], a[120:123], v[104:107], v[56:59]
    s_add_u32 s58, s58, s59
    s_add_u32 s58, s58, 8650752
    ds_read_b64_tr_b16 v[120:121], v168 offset:45056
    v_mfma_f32_16x16x32_bf16 v[60:63], a[124:127], v[104:107], v[60:63]
    s_lshl_b32 s59, s3, 6
    ds_read_b64_tr_b16 v[122:123], v168 offset:47104
    v_add_u32 v252, s59, v1
    v_mfma_f32_16x16x32_bf16 v[64:67], a[128:131], v[104:107], v[64:67]
    ds_read_b64_tr_b16 v[124:125], v169 offset:45056
    v_and_b32 v253, 3, v1
    v_mfma_f32_16x16x32_bf16 v[68:71], a[120:123], v[108:111], v[68:71]
    buffer_load_dwordx4 a[100:103], v248, s[36:39], s62 offen offset:3072 sc1
    v_mfma_f32_16x16x32_bf16 v[72:75], a[124:127], v[108:111], v[72:75]
    s_add_u32 s62, s62, 4096
    ds_read_b64_tr_b16 v[126:127], v169 offset:47104
    v_lshl_add_u32 v253, v253, 4, s58
    v_mfma_f32_16x16x32_bf16 v[76:79], a[128:131], v[108:111], v[76:79]
    s_waitcnt lgkmcnt(6)
    ds_read_b64_tr_b16 v[128:129], v170 offset:45056
    v_lshrrev_b32 v249, 2, v252
    v_mfma_f32_16x16x32_bf16 v[80:83], a[120:123], v[112:115], v[80:83]
    ds_read_b64_tr_b16 v[130:131], v170 offset:47104
    v_mul_u32_u24 v249, 4224, v249
    v_mfma_f32_16x16x32_bf16 v[84:87], a[124:127], v[112:115], v[84:87]
    buffer_load_dwordx4 a[104:107], v248, s[36:39], s62 offen offset:0 sc1
    v_mfma_f32_16x16x32_bf16 v[88:91], a[128:131], v[112:115], v[88:91]
    s_waitcnt lgkmcnt(6)
    ds_read_b64_tr_b16 v[132:133], v171 offset:45056
    v_add_u32 v249, v249, v253
    v_mfma_f32_16x16x32_bf16 v[92:95], a[120:123], v[116:119], v[92:95]
    s_waitcnt lgkmcnt(3)
    ds_read_b64_tr_b16 v[134:135], v171 offset:47104
    v_mov_b32 v250, 269312
    v_mfma_f32_16x16x32_bf16 v[96:99], a[124:127], v[116:119], v[96:99]
    v_mov_b32 v251, 4294900736
    v_add_u32 v219, 3293184, v217
    v_mfma_f32_16x16x32_bf16 v[100:103], a[128:131], v[116:119], v[100:103]
    s_add_u32 s18, s16, 0
    s_and_b32 s18, s18, 3
    s_mul_i32 s18, s18, 3072
    buffer_load_dwordx4 a[108:111], v248, s[36:39], s62 offen offset:1024 sc1
    v_mfma_f32_16x16x32_bf16 v[56:59], a[132:135], v[120:123], v[56:59]
    s_add_u32 s19, s16, 1
    s_and_b32 s19, s19, 3
    ds_read_b64_tr_b16 v[104:105], v168 offset:49152
    v_mfma_f32_16x16x32_bf16 v[60:63], a[136:139], v[120:123], v[60:63]
    s_mul_i32 s19, s19, 3072
    ds_read_b64_tr_b16 v[106:107], v168 offset:51200
    v_mfma_f32_16x16x32_bf16 v[64:67], a[140:143], v[120:123], v[64:67]
    s_add_u32 s20, s16, 2
    s_and_b32 s20, s20, 3
    ds_read_b64_tr_b16 v[108:109], v169 offset:49152
    v_mfma_f32_16x16x32_bf16 v[68:71], a[132:135], v[124:127], v[68:71]
    s_mul_i32 s20, s20, 3072
    s_add_u32 s21, s16, 3
    s_and_b32 s21, s21, 3
    buffer_load_dwordx4 a[112:115], v248, s[36:39], s62 offen offset:2048 sc1
    v_mfma_f32_16x16x32_bf16 v[72:75], a[136:139], v[124:127], v[72:75]
    s_mul_i32 s21, s21, 3072
    ds_read_b64_tr_b16 v[110:111], v169 offset:51200
    v_mfma_f32_16x16x32_bf16 v[76:79], a[140:143], v[124:127], v[76:79]
    s_waitcnt lgkmcnt(6)
    s_lshr_b32 s50, s74, 1
    s_lshl_b32 s50, s50, 2
    ds_read_b64_tr_b16 v[112:113], v170 offset:49152
    v_mfma_f32_16x16x32_bf16 v[80:83], a[132:135], v[128:131], v[80:83]
    s_add_u32 s50, s50, s3
    s_lshl_b32 s50, s50, 9
    ds_read_b64_tr_b16 v[114:115], v170 offset:51200
    v_mfma_f32_16x16x32_bf16 v[84:87], a[136:139], v[128:131], v[84:87]
    s_add_u32 s50, s50, 155648
    buffer_load_dwordx4 a[116:119], v248, s[36:39], s62 offen offset:3072 sc1
    v_mfma_f32_16x16x32_bf16 v[88:91], a[140:143], v[128:131], v[88:91]
    s_waitcnt lgkmcnt(6)
    s_add_u32 s62, s62, 4096
    ds_read_b64_tr_b16 v[116:117], v171 offset:49152
    v_min_u32 v246, 3, v1
    v_mfma_f32_16x16x32_bf16 v[92:95], a[132:135], v[132:135], v[92:95]
    s_waitcnt lgkmcnt(3)
    ds_read_b64_tr_b16 v[118:119], v171 offset:51200
    v_lshlrev_b32 v246, 7, v246
    v_mfma_f32_16x16x32_bf16 v[96:99], a[136:139], v[132:135], v[96:99]
    v_cmp_gt_u32 vcc, 64, v252
    s_nop 1
    v_cndmask_b32 v250, v251, v250, vcc
    v_mfma_f32_16x16x32_bf16 v[100:103], a[140:143], v[132:135], v[100:103]
    buffer_load_dwordx4 a[120:123], v248, s[36:39], s62 offen offset:0 sc1
    v_mfma_f32_16x16x32_bf16 v[56:59], a[144:147], v[104:107], v[56:59]
    ds_read_b64_tr_b16 v[120:121], v168 offset:53248
    v_add_u32 v250, v250, v249
    v_mfma_f32_16x16x32_bf16 v[60:63], a[148:151], v[104:107], v[60:63]
    ds_read_b64_tr_b16 v[122:123], v168 offset:55296
    v_add_u32 v251, 202752, v249
    v_mfma_f32_16x16x32_bf16 v[64:67], a[152:155], v[104:107], v[64:67]
    s_mul_i32 s59, s75, 320
    ds_read_b64_tr_b16 v[124:125], v169 offset:53248
    v_lshl_add_u32 v253, v252, 4, s59
    v_mfma_f32_16x16x32_bf16 v[68:71], a[144:147], v[108:111], v[68:71]
    buffer_load_dwordx4 a[124:127], v248, s[36:39], s62 offen offset:1024 sc1
    v_mfma_f32_16x16x32_bf16 v[72:75], a[148:151], v[108:111], v[72:75]
    ds_read_b64_tr_b16 v[126:127], v169 offset:55296
    v_add_u32 v253, 23142912, v253
    v_mfma_f32_16x16x32_bf16 v[76:79], a[152:155], v[108:111], v[76:79]
    s_waitcnt lgkmcnt(6)
    ds_read_b64_tr_b16 v[128:129], v170 offset:53248
    v_add_u32 v246, s50, v246
    v_mfma_f32_16x16x32_bf16 v[80:83], a[144:147], v[112:115], v[80:83]
    ds_read_b64_tr_b16 v[130:131], v170 offset:55296
    v_mfma_f32_16x16x32_bf16 v[84:87], a[148:151], v[112:115], v[84:87]
    buffer_load_dwordx4 a[128:131], v248, s[36:39], s62 offen offset:2048 sc1
    v_mfma_f32_16x16x32_bf16 v[88:91], a[152:155], v[112:115], v[88:91]
    s_waitcnt lgkmcnt(6)
    s_add_u32 s62, s16, 3
    s_and_b32 s62, s62, 3
    ds_read_b64_tr_b16 v[132:133], v171 offset:53248
    v_mfma_f32_16x16x32_bf16 v[92:95], a[144:147], v[116:119], v[92:95]
    s_waitcnt lgkmcnt(3)
    ds_read_b64_tr_b16 v[134:135], v171 offset:55296
    v_mfma_f32_16x16x32_bf16 v[96:99], a[148:151], v[116:119], v[96:99]
    s_mul_i32 s62, s62, 15360
    v_cmp_lt_u32 vcc, 127, v252
    s_nop 1
    v_cndmask_b32 v251, v251, v253, vcc
    v_mfma_f32_16x16x32_bf16 v[100:103], a[152:155], v[116:119], v[100:103]
    s_add_u32 s62, s62, s65
    buffer_load_dwordx4 a[132:135], v248, s[36:39], s62 offen offset:0 sc1
    v_mfma_f32_16x16x32_bf16 v[56:59], a[156:159], v[120:123], v[56:59]
    ds_read_b64_tr_b16 v[104:105], v168 offset:57344
    v_add_u32 v253, 36032, v253
    v_mfma_f32_16x16x32_bf16 v[60:63], a[160:163], v[120:123], v[60:63]
    ds_read_b64_tr_b16 v[106:107], v168 offset:59392
    v_mfma_f32_16x16x32_bf16 v[64:67], a[164:167], v[120:123], v[64:67]
    ds_read_b64_tr_b16 v[108:109], v169 offset:57344
    v_mfma_f32_16x16x32_bf16 v[68:71], a[156:159], v[124:127], v[68:71]
    buffer_load_dwordx4 a[136:139], v248, s[36:39], s62 offen offset:1024 sc1
    v_mfma_f32_16x16x32_bf16 v[72:75], a[160:163], v[124:127], v[72:75]
    ds_read_b64_tr_b16 v[110:111], v169 offset:59392
    v_mfma_f32_16x16x32_bf16 v[76:79], a[164:167], v[124:127], v[76:79]
    s_waitcnt lgkmcnt(6)
    ds_read_b64_tr_b16 v[112:113], v170 offset:57344
    v_mfma_f32_16x16x32_bf16 v[80:83], a[156:159], v[128:131], v[80:83]
    ds_read_b64_tr_b16 v[114:115], v170 offset:59392
    v_mfma_f32_16x16x32_bf16 v[84:87], a[160:163], v[128:131], v[84:87]
    buffer_load_dword v244, v246, s[36:39], s17 offen sc1
    v_mfma_f32_16x16x32_bf16 v[88:91], a[164:167], v[128:131], v[88:91]
    s_waitcnt lgkmcnt(6)
    ds_read_b64_tr_b16 v[116:117], v171 offset:57344
    v_mfma_f32_16x16x32_bf16 v[92:95], a[156:159], v[132:135], v[92:95]
    s_waitcnt lgkmcnt(3)
    ds_read_b64_tr_b16 v[118:119], v171 offset:59392
    v_mfma_f32_16x16x32_bf16 v[96:99], a[160:163], v[132:135], v[96:99]
    v_cmp_lt_u32 vcc, 147, v252
    s_nop 1
    v_cndmask_b32 v251, v251, v253, vcc
    v_mfma_f32_16x16x32_bf16 v[100:103], a[164:167], v[132:135], v[100:103]
    buffer_load_dwordx4 a[140:143], v248, s[36:39], s62 offen offset:2048 sc1
    v_mfma_f32_16x16x32_bf16 v[56:59], a[168:171], v[104:107], v[56:59]
    ds_read_b64_tr_b16 v[120:121], v168 offset:61440
    v_mov_b32 v253, 268435456
    v_mfma_f32_16x16x32_bf16 v[60:63], a[172:175], v[104:107], v[60:63]
    ds_read_b64_tr_b16 v[122:123], v168 offset:63488
    v_add_u32 v168, 65536, v168
    v_mfma_f32_16x16x32_bf16 v[64:67], a[176:179], v[104:107], v[64:67]
    ds_read_b64_tr_b16 v[124:125], v169 offset:61440
    v_mfma_f32_16x16x32_bf16 v[68:71], a[168:171], v[108:111], v[68:71]
    buffer_load_dwordx4 a[144:147], v248, s[36:39], s62 offen offset:3072 sc1
    v_mfma_f32_16x16x32_bf16 v[72:75], a[172:175], v[108:111], v[72:75]
    s_add_u32 s62, s62, 4096
    ds_read_b64_tr_b16 v[126:127], v169 offset:63488
    v_add_u32 v169, 65536, v169
    v_mfma_f32_16x16x32_bf16 v[76:79], a[176:179], v[108:111], v[76:79]
    s_waitcnt lgkmcnt(6)
    ds_read_b64_tr_b16 v[128:129], v170 offset:61440
    v_mfma_f32_16x16x32_bf16 v[80:83], a[168:171], v[112:115], v[80:83]
    ds_read_b64_tr_b16 v[130:131], v170 offset:63488
    v_add_u32 v170, 65536, v170
    v_mfma_f32_16x16x32_bf16 v[84:87], a[172:175], v[112:115], v[84:87]
    buffer_load_dwordx4 a[148:151], v248, s[36:39], s62 offen offset:0 sc1
    v_mfma_f32_16x16x32_bf16 v[88:91], a[176:179], v[112:115], v[88:91]
    s_waitcnt lgkmcnt(6)
    ds_read_b64_tr_b16 v[132:133], v171 offset:61440
    v_mfma_f32_16x16x32_bf16 v[92:95], a[168:171], v[116:119], v[92:95]
    s_waitcnt lgkmcnt(3)
    ds_read_b64_tr_b16 v[134:135], v171 offset:63488
    v_add_u32 v171, 65536, v171
    v_mfma_f32_16x16x32_bf16 v[96:99], a[172:175], v[116:119], v[96:99]
    s_add_u32 m0, s63, 73728
    v_cmp_lt_u32 vcc, 167, v252
    s_nop 1
    v_cndmask_b32 v251, v251, v253, vcc
    v_mfma_f32_16x16x32_bf16 v[100:103], a[176:179], v[116:119], v[100:103]
    buffer_load_dwordx4 v248, s[36:39], s6 offen sc1 lds
    v_mfma_f32_16x16x32_bf16 v[56:59], a[180:183], v[120:123], v[56:59]
    ds_read_b64_tr_b16 v[104:105], v168 offset:0
    v_mfma_f32_16x16x32_bf16 v[60:63], a[184:187], v[120:123], v[60:63]
    ds_read_b64_tr_b16 v[106:107], v168 offset:2048
    v_mfma_f32_16x16x32_bf16 v[64:67], a[188:191], v[120:123], v[64:67]
    s_add_u32 m0, s63, 61440
    ds_read_b64_tr_b16 v[108:109], v169 offset:0
    v_mfma_f32_16x16x32_bf16 v[68:71], a[180:183], v[124:127], v[68:71]
    buffer_load_dwordx4 v249, s[36:39], 0 offen offset:0 sc1 lds
    v_mfma_f32_16x16x32_bf16 v[72:75], a[184:187], v[124:127], v[72:75]
    ds_read_b64_tr_b16 v[110:111], v169 offset:2048
    v_mfma_f32_16x16x32_bf16 v[76:79], a[188:191], v[124:127], v[76:79]
    s_waitcnt lgkmcnt(6)
    ds_read_b64_tr_b16 v[112:113], v170 offset:0
    v_mfma_f32_16x16x32_bf16 v[80:83], a[180:183], v[128:131], v[80:83]
    s_add_u32 m0, s63, 64512
    ds_read_b64_tr_b16 v[114:115], v170 offset:2048
    s_waitcnt vmcnt(5)
    v_cmp_ne_u32 vcc, s48, v244
    s_cbranch_vccnz L_chk22_slow
L_chk22_back:
    v_mfma_f32_16x16x32_bf16 v[84:87], a[184:187], v[128:131], v[84:87]
    buffer_load_dwordx4 v250, s[36:39], 0 offen offset:1024 sc1 lds
    v_mfma_f32_16x16x32_bf16 v[88:91], a[188:191], v[128:131], v[88:91]
    s_waitcnt lgkmcnt(6)
    ds_read_b64_tr_b16 v[116:117], v171 offset:0
    v_mfma_f32_16x16x32_bf16 v[92:95], a[180:183], v[132:135], v[92:95]
    s_waitcnt lgkmcnt(3)
    ds_read_b64_tr_b16 v[118:119], v171 offset:2048
    v_mfma_f32_16x16x32_bf16 v[96:99], a[184:187], v[132:135], v[96:99]
    s_add_u32 m0, s63, 67584
    v_mfma_f32_16x16x32_bf16 v[100:103], a[188:191], v[132:135], v[100:103]
    buffer_load_dwordx4 v251, s[36:39], 0 offen offset:2048 sc1 lds
    v_mfma_f32_16x16x32_bf16 v[56:59], a[192:195], v[104:107], v[56:59]
    ds_read_b64_tr_b16 v[120:121], v168 offset:4096
    v_mfma_f32_16x16x32_bf16 v[60:63], a[196:199], v[104:107], v[60:63]
    ds_read_b64_tr_b16 v[122:123], v168 offset:6144
    v_mfma_f32_16x16x32_bf16 v[64:67], a[200:203], v[104:107], v[64:67]
    ds_read_b64_tr_b16 v[124:125], v169 offset:4096
    v_mfma_f32_16x16x32_bf16 v[68:71], a[192:195], v[108:111], v[68:71]
    buffer_load_dwordx4 v[8:11], v216, s[36:39], s18 offen offset:0 sc1
    v_mfma_f32_16x16x32_bf16 v[72:75], a[196:199], v[108:111], v[72:75]
    ds_read_b64_tr_b16 v[126:127], v169 offset:6144
    v_mfma_f32_16x16x32_bf16 v[76:79], a[200:203], v[108:111], v[76:79]
    s_waitcnt lgkmcnt(6)
    ds_read_b64_tr_b16 v[128:129], v170 offset:4096
    v_mfma_f32_16x16x32_bf16 v[80:83], a[192:195], v[112:115], v[80:83]
    ds_read_b64_tr_b16 v[130:131], v170 offset:6144
    v_mfma_f32_16x16x32_bf16 v[84:87], a[196:199], v[112:115], v[84:87]
    buffer_load_dwordx4 v[12:15], v216, s[36:39], s18 offen offset:1024 sc1
    v_mfma_f32_16x16x32_bf16 v[88:91], a[200:203], v[112:115], v[88:91]
    s_waitcnt lgkmcnt(6)
    ds_read_b64_tr_b16 v[132:133], v171 offset:4096
    v_mfma_f32_16x16x32_bf16 v[92:95], a[192:195], v[116:119], v[92:95]
    s_waitcnt lgkmcnt(3)
    ds_read_b64_tr_b16 v[134:135], v171 offset:6144
    v_mfma_f32_16x16x32_bf16 v[96:99], a[196:199], v[116:119], v[96:99]
    v_mfma_f32_16x16x32_bf16 v[100:103], a[200:203], v[116:119], v[100:103]
    buffer_load_dwordx4 v[16:19], v216, s[36:39], s18 offen offset:2048 sc1
    v_mfma_f32_16x16x32_bf16 v[56:59], a[204:207], v[120:123], v[56:59]
    ds_read_b64_tr_b16 v[104:105], v168 offset:8192
    v_mfma_f32_16x16x32_bf16 v[60:63], a[208:211], v[120:123], v[60:63]
    ds_read_b64_tr_b16 v[106:107], v168 offset:10240
    v_mfma_f32_16x16x32_bf16 v[64:67], a[212:215], v[120:123], v[64:67]
    ds_read_b64_tr_b16 v[108:109], v169 offset:8192
    v_mfma_f32_16x16x32_bf16 v[68:71], a[204:207], v[124:127], v[68:71]
    buffer_load_dwordx4 v[20:23], v216, s[36:39], s19 offen offset:0 sc1
    v_mfma_f32_16x16x32_bf16 v[72:75], a[208:211], v[124:127], v[72:75]
    ds_read_b64_tr_b16 v[110:111], v169 offset:10240
    v_mfma_f32_16x16x32_bf16 v[76:79], a[212:215], v[124:127], v[76:79]
    s_waitcnt lgkmcnt(6)
    ds_read_b64_tr_b16 v[112:113], v170 offset:8192
    v_mfma_f32_16x16x32_bf16 v[80:83], a[204:207], v[128:131], v[80:83]
    ds_read_b64_tr_b16 v[114:115], v170 offset:10240
    v_mfma_f32_16x16x32_bf16 v[84:87], a[208:211], v[128:131], v[84:87]
    buffer_load_dwordx4 v[24:27], v216, s[36:39], s19 offen offset:1024 sc1
    v_mfma_f32_16x16x32_bf16 v[88:91], a[212:215], v[128:131], v[88:91]
    s_waitcnt lgkmcnt(6)
    ds_read_b64_tr_b16 v[116:117], v171 offset:8192
    v_mfma_f32_16x16x32_bf16 v[92:95], a[204:207], v[132:135], v[92:95]
    s_waitcnt lgkmcnt(3)
    ds_read_b64_tr_b16 v[118:119], v171 offset:10240
    v_mfma_f32_16x16x32_bf16 v[96:99], a[208:211], v[132:135], v[96:99]
    v_mfma_f32_16x16x32_bf16 v[100:103], a[212:215], v[132:135], v[100:103]
    buffer_load_dwordx4 v[28:31], v216, s[36:39], s19 offen offset:2048 sc1
    v_mfma_f32_16x16x32_bf16 v[56:59], a[216:219], v[104:107], v[56:59]
    ds_read_b64_tr_b16 v[120:121], v168 offset:12288
    v_mfma_f32_16x16x32_bf16 v[60:63], a[220:223], v[104:107], v[60:63]
    ds_read_b64_tr_b16 v[122:123], v168 offset:14336
    v_mfma_f32_16x16x32_bf16 v[64:67], a[224:227], v[104:107], v[64:67]
    ds_read_b64_tr_b16 v[124:125], v169 offset:12288
    v_mfma_f32_16x16x32_bf16 v[68:71], a[216:219], v[108:111], v[68:71]
    buffer_load_dwordx4 a[152:155], v248, s[36:39], s62 offen offset:1024 sc1
    v_mfma_f32_16x16x32_bf16 v[72:75], a[220:223], v[108:111], v[72:75]
    s_waitcnt vmcnt(10)
    ds_read_b64_tr_b16 v[126:127], v169 offset:14336
    ds_read_b128 v[200:203], v223 offset:0
    v_mfma_f32_16x16x32_bf16 v[76:79], a[224:227], v[108:111], v[76:79]
    s_waitcnt lgkmcnt(7)
    ds_read_b64_tr_b16 v[128:129], v170 offset:12288
    ds_read_b128 v[204:207], v223 offset:256
    v_mfma_f32_16x16x32_bf16 v[80:83], a[216:219], v[112:115], v[80:83]
    ds_read_b64_tr_b16 v[130:131], v170 offset:14336
    ds_read_b128 v[208:211], v223 offset:512
    v_mfma_f32_16x16x32_bf16 v[84:87], a[220:223], v[112:115], v[84:87]
    buffer_load_dwordx4 a[156:159], v248, s[36:39], s62 offen offset:2048 sc1
    v_mfma_f32_16x16x32_bf16 v[88:91], a[224:227], v[112:115], v[88:91]
    s_waitcnt lgkmcnt(9)
    ds_read_b64_tr_b16 v[132:133], v171 offset:12288
    ds_read_b128 v[212:215], v223 offset:768
    v_mfma_f32_16x16x32_bf16 v[92:95], a[216:219], v[116:119], v[92:95]
    s_waitcnt lgkmcnt(3)
    ds_read_b64_tr_b16 v[134:135], v171 offset:14336
    v_mfma_f32_16x16x32_bf16 v[96:99], a[220:223], v[116:119], v[96:99]
    v_mfma_f32_16x16x32_bf16 v[100:103], a[224:227], v[116:119], v[100:103]
    buffer_load_dwordx4 a[160:163], v248, s[36:39], s62 offen offset:3072 sc1
    v_mfma_f32_16x16x32_bf16 v[56:59], a[228:231], v[120:123], v[56:59]
    s_add_u32 s62, s62, 4096
    v_xor_b32 v3, s48, v201
    v_bitop3_b32 v3, v203, s48, v3 bitop3:0xbe
    v_mfma_f32_16x16x32_bf16 v[60:63], a[232:235], v[120:123], v[60:63]
    v_bitop3_b32 v3, v205, s48, v3 bitop3:0xbe
    v_bitop3_b32 v3, v207, s48, v3 bitop3:0xbe
    v_mfma_f32_16x16x32_bf16 v[64:67], a[236:239], v[120:123], v[64:67]
    s_waitcnt lgkmcnt(3)
    v_bitop3_b32 v3, v209, s48, v3 bitop3:0xbe
    v_bitop3_b32 v3, v211, s48, v3 bitop3:0xbe
    v_mfma_f32_16x16x32_bf16 v[68:71], a[228:231], v[124:127], v[68:71]
    buffer_load_dwordx4 a[164:167], v248, s[36:39], s62 offen offset:0 sc1
    v_mfma_f32_16x16x32_bf16 v[72:75], a[232:235], v[124:127], v[72:75]
    s_waitcnt lgkmcnt(1)
    v_bitop3_b32 v3, v213, s48, v3 bitop3:0xbe
    v_bitop3_b32 v3, v215, s48, v3 bitop3:0xbe
    v_mfma_f32_16x16x32_bf16 v[76:79], a[236:239], v[124:127], v[76:79]
    v_cmp_ne_u32 vcc, 0, v3
    s_cbranch_vccnz L_st1_slow
L_st1_back:
    v_mfma_f32_16x16x32_bf16 v[80:83], a[228:231], v[128:131], v[80:83]
    v_mfma_f32_16x16x32_bf16 v[84:87], a[232:235], v[128:131], v[84:87]
    buffer_load_dwordx4 a[168:171], v248, s[36:39], s62 offen offset:1024 sc1
    v_mfma_f32_16x16x32_bf16 v[88:91], a[236:239], v[128:131], v[88:91]
    s_waitcnt lgkmcnt(0)
    v_mfma_f32_16x16x32_bf16 v[92:95], a[228:231], v[132:135], v[92:95]
    v_mfma_f32_16x16x32_bf16 v[96:99], a[232:235], v[132:135], v[96:99]
    v_mfma_f32_16x16x32_bf16 v[100:103], a[236:239], v[132:135], v[100:103]
L_g1done:
    s_add_u32 s8, s8, 3293184
    s_add_u32 s50, s8, 102912
    v_pk_fma_f32 v[238:239], v[176:177], v[202:203], v[188:189] op_sel_hi:[1,0,1]
    v_pk_fma_f32 v[240:241], v[178:179], v[202:203], v[190:191] op_sel_hi:[1,0,1]
    v_pk_fma_f32 v[56:57], v[56:57], v[200:201], v[238:239] op_sel_hi:[1,0,1]
    v_pk_fma_f32 v[58:59], v[58:59], v[200:201], v[240:241] op_sel_hi:[1,0,1]
    v_pk_fma_f32 v[242:243], v[180:181], v[202:203], v[192:193] op_sel_hi:[1,0,1]
    v_pk_fma_f32 v[244:245], v[182:183], v[202:203], v[194:195] op_sel_hi:[1,0,1]
    v_pk_fma_f32 v[60:61], v[60:61], v[200:201], v[242:243] op_sel_hi:[1,0,1]
    v_pk_fma_f32 v[62:63], v[62:63], v[200:201], v[244:245] op_sel_hi:[1,0,1]
    buffer_load_dwordx4 v[32:35], v216, s[36:39], s20 offen offset:0 sc1
    v_pk_mul_f32 v[56:57], v[56:57], v[60:61]
    v_pk_mul_f32 v[58:59], v[58:59], v[62:63]
    v_cvt_pk_bf16_f32 v60, v56, v57
    v_cvt_pk_bf16_f32 v61, v58, v59
    v_pk_fma_f32 v[242:243], v[176:177], v[206:207], v[188:189] op_sel_hi:[1,0,1]
    v_pk_fma_f32 v[244:245], v[178:179], v[206:207], v[190:191] op_sel_hi:[1,0,1]
    v_pk_fma_f32 v[68:69], v[68:69], v[204:205], v[242:243] op_sel_hi:[1,0,1]
    v_pk_fma_f32 v[70:71], v[70:71], v[204:205], v[244:245] op_sel_hi:[1,0,1]
    v_pk_fma_f32 v[238:239], v[180:181], v[206:207], v[192:193] op_sel_hi:[1,0,1]
    v_pk_fma_f32 v[240:241], v[182:183], v[206:207], v[194:195] op_sel_hi:[1,0,1]
    buffer_load_dwordx4 v[36:39], v216, s[36:39], s20 offen offset:1024 sc1
    v_pk_fma_f32 v[72:73], v[72:73], v[204:205], v[238:239] op_sel_hi:[1,0,1]
    v_pk_fma_f32 v[74:75], v[74:75], v[204:205], v[240:241] op_sel_hi:[1,0,1]
    v_pk_mul_f32 v[68:69], v[68:69], v[72:73]
    v_pk_mul_f32 v[70:71], v[70:71], v[74:75]
    v_cvt_pk_bf16_f32 v62, v68, v69
    v_cvt_pk_bf16_f32 v63, v70, v71
    s_nop 0
    v_permlane16_swap_b32 v60, v62
    v_permlane16_swap_b32 v61, v63
    buffer_store_dwordx4 v[60:63], v173, s[36:39], s8 offen sc1
    v_pk_fma_f32 v[238:239], v[176:177], v[210:211], v[188:189] op_sel_hi:[1,0,1]
    buffer_load_dwordx4 v[40:43], v216, s[36:39], s20 offen offset:2048 sc1
    v_pk_fma_f32 v[240:241], v[178:179], v[210:211], v[190:191] op_sel_hi:[1,0,1]
    v_pk_fma_f32 v[80:81], v[80:81], v[208:209], v[238:239] op_sel_hi:[1,0,1]
    v_pk_fma_f32 v[82:83], v[82:83], v[208:209], v[240:241] op_sel_hi:[1,0,1]
    v_pk_fma_f32 v[242:243], v[180:181], v[210:211], v[192:193] op_sel_hi:[1,0,1]
    v_pk_fma_f32 v[244:245], v[182:183], v[210:211], v[194:195] op_sel_hi:[1,0,1]
    v_pk_fma_f32 v[84:85], v[84:85], v[208:209], v[242:243] op_sel_hi:[1,0,1]
    v_pk_fma_f32 v[86:87], v[86:87], v[208:209], v[244:245] op_sel_hi:[1,0,1]
    v_pk_mul_f32 v[80:81], v[80:81], v[84:85]
    v_pk_mul_f32 v[82:83], v[82:83], v[86:87]
    v_cvt_pk_bf16_f32 v84, v80, v81
    buffer_load_dwordx4 v[44:47], v216, s[36:39], s21 offen offset:0 sc1
    v_cvt_pk_bf16_f32 v85, v82, v83
    v_pk_fma_f32 v[242:243], v[176:177], v[214:215], v[188:189] op_sel_hi:[1,0,1]
    v_pk_fma_f32 v[244:245], v[178:179], v[214:215], v[190:191] op_sel_hi:[1,0,1]
    v_pk_fma_f32 v[92:93], v[92:93], v[212:213], v[242:243] op_sel_hi:[1,0,1]
    v_pk_fma_f32 v[94:95], v[94:95], v[212:213], v[244:245] op_sel_hi:[1,0,1]
    v_pk_fma_f32 v[238:239], v[180:181], v[214:215], v[192:193] op_sel_hi:[1,0,1]
    v_pk_fma_f32 v[240:241], v[182:183], v[214:215], v[194:195] op_sel_hi:[1,0,1]
    v_pk_fma_f32 v[96:97], v[96:97], v[212:213], v[238:239] op_sel_hi:[1,0,1]
    v_pk_fma_f32 v[98:99], v[98:99], v[212:213], v[240:241] op_sel_hi:[1,0,1]
    v_pk_mul_f32 v[92:93], v[92:93], v[96:97]
    buffer_load_dwordx4 v[48:51], v216, s[36:39], s21 offen offset:1024 sc1
    v_pk_mul_f32 v[94:95], v[94:95], v[98:99]
    v_cvt_pk_bf16_f32 v86, v92, v93
    v_cvt_pk_bf16_f32 v87, v94, v95
    s_nop 0
    v_permlane16_swap_b32 v84, v86
    v_permlane16_swap_b32 v85, v87
    buffer_store_dwordx4 v[84:87], v173, s[36:39], s50 offen sc1
    v_pk_fma_f32 v[238:239], v[184:185], v[202:203], v[196:197] op_sel_hi:[1,0,1]
    v_pk_fma_f32 v[240:241], v[186:187], v[202:203], v[198:199] op_sel_hi:[1,0,1]
    v_pk_fma_f32 v[64:65], v[64:65], v[200:201], v[238:239] op_sel_hi:[1,0,1]
    v_pk_fma_f32 v[66:67], v[66:67], v[200:201], v[240:241] op_sel_hi:[1,0,1]
    buffer_load_dwordx4 v[52:55], v216, s[36:39], s21 offen offset:2048 sc1
    v_pk_fma_f32 v[242:243], v[184:185], v[206:207], v[196:197] op_sel_hi:[1,0,1]
    v_pk_fma_f32 v[244:245], v[186:187], v[206:207], v[198:199] op_sel_hi:[1,0,1]
    v_pk_fma_f32 v[76:77], v[76:77], v[204:205], v[242:243] op_sel_hi:[1,0,1]
    v_pk_fma_f32 v[78:79], v[78:79], v[204:205], v[244:245] op_sel_hi:[1,0,1]
    s_nop 0
    v_permlane32_swap_b32 v64, v76
    v_permlane32_swap_b32 v65, v77
    v_permlane32_swap_b32 v66, v78
    v_permlane32_swap_b32 v67, v79
    v_pk_mul_f32 v[64:65], v[64:65], v[76:77]
    v_pk_mul_f32 v[66:67], v[66:67], v[78:79]
    v_cvt_pk_bf16_f32 v56, v64, v65
    v_cvt_pk_bf16_f32 v57, v66, v67
    v_pk_fma_f32 v[238:239], v[184:185], v[210:211], v[196:197] op_sel_hi:[1,0,1]
    v_pk_fma_f32 v[240:241], v[186:187], v[210:211], v[198:199] op_sel_hi:[1,0,1]
    v_pk_fma_f32 v[88:89], v[88:89], v[208:209], v[238:239] op_sel_hi:[1,0,1]
    v_pk_fma_f32 v[90:91], v[90:91], v[208:209], v[240:241] op_sel_hi:[1,0,1]
    v_pk_fma_f32 v[242:243], v[184:185], v[214:215], v[196:197] op_sel_hi:[1,0,1]
    v_pk_fma_f32 v[244:245], v[186:187], v[214:215], v[198:199] op_sel_hi:[1,0,1]
    v_pk_fma_f32 v[100:101], v[100:101], v[212:213], v[242:243] op_sel_hi:[1,0,1]
    v_pk_fma_f32 v[102:103], v[102:103], v[212:213], v[244:245] op_sel_hi:[1,0,1]
    s_nop 0
    v_permlane32_swap_b32 v88, v100
    v_permlane32_swap_b32 v89, v101
    v_permlane32_swap_b32 v90, v102
    v_permlane32_swap_b32 v91, v103
    v_pk_mul_f32 v[88:89], v[88:89], v[100:101]
    v_pk_mul_f32 v[90:91], v[90:91], v[102:103]
    v_cvt_pk_bf16_f32 v58, v88, v89
    v_cvt_pk_bf16_f32 v59, v90, v91
    s_nop 0
    v_permlane16_swap_b32 v56, v58
    v_permlane16_swap_b32 v57, v59
    buffer_store_dwordx4 v[56:59], v174, s[36:39], s8 offen offset:512 sc1
    s_mov_b32 s40, s28
    s_mov_b32 s41, s29
    s_mov_b32 s42, 0x280000
    s_mov_b32 s43, 0x20000
    s_waitcnt vmcnt(19)
    v_mfma_f32_16x16x32_bf16 v[72:75], a[240:243], v[8:11], 0
    buffer_load_dwordx4 a[172:175], v248, s[36:39], s62 offen offset:2048 sc1
    v_mfma_f32_16x16x32_bf16 v[76:79], a[244:247], v[8:11], 0
    s_and_b32 s50, s3, 1
    s_lshr_b32 s51, s3, 1
    v_mfma_f32_16x16x32_bf16 v[80:83], a[248:251], v[8:11], 0
    s_mul_i32 s52, s50, 20480
    s_mul_i32 s53, s3, 5120
    v_add_u32 v223, s53, v248
    v_mfma_f32_16x16x32_bf16 v[84:87], a[252:255], v[8:11], 0
    v_add_u32 v220, s52, v223
    v_add_u32 v222, 40960, v223
    v_mfma_f32_16x16x32_bf16 v[88:91], v[136:139], v[8:11], 0
    s_waitcnt vmcnt(19)
    buffer_load_dwordx4 a[176:179], v248, s[36:39], s62 offen offset:3072 sc1
    v_mfma_f32_16x16x32_bf16 v[72:75], v[140:143], v[12:15], v[72:75]
    s_add_u32 s62, s62, 4096
    s_xor_b32 s52, s50, 1
    s_mul_i32 s52, s52, 20480
    v_mfma_f32_16x16x32_bf16 v[76:79], v[144:147], v[12:15], v[76:79]
    v_add_u32 v221, s52, v223
    v_mfma_f32_16x16x32_bf16 v[80:83], v[148:151], v[12:15], v[80:83]
    s_lshl_b32 s53, s50, 11
    v_add_u32 v226, s53, v248
    v_mfma_f32_16x16x32_bf16 v[84:87], v[152:155], v[12:15], v[84:87]
    buffer_load_dwordx4 a[180:183], v248, s[36:39], s62 offen offset:0 sc1
    v_mfma_f32_16x16x32_bf16 v[88:91], v[156:159], v[12:15], v[88:91]
    s_waitcnt vmcnt(20)
    s_mul_i32 s52, s51, 20480
    v_add_u32 v224, s52, v226
    v_mfma_f32_16x16x32_bf16 v[72:75], v[160:163], v[16:19], v[72:75]
    s_waitcnt lgkmcnt(0)
    s_barrier
    v_mfma_f32_16x16x32_bf16 v[76:79], v[164:167], v[16:19], v[76:79]
    s_mul_i32 s53, s51, 5120
    s_add_u32 s53, s53, 40960
    v_add_u32 v225, s53, v226
    v_mfma_f32_16x16x32_bf16 v[80:83], a[0:3], v[16:19], v[80:83]
    buffer_load_dwordx4 a[184:187], v248, s[36:39], s62 offen offset:1024 sc1
    v_mfma_f32_16x16x32_bf16 v[84:87], a[4:7], v[16:19], v[84:87]
    s_xor_b32 s53, s51, 1
    s_mul_i32 s53, s53, 5120
    v_add_u32 v226, s53, v226
    v_mfma_f32_16x16x32_bf16 v[88:91], a[8:11], v[16:19], v[88:91]
    s_waitcnt vmcnt(20)
    s_lshl_b32 s52, s74, 1
    s_add_u32 s52, s52, s51
    v_mfma_f32_16x16x32_bf16 v[72:75], a[12:15], v[20:23], v[72:75]
    s_mul_i32 s13, s52, 20480
    s_mul_i32 s53, s75, 160
    v_mfma_f32_16x16x32_bf16 v[76:79], a[16:19], v[20:23], v[76:79]
    buffer_load_dwordx4 a[188:191], v248, s[36:39], s62 offen offset:2048 sc1
    v_mfma_f32_16x16x32_bf16 v[80:83], a[20:23], v[20:23], v[80:83]
    s_add_u32 s13, s13, s53
    s_lshl_b32 s53, s50, 6
    v_mfma_f32_16x16x32_bf16 v[84:87], a[24:27], v[20:23], v[84:87]
    s_add_u32 s13, s13, s53
    s_add_u32 s14, s13, 1310720
    v_lshrrev_b32 v244, 2, v1
    v_mfma_f32_16x16x32_bf16 v[88:91], a[28:31], v[20:23], v[88:91]
    s_waitcnt vmcnt(20)
    v_lshlrev_b32 v244, 6, v244
    v_and_b32 v2, 3, v1
    v_mfma_f32_16x16x32_bf16 v[72:75], a[32:35], v[24:27], v[72:75]
    buffer_load_dwordx4 v[104:107], v217, s[36:39], s18 offen offset:0 sc1
    v_mfma_f32_16x16x32_bf16 v[76:79], a[36:39], v[24:27], v[76:79]
    v_lshl_add_u32 v244, v2, 3, v244
    v_mfma_f32_16x16x32_bf16 v[80:83], a[40:43], v[24:27], v[80:83]
    s_lshl_b32 s52, s50, 11
    s_lshl_b32 s53, s51, 5
    v_mfma_f32_16x16x32_bf16 v[84:87], a[44:47], v[24:27], v[84:87]
    s_add_u32 s52, s52, s53
    s_add_u32 s52, s52, 61440
    v_add_u32 v244, s52, v244
    v_mfma_f32_16x16x32_bf16 v[88:91], a[48:51], v[24:27], v[88:91]
    s_waitcnt vmcnt(20)
    buffer_load_dwordx4 v[108:111], v217, s[36:39], s18 offen offset:1024 sc1
    v_mfma_f32_16x16x32_bf16 v[72:75], a[52:55], v[28:31], v[72:75]
    v_and_b32 v245, 48, v1
    v_mfma_f32_16x16x32_bf16 v[76:79], a[56:59], v[28:31], v[76:79]
    s_lshl_b32 s52, s50, 7
    s_add_u32 s52, s52, 71680
    v_add_u32 v245, s52, v245
    v_mfma_f32_16x16x32_bf16 v[80:83], a[60:63], v[28:31], v[80:83]
    v_and_b32 v2, 15, v1
    v_lshrrev_b32 v3, 4, v1
    v_mfma_f32_16x16x32_bf16 v[84:87], a[64:67], v[28:31], v[84:87]
    buffer_load_dwordx4 v[112:115], v217, s[36:39], s18 offen offset:2048 sc1
    v_mfma_f32_16x16x32_bf16 v[88:91], a[68:71], v[28:31], v[88:91]
    s_waitcnt vmcnt(16)
    v_mul_u32_u24 v2, 1280, v2
    v_and_b32 v227, 1, v3
    v_mfma_f32_16x16x32_bf16 v[72:75], a[72:75], v[32:35], v[72:75]
    v_lshl_add_u32 v227, v227, 5, v2
    v_lshl_add_u32 v2, v3, 3, v2
    v_mfma_f32_16x16x32_bf16 v[76:79], a[76:79], v[32:35], v[76:79]
    v_lshrrev_b32 v3, 1, v3
    v_lshl_add_u32 v227, v3, 4, v227
    v_mfma_f32_16x16x32_bf16 v[80:83], a[80:83], v[32:35], v[80:83]
    buffer_load_dwordx4 v[116:119], v217, s[36:39], s19 offen offset:0 sc1
    v_mfma_f32_16x16x32_bf16 v[84:87], a[84:87], v[32:35], v[84:87]
    s_lshr_b32 s50, s74, 1
    s_lshl_b32 s50, s50, 2
    v_mfma_f32_16x16x32_bf16 v[88:91], a[88:91], v[32:35], v[88:91]
    s_waitcnt vmcnt(16)
    s_add_u32 s50, s50, s3
    s_lshl_b32 s50, s50, 9
    s_add_u32 s50, s50, 188416
    v_mfma_f32_16x16x32_bf16 v[72:75], a[92:95], v[36:39], v[72:75]
    v_min_u32 v246, 3, v1
    v_lshlrev_b32 v246, 7, v246
    v_mfma_f32_16x16x32_bf16 v[76:79], a[96:99], v[36:39], v[76:79]
    buffer_load_dwordx4 v[120:123], v217, s[36:39], s19 offen offset:1024 sc1
    v_mfma_f32_16x16x32_bf16 v[80:83], a[100:103], v[36:39], v[80:83]
    v_add_u32 v246, s50, v246
    v_mfma_f32_16x16x32_bf16 v[84:87], a[104:107], v[36:39], v[84:87]
    ds_read_b128 v[92:95], v245 offset:0
    v_mfma_f32_16x16x32_bf16 v[88:91], a[108:111], v[36:39], v[88:91]
    s_waitcnt vmcnt(15)
    ds_read_b128 v[96:99], v245 offset:64
    v_mfma_f32_16x16x32_bf16 v[72:75], a[112:115], v[40:43], v[72:75]
    s_waitcnt vmcnt(10)
    s_barrier
    s_cmp_eq_u32 s3, 0
    s_cbranch_scc0 L_wf23
    s_lshl_b32 s54, s76, 7
    s_add_u32 s54, s54, 23388160
    v_mov_b32 v249, 0
    v_mov_b32 v250, s48
    s_mov_b64 exec, 1
    buffer_store_dword v250, v249, s[36:39], s54 offen sc1
    s_mov_b64 exec, -1
L_wf23:
    buffer_load_dwordx4 v[124:127], v217, s[36:39], s19 offen offset:2048 sc1
    v_mfma_f32_16x16x32_bf16 v[76:79], a[116:119], v[40:43], v[76:79]
    ds_read_b128 v[100:103], v245 offset:128
    v_mfma_f32_16x16x32_bf16 v[80:83], a[120:123], v[40:43], v[80:83]
    ds_read_b128 v[232:235], v245 offset:320
    v_mfma_f32_16x16x32_bf16 v[84:87], a[124:127], v[40:43], v[84:87]
    ds_read_b128 v[236:239], v245 offset:384
    v_mfma_f32_16x16x32_bf16 v[88:91], a[128:131], v[40:43], v[88:91]
    buffer_load_dwordx4 v[128:131], v217, s[36:39], s20 offen offset:0 sc1
    v_mfma_f32_16x16x32_bf16 v[72:75], a[132:135], v[44:47], v[72:75]
    ds_read_b128 v[240:243], v245 offset:448
    v_mfma_f32_16x16x32_bf16 v[76:79], a[136:139], v[44:47], v[76:79]
    ds_read_b64_tr_b16 v[212:213], v244 offset:0
    v_mfma_f32_16x16x32_bf16 v[80:83], a[140:143], v[44:47], v[80:83]
    ds_read_b64_tr_b16 v[214:215], v244 offset:5120
    v_mfma_f32_16x16x32_bf16 v[84:87], a[144:147], v[44:47], v[84:87]
    buffer_load_dwordx4 v[132:135], v217, s[36:39], s20 offen offset:1024 sc1
    v_mfma_f32_16x16x32_bf16 v[88:91], a[148:151], v[44:47], v[88:91]
    ds_read_b64_tr_b16 v[252:253], v244 offset:1024
    v_mfma_f32_16x16x32_bf16 v[72:75], a[152:155], v[48:51], v[72:75]
    ds_read_b64_tr_b16 v[254:255], v244 offset:6144
    v_mfma_f32_16x16x32_bf16 v[76:79], a[156:159], v[48:51], v[76:79]
    ds_read_b64_tr_b16 v[228:229], v244 offset:2048
    v_mfma_f32_16x16x32_bf16 v[80:83], a[160:163], v[48:51], v[80:83]
    buffer_load_dwordx4 v[56:59], v217, s[36:39], s20 offen offset:2048 sc1
    v_mfma_f32_16x16x32_bf16 v[84:87], a[164:167], v[48:51], v[84:87]
    ds_read_b64_tr_b16 v[230:231], v244 offset:7168
    s_waitcnt lgkmcnt(5)
    v_lshlrev_b32 v188, 16, v212
    v_mfma_f32_16x16x32_bf16 v[88:91], a[168:171], v[48:51], v[88:91]
    s_waitcnt vmcnt(13)
    v_and_b32 v189, 0xffff0000, v212
    v_lshlrev_b32 v190, 16, v213
    v_mfma_f32_16x16x32_bf16 v[72:75], a[172:175], v[52:55], v[72:75]
    s_waitcnt vmcnt(12)
    v_and_b32 v191, 0xffff0000, v213
    v_mul_f32 v188, v188, v232
    v_mfma_f32_16x16x32_bf16 v[76:79], a[176:179], v[52:55], v[76:79]
    s_waitcnt vmcnt(11)
    buffer_load_dwordx4 v[60:63], v217, s[36:39], s21 offen offset:0 sc1
    v_mfma_f32_16x16x32_bf16 v[80:83], a[180:183], v[52:55], v[80:83]
    s_waitcnt vmcnt(11)
    v_mul_f32 v189, v189, v233
    v_mul_f32 v190, v190, v234
    v_mfma_f32_16x16x32_bf16 v[84:87], a[184:187], v[52:55], v[84:87]
    v_mul_f32 v191, v191, v235
    s_waitcnt lgkmcnt(4)
    v_lshlrev_b32 v200, 16, v214
    s_waitcnt vmcnt(10)
    v_mfma_f32_16x16x32_bf16 v[88:91], a[188:191], v[52:55], v[88:91]
    s_waitcnt vmcnt(9)
    v_and_b32 v201, 0xffff0000, v214
    v_lshlrev_b32 v202, 16, v215
    v_mfma_f32_16x16x32_bf16 v[168:171], a[240:243], v[104:107], 0
    buffer_load_dwordx4 v[64:67], v217, s[36:39], s21 offen offset:1024 sc1
    v_mfma_f32_16x16x32_bf16 v[172:175], a[244:247], v[104:107], 0
    v_and_b32 v203, 0xffff0000, v215
    v_mul_f32 v200, v200, v232
    v_mfma_f32_16x16x32_bf16 v[176:179], a[248:251], v[104:107], 0
    v_mul_f32 v201, v201, v233
    v_mul_f32 v202, v202, v234
    v_mfma_f32_16x16x32_bf16 v[180:183], a[252:255], v[104:107], 0
    v_mul_f32 v203, v203, v235
    s_waitcnt lgkmcnt(3)
    v_lshlrev_b32 v192, 16, v252
    v_mfma_f32_16x16x32_bf16 v[184:187], v[136:139], v[104:107], 0
    s_waitcnt vmcnt(9)
    buffer_load_dwordx4 v[68:71], v217, s[36:39], s21 offen offset:2048 sc1
    v_mfma_f32_16x16x32_bf16 v[168:171], v[140:143], v[108:111], v[168:171]
    v_and_b32 v193, 0xffff0000, v252
    v_lshlrev_b32 v194, 16, v253
    v_mfma_f32_16x16x32_bf16 v[172:175], v[144:147], v[108:111], v[172:175]
    v_and_b32 v195, 0xffff0000, v253
    v_mul_f32 v192, v192, v236
    v_mfma_f32_16x16x32_bf16 v[176:179], v[148:151], v[108:111], v[176:179]
    v_mul_f32 v193, v193, v237
    v_mul_f32 v194, v194, v238
    v_mfma_f32_16x16x32_bf16 v[180:183], v[152:155], v[108:111], v[180:183]
    v_mul_f32 v195, v195, v239
    s_waitcnt lgkmcnt(2)
    v_lshlrev_b32 v204, 16, v254
    v_mfma_f32_16x16x32_bf16 v[184:187], v[156:159], v[108:111], v[184:187]
    s_waitcnt vmcnt(9)
    v_and_b32 v205, 0xffff0000, v254
    v_lshlrev_b32 v206, 16, v255
    v_mfma_f32_16x16x32_bf16 v[168:171], v[160:163], v[112:115], v[168:171]
    v_and_b32 v207, 0xffff0000, v255
    v_mul_f32 v204, v204, v236
    v_mfma_f32_16x16x32_bf16 v[172:175], v[164:167], v[112:115], v[172:175]
    v_mul_f32 v205, v205, v237
    v_mul_f32 v206, v206, v238
    v_mfma_f32_16x16x32_bf16 v[176:179], a[0:3], v[112:115], v[176:179]
    v_mul_f32 v207, v207, v239
    s_waitcnt lgkmcnt(1)
    v_lshlrev_b32 v196, 16, v228
    v_mfma_f32_16x16x32_bf16 v[180:183], a[4:7], v[112:115], v[180:183]
    v_and_b32 v197, 0xffff0000, v228
    v_lshlrev_b32 v198, 16, v229
    v_mfma_f32_16x16x32_bf16 v[184:187], a[8:11], v[112:115], v[184:187]
    s_waitcnt vmcnt(8)
    v_and_b32 v199, 0xffff0000, v229
    v_mul_f32 v196, v196, v240
    v_mfma_f32_16x16x32_bf16 v[168:171], a[12:15], v[116:119], v[168:171]
    v_mul_f32 v197, v197, v241
    v_mul_f32 v198, v198, v242
    v_mfma_f32_16x16x32_bf16 v[172:175], a[16:19], v[116:119], v[172:175]
    v_mul_f32 v199, v199, v243
    s_waitcnt lgkmcnt(0)
    v_lshlrev_b32 v208, 16, v230
    v_mfma_f32_16x16x32_bf16 v[176:179], a[20:23], v[116:119], v[176:179]
    v_and_b32 v209, 0xffff0000, v230
    v_lshlrev_b32 v210, 16, v231
    v_mfma_f32_16x16x32_bf16 v[180:183], a[24:27], v[116:119], v[180:183]
    v_and_b32 v211, 0xffff0000, v231
    v_mul_f32 v208, v208, v240
    v_mfma_f32_16x16x32_bf16 v[184:187], a[28:31], v[116:119], v[184:187]
    s_waitcnt vmcnt(7)
    v_mul_f32 v209, v209, v241
    v_mul_f32 v210, v210, v242
    v_mfma_f32_16x16x32_bf16 v[168:171], a[32:35], v[120:123], v[168:171]
    ds_write_b128 v220, v[72:75] offset:0
    v_mul_f32 v211, v211, v243
    v_mfma_f32_16x16x32_bf16 v[172:175], a[36:39], v[120:123], v[172:175]
    v_mfma_f32_16x16x32_bf16 v[176:179], a[40:43], v[120:123], v[176:179]
    ds_write_b128 v220, v[76:79] offset:1024
    v_mfma_f32_16x16x32_bf16 v[180:183], a[44:47], v[120:123], v[180:183]
    v_mfma_f32_16x16x32_bf16 v[184:187], a[48:51], v[120:123], v[184:187]
    s_waitcnt vmcnt(6)
    buffer_load_dword v247, v246, s[36:39], s17 offen sc1
    v_mfma_f32_16x16x32_bf16 v[168:171], a[52:55], v[124:127], v[168:171]
    ds_write_b128 v220, v[80:83] offset:2048
    v_mfma_f32_16x16x32_bf16 v[172:175], a[56:59], v[124:127], v[172:175]
    v_mfma_f32_16x16x32_bf16 v[176:179], a[60:63], v[124:127], v[176:179]
    ds_write_b128 v220, v[84:87] offset:3072
    v_mfma_f32_16x16x32_bf16 v[180:183], a[64:67], v[124:127], v[180:183]
    v_mfma_f32_16x16x32_bf16 v[184:187], a[68:71], v[124:127], v[184:187]
    s_waitcnt vmcnt(6)
    ds_write_b128 v220, v[88:91] offset:4096
    v_mfma_f32_16x16x32_bf16 v[168:171], a[72:75], v[128:131], v[168:171]
    v_mfma_f32_16x16x32_bf16 v[172:175], a[76:79], v[128:131], v[172:175]
    v_mfma_f32_16x16x32_bf16 v[176:179], a[80:83], v[128:131], v[176:179]
    v_mfma_f32_16x16x32_bf16 v[180:183], a[84:87], v[128:131], v[180:183]
    v_mfma_f32_16x16x32_bf16 v[184:187], a[88:91], v[128:131], v[184:187]
    s_waitcnt vmcnt(5)
    v_mfma_f32_16x16x32_bf16 v[168:171], a[92:95], v[132:135], v[168:171]
    v_mfma_f32_16x16x32_bf16 v[172:175], a[96:99], v[132:135], v[172:175]
    v_mfma_f32_16x16x32_bf16 v[176:179], a[100:103], v[132:135], v[176:179]
    v_mfma_f32_16x16x32_bf16 v[180:183], a[104:107], v[132:135], v[180:183]
    v_mfma_f32_16x16x32_bf16 v[184:187], a[108:111], v[132:135], v[184:187]
    s_waitcnt vmcnt(4)
    v_mfma_f32_16x16x32_bf16 v[168:171], a[112:115], v[56:59], v[168:171]
    v_mfma_f32_16x16x32_bf16 v[172:175], a[116:119], v[56:59], v[172:175]
    v_mfma_f32_16x16x32_bf16 v[176:179], a[120:123], v[56:59], v[176:179]
    v_mfma_f32_16x16x32_bf16 v[180:183], a[124:127], v[56:59], v[180:183]
    v_mfma_f32_16x16x32_bf16 v[184:187], a[128:131], v[56:59], v[184:187]
    s_waitcnt vmcnt(3)
    v_mfma_f32_16x16x32_bf16 v[168:171], a[132:135], v[60:63], v[168:171]
    v_mfma_f32_16x16x32_bf16 v[172:175], a[136:139], v[60:63], v[172:175]
    v_mfma_f32_16x16x32_bf16 v[176:179], a[140:143], v[60:63], v[176:179]
    v_mfma_f32_16x16x32_bf16 v[180:183], a[144:147], v[60:63], v[180:183]
    s_waitcnt vmcnt(0)
    v_cmp_ne_u32 vcc, s48, v247
    s_cbranch_vccnz L_chk24_slow
L_chk24_back:
    v_mfma_f32_16x16x32_bf16 v[184:187], a[148:151], v[60:63], v[184:187]
    buffer_load_dwordx4 v[8:11], v218, s[36:39], s18 offen offset:0 sc1
    v_mfma_f32_16x16x32_bf16 v[168:171], a[152:155], v[64:67], v[168:171]
    v_mfma_f32_16x16x32_bf16 v[172:175], a[156:159], v[64:67], v[172:175]
    v_mfma_f32_16x16x32_bf16 v[176:179], a[160:163], v[64:67], v[176:179]
    buffer_load_dwordx4 v[12:15], v218, s[36:39], s18 offen offset:1024 sc1
    v_mfma_f32_16x16x32_bf16 v[180:183], a[164:167], v[64:67], v[180:183]
    v_mfma_f32_16x16x32_bf16 v[184:187], a[168:171], v[64:67], v[184:187]
    v_mfma_f32_16x16x32_bf16 v[168:171], a[172:175], v[68:71], v[168:171]
    buffer_load_dwordx4 v[16:19], v218, s[36:39], s18 offen offset:2048 sc1
    v_mfma_f32_16x16x32_bf16 v[172:175], a[176:179], v[68:71], v[172:175]
    v_mfma_f32_16x16x32_bf16 v[176:179], a[180:183], v[68:71], v[176:179]
    v_mfma_f32_16x16x32_bf16 v[180:183], a[184:187], v[68:71], v[180:183]
    buffer_load_dwordx4 v[20:23], v218, s[36:39], s19 offen offset:0 sc1
    v_mfma_f32_16x16x32_bf16 v[184:187], a[188:191], v[68:71], v[184:187]
    s_waitcnt vmcnt(3)
    v_mfma_f32_16x16x32_bf16 v[72:75], a[240:243], v[8:11], 0
    v_mfma_f32_16x16x32_bf16 v[76:79], a[244:247], v[8:11], 0
    buffer_load_dwordx4 v[24:27], v218, s[36:39], s19 offen offset:1024 sc1
    v_mfma_f32_16x16x32_bf16 v[80:83], a[248:251], v[8:11], 0
    v_mfma_f32_16x16x32_bf16 v[84:87], a[252:255], v[8:11], 0
    ds_write_b128 v221, v[168:171] offset:0
    v_mfma_f32_16x16x32_bf16 v[88:91], v[136:139], v[8:11], 0
    s_waitcnt vmcnt(3)
    buffer_load_dwordx4 v[28:31], v218, s[36:39], s19 offen offset:2048 sc1
    v_mfma_f32_16x16x32_bf16 v[72:75], v[140:143], v[12:15], v[72:75]
    ds_write_b128 v221, v[172:175] offset:1024
    v_mfma_f32_16x16x32_bf16 v[76:79], v[144:147], v[12:15], v[76:79]
    v_mfma_f32_16x16x32_bf16 v[80:83], v[148:151], v[12:15], v[80:83]
    buffer_load_dwordx4 v[32:35], v218, s[36:39], s20 offen offset:0 sc1
    v_mfma_f32_16x16x32_bf16 v[84:87], v[152:155], v[12:15], v[84:87]
    ds_write_b128 v221, v[176:179] offset:2048
    v_mfma_f32_16x16x32_bf16 v[88:91], v[156:159], v[12:15], v[88:91]
    s_waitcnt vmcnt(4)
    v_mfma_f32_16x16x32_bf16 v[72:75], v[160:163], v[16:19], v[72:75]
    buffer_load_dwordx4 v[36:39], v218, s[36:39], s20 offen offset:1024 sc1
    v_mfma_f32_16x16x32_bf16 v[76:79], v[164:167], v[16:19], v[76:79]
    ds_write_b128 v221, v[180:183] offset:3072
    v_mfma_f32_16x16x32_bf16 v[80:83], a[0:3], v[16:19], v[80:83]
    v_mfma_f32_16x16x32_bf16 v[84:87], a[4:7], v[16:19], v[84:87]
    buffer_load_dwordx4 v[40:43], v218, s[36:39], s20 offen offset:2048 sc1
    v_mfma_f32_16x16x32_bf16 v[88:91], a[8:11], v[16:19], v[88:91]
    s_waitcnt vmcnt(5)
    ds_write_b128 v221, v[184:187] offset:4096
    v_mfma_f32_16x16x32_bf16 v[72:75], a[12:15], v[20:23], v[72:75]
    v_mfma_f32_16x16x32_bf16 v[76:79], a[16:19], v[20:23], v[76:79]
    buffer_load_dwordx4 v[44:47], v218, s[36:39], s21 offen offset:0 sc1
    v_mfma_f32_16x16x32_bf16 v[80:83], a[20:23], v[20:23], v[80:83]
    v_mfma_f32_16x16x32_bf16 v[84:87], a[24:27], v[20:23], v[84:87]
    s_waitcnt lgkmcnt(0)
    s_barrier
    ds_read_b128 v[232:235], v224 offset:0
    v_mfma_f32_16x16x32_bf16 v[88:91], a[28:31], v[20:23], v[88:91]
    s_waitcnt vmcnt(5)
    buffer_load_dwordx4 v[48:51], v218, s[36:39], s21 offen offset:1024 sc1
    v_mfma_f32_16x16x32_bf16 v[72:75], a[32:35], v[24:27], v[72:75]
    ds_read_b128 v[236:239], v224 offset:1024
    v_mfma_f32_16x16x32_bf16 v[76:79], a[36:39], v[24:27], v[76:79]
    ds_read_b128 v[240:243], v224 offset:2048
    v_mfma_f32_16x16x32_bf16 v[80:83], a[40:43], v[24:27], v[80:83]
    buffer_load_dwordx4 v[52:55], v218, s[36:39], s21 offen offset:2048 sc1
    v_mfma_f32_16x16x32_bf16 v[84:87], a[44:47], v[24:27], v[84:87]
    ds_read_b128 v[212:215], v224 offset:5120
    v_mfma_f32_16x16x32_bf16 v[88:91], a[48:51], v[24:27], v[88:91]
    s_waitcnt vmcnt(6)
    ds_read_b128 v[252:255], v224 offset:6144
    v_mfma_f32_16x16x32_bf16 v[72:75], a[52:55], v[28:31], v[72:75]
    buffer_load_dwordx4 v[104:107], v219, s[36:39], s18 offen offset:0 sc1
    v_mfma_f32_16x16x32_bf16 v[76:79], a[56:59], v[28:31], v[76:79]
    ds_read_b128 v[228:231], v224 offset:7168
    v_mfma_f32_16x16x32_bf16 v[80:83], a[60:63], v[28:31], v[80:83]
    v_mfma_f32_16x16x32_bf16 v[84:87], a[64:67], v[28:31], v[84:87]
    buffer_load_dwordx4 v[108:111], v219, s[36:39], s18 offen offset:1024 sc1
    v_mfma_f32_16x16x32_bf16 v[88:91], a[68:71], v[28:31], v[88:91]
    s_waitcnt lgkmcnt(5)
    v_fma_f32 v188, v232, v92, v188
    v_fma_f32 v189, v233, v93, v189
    s_waitcnt vmcnt(7)
    v_mfma_f32_16x16x32_bf16 v[72:75], a[72:75], v[32:35], v[72:75]
    v_fma_f32 v190, v234, v94, v190
    v_fma_f32 v191, v235, v95, v191
    v_mfma_f32_16x16x32_bf16 v[76:79], a[76:79], v[32:35], v[76:79]
    buffer_load_dwordx4 v[112:115], v219, s[36:39], s18 offen offset:2048 sc1
    v_mfma_f32_16x16x32_bf16 v[80:83], a[80:83], v[32:35], v[80:83]
    s_waitcnt lgkmcnt(4)
    v_fma_f32 v192, v236, v96, v192
    v_fma_f32 v193, v237, v97, v193
    v_mfma_f32_16x16x32_bf16 v[84:87], a[84:87], v[32:35], v[84:87]
    v_fma_f32 v194, v238, v98, v194
    v_fma_f32 v195, v239, v99, v195
    v_mfma_f32_16x16x32_bf16 v[88:91], a[88:91], v[32:35], v[88:91]
    s_waitcnt vmcnt(7)
    buffer_load_dwordx4 v[116:119], v219, s[36:39], s19 offen offset:0 sc1
    v_mfma_f32_16x16x32_bf16 v[72:75], a[92:95], v[36:39], v[72:75]
    s_waitcnt lgkmcnt(3)
    v_fma_f32 v196, v240, v100, v196
    v_fma_f32 v197, v241, v101, v197
    v_mfma_f32_16x16x32_bf16 v[76:79], a[96:99], v[36:39], v[76:79]
    v_fma_f32 v198, v242, v102, v198
    v_fma_f32 v199, v243, v103, v199
    v_mfma_f32_16x16x32_bf16 v[80:83], a[100:103], v[36:39], v[80:83]
    buffer_load_dwordx4 v[120:123], v219, s[36:39], s19 offen offset:1024 sc1
    v_mfma_f32_16x16x32_bf16 v[84:87], a[104:107], v[36:39], v[84:87]
    ds_read_b128 v[232:235], v224 offset:10240
    v_mfma_f32_16x16x32_bf16 v[88:91], a[108:111], v[36:39], v[88:91]
    s_waitcnt vmcnt(8)
    ds_read_b128 v[236:239], v224 offset:11264
    v_mfma_f32_16x16x32_bf16 v[72:75], a[112:115], v[40:43], v[72:75]
    buffer_load_dwordx4 v[124:127], v219, s[36:39], s19 offen offset:2048 sc1
    v_mfma_f32_16x16x32_bf16 v[76:79], a[116:119], v[40:43], v[76:79]
    ds_read_b128 v[240:243], v224 offset:12288
    s_waitcnt lgkmcnt(5)
    v_fma_f32 v188, v212, v92, v188
    v_mfma_f32_16x16x32_bf16 v[80:83], a[120:123], v[40:43], v[80:83]
    v_fma_f32 v189, v213, v93, v189
    v_fma_f32 v190, v214, v94, v190
    v_mfma_f32_16x16x32_bf16 v[84:87], a[124:127], v[40:43], v[84:87]
    buffer_load_dwordx4 v[128:131], v219, s[36:39], s20 offen offset:0 sc1
    v_mfma_f32_16x16x32_bf16 v[88:91], a[128:131], v[40:43], v[88:91]
    v_fma_f32 v191, v215, v95, v191
    s_waitcnt lgkmcnt(4)
    v_fma_f32 v192, v252, v96, v192
    s_waitcnt vmcnt(9)
    v_mfma_f32_16x16x32_bf16 v[72:75], a[132:135], v[44:47], v[72:75]
    v_fma_f32 v193, v253, v97, v193
    v_fma_f32 v194, v254, v98, v194
    v_mfma_f32_16x16x32_bf16 v[76:79], a[136:139], v[44:47], v[76:79]
    buffer_load_dwordx4 v[132:135], v219, s[36:39], s20 offen offset:1024 sc1
    v_mfma_f32_16x16x32_bf16 v[80:83], a[140:143], v[44:47], v[80:83]
    v_fma_f32 v195, v255, v99, v195
    s_waitcnt lgkmcnt(3)
    v_fma_f32 v196, v228, v100, v196
    v_mfma_f32_16x16x32_bf16 v[84:87], a[144:147], v[44:47], v[84:87]
    v_fma_f32 v197, v229, v101, v197
    v_fma_f32 v198, v230, v102, v198
    v_mfma_f32_16x16x32_bf16 v[88:91], a[148:151], v[44:47], v[88:91]
    s_waitcnt vmcnt(9)
    buffer_load_dwordx4 v[56:59], v219, s[36:39], s20 offen offset:2048 sc1
    v_mfma_f32_16x16x32_bf16 v[72:75], a[152:155], v[48:51], v[72:75]
    v_fma_f32 v199, v231, v103, v199
    v_mfma_f32_16x16x32_bf16 v[76:79], a[156:159], v[48:51], v[76:79]
    ds_read_b128 v[212:215], v224 offset:15360
    v_mfma_f32_16x16x32_bf16 v[80:83], a[160:163], v[48:51], v[80:83]
    buffer_load_dwordx4 v[60:63], v219, s[36:39], s21 offen offset:0 sc1
    v_mfma_f32_16x16x32_bf16 v[84:87], a[164:167], v[48:51], v[84:87]
    ds_read_b128 v[252:255], v224 offset:16384
    v_mfma_f32_16x16x32_bf16 v[88:91], a[168:171], v[48:51], v[88:91]
    ds_read_b128 v[228:231], v224 offset:17408
    s_waitcnt lgkmcnt(5)
    v_fma_f32 v188, v232, v92, v188
    s_waitcnt vmcnt(10)
    v_mfma_f32_16x16x32_bf16 v[72:75], a[172:175], v[52:55], v[72:75]
    buffer_load_dwordx4 v[64:67], v219, s[36:39], s21 offen offset:1024 sc1
    v_mfma_f32_16x16x32_bf16 v[76:79], a[176:179], v[52:55], v[76:79]
    v_fma_f32 v189, v233, v93, v189
    v_fma_f32 v190, v234, v94, v190
    v_mfma_f32_16x16x32_bf16 v[80:83], a[180:183], v[52:55], v[80:83]
    v_fma_f32 v191, v235, v95, v191
    s_waitcnt lgkmcnt(4)
    v_fma_f32 v192, v236, v96, v192
    v_mfma_f32_16x16x32_bf16 v[84:87], a[184:187], v[52:55], v[84:87]
    buffer_load_dwordx4 v[68:71], v219, s[36:39], s21 offen offset:2048 sc1
    v_mfma_f32_16x16x32_bf16 v[88:91], a[188:191], v[52:55], v[88:91]
    s_waitcnt vmcnt(11)
    v_fma_f32 v193, v237, v97, v193
    v_fma_f32 v194, v238, v98, v194
    v_mfma_f32_16x16x32_bf16 v[168:171], a[240:243], v[104:107], 0
    v_fma_f32 v195, v239, v99, v195
    s_waitcnt lgkmcnt(3)
    v_fma_f32 v196, v240, v100, v196
    v_mfma_f32_16x16x32_bf16 v[172:175], a[244:247], v[104:107], 0
    v_fma_f32 v197, v241, v101, v197
    v_fma_f32 v198, v242, v102, v198
    v_mfma_f32_16x16x32_bf16 v[176:179], a[248:251], v[104:107], 0
    v_fma_f32 v199, v243, v103, v199
    s_waitcnt lgkmcnt(2)
    v_fma_f32 v188, v212, v92, v188
    v_mfma_f32_16x16x32_bf16 v[180:183], a[252:255], v[104:107], 0
    v_fma_f32 v189, v213, v93, v189
    v_fma_f32 v190, v214, v94, v190
    v_mfma_f32_16x16x32_bf16 v[184:187], v[136:139], v[104:107], 0
    v_fma_f32 v191, v215, v95, v191
    s_waitcnt lgkmcnt(1)
    v_fma_f32 v192, v252, v96, v192
    s_waitcnt vmcnt(10)
    v_mfma_f32_16x16x32_bf16 v[168:171], v[140:143], v[108:111], v[168:171]
    v_fma_f32 v193, v253, v97, v193
    v_fma_f32 v194, v254, v98, v194
    v_mfma_f32_16x16x32_bf16 v[172:175], v[144:147], v[108:111], v[172:175]
    v_fma_f32 v195, v255, v99, v195
    s_waitcnt lgkmcnt(0)
    v_fma_f32 v196, v228, v100, v196
    v_mfma_f32_16x16x32_bf16 v[176:179], v[148:151], v[108:111], v[176:179]
    v_fma_f32 v197, v229, v101, v197
    v_fma_f32 v198, v230, v102, v198
    v_mfma_f32_16x16x32_bf16 v[180:183], v[152:155], v[108:111], v[180:183]
    v_fma_f32 v199, v231, v103, v199
    v_cvt_pk_bf16_f32 v232, v188, v189
    v_mfma_f32_16x16x32_bf16 v[184:187], v[156:159], v[108:111], v[184:187]
    s_waitcnt vmcnt(9)
    v_cvt_pk_bf16_f32 v233, v190, v191
    v_cvt_pk_bf16_f32 v234, v192, v193
    v_mfma_f32_16x16x32_bf16 v[168:171], v[160:163], v[112:115], v[168:171]
    v_cvt_pk_bf16_f32 v235, v194, v195
    v_cvt_pk_bf16_f32 v236, v196, v197
    v_mfma_f32_16x16x32_bf16 v[172:175], v[164:167], v[112:115], v[172:175]
    ds_write_b128 v222, v[72:75] offset:0
    v_cvt_pk_bf16_f32 v237, v198, v199
    v_mfma_f32_16x16x32_bf16 v[176:179], a[0:3], v[112:115], v[176:179]
    v_permlane16_swap_b32 v232, v234
    v_mfma_f32_16x16x32_bf16 v[180:183], a[4:7], v[112:115], v[180:183]
    v_permlane16_swap_b32 v233, v235
    v_mfma_f32_16x16x32_bf16 v[184:187], a[8:11], v[112:115], v[184:187]
    s_waitcnt vmcnt(8)
    buffer_store_dwordx4 v[232:235], v227, s[40:43], s13 offen
    v_mfma_f32_16x16x32_bf16 v[168:171], a[12:15], v[116:119], v[168:171]
    buffer_store_dwordx2 v[236:237], v2, s[40:43], s13 offen offset:64
    v_mfma_f32_16x16x32_bf16 v[172:175], a[16:19], v[116:119], v[172:175]
    ds_write_b128 v222, v[76:79] offset:1024
    v_mfma_f32_16x16x32_bf16 v[176:179], a[20:23], v[116:119], v[176:179]
    v_mfma_f32_16x16x32_bf16 v[180:183], a[24:27], v[116:119], v[180:183]
    ds_write_b128 v222, v[80:83] offset:2048
    v_mfma_f32_16x16x32_bf16 v[184:187], a[28:31], v[116:119], v[184:187]
    s_waitcnt vmcnt(9)
    v_mfma_f32_16x16x32_bf16 v[168:171], a[32:35], v[120:123], v[168:171]
    ds_write_b128 v222, v[84:87] offset:3072
    v_mfma_f32_16x16x32_bf16 v[172:175], a[36:39], v[120:123], v[172:175]
    v_mfma_f32_16x16x32_bf16 v[176:179], a[40:43], v[120:123], v[176:179]
    ds_write_b128 v222, v[88:91] offset:4096
    v_mfma_f32_16x16x32_bf16 v[180:183], a[44:47], v[120:123], v[180:183]
    v_mfma_f32_16x16x32_bf16 v[184:187], a[48:51], v[120:123], v[184:187]
    s_waitcnt vmcnt(8)
    v_mfma_f32_16x16x32_bf16 v[168:171], a[52:55], v[124:127], v[168:171]
    v_mfma_f32_16x16x32_bf16 v[172:175], a[56:59], v[124:127], v[172:175]
    s_waitcnt lgkmcnt(0)
    s_barrier
    ds_read_b128 v[232:235], v225 offset:0
    v_mfma_f32_16x16x32_bf16 v[176:179], a[60:63], v[124:127], v[176:179]
    ds_read_b128 v[236:239], v225 offset:1024
    v_mfma_f32_16x16x32_bf16 v[180:183], a[64:67], v[124:127], v[180:183]
    ds_read_b128 v[240:243], v225 offset:2048
    v_mfma_f32_16x16x32_bf16 v[184:187], a[68:71], v[124:127], v[184:187]
    s_waitcnt vmcnt(7)
    ds_read_b128 v[212:215], v225 offset:10240
    v_mfma_f32_16x16x32_bf16 v[168:171], a[72:75], v[128:131], v[168:171]
    ds_read_b128 v[252:255], v225 offset:11264
    v_mfma_f32_16x16x32_bf16 v[172:175], a[76:79], v[128:131], v[172:175]
    ds_read_b128 v[228:231], v225 offset:12288
    v_mfma_f32_16x16x32_bf16 v[176:179], a[80:83], v[128:131], v[176:179]
    v_mfma_f32_16x16x32_bf16 v[180:183], a[84:87], v[128:131], v[180:183]
    v_mfma_f32_16x16x32_bf16 v[184:187], a[88:91], v[128:131], v[184:187]
    s_waitcnt vmcnt(6)
    v_mfma_f32_16x16x32_bf16 v[168:171], a[92:95], v[132:135], v[168:171]
    s_waitcnt lgkmcnt(5)
    v_fma_f32 v200, v232, v92, v200
    v_fma_f32 v201, v233, v93, v201
    v_mfma_f32_16x16x32_bf16 v[172:175], a[96:99], v[132:135], v[172:175]
    v_fma_f32 v202, v234, v94, v202
    v_fma_f32 v203, v235, v95, v203
    v_mfma_f32_16x16x32_bf16 v[176:179], a[100:103], v[132:135], v[176:179]
    s_waitcnt lgkmcnt(4)
    v_fma_f32 v204, v236, v96, v204
    v_fma_f32 v205, v237, v97, v205
    v_mfma_f32_16x16x32_bf16 v[180:183], a[104:107], v[132:135], v[180:183]
    v_fma_f32 v206, v238, v98, v206
    v_fma_f32 v207, v239, v99, v207
    v_mfma_f32_16x16x32_bf16 v[184:187], a[108:111], v[132:135], v[184:187]
    s_waitcnt lgkmcnt(3)
    v_fma_f32 v208, v240, v100, v208
    v_fma_f32 v209, v241, v101, v209
    s_waitcnt vmcnt(5)
    v_mfma_f32_16x16x32_bf16 v[168:171], a[112:115], v[56:59], v[168:171]
    v_fma_f32 v210, v242, v102, v210
    v_fma_f32 v211, v243, v103, v211
    v_mfma_f32_16x16x32_bf16 v[172:175], a[116:119], v[56:59], v[172:175]
    s_waitcnt lgkmcnt(2)
    v_fma_f32 v200, v212, v92, v200
    v_fma_f32 v201, v213, v93, v201
    v_mfma_f32_16x16x32_bf16 v[176:179], a[120:123], v[56:59], v[176:179]
    v_fma_f32 v202, v214, v94, v202
    v_fma_f32 v203, v215, v95, v203
    v_mfma_f32_16x16x32_bf16 v[180:183], a[124:127], v[56:59], v[180:183]
    s_waitcnt lgkmcnt(1)
    v_fma_f32 v204, v252, v96, v204
    v_fma_f32 v205, v253, v97, v205
    v_mfma_f32_16x16x32_bf16 v[184:187], a[128:131], v[56:59], v[184:187]
    s_waitcnt vmcnt(4)
    v_fma_f32 v206, v254, v98, v206
    v_fma_f32 v207, v255, v99, v207
    v_mfma_f32_16x16x32_bf16 v[168:171], a[132:135], v[60:63], v[168:171]
    s_waitcnt lgkmcnt(0)
    v_fma_f32 v208, v228, v100, v208
    v_fma_f32 v209, v229, v101, v209
    v_mfma_f32_16x16x32_bf16 v[172:175], a[136:139], v[60:63], v[172:175]
    v_fma_f32 v210, v230, v102, v210
    v_fma_f32 v211, v231, v103, v211
    v_mfma_f32_16x16x32_bf16 v[176:179], a[140:143], v[60:63], v[176:179]
    v_mfma_f32_16x16x32_bf16 v[180:183], a[144:147], v[60:63], v[180:183]
    v_mfma_f32_16x16x32_bf16 v[184:187], a[148:151], v[60:63], v[184:187]
    s_waitcnt vmcnt(3)
    v_mfma_f32_16x16x32_bf16 v[168:171], a[152:155], v[64:67], v[168:171]
    v_mfma_f32_16x16x32_bf16 v[172:175], a[156:159], v[64:67], v[172:175]
    v_mfma_f32_16x16x32_bf16 v[176:179], a[160:163], v[64:67], v[176:179]
    v_mfma_f32_16x16x32_bf16 v[180:183], a[164:167], v[64:67], v[180:183]
    v_mfma_f32_16x16x32_bf16 v[184:187], a[168:171], v[64:67], v[184:187]
    s_waitcnt vmcnt(2)
    v_mfma_f32_16x16x32_bf16 v[168:171], a[172:175], v[68:71], v[168:171]
    v_mfma_f32_16x16x32_bf16 v[172:175], a[176:179], v[68:71], v[172:175]
    v_mfma_f32_16x16x32_bf16 v[176:179], a[180:183], v[68:71], v[176:179]
    v_mfma_f32_16x16x32_bf16 v[180:183], a[184:187], v[68:71], v[180:183]
    v_mfma_f32_16x16x32_bf16 v[184:187], a[188:191], v[68:71], v[184:187]
    s_nop 3
    ds_write_b128 v223, v[168:171] offset:0
    ds_write_b128 v223, v[172:175] offset:1024
    ds_write_b128 v223, v[176:179] offset:2048
    ds_write_b128 v223, v[180:183] offset:3072
    ds_write_b128 v223, v[184:187] offset:4096
    s_waitcnt lgkmcnt(0)
    s_barrier
    ds_read_b128 v[232:235], v226 offset:0
    ds_read_b128 v[236:239], v226 offset:1024
    ds_read_b128 v[240:243], v226 offset:2048
    ds_read_b128 v[212:215], v226 offset:10240
    ds_read_b128 v[252:255], v226 offset:11264
    ds_read_b128 v[228:231], v226 offset:12288
    s_waitcnt lgkmcnt(2)
    v_pk_add_f32 v[232:233], v[232:233], v[212:213]
    v_pk_add_f32 v[234:235], v[234:235], v[214:215]
    s_waitcnt lgkmcnt(1)
    v_pk_add_f32 v[236:237], v[236:237], v[252:253]
    v_pk_add_f32 v[238:239], v[238:239], v[254:255]
    s_waitcnt lgkmcnt(0)
    v_pk_add_f32 v[240:241], v[240:241], v[228:229]
    v_pk_add_f32 v[242:243], v[242:243], v[230:231]
    v_pk_fma_f32 v[200:201], v[232:233], v[92:93], v[200:201]
    v_pk_fma_f32 v[202:203], v[234:235], v[94:95], v[202:203]
    v_pk_fma_f32 v[204:205], v[236:237], v[96:97], v[204:205]
    v_pk_fma_f32 v[206:207], v[238:239], v[98:99], v[206:207]
    v_pk_fma_f32 v[208:209], v[240:241], v[100:101], v[208:209]
    v_pk_fma_f32 v[210:211], v[242:243], v[102:103], v[210:211]
    v_cvt_pk_bf16_f32 v232, v200, v201
    v_cvt_pk_bf16_f32 v233, v202, v203
    v_cvt_pk_bf16_f32 v234, v204, v205
    v_cvt_pk_bf16_f32 v235, v206, v207
    v_cvt_pk_bf16_f32 v236, v208, v209
    v_cvt_pk_bf16_f32 v237, v210, v211
    v_permlane16_swap_b32 v232, v234
    v_permlane16_swap_b32 v233, v235
    buffer_store_dwordx4 v[232:235], v227, s[40:43], s14 offen
    buffer_store_dwordx2 v[236:237], v2, s[40:43], s14 offen offset:64
L_end:
    s_endpgm
L_bias:
    s_waitcnt lgkmcnt(0)
    s_mov_b32 s52, 23301888
    v_min_u32 v5, 19, v1
    v_lshlrev_b32 v5, 7, v5
    buffer_load_dword v6, v5, s[36:39], s52 offen sc1
    s_barrier
    s_add_u32 m0, s61, 32768
    s_nop 0
    buffer_load_dwordx4 v228, s[40:43], s64 offen offset:0 lds
    buffer_load_dwordx4 v229, s[40:43], s64 offen offset:1024 lds
    buffer_load_dwordx4 v230, s[40:43], s64 offen offset:2048 lds
    s_add_u32 s64, s64, 98304
    s_sub_u32 s35, s64, 1966080
    s_min_u32 s64, s64, s35
    s_add_u32 m0, s61, 45056
    s_nop 0
    buffer_load_dwordx4 v228, s[40:43], s64 offen offset:0 lds
    buffer_load_dwordx4 v229, s[40:43], s64 offen offset:1024 lds
    buffer_load_dwordx4 v230, s[40:43], s64 offen offset:2048 lds
    s_add_u32 s64, s64, 98304
    s_sub_u32 s35, s64, 1966080
    s_min_u32 s64, s64, s35
    v_and_b32 v165, 1, v1
    v_lshlrev_b32 v165, 6, v165
    v_and_b32 v166, 48, v1
    s_mul_i32 s57, s3, 2560
    s_add_u32 s57, s57, 122880
    v_add3_u32 v165, v165, v166, s57
    s_waitcnt vmcnt(6)
    v_cmp_ne_u32 vcc, s48, v6
    s_cbranch_vccnz L_chk25_slow
L_chk25_back:
    s_mul_i32 s52, s3, 2560
    s_add_u32 m0, s52, 122880
    s_lshl_b32 s52, s34, 7
    v_add_u32 v2, s52, v248
    s_add_u32 s52, s52, 1024
    v_subrev_u32 v5, 2560, v2
    v_min_u32 v2, v2, v5
    v_add_u32 v3, s52, v248
    s_add_u32 s52, s52, 1024
    v_subrev_u32 v5, 2560, v3
    v_min_u32 v3, v3, v5
    v_add_u32 v4, s52, v248
    s_add_u32 s52, s52, 1024
    v_subrev_u32 v5, 2560, v4
    v_min_u32 v4, v4, v5
    s_mov_b32 s52, 23166976
    buffer_load_dwordx4 v2, s[36:39], s52 offen offset:0 sc1 lds
    s_mov_b32 s52, 23165952
    buffer_load_dwordx4 v3, s[36:39], s52 offen offset:1024 sc1 lds
    s_mov_b32 exec_hi, 0
    s_mov_b32 s52, 23164928
    buffer_load_dwordx4 v4, s[36:39], s52 offen offset:2048 sc1 lds
    s_mov_b32 exec_hi, -1
    s_barrier
    ds_read_b64_tr_b16 a[72:73], v237 offset:24576
    ds_read_b64_tr_b16 a[74:75], v237 offset:27648
    ds_read_b64_tr_b16 a[76:77], v238 offset:30720
    ds_read_b64_tr_b16 a[78:79], v238 offset:33792
    ds_read_b64_tr_b16 a[80:81], v239 offset:24576
    ds_read_b64_tr_b16 a[82:83], v239 offset:27648
    ds_read_b64_tr_b16 a[84:85], v237 offset:36864
    ds_read_b64_tr_b16 a[86:87], v237 offset:39936
    ds_read_b64_tr_b16 a[88:89], v238 offset:43008
    ds_read_b64_tr_b16 a[90:91], v238 offset:46080
    ds_read_b64_tr_b16 a[92:93], v239 offset:36864
    ds_read_b64_tr_b16 a[94:95], v239 offset:39936
    s_add_u32 m0, s61, 57344
    s_nop 0
    buffer_load_dwordx4 v228, s[40:43], s64 offen offset:0 lds
    buffer_load_dwordx4 v229, s[40:43], s64 offen offset:1024 lds
    buffer_load_dwordx4 v230, s[40:43], s64 offen offset:2048 lds
    s_add_u32 s64, s64, 98304
    s_sub_u32 s35, s64, 1966080
    s_min_u32 s64, s64, s35
    s_add_u32 m0, s61, 69632
    s_nop 0
    buffer_load_dwordx4 v228, s[40:43], s64 offen offset:0 lds
    buffer_load_dwordx4 v229, s[40:43], s64 offen offset:1024 lds
    buffer_load_dwordx4 v230, s[40:43], s64 offen offset:2048 lds
    s_add_u32 s64, s64, 98304
    s_sub_u32 s35, s64, 1966080
    s_min_u32 s64, s64, s35
    s_waitcnt lgkmcnt(0)
    s_barrier
    ds_read_b64_tr_b16 a[96:97], v231 offset:0
    ds_read_b64_tr_b16 a[98:99], v231 offset:3072
    ds_read_b64_tr_b16 a[100:101], v232 offset:6144
    ds_read_b64_tr_b16 a[102:103], v232 offset:9216
    ds_read_b64_tr_b16 a[104:105], v233 offset:0
    ds_read_b64_tr_b16 a[106:107], v233 offset:3072
    ds_read_b64_tr_b16 a[108:109], v231 offset:12288
    ds_read_b64_tr_b16 a[110:111], v231 offset:15360
    ds_read_b64_tr_b16 a[112:113], v232 offset:18432
    ds_read_b64_tr_b16 a[114:115], v232 offset:21504
    ds_read_b64_tr_b16 a[116:117], v233 offset:12288
    ds_read_b64_tr_b16 a[118:119], v233 offset:15360
    s_add_u32 m0, s61, 81920
    s_nop 0
    buffer_load_dwordx4 v228, s[40:43], s64 offen offset:0 lds
    buffer_load_dwordx4 v229, s[40:43], s64 offen offset:1024 lds
    buffer_load_dwordx4 v230, s[40:43], s64 offen offset:2048 lds
    s_add_u32 s64, s64, 98304
    s_sub_u32 s35, s64, 1966080
    s_min_u32 s64, s64, s35
    s_add_u32 m0, s61, 94208
    s_nop 0
    buffer_load_dwordx4 v228, s[40:43], s64 offen offset:0 lds
    buffer_load_dwordx4 v229, s[40:43], s64 offen offset:1024 lds
    buffer_load_dwordx4 v230, s[40:43], s64 offen offset:2048 lds
    s_add_u32 s64, s64, 98304
    s_sub_u32 s35, s64, 1966080
    s_min_u32 s64, s64, s35
    s_waitcnt vmcnt(12)
    ds_read_b128 v[64:67], v165 offset:0
    ds_read_b128 v[68:71], v165 offset:128
    ds_read_b128 v[72:75], v165 offset:256
    ds_read_b128 v[76:79], v165 offset:384
    ds_read_b128 v[80:83], v165 offset:512
    ds_read_b128 v[84:87], v165 offset:640
    s_waitcnt lgkmcnt(5)
    v_mfma_f32_16x16x32_bf16 v[176:179], a[0:3], v[64:67], 0
    v_mfma_f32_16x16x32_bf16 v[180:183], a[4:7], v[64:67], 0
    v_mfma_f32_16x16x32_bf16 v[184:187], a[8:11], v[64:67], 0
    s_waitcnt lgkmcnt(4)
    v_mfma_f32_16x16x32_bf16 v[176:179], a[12:15], v[68:71], v[176:179]
    v_mfma_f32_16x16x32_bf16 v[180:183], a[16:19], v[68:71], v[180:183]
    v_mfma_f32_16x16x32_bf16 v[184:187], a[20:23], v[68:71], v[184:187]
    s_waitcnt lgkmcnt(3)
    v_mfma_f32_16x16x32_bf16 v[176:179], a[24:27], v[72:75], v[176:179]
    v_mfma_f32_16x16x32_bf16 v[180:183], a[28:31], v[72:75], v[180:183]
    v_mfma_f32_16x16x32_bf16 v[184:187], a[32:35], v[72:75], v[184:187]
    s_waitcnt lgkmcnt(2)
    v_mfma_f32_16x16x32_bf16 v[176:179], a[36:39], v[76:79], v[176:179]
    v_mfma_f32_16x16x32_bf16 v[180:183], a[40:43], v[76:79], v[180:183]
    v_mfma_f32_16x16x32_bf16 v[184:187], a[44:47], v[76:79], v[184:187]
    s_waitcnt lgkmcnt(1)
    v_mfma_f32_16x16x32_bf16 v[176:179], a[48:51], v[80:83], v[176:179]
    v_mfma_f32_16x16x32_bf16 v[180:183], a[52:55], v[80:83], v[180:183]
    v_mfma_f32_16x16x32_bf16 v[184:187], a[56:59], v[80:83], v[184:187]
    s_waitcnt lgkmcnt(0)
    v_mfma_f32_16x16x32_bf16 v[176:179], a[60:63], v[84:87], v[176:179]
    v_mfma_f32_16x16x32_bf16 v[180:183], a[64:67], v[84:87], v[180:183]
    v_mfma_f32_16x16x32_bf16 v[184:187], a[68:71], v[84:87], v[184:187]
    s_barrier
    ds_read_b64_tr_b16 a[120:121], v231 offset:24576
    ds_read_b64_tr_b16 a[122:123], v231 offset:27648
    ds_read_b64_tr_b16 a[124:125], v232 offset:30720
    ds_read_b64_tr_b16 a[126:127], v232 offset:33792
    ds_read_b64_tr_b16 a[128:129], v233 offset:24576
    ds_read_b64_tr_b16 a[130:131], v233 offset:27648
    ds_read_b64_tr_b16 a[132:133], v231 offset:36864
    ds_read_b64_tr_b16 a[134:135], v231 offset:39936
    ds_read_b64_tr_b16 a[136:137], v232 offset:43008
    ds_read_b64_tr_b16 a[138:139], v232 offset:46080
    ds_read_b64_tr_b16 a[140:141], v233 offset:36864
    ds_read_b64_tr_b16 a[142:143], v233 offset:39936
    s_add_u32 m0, s61, 8192
    s_nop 0
    buffer_load_dwordx4 v228, s[40:43], s64 offen offset:0 lds
    buffer_load_dwordx4 v229, s[40:43], s64 offen offset:1024 lds
    buffer_load_dwordx4 v230, s[40:43], s64 offen offset:2048 lds
    s_add_u32 s64, s64, 98304
    s_sub_u32 s35, s64, 1966080
    s_min_u32 s64, s64, s35
    s_add_u32 m0, s61, 20480
    s_nop 0
    buffer_load_dwordx4 v228, s[40:43], s64 offen offset:0 lds
    buffer_load_dwordx4 v229, s[40:43], s64 offen offset:1024 lds
    buffer_load_dwordx4 v230, s[40:43], s64 offen offset:2048 lds
    s_add_u32 s64, s64, 98304
    s_sub_u32 s35, s64, 1966080
    s_min_u32 s64, s64, s35
    ds_read_b128 v[64:67], v165 offset:768
    ds_read_b128 v[68:71], v165 offset:896
    ds_read_b128 v[72:75], v165 offset:1024
    ds_read_b128 v[76:79], v165 offset:1152
    s_waitcnt lgkmcnt(3)
    v_mfma_f32_16x16x32_bf16 v[176:179], a[72:75], v[64:67], v[176:179]
    v_mfma_f32_16x16x32_bf16 v[180:183], a[76:79], v[64:67], v[180:183]
    v_mfma_f32_16x16x32_bf16 v[184:187], a[80:83], v[64:67], v[184:187]
    s_waitcnt lgkmcnt(2)
    v_mfma_f32_16x16x32_bf16 v[176:179], a[84:87], v[68:71], v[176:179]
    v_mfma_f32_16x16x32_bf16 v[180:183], a[88:91], v[68:71], v[180:183]
    v_mfma_f32_16x16x32_bf16 v[184:187], a[92:95], v[68:71], v[184:187]
    s_waitcnt lgkmcnt(1)
    v_mfma_f32_16x16x32_bf16 v[176:179], a[96:99], v[72:75], v[176:179]
    v_mfma_f32_16x16x32_bf16 v[180:183], a[100:103], v[72:75], v[180:183]
    v_mfma_f32_16x16x32_bf16 v[184:187], a[104:107], v[72:75], v[184:187]
    s_waitcnt lgkmcnt(0)
    v_mfma_f32_16x16x32_bf16 v[176:179], a[108:111], v[76:79], v[176:179]
    v_mfma_f32_16x16x32_bf16 v[180:183], a[112:115], v[76:79], v[180:183]
    v_mfma_f32_16x16x32_bf16 v[184:187], a[116:119], v[76:79], v[184:187]
    s_waitcnt vmcnt(12)
    s_barrier
    ds_read_b64_tr_b16 a[144:145], v237 offset:0
    ds_read_b64_tr_b16 a[146:147], v237 offset:3072
    ds_read_b64_tr_b16 a[148:149], v238 offset:6144
    ds_read_b64_tr_b16 a[150:151], v238 offset:9216
    ds_read_b64_tr_b16 a[152:153], v239 offset:0
    ds_read_b64_tr_b16 a[154:155], v239 offset:3072
    ds_read_b64_tr_b16 a[156:157], v237 offset:12288
    ds_read_b64_tr_b16 a[158:159], v237 offset:15360
    ds_read_b64_tr_b16 a[160:161], v238 offset:18432
    ds_read_b64_tr_b16 a[162:163], v238 offset:21504
    ds_read_b64_tr_b16 a[164:165], v239 offset:12288
    ds_read_b64_tr_b16 a[166:167], v239 offset:15360
    s_add_u32 m0, s61, 32768
    s_nop 0
    buffer_load_dwordx4 v228, s[40:43], s64 offen offset:0 lds
    buffer_load_dwordx4 v229, s[40:43], s64 offen offset:1024 lds
    buffer_load_dwordx4 v230, s[40:43], s64 offen offset:2048 lds
    s_add_u32 s64, s64, 98304
    s_sub_u32 s35, s64, 1966080
    s_min_u32 s64, s64, s35
    s_add_u32 m0, s61, 45056
    s_nop 0
    buffer_load_dwordx4 v228, s[40:43], s64 offen offset:0 lds
    buffer_load_dwordx4 v229, s[40:43], s64 offen offset:1024 lds
    buffer_load_dwordx4 v230, s[40:43], s64 offen offset:2048 lds
    s_add_u32 s64, s64, 98304
    s_sub_u32 s35, s64, 1966080
    s_min_u32 s64, s64, s35
    ds_read_b128 v[64:67], v165 offset:1280
    ds_read_b128 v[68:71], v165 offset:1408
    s_waitcnt lgkmcnt(1)
    v_mfma_f32_16x16x32_bf16 v[176:179], a[120:123], v[64:67], v[176:179]
    v_mfma_f32_16x16x32_bf16 v[180:183], a[124:127], v[64:67], v[180:183]
    v_mfma_f32_16x16x32_bf16 v[184:187], a[128:131], v[64:67], v[184:187]
    s_waitcnt lgkmcnt(0)
    v_mfma_f32_16x16x32_bf16 v[176:179], a[132:135], v[68:71], v[176:179]
    v_mfma_f32_16x16x32_bf16 v[180:183], a[136:139], v[68:71], v[180:183]
    v_mfma_f32_16x16x32_bf16 v[184:187], a[140:143], v[68:71], v[184:187]
    s_waitcnt vmcnt(12)
    s_barrier
    ds_read_b64_tr_b16 a[168:169], v237 offset:24576
    ds_read_b64_tr_b16 a[170:171], v237 offset:27648
    ds_read_b64_tr_b16 a[172:173], v238 offset:30720
    ds_read_b64_tr_b16 a[174:175], v238 offset:33792
    ds_read_b64_tr_b16 a[176:177], v239 offset:24576
    ds_read_b64_tr_b16 a[178:179], v239 offset:27648
    ds_read_b64_tr_b16 a[180:181], v237 offset:36864
    ds_read_b64_tr_b16 a[182:183], v237 offset:39936
    ds_read_b64_tr_b16 a[184:185], v238 offset:43008
    ds_read_b64_tr_b16 a[186:187], v238 offset:46080
    ds_read_b64_tr_b16 a[188:189], v239 offset:36864
    ds_read_b64_tr_b16 a[190:191], v239 offset:39936
    ds_read_b128 v[64:67], v165 offset:1536
    ds_read_b128 v[68:71], v165 offset:1664
    s_waitcnt lgkmcnt(1)
    v_mfma_f32_16x16x32_bf16 v[176:179], a[144:147], v[64:67], v[176:179]
    v_mfma_f32_16x16x32_bf16 v[180:183], a[148:151], v[64:67], v[180:183]
    v_mfma_f32_16x16x32_bf16 v[184:187], a[152:155], v[64:67], v[184:187]
    s_waitcnt lgkmcnt(0)
    v_mfma_f32_16x16x32_bf16 v[176:179], a[156:159], v[68:71], v[176:179]
    v_mfma_f32_16x16x32_bf16 v[180:183], a[160:163], v[68:71], v[180:183]
    v_mfma_f32_16x16x32_bf16 v[184:187], a[164:167], v[68:71], v[184:187]
    s_waitcnt vmcnt(6)
    s_barrier
    ds_read_b64_tr_b16 a[192:193], v231 offset:0
    ds_read_b64_tr_b16 a[194:195], v231 offset:3072
    ds_read_b64_tr_b16 a[196:197], v232 offset:6144
    ds_read_b64_tr_b16 a[198:199], v232 offset:9216
    ds_read_b64_tr_b16 a[200:201], v233 offset:0
    ds_read_b64_tr_b16 a[202:203], v233 offset:3072
    ds_read_b64_tr_b16 a[204:205], v231 offset:12288
    ds_read_b64_tr_b16 a[206:207], v231 offset:15360
    ds_read_b64_tr_b16 a[208:209], v232 offset:18432
    ds_read_b64_tr_b16 a[210:211], v232 offset:21504
    ds_read_b64_tr_b16 a[212:213], v233 offset:12288
    ds_read_b64_tr_b16 a[214:215], v233 offset:15360
    ds_read_b128 v[64:67], v165 offset:1792
    ds_read_b128 v[68:71], v165 offset:1920
    s_waitcnt lgkmcnt(1)
    v_mfma_f32_16x16x32_bf16 v[176:179], a[168:171], v[64:67], v[176:179]
    v_mfma_f32_16x16x32_bf16 v[180:183], a[172:175], v[64:67], v[180:183]
    v_mfma_f32_16x16x32_bf16 v[184:187], a[176:179], v[64:67], v[184:187]
    s_waitcnt lgkmcnt(0)
    v_mfma_f32_16x16x32_bf16 v[176:179], a[180:183], v[68:71], v[176:179]
    v_mfma_f32_16x16x32_bf16 v[180:183], a[184:187], v[68:71], v[180:183]
    v_mfma_f32_16x16x32_bf16 v[184:187], a[188:191], v[68:71], v[184:187]
    s_waitcnt vmcnt(0)
    s_barrier
    ds_read_b64_tr_b16 a[216:217], v231 offset:24576
    ds_read_b64_tr_b16 a[218:219], v231 offset:27648
    ds_read_b64_tr_b16 a[220:221], v232 offset:30720
    ds_read_b64_tr_b16 a[222:223], v232 offset:33792
    ds_read_b64_tr_b16 a[224:225], v233 offset:24576
    ds_read_b64_tr_b16 a[226:227], v233 offset:27648
    ds_read_b64_tr_b16 a[228:229], v231 offset:36864
    ds_read_b64_tr_b16 a[230:231], v231 offset:39936
    ds_read_b64_tr_b16 a[232:233], v232 offset:43008
    ds_read_b64_tr_b16 a[234:235], v232 offset:46080
    ds_read_b64_tr_b16 a[236:237], v233 offset:36864
    ds_read_b64_tr_b16 a[238:239], v233 offset:39936
    ds_read_b128 v[64:67], v165 offset:2048
    ds_read_b128 v[68:71], v165 offset:2176
    s_waitcnt lgkmcnt(1)
    v_mfma_f32_16x16x32_bf16 v[176:179], a[192:195], v[64:67], v[176:179]
    v_mfma_f32_16x16x32_bf16 v[180:183], a[196:199], v[64:67], v[180:183]
    v_mfma_f32_16x16x32_bf16 v[184:187], a[200:203], v[64:67], v[184:187]
    s_waitcnt lgkmcnt(0)
    v_mfma_f32_16x16x32_bf16 v[176:179], a[204:207], v[68:71], v[176:179]
    v_mfma_f32_16x16x32_bf16 v[180:183], a[208:211], v[68:71], v[180:183]
    v_mfma_f32_16x16x32_bf16 v[184:187], a[212:215], v[68:71], v[184:187]
    ds_read_b128 v[64:67], v165 offset:2304
    ds_read_b128 v[68:71], v165 offset:2432
    s_waitcnt lgkmcnt(1)
    v_mfma_f32_16x16x32_bf16 v[176:179], a[216:219], v[64:67], v[176:179]
    v_mfma_f32_16x16x32_bf16 v[180:183], a[220:223], v[64:67], v[180:183]
    v_mfma_f32_16x16x32_bf16 v[184:187], a[224:227], v[64:67], v[184:187]
    s_waitcnt lgkmcnt(0)
    v_mfma_f32_16x16x32_bf16 v[176:179], a[228:231], v[68:71], v[176:179]
    v_mfma_f32_16x16x32_bf16 v[180:183], a[232:235], v[68:71], v[180:183]
    v_mfma_f32_16x16x32_bf16 v[184:187], a[236:239], v[68:71], v[184:187]
    v_and_b32 v90, 1, v1
    v_mul_u32_u24 v90, 192, v90
    v_and_b32 v91, 48, v1
    v_add_u32 v90, v90, v91
    s_mov_b32 exec_lo, 0x00030003
    s_mov_b32 exec_hi, 0x00030003
    buffer_store_dwordx4 v[176:179], v90, s[36:39], s9 offen offset:0 sc1
    buffer_store_dwordx4 v[180:183], v90, s[36:39], s9 offen offset:64 sc1
    buffer_store_dwordx4 v[184:187], v90, s[36:39], s9 offen offset:128 sc1
    s_mov_b64 exec, -1
    s_waitcnt lgkmcnt(0)
    s_barrier
L_poll26:
    buffer_load_dword v223, v219, s[36:39], s17 offen sc1
    s_waitcnt vmcnt(0)
    v_cmp_ne_u32 vcc, s48, v223
    s_cbranch_vccz L_poll26_ok
    s_cmp_eq_u32 s49, 0
    s_cbranch_scc1 L_poll26_ok
    s_sub_u32 s49, s49, 1
    s_sleep 1
    s_branch L_poll26
L_poll26_ok:
    s_barrier
    s_cmp_eq_u32 s3, 0
    s_cbranch_scc0 L_wf27
    s_lshl_b32 s54, s73, 7
    s_add_u32 s54, s54, 23353344
    v_mov_b32 v254, 0
    v_mov_b32 v255, s48
    s_mov_b64 exec, 1
    buffer_store_dword v255, v254, s[36:39], s54 offen sc1
    s_mov_b64 exec, -1
L_wf27:
    s_branch L_prepE
L_id_slow:
    v_or_b32 v242, 15, v242
    s_or_b32 s50, s48, 15
    v_cmp_ne_u32 vcc, s50, v242
    buffer_load_dword v242, v234, s[36:39], s17 offen sc1
    s_waitcnt vmcnt(0)
    s_cbranch_vccz L_id_all
    s_cmp_eq_u32 s49, 0
    s_cbranch_scc1 L_id_all
    s_sub_u32 s49, s49, 1
    s_branch L_id_slow
L_id_all:
    v_cmp_ne_u32 vcc, s30, v242
    s_cmp_eq_u64 vcc, 0
    s_cselect_b32 s30, 1, 0
    s_branch L_id_back
L_kv_far:
    buffer_store_dwordx4 v[96:99], v247, s[36:39], 0 offen offset:128 sc1
    buffer_store_dwordx4 v[100:103], v247, s[36:39], 0 offen offset:0 sc1
    buffer_store_dwordx4 v[104:107], v247, s[36:39], s16 offen offset:128 sc1
    buffer_store_dwordx4 v[108:111], v247, s[36:39], s16 offen offset:0 sc1
    s_waitcnt vmcnt(0)
    s_branch L_kv_back
L_lf2_far:
    s_lshl_b32 s54, s70, 7
    s_add_u32 s54, s54, 23232512
    v_mov_b32 v254, 0
    v_mov_b32 v255, s48
    s_mov_b64 exec, 1
    buffer_store_dword v255, v254, s[36:39], s54 offen sc1
    s_mov_b64 exec, -1
    s_branch L_lf2
L_q_far:
    buffer_store_dwordx4 v[112:115], v245, s[36:39], s55 offen offset:0 sc1
    buffer_store_dwordx4 v[116:119], v245, s[36:39], s55 offen offset:128 sc1
    buffer_store_dwordx4 v[120:123], v245, s[36:39], s56 offen offset:0 sc1
    buffer_store_dwordx4 v[124:127], v245, s[36:39], s56 offen offset:128 sc1
    s_waitcnt vmcnt(0)
    s_branch L_q_back
L_m_slow:
    buffer_load_dwordx2 v[242:243], v239, s[36:39], s69 offen sc1
    s_waitcnt vmcnt(0)
    v_cmp_ne_u32 vcc, s48, v243
    s_cbranch_vccz L_m_back
    s_cmp_eq_u32 s49, 0
    s_cbranch_scc1 L_m_back
    s_sub_u32 s49, s49, 1
    s_branch L_m_slow
L_lf4_far:
    s_lshl_b32 s54, s70, 7
    s_add_u32 s54, s54, 23252992
    v_mov_b32 v254, 0
    v_mov_b32 v255, s48
    s_mov_b64 exec, 1
    buffer_store_dword v255, v254, s[36:39], s54 offen sc1
    s_mov_b64 exec, -1
    s_branch L_lf4
L_st0_slow:
    buffer_load_dwordx4 v[200:203], v175, s[36:39], s6 offen offset:0 sc1
    buffer_load_dwordx4 v[204:207], v175, s[36:39], s6 offen offset:256 sc1
    buffer_load_dwordx4 v[208:211], v175, s[36:39], s6 offen offset:512 sc1
    buffer_load_dwordx4 v[212:215], v175, s[36:39], s6 offen offset:768 sc1
    s_waitcnt vmcnt(3)
    v_xor_b32 v3, s48, v201
    v_bitop3_b32 v3, v203, s48, v3 bitop3:0xbe
    s_waitcnt vmcnt(2)
    v_bitop3_b32 v3, v205, s48, v3 bitop3:0xbe
    v_bitop3_b32 v3, v207, s48, v3 bitop3:0xbe
    s_waitcnt vmcnt(1)
    v_bitop3_b32 v3, v209, s48, v3 bitop3:0xbe
    v_bitop3_b32 v3, v211, s48, v3 bitop3:0xbe
    s_waitcnt vmcnt(0)
    v_bitop3_b32 v3, v213, s48, v3 bitop3:0xbe
    v_bitop3_b32 v3, v215, s48, v3 bitop3:0xbe
    v_cmp_ne_u32 vcc, 0, v3
    s_cbranch_vccz L_st0_back
    s_cmp_eq_u32 s49, 0
    s_cbranch_scc1 L_st0_back
    s_sub_u32 s49, s49, 1
    s_branch L_st0_slow
L_st1_slow:
    buffer_load_dwordx4 v[200:203], v175, s[36:39], s6 offen offset:0 sc1
    buffer_load_dwordx4 v[204:207], v175, s[36:39], s6 offen offset:256 sc1
    buffer_load_dwordx4 v[208:211], v175, s[36:39], s6 offen offset:512 sc1
    buffer_load_dwordx4 v[212:215], v175, s[36:39], s6 offen offset:768 sc1
    s_waitcnt vmcnt(3)
    v_xor_b32 v3, s48, v201
    v_bitop3_b32 v3, v203, s48, v3 bitop3:0xbe
    s_waitcnt vmcnt(2)
    v_bitop3_b32 v3, v205, s48, v3 bitop3:0xbe
    v_bitop3_b32 v3, v207, s48, v3 bitop3:0xbe
    s_waitcnt vmcnt(1)
    v_bitop3_b32 v3, v209, s48, v3 bitop3:0xbe
    v_bitop3_b32 v3, v211, s48, v3 bitop3:0xbe
    s_waitcnt vmcnt(0)
    v_bitop3_b32 v3, v213, s48, v3 bitop3:0xbe
    v_bitop3_b32 v3, v215, s48, v3 bitop3:0xbe
    v_cmp_ne_u32 vcc, 0, v3
    s_cbranch_vccz L_st1_back
    s_cmp_eq_u32 s49, 0
    s_cbranch_scc1 L_st1_back
    s_sub_u32 s49, s49, 1
    s_branch L_st1_slow
L_chk5_slow:
L_poll28:
    buffer_load_dword v240, v238, s[36:39], s17 offen sc1
    s_waitcnt vmcnt(0)
    v_cmp_ne_u32 vcc, s48, v240
    s_cbranch_vccz L_poll28_ok
    s_cmp_eq_u32 s49, 0
    s_cbranch_scc1 L_poll28_ok
    s_sub_u32 s49, s49, 1
    s_sleep 1
    s_branch L_poll28
L_poll28_ok:
    s_branch L_chk5_back
L_chk7_slow:
L_poll29:
    buffer_load_dword v240, v238, s[36:39], s17 offen sc1
    s_waitcnt vmcnt(0)
    v_cmp_ne_u32 vcc, s48, v240
    s_cbranch_vccz L_poll29_ok
    s_cmp_eq_u32 s49, 0
    s_cbranch_scc1 L_poll29_ok
    s_sub_u32 s49, s49, 1
    s_sleep 1
    s_branch L_poll29
L_poll29_ok:
    s_branch L_chk7_back
L_chk8_slow:
L_poll30:
    buffer_load_dword v223, v219, s[36:39], s17 offen sc1
    s_waitcnt vmcnt(0)
    v_cmp_ne_u32 vcc, s48, v223
    s_cbranch_vccz L_poll30_ok
    s_cmp_eq_u32 s49, 0
    s_cbranch_scc1 L_poll30_ok
    s_sub_u32 s49, s49, 1
    s_sleep 1
    s_branch L_poll30
L_poll30_ok:
    s_branch L_chk8_back
L_chk10_slow:
L_poll31:
    buffer_load_dword v244, v243, s[36:39], s58 offen sc1
    s_waitcnt vmcnt(0)
    v_cmp_ne_u32 vcc, s48, v244
    s_cbranch_vccz L_poll31_ok
    s_cmp_eq_u32 s49, 0
    s_cbranch_scc1 L_poll31_ok
    s_sub_u32 s49, s49, 1
    s_sleep 1
    s_branch L_poll31
L_poll31_ok:
    s_branch L_chk10_back
L_chk11_slow:
L_poll32:
    buffer_load_dword v240, v219, s[36:39], s17 offen sc1
    s_waitcnt vmcnt(0)
    v_cmp_ne_u32 vcc, s48, v240
    s_cbranch_vccz L_poll32_ok
    s_cmp_eq_u32 s49, 0
    s_cbranch_scc1 L_poll32_ok
    s_sub_u32 s49, s49, 1
    s_sleep 1
    s_branch L_poll32
L_poll32_ok:
    s_branch L_chk11_back
L_chk19_slow:
L_poll33:
    buffer_load_dword v244, v243, s[36:39], s58 offen sc1
    s_waitcnt vmcnt(0)
    v_cmp_ne_u32 vcc, s48, v244
    s_cbranch_vccz L_poll33_ok
    s_cmp_eq_u32 s49, 0
    s_cbranch_scc1 L_poll33_ok
    s_sub_u32 s49, s49, 1
    s_sleep 1
    s_branch L_poll33
L_poll33_ok:
    s_branch L_chk19_back
L_chk20_slow:
L_poll34:
    buffer_load_dword v240, v219, s[36:39], s17 offen sc1
    s_waitcnt vmcnt(0)
    v_cmp_ne_u32 vcc, s48, v240
    s_cbranch_vccz L_poll34_ok
    s_cmp_eq_u32 s49, 0
    s_cbranch_scc1 L_poll34_ok
    s_sub_u32 s49, s49, 1
    s_sleep 1
    s_branch L_poll34
L_poll34_ok:
    s_branch L_chk20_back
L_chk22_slow:
L_poll35:
    buffer_load_dword v244, v246, s[36:39], s17 offen sc1
    s_waitcnt vmcnt(0)
    v_cmp_ne_u32 vcc, s48, v244
    s_cbranch_vccz L_poll35_ok
    s_cmp_eq_u32 s49, 0
    s_cbranch_scc1 L_poll35_ok
    s_sub_u32 s49, s49, 1
    s_sleep 1
    s_branch L_poll35
L_poll35_ok:
    s_branch L_chk22_back
L_chk24_slow:
L_poll36:
    buffer_load_dword v247, v246, s[36:39], s17 offen sc1
    s_waitcnt vmcnt(0)
    v_cmp_ne_u32 vcc, s48, v247
    s_cbranch_vccz L_poll36_ok
    s_cmp_eq_u32 s49, 0
    s_cbranch_scc1 L_poll36_ok
    s_sub_u32 s49, s49, 1
    s_sleep 1
    s_branch L_poll36
L_poll36_ok:
    s_branch L_chk24_back
L_chk25_slow:
L_poll37:
    buffer_load_dword v6, v5, s[36:39], s52 offen sc1
    s_waitcnt vmcnt(0)
    v_cmp_ne_u32 vcc, s48, v6
    s_cbranch_vccz L_poll37_ok
    s_cmp_eq_u32 s49, 0
    s_cbranch_scc1 L_poll37_ok
    s_sub_u32 s49, s49, 1
    s_sleep 1
    s_branch L_poll37
L_poll37_ok:
    s_branch L_chk25_back
L_code_end:
.section .rodata,"a"
.p2align 6
.amdhsa_kernel adaLN_cond__ssm_conv_h3__glu_gated_bilinear__prompt_kernel
  .amdhsa_next_free_vgpr 512
  .amdhsa_next_free_sgpr 102
  .amdhsa_accum_offset 256
  .amdhsa_group_segment_fixed_size 0
  .amdhsa_kernarg_size 120
  .amdhsa_user_sgpr_count 2
  .amdhsa_user_sgpr_kernarg_segment_ptr 1
  .amdhsa_system_sgpr_workgroup_id_x 1
.end_amdhsa_kernel
```
